```python
import torch

def _softmax(x, axis=-1):
    return torch.softmax(x, dim=axis)
def _gelu(x):
    return torch.nn.functional.gelu(x, approximate="tanh")
def _silu(x):
    return torch.nn.functional.silu(x)
def _sigmoid(x):
    return torch.sigmoid(x)
def _layernorm(x, axis=-1, eps=1e-5):
    m = x.mean(dim=axis, keepdim=True)
    v = x.var(dim=axis, keepdim=True, unbiased=False)
    return (x - m) / torch.sqrt(v + eps)
def _scatter_add(tgt, idx, src, axis=0):
    return tgt.clone().index_add_(axis, idx, src)
def _segment_sum(src, seg, n):
    out = torch.zeros((n,) + src.shape[1:], dtype=src.dtype)
    return out.index_add_(0, seg, src)
def _pad(x, pw):
    flat = tuple(v for pair in reversed(pw) for v in pair)
    return torch.nn.functional.pad(x, flat)

kernel_name = 'sequential_preLN__sliding_block__mixer_s_mlp__prompt'

def setup_inputs():

    _w = (lambda a: (lambda t: t.to(torch.bfloat16) if t.is_floating_point() else t)(torch.as_tensor(a)))
    def _A_setup():
        B, S, D = 1, 2048, 640
        return {
            "x": _w((lambda *s: torch.randn(*s, dtype=torch.bfloat16) * 0.05)(B, S, D)),
            "wqkv": _w((lambda *s: torch.randn(*s, dtype=torch.bfloat16) * 0.05)(D, 3 * D)),
            "wo": _w((lambda *s: torch.randn(*s, dtype=torch.bfloat16) * 0.05)(D, D)),
        }
    _A_in = _A_setup()

    def _B_setup():
        B, S, D, F = 1, 2048, 640, 1536
        return {
            "x":  _w((lambda *s: torch.randn(*s, dtype=torch.bfloat16) * 0.05)(B, S, D)),
            "w1": _w((lambda *s: torch.randn(*s, dtype=torch.bfloat16) * 3.2)(D, D) * (D ** -0.5)),
            "w2": _w((lambda *s: torch.randn(*s, dtype=torch.bfloat16) * 3.2)(D, D) * (D ** -0.5)),
            "w3": _w((lambda *s: torch.randn(*s, dtype=torch.bfloat16) * 3.2)(D, F) * (D ** -0.5)),
            "w4": _w((lambda *s: torch.randn(*s, dtype=torch.bfloat16) * 3.2)(F, D) * (F ** -0.5)),
        }
    _B_in = _B_setup()

    return {
        "A_x": _A_in["x"],
        "A_wqkv": _A_in["wqkv"],
        "A_wo": _A_in["wo"],
        "B_x": _B_in["x"],
        "B_w1": _B_in["w1"],
        "B_w2": _B_in["w2"],
        "B_w3": _B_in["w3"],
        "B_w4": _B_in["w4"],
    }

def reference(A_x, A_wqkv, A_wo, B_x, B_w1, B_w2, B_w3, B_w4):
    def _A_ref(x, wqkv, wo):
        B, S, D = x.shape
        H = 32; Dh = D // H; W = 256
        qkv = (lambda x, *d: x.permute(*d))((x @ wqkv).reshape(B, S, 3, H, Dh), 2, 0, 3, 1, 4)
        q, k, v = qkv[0], qkv[1], qkv[2]
        scores = torch.einsum("bhqd,bhkd->bhqk", q, k) * (Dh ** -0.5)
        idx = torch.arange(S)
        mask = (idx[:, None] - idx[None, :] >= 0) & (idx[:, None] - idx[None, :] < W)
        scores = torch.where(mask[None, None], scores, -1e9)
        p = _softmax(scores, axis=-1)
        o = torch.einsum("bhqk,bhkd->bhqd", p, v)
        return (lambda x, *d: x.permute(*d))(o, 0, 2, 1, 3).reshape(B, S, D) @ wo

    def _B_ref(x, w1, w2, w3, w4):
        B, S, D = x.shape
        h = _gelu(_layernorm(x, axis=-1) @ w1)
        c = D // 4
        g0 = _pad(h[:, :, 0*c:1*c], ((0, 0), (1, 0), (0, 0)))[:, :S, :]
        g1 = _pad(h[:, :, 1*c:2*c], ((0, 0), (0, 1), (0, 0)))[:, 1:, :]
        g2 = _pad(h[:, :, 2*c:3*c], ((0, 0), (2, 0), (0, 0)))[:, :S, :]
        g3 = _pad(h[:, :, 3*c:   ], ((0, 0), (0, 2), (0, 0)))[:, 2:, :]
        hs = torch.concatenate([g0, g1, g2, g3], axis=-1) @ w2
        x1 = x + hs
        h2 = _gelu(_layernorm(x1, axis=-1) @ w3) @ w4
        return x1 + h2

    x = A_x
    h = x + _A_ref(_layernorm(x, axis=-1), A_wqkv, A_wo)
    h2 = h + _B_ref(_layernorm(h, axis=-1), B_w1, B_w2, B_w3, B_w4)
    return h2
```

```asm
; @launch kernel=k1_kernel grid=(240,1,1) block=(512,1,1) lds=133120
; @launch kernel=k2_kernel grid=(512,1,1) block=(256,1,1) lds=44032
; @launch kernel=k3_kernel grid=(256,1,1) block=(512,1,1) lds=148992
; @launch kernel=k4_kernel grid=(256,1,1) block=(512,1,1) lds=148992
; @launch kernel=k5_kernel grid=(256,1,1) block=(512,1,1) lds=148992
; @launch kernel=k6_kernel grid=(256,1,1) block=(512,1,1) lds=145408
; @launch kernel=k7_kernel grid=(256,1,1) block=(512,1,1) lds=148992
.amdgcn_target "amdgcn-amd-amdhsa--gfx950"
.text
.p2align 8
.globl k1_kernel
.type k1_kernel,@function
k1_kernel:
    s_cmp_ge_u32 s2, 240
    s_cbranch_scc1 k1_kernel_end
    s_load_dwordx2 s[4:5], s[0:1], 80
    s_load_dwordx2 s[12:13], s[0:1], 8
    s_load_dwordx2 s[8:9], s[0:1], 0
    s_and_b32 s37, s2, 7
    s_lshr_b32 s38, s2, 3
    s_cmp_ge_u32 s38, 15
    s_cselect_b32 s33, 1, 0
    s_mul_i32 s34, s33, 15
    s_sub_u32 s34, s38, s34
    s_mul_i32 s37, s37, 2
    s_add_u32 s33, s33, s37
    s_mul_i32 s35, s33, 128
    s_mul_i32 s36, s34, 128
    v_and_b32 v1, 63, v0
    v_lshrrev_b32 v24, 6, v0
    v_and_b32 v2, 15, v0
    v_bfe_u32 v3, v0, 4, 2
    v_readfirstlane_b32 s43, v24
    s_and_b32 s32, s43, 3
    s_mul_i32 s56, s32, 32
    s_cmp_lt_u32 s43, 4
    s_cbranch_scc1 k1_kernel_cons
    v_lshrrev_b32 v24, 3, v1
    v_and_b32 v25, 7, v1
    v_add_u32 v24, s56, v24
    s_mov_b32 s38, 1280
    v_add_u32 v26, 0, v24
    v_bfe_u32 v27, v26, 1, 3
    v_xor_b32 v27, v27, v25
    v_add_u32 v26, s35, v26
    v_mul_lo_u32 v26, v26, s38
    v_lshl_add_u32 v4, v27, 4, v26
    v_add_u32 v26, 8, v24
    v_bfe_u32 v27, v26, 1, 3
    v_xor_b32 v27, v27, v25
    v_add_u32 v26, s35, v26
    v_mul_lo_u32 v26, v26, s38
    v_lshl_add_u32 v5, v27, 4, v26
    v_add_u32 v26, 16, v24
    v_bfe_u32 v27, v26, 1, 3
    v_xor_b32 v27, v27, v25
    v_add_u32 v26, s35, v26
    v_mul_lo_u32 v26, v26, s38
    v_lshl_add_u32 v6, v27, 4, v26
    v_add_u32 v26, 24, v24
    v_bfe_u32 v27, v26, 1, 3
    v_xor_b32 v27, v27, v25
    v_add_u32 v26, s35, v26
    v_mul_lo_u32 v26, v26, s38
    v_lshl_add_u32 v7, v27, 4, v26
    s_mov_b32 s38, 4096
    s_mul_i32 s37, s32, 256
    v_add_u32 v31, s37, v1
    s_lshl_b32 s37, s36, 1
    s_mov_b32 s42, 3840
    v_add_u32 v24, 0, v31
    v_mul_lo_u32 v25, v24, s38
    v_lshrrev_b32 v25, 16, v25
    v_mul_u32_u24 v26, 16, v25
    v_sub_u32 v26, v24, v26
    v_lshrrev_b32 v27, 1, v26
    v_and_b32 v26, 1, v26
    v_and_b32 v28, 7, v25
    v_xor_b32 v27, v27, v28
    v_bfe_u32 v28, v25, 2, 2
    v_bfe_u32 v29, v25, 4, 1
    v_and_b32 v30, 0xffe3, v25
    v_lshl_add_u32 v30, v28, 3, v30
    v_lshl_add_u32 v30, v29, 2, v30
    v_mul_lo_u32 v30, v30, s42
    v_lshlrev_b32 v27, 5, v27
    v_lshl_add_u32 v27, v26, 4, v27
    v_add_u32 v8, v30, v27
    v_add_u32 v8, s37, v8
    v_add_u32 v24, 64, v31
    v_mul_lo_u32 v25, v24, s38
    v_lshrrev_b32 v25, 16, v25
    v_mul_u32_u24 v26, 16, v25
    v_sub_u32 v26, v24, v26
    v_lshrrev_b32 v27, 1, v26
    v_and_b32 v26, 1, v26
    v_and_b32 v28, 7, v25
    v_xor_b32 v27, v27, v28
    v_bfe_u32 v28, v25, 2, 2
    v_bfe_u32 v29, v25, 4, 1
    v_and_b32 v30, 0xffe3, v25
    v_lshl_add_u32 v30, v28, 3, v30
    v_lshl_add_u32 v30, v29, 2, v30
    v_mul_lo_u32 v30, v30, s42
    v_lshlrev_b32 v27, 5, v27
    v_lshl_add_u32 v27, v26, 4, v27
    v_add_u32 v9, v30, v27
    v_add_u32 v9, s37, v9
    v_add_u32 v24, 128, v31
    v_mul_lo_u32 v25, v24, s38
    v_lshrrev_b32 v25, 16, v25
    v_mul_u32_u24 v26, 16, v25
    v_sub_u32 v26, v24, v26
    v_lshrrev_b32 v27, 1, v26
    v_and_b32 v26, 1, v26
    v_and_b32 v28, 7, v25
    v_xor_b32 v27, v27, v28
    v_bfe_u32 v28, v25, 2, 2
    v_bfe_u32 v29, v25, 4, 1
    v_and_b32 v30, 0xffe3, v25
    v_lshl_add_u32 v30, v28, 3, v30
    v_lshl_add_u32 v30, v29, 2, v30
    v_mul_lo_u32 v30, v30, s42
    v_lshlrev_b32 v27, 5, v27
    v_lshl_add_u32 v27, v26, 4, v27
    v_add_u32 v10, v30, v27
    v_add_u32 v10, s37, v10
    v_add_u32 v24, 192, v31
    v_mul_lo_u32 v25, v24, s38
    v_lshrrev_b32 v25, 16, v25
    v_mul_u32_u24 v26, 16, v25
    v_sub_u32 v26, v24, v26
    v_lshrrev_b32 v27, 1, v26
    v_and_b32 v26, 1, v26
    v_and_b32 v28, 7, v25
    v_xor_b32 v27, v27, v28
    v_bfe_u32 v28, v25, 2, 2
    v_bfe_u32 v29, v25, 4, 1
    v_and_b32 v30, 0xffe3, v25
    v_lshl_add_u32 v30, v28, 3, v30
    v_lshl_add_u32 v30, v29, 2, v30
    v_mul_lo_u32 v30, v30, s42
    v_lshlrev_b32 v27, 5, v27
    v_lshl_add_u32 v27, v26, 4, v27
    v_add_u32 v11, v30, v27
    v_add_u32 v11, s37, v11
    s_waitcnt lgkmcnt(0)
    s_and_b32 s13, s13, 0xffff
    s_mov_b32 s14, 0x258000
    s_mov_b32 s15, 0x00020000
    s_and_b32 s9, s9, 0xffff
    s_mov_b32 s10, 0x280000
    s_mov_b32 s11, 0x00020000
    s_mul_i32 s39, s32, 4096
    s_mul_i32 s40, s32, 4096
    s_mov_b32 s46, 0x7ff00000
    s_mov_b32 s41, 0x0
    s_add_u32 m0, s39, 0x0
    s_nop 0
    buffer_load_dwordx4 v4, s[8:11], s41 offen lds
    s_add_u32 m0, s39, 0x400
    s_nop 0
    buffer_load_dwordx4 v5, s[8:11], s41 offen lds
    s_add_u32 m0, s39, 0x800
    s_nop 0
    buffer_load_dwordx4 v6, s[8:11], s41 offen lds
    s_add_u32 m0, s39, 0xc00
    s_nop 0
    buffer_load_dwordx4 v7, s[8:11], s41 offen lds
    s_mov_b32 s42, 0x0
    s_add_u32 m0, s40, 0x4000
    s_nop 0
    buffer_load_dwordx4 v8, s[12:15], s42 offen lds
    s_add_u32 m0, s40, 0x4400
    s_nop 0
    buffer_load_dwordx4 v9, s[12:15], s42 offen lds
    s_add_u32 m0, s40, 0x4800
    s_nop 0
    buffer_load_dwordx4 v10, s[12:15], s42 offen lds
    s_add_u32 m0, s40, 0x4c00
    s_nop 0
    buffer_load_dwordx4 v11, s[12:15], s42 offen lds
    s_mov_b32 s41, 0x80
    s_add_u32 m0, s39, 0x8000
    s_nop 0
    buffer_load_dwordx4 v4, s[8:11], s41 offen lds
    s_add_u32 m0, s39, 0x8400
    s_nop 0
    buffer_load_dwordx4 v5, s[8:11], s41 offen lds
    s_add_u32 m0, s39, 0x8800
    s_nop 0
    buffer_load_dwordx4 v6, s[8:11], s41 offen lds
    s_add_u32 m0, s39, 0x8c00
    s_nop 0
    buffer_load_dwordx4 v7, s[8:11], s41 offen lds
    s_mov_b32 s42, 0x3c000
    s_add_u32 m0, s40, 0xc000
    s_nop 0
    buffer_load_dwordx4 v8, s[12:15], s42 offen lds
    s_add_u32 m0, s40, 0xc400
    s_nop 0
    buffer_load_dwordx4 v9, s[12:15], s42 offen lds
    s_add_u32 m0, s40, 0xc800
    s_nop 0
    buffer_load_dwordx4 v10, s[12:15], s42 offen lds
    s_add_u32 m0, s40, 0xcc00
    s_nop 0
    buffer_load_dwordx4 v11, s[12:15], s42 offen lds
    s_mov_b32 s41, 0x100
    s_add_u32 m0, s39, 0x10000
    s_nop 0
    buffer_load_dwordx4 v4, s[8:11], s41 offen lds
    s_add_u32 m0, s39, 0x10400
    s_nop 0
    buffer_load_dwordx4 v5, s[8:11], s41 offen lds
    s_add_u32 m0, s39, 0x10800
    s_nop 0
    buffer_load_dwordx4 v6, s[8:11], s41 offen lds
    s_add_u32 m0, s39, 0x10c00
    s_nop 0
    buffer_load_dwordx4 v7, s[8:11], s41 offen lds
    s_mov_b32 s42, 0x78000
    s_add_u32 m0, s40, 0x14000
    s_nop 0
    buffer_load_dwordx4 v8, s[12:15], s42 offen lds
    s_add_u32 m0, s40, 0x14400
    s_nop 0
    buffer_load_dwordx4 v9, s[12:15], s42 offen lds
    s_add_u32 m0, s40, 0x14800
    s_nop 0
    buffer_load_dwordx4 v10, s[12:15], s42 offen lds
    s_add_u32 m0, s40, 0x14c00
    s_nop 0
    buffer_load_dwordx4 v11, s[12:15], s42 offen lds
    s_mov_b32 s16, s4
    s_and_b32 s17, s5, 0xffff
    s_mov_b32 s18, 0xa80000
    s_mov_b32 s19, 0x00020000
    s_mov_b32 s38, 4096
    s_mul_i32 s37, s43, 0
    s_waitcnt vmcnt(16)
    s_barrier
    s_mov_b32 s41, 0x180
    s_add_u32 m0, s39, 0x18000
    s_nop 0
    buffer_load_dwordx4 v4, s[8:11], s41 offen lds
    s_add_u32 m0, s39, 0x18400
    s_nop 0
    buffer_load_dwordx4 v5, s[8:11], s41 offen lds
    s_add_u32 m0, s39, 0x18800
    s_nop 0
    buffer_load_dwordx4 v6, s[8:11], s41 offen lds
    s_add_u32 m0, s39, 0x18c00
    s_nop 0
    buffer_load_dwordx4 v7, s[8:11], s41 offen lds
    s_mov_b32 s42, 0xb4000
    s_add_u32 m0, s40, 0x1c000
    s_nop 0
    buffer_load_dwordx4 v8, s[12:15], s42 offen lds
    s_add_u32 m0, s40, 0x1c400
    s_nop 0
    buffer_load_dwordx4 v9, s[12:15], s42 offen lds
    s_add_u32 m0, s40, 0x1c800
    s_nop 0
    buffer_load_dwordx4 v10, s[12:15], s42 offen lds
    s_add_u32 m0, s40, 0x1cc00
    s_nop 0
    buffer_load_dwordx4 v11, s[12:15], s42 offen lds
    s_waitcnt vmcnt(16)
    s_barrier
    s_mov_b32 s41, 0x200
    s_add_u32 m0, s39, 0x0
    s_nop 0
    buffer_load_dwordx4 v4, s[8:11], s41 offen lds
    s_add_u32 m0, s39, 0x400
    s_nop 0
    buffer_load_dwordx4 v5, s[8:11], s41 offen lds
    s_add_u32 m0, s39, 0x800
    s_nop 0
    buffer_load_dwordx4 v6, s[8:11], s41 offen lds
    s_add_u32 m0, s39, 0xc00
    s_nop 0
    buffer_load_dwordx4 v7, s[8:11], s41 offen lds
    s_mov_b32 s42, 0xf0000
    s_add_u32 m0, s40, 0x4000
    s_nop 0
    buffer_load_dwordx4 v8, s[12:15], s42 offen lds
    s_add_u32 m0, s40, 0x4400
    s_nop 0
    buffer_load_dwordx4 v9, s[12:15], s42 offen lds
    s_add_u32 m0, s40, 0x4800
    s_nop 0
    buffer_load_dwordx4 v10, s[12:15], s42 offen lds
    s_add_u32 m0, s40, 0x4c00
    s_nop 0
    buffer_load_dwordx4 v11, s[12:15], s42 offen lds
    s_waitcnt vmcnt(16)
    s_barrier
    s_mov_b32 s41, 0x280
    s_add_u32 m0, s39, 0x8000
    s_nop 0
    buffer_load_dwordx4 v4, s[8:11], s41 offen lds
    s_add_u32 m0, s39, 0x8400
    s_nop 0
    buffer_load_dwordx4 v5, s[8:11], s41 offen lds
    s_add_u32 m0, s39, 0x8800
    s_nop 0
    buffer_load_dwordx4 v6, s[8:11], s41 offen lds
    s_add_u32 m0, s39, 0x8c00
    s_nop 0
    buffer_load_dwordx4 v7, s[8:11], s41 offen lds
    s_mov_b32 s42, 0x12c000
    s_add_u32 m0, s40, 0xc000
    s_nop 0
    buffer_load_dwordx4 v8, s[12:15], s42 offen lds
    s_add_u32 m0, s40, 0xc400
    s_nop 0
    buffer_load_dwordx4 v9, s[12:15], s42 offen lds
    s_add_u32 m0, s40, 0xc800
    s_nop 0
    buffer_load_dwordx4 v10, s[12:15], s42 offen lds
    s_add_u32 m0, s40, 0xcc00
    s_nop 0
    buffer_load_dwordx4 v11, s[12:15], s42 offen lds
    s_waitcnt vmcnt(16)
    s_barrier
    s_mov_b32 s41, 0x300
    s_add_u32 m0, s39, 0x10000
    s_nop 0
    buffer_load_dwordx4 v4, s[8:11], s41 offen lds
    s_add_u32 m0, s39, 0x10400
    s_nop 0
    buffer_load_dwordx4 v5, s[8:11], s41 offen lds
    s_add_u32 m0, s39, 0x10800
    s_nop 0
    buffer_load_dwordx4 v6, s[8:11], s41 offen lds
    s_add_u32 m0, s39, 0x10c00
    s_nop 0
    buffer_load_dwordx4 v7, s[8:11], s41 offen lds
    s_mov_b32 s42, 0x168000
    s_add_u32 m0, s40, 0x14000
    s_nop 0
    buffer_load_dwordx4 v8, s[12:15], s42 offen lds
    s_add_u32 m0, s40, 0x14400
    s_nop 0
    buffer_load_dwordx4 v9, s[12:15], s42 offen lds
    s_add_u32 m0, s40, 0x14800
    s_nop 0
    buffer_load_dwordx4 v10, s[12:15], s42 offen lds
    s_add_u32 m0, s40, 0x14c00
    s_nop 0
    buffer_load_dwordx4 v11, s[12:15], s42 offen lds
    s_waitcnt vmcnt(16)
    s_barrier
    s_mov_b32 s41, 0x380
    s_add_u32 m0, s39, 0x18000
    s_nop 0
    buffer_load_dwordx4 v4, s[8:11], s41 offen lds
    s_add_u32 m0, s39, 0x18400
    s_nop 0
    buffer_load_dwordx4 v5, s[8:11], s41 offen lds
    s_add_u32 m0, s39, 0x18800
    s_nop 0
    buffer_load_dwordx4 v6, s[8:11], s41 offen lds
    s_add_u32 m0, s39, 0x18c00
    s_nop 0
    buffer_load_dwordx4 v7, s[8:11], s41 offen lds
    s_mov_b32 s42, 0x1a4000
    s_add_u32 m0, s40, 0x1c000
    s_nop 0
    buffer_load_dwordx4 v8, s[12:15], s42 offen lds
    s_add_u32 m0, s40, 0x1c400
    s_nop 0
    buffer_load_dwordx4 v9, s[12:15], s42 offen lds
    s_add_u32 m0, s40, 0x1c800
    s_nop 0
    buffer_load_dwordx4 v10, s[12:15], s42 offen lds
    s_add_u32 m0, s40, 0x1cc00
    s_nop 0
    buffer_load_dwordx4 v11, s[12:15], s42 offen lds
    s_waitcnt vmcnt(16)
    s_barrier
    s_mov_b32 s41, 0x400
    s_add_u32 m0, s39, 0x0
    s_nop 0
    buffer_load_dwordx4 v4, s[8:11], s41 offen lds
    s_add_u32 m0, s39, 0x400
    s_nop 0
    buffer_load_dwordx4 v5, s[8:11], s41 offen lds
    s_add_u32 m0, s39, 0x800
    s_nop 0
    buffer_load_dwordx4 v6, s[8:11], s41 offen lds
    s_add_u32 m0, s39, 0xc00
    s_nop 0
    buffer_load_dwordx4 v7, s[8:11], s41 offen lds
    s_mov_b32 s42, 0x1e0000
    s_add_u32 m0, s40, 0x4000
    s_nop 0
    buffer_load_dwordx4 v8, s[12:15], s42 offen lds
    s_add_u32 m0, s40, 0x4400
    s_nop 0
    buffer_load_dwordx4 v9, s[12:15], s42 offen lds
    s_add_u32 m0, s40, 0x4800
    s_nop 0
    buffer_load_dwordx4 v10, s[12:15], s42 offen lds
    s_add_u32 m0, s40, 0x4c00
    s_nop 0
    buffer_load_dwordx4 v11, s[12:15], s42 offen lds
    s_waitcnt vmcnt(16)
    s_barrier
    s_mov_b32 s41, 0x480
    s_add_u32 m0, s39, 0x8000
    s_nop 0
    buffer_load_dwordx4 v4, s[8:11], s41 offen lds
    s_add_u32 m0, s39, 0x8400
    s_nop 0
    buffer_load_dwordx4 v5, s[8:11], s41 offen lds
    s_add_u32 m0, s39, 0x8800
    s_nop 0
    buffer_load_dwordx4 v6, s[8:11], s41 offen lds
    s_add_u32 m0, s39, 0x8c00
    s_nop 0
    buffer_load_dwordx4 v7, s[8:11], s41 offen lds
    s_mov_b32 s42, 0x21c000
    s_add_u32 m0, s40, 0xc000
    s_nop 0
    buffer_load_dwordx4 v8, s[12:15], s42 offen lds
    s_add_u32 m0, s40, 0xc400
    s_nop 0
    buffer_load_dwordx4 v9, s[12:15], s42 offen lds
    s_add_u32 m0, s40, 0xc800
    s_nop 0
    buffer_load_dwordx4 v10, s[12:15], s42 offen lds
    s_add_u32 m0, s40, 0xcc00
    s_nop 0
    buffer_load_dwordx4 v11, s[12:15], s42 offen lds
    s_waitcnt vmcnt(16)
    s_barrier
    s_waitcnt vmcnt(8)
    s_barrier
    s_waitcnt vmcnt(0)
    s_barrier
    s_barrier
    s_branch k1_kernel_phase2
k1_kernel_cons:
    s_waitcnt lgkmcnt(0)
    s_mov_b32 s16, s4
    s_and_b32 s17, s5, 0xffff
    s_mov_b32 s18, 0xa80000
    s_mov_b32 s19, 0x00020000
    s_mul_i32 s48, s32, 2
    s_add_u32 s48, s48, 0
    s_cmp_ge_u32 s48, 8
    s_cselect_b32 s37, 8, 0
    s_sub_u32 s48, s48, s37
    s_mul_i32 s49, s32, 2
    s_add_u32 s49, s49, 1
    s_cmp_ge_u32 s49, 8
    s_cselect_b32 s37, 8, 0
    s_sub_u32 s49, s49, s37
    s_mul_i32 s50, s32, 2
    s_add_u32 s50, s50, 2
    s_cmp_ge_u32 s50, 8
    s_cselect_b32 s37, 8, 0
    s_sub_u32 s50, s50, s37
    s_mul_i32 s51, s32, 2
    s_add_u32 s51, s51, 3
    s_cmp_ge_u32 s51, 8
    s_cselect_b32 s37, 8, 0
    s_sub_u32 s51, s51, s37
    s_mul_i32 s52, s32, 2
    s_add_u32 s52, s52, 4
    s_cmp_ge_u32 s52, 8
    s_cselect_b32 s37, 8, 0
    s_sub_u32 s52, s52, s37
    s_mul_i32 s53, s32, 2
    s_add_u32 s53, s53, 5
    s_cmp_ge_u32 s53, 8
    s_cselect_b32 s37, 8, 0
    s_sub_u32 s53, s53, s37
    s_mul_i32 s54, s32, 2
    s_add_u32 s54, s54, 6
    s_cmp_ge_u32 s54, 8
    s_cselect_b32 s37, 8, 0
    s_sub_u32 s54, s54, s37
    s_mul_i32 s55, s32, 2
    s_add_u32 s55, s55, 7
    s_cmp_ge_u32 s55, 8
    s_cselect_b32 s37, 8, 0
    s_sub_u32 s55, s55, s37
    v_lshrrev_b32 v24, 2, v2
    v_lshl_add_u32 v25, v3, 2, v24
    v_mul_u32_u24 v26, 256, v25
    v_and_b32 v27, 3, v2
    v_lshl_add_u32 v26, v27, 3, v26
    v_add_u32 v26, 16384, v26
    v_and_b32 v25, 7, v25
    v_xor_b32 v27, s48, v25
    v_lshl_add_u32 v4, v27, 5, v26
    v_xor_b32 v27, s49, v25
    v_lshl_add_u32 v5, v27, 5, v26
    v_xor_b32 v27, s50, v25
    v_lshl_add_u32 v6, v27, 5, v26
    v_xor_b32 v27, s51, v25
    v_lshl_add_u32 v7, v27, 5, v26
    v_xor_b32 v27, s52, v25
    v_lshl_add_u32 v8, v27, 5, v26
    v_xor_b32 v27, s53, v25
    v_lshl_add_u32 v9, v27, 5, v26
    v_xor_b32 v27, s54, v25
    v_lshl_add_u32 v10, v27, 5, v26
    v_xor_b32 v27, s55, v25
    v_lshl_add_u32 v11, v27, 5, v26
    v_add_u32 v24, s56, v2
    v_mul_u32_u24 v24, 128, v24
    v_lshrrev_b32 v25, 1, v2
    v_xor_b32 v25, v25, v3
    v_xor_b32 v26, 0, v25
    v_lshl_add_u32 v20, v26, 4, v24
    v_xor_b32 v26, 4, v25
    v_lshl_add_u32 v21, v26, 4, v24
    v_add_u32 v12, 0x10000, v4
    v_add_u32 v13, 0x10000, v5
    v_add_u32 v14, 0x10000, v6
    v_add_u32 v15, 0x10000, v7
    v_add_u32 v16, 0x10000, v8
    v_add_u32 v17, 0x10000, v9
    v_add_u32 v18, 0x10000, v10
    v_add_u32 v19, 0x10000, v11
    v_add_u32 v22, 0x10000, v20
    v_add_u32 v23, 0x10000, v21
    v_mov_b32 v36, 0x3f803f80
    v_mov_b32 v37, 0x3f803f80
    v_mov_b32 v38, 0x3f803f80
    v_mov_b32 v39, 0x3f803f80
    v_accvgpr_write_b32 a0, 0
    v_accvgpr_write_b32 a1, 0
    v_accvgpr_write_b32 a2, 0
    v_accvgpr_write_b32 a3, 0
    v_accvgpr_write_b32 a4, 0
    v_accvgpr_write_b32 a5, 0
    v_accvgpr_write_b32 a6, 0
    v_accvgpr_write_b32 a7, 0
    v_accvgpr_write_b32 a8, 0
    v_accvgpr_write_b32 a9, 0
    v_accvgpr_write_b32 a10, 0
    v_accvgpr_write_b32 a11, 0
    v_accvgpr_write_b32 a12, 0
    v_accvgpr_write_b32 a13, 0
    v_accvgpr_write_b32 a14, 0
    v_accvgpr_write_b32 a15, 0
    v_accvgpr_write_b32 a16, 0
    v_accvgpr_write_b32 a17, 0
    v_accvgpr_write_b32 a18, 0
    v_accvgpr_write_b32 a19, 0
    v_accvgpr_write_b32 a20, 0
    v_accvgpr_write_b32 a21, 0
    v_accvgpr_write_b32 a22, 0
    v_accvgpr_write_b32 a23, 0
    v_accvgpr_write_b32 a24, 0
    v_accvgpr_write_b32 a25, 0
    v_accvgpr_write_b32 a26, 0
    v_accvgpr_write_b32 a27, 0
    v_accvgpr_write_b32 a28, 0
    v_accvgpr_write_b32 a29, 0
    v_accvgpr_write_b32 a30, 0
    v_accvgpr_write_b32 a31, 0
    v_accvgpr_write_b32 a32, 0
    v_accvgpr_write_b32 a33, 0
    v_accvgpr_write_b32 a34, 0
    v_accvgpr_write_b32 a35, 0
    v_accvgpr_write_b32 a36, 0
    v_accvgpr_write_b32 a37, 0
    v_accvgpr_write_b32 a38, 0
    v_accvgpr_write_b32 a39, 0
    v_accvgpr_write_b32 a40, 0
    v_accvgpr_write_b32 a41, 0
    v_accvgpr_write_b32 a42, 0
    v_accvgpr_write_b32 a43, 0
    v_accvgpr_write_b32 a44, 0
    v_accvgpr_write_b32 a45, 0
    v_accvgpr_write_b32 a46, 0
    v_accvgpr_write_b32 a47, 0
    v_accvgpr_write_b32 a48, 0
    v_accvgpr_write_b32 a49, 0
    v_accvgpr_write_b32 a50, 0
    v_accvgpr_write_b32 a51, 0
    v_accvgpr_write_b32 a52, 0
    v_accvgpr_write_b32 a53, 0
    v_accvgpr_write_b32 a54, 0
    v_accvgpr_write_b32 a55, 0
    v_accvgpr_write_b32 a56, 0
    v_accvgpr_write_b32 a57, 0
    v_accvgpr_write_b32 a58, 0
    v_accvgpr_write_b32 a59, 0
    v_accvgpr_write_b32 a60, 0
    v_accvgpr_write_b32 a61, 0
    v_accvgpr_write_b32 a62, 0
    v_accvgpr_write_b32 a63, 0
    v_accvgpr_write_b32 a64, 0
    v_accvgpr_write_b32 a65, 0
    v_accvgpr_write_b32 a66, 0
    v_accvgpr_write_b32 a67, 0
    v_accvgpr_write_b32 a68, 0
    v_accvgpr_write_b32 a69, 0
    v_accvgpr_write_b32 a70, 0
    v_accvgpr_write_b32 a71, 0
    v_accvgpr_write_b32 a72, 0
    v_accvgpr_write_b32 a73, 0
    v_accvgpr_write_b32 a74, 0
    v_accvgpr_write_b32 a75, 0
    v_accvgpr_write_b32 a76, 0
    v_accvgpr_write_b32 a77, 0
    v_accvgpr_write_b32 a78, 0
    v_accvgpr_write_b32 a79, 0
    v_accvgpr_write_b32 a80, 0
    v_accvgpr_write_b32 a81, 0
    v_accvgpr_write_b32 a82, 0
    v_accvgpr_write_b32 a83, 0
    v_accvgpr_write_b32 a84, 0
    v_accvgpr_write_b32 a85, 0
    v_accvgpr_write_b32 a86, 0
    v_accvgpr_write_b32 a87, 0
    s_mov_b32 s38, 4096
    s_mul_i32 s37, s43, 0
    s_cmp_ge_u32 s34, 10
    s_cbranch_scc1 k1_kernel_vpath
    s_barrier
    ds_read_b128 v[64:67], v20 offset:0
    ds_read_b128 v[68:71], v20 offset:2048
    ds_read_b64_tr_b16 v[40:41], v4 offset:0
    ds_read_b64_tr_b16 v[42:43], v4 offset:4096
    ds_read_b64_tr_b16 v[44:45], v5 offset:0
    ds_read_b64_tr_b16 v[46:47], v5 offset:4096
    ds_read_b64_tr_b16 v[48:49], v6 offset:0
    ds_read_b64_tr_b16 v[50:51], v6 offset:4096
    ds_read_b64_tr_b16 v[52:53], v7 offset:0
    ds_read_b64_tr_b16 v[54:55], v7 offset:4096
    ds_read_b64_tr_b16 v[56:57], v8 offset:0
    ds_read_b64_tr_b16 v[58:59], v8 offset:4096
    ds_read_b64_tr_b16 v[60:61], v9 offset:0
    ds_read_b64_tr_b16 v[62:63], v9 offset:4096
    s_waitcnt lgkmcnt(10)
    v_mfma_f32_16x16x32_bf16 a[0:3], v[40:43], v[64:67], a[0:3]
    v_mfma_f32_16x16x32_bf16 a[32:35], v[40:43], v[68:71], a[32:35]
    v_mfma_f32_16x16x32_bf16 a[64:67], v[40:43], v[36:39], a[64:67]
    ds_read_b64_tr_b16 v[40:41], v10 offset:0
    ds_read_b64_tr_b16 v[42:43], v10 offset:4096
    s_waitcnt lgkmcnt(10)
    v_mfma_f32_16x16x32_bf16 a[4:7], v[44:47], v[64:67], a[4:7]
    v_mfma_f32_16x16x32_bf16 a[36:39], v[44:47], v[68:71], a[36:39]
    v_mfma_f32_16x16x32_bf16 a[68:71], v[44:47], v[36:39], a[68:71]
    ds_read_b64_tr_b16 v[44:45], v11 offset:0
    ds_read_b64_tr_b16 v[46:47], v11 offset:4096
    s_waitcnt lgkmcnt(10)
    v_mfma_f32_16x16x32_bf16 a[8:11], v[48:51], v[64:67], a[8:11]
    v_mfma_f32_16x16x32_bf16 a[40:43], v[48:51], v[68:71], a[40:43]
    v_mfma_f32_16x16x32_bf16 a[72:75], v[36:39], v[64:67], a[72:75]
    v_mfma_f32_16x16x32_bf16 a[76:79], v[36:39], v[68:71], a[76:79]
    ds_read_b128 v[72:75], v21 offset:0
    ds_read_b128 v[76:79], v21 offset:2048
    ds_read_b64_tr_b16 v[48:49], v4 offset:8192
    ds_read_b64_tr_b16 v[50:51], v4 offset:12288
    s_waitcnt lgkmcnt(12)
    v_mfma_f32_16x16x32_bf16 a[12:15], v[52:55], v[64:67], a[12:15]
    v_mfma_f32_16x16x32_bf16 a[44:47], v[52:55], v[68:71], a[44:47]
    v_mfma_f32_16x16x32_bf16 a[80:83], v[64:67], v[64:67], a[80:83]
    v_mfma_f32_16x16x32_bf16 a[84:87], v[68:71], v[68:71], a[84:87]
    ds_read_b64_tr_b16 v[52:53], v5 offset:8192
    ds_read_b64_tr_b16 v[54:55], v5 offset:12288
    s_waitcnt lgkmcnt(12)
    v_mfma_f32_16x16x32_bf16 a[16:19], v[56:59], v[64:67], a[16:19]
    v_mfma_f32_16x16x32_bf16 a[48:51], v[56:59], v[68:71], a[48:51]
    ds_read_b64_tr_b16 v[56:57], v6 offset:8192
    ds_read_b64_tr_b16 v[58:59], v6 offset:12288
    s_waitcnt lgkmcnt(12)
    v_mfma_f32_16x16x32_bf16 a[20:23], v[60:63], v[64:67], a[20:23]
    v_mfma_f32_16x16x32_bf16 a[52:55], v[60:63], v[68:71], a[52:55]
    ds_read_b64_tr_b16 v[60:61], v7 offset:8192
    ds_read_b64_tr_b16 v[62:63], v7 offset:12288
    s_waitcnt lgkmcnt(12)
    v_mfma_f32_16x16x32_bf16 a[24:27], v[40:43], v[64:67], a[24:27]
    v_mfma_f32_16x16x32_bf16 a[56:59], v[40:43], v[68:71], a[56:59]
    ds_read_b64_tr_b16 v[40:41], v8 offset:8192
    ds_read_b64_tr_b16 v[42:43], v8 offset:12288
    s_waitcnt lgkmcnt(12)
    v_mfma_f32_16x16x32_bf16 a[28:31], v[44:47], v[64:67], a[28:31]
    v_mfma_f32_16x16x32_bf16 a[60:63], v[44:47], v[68:71], a[60:63]
    ds_read_b64_tr_b16 v[44:45], v9 offset:8192
    ds_read_b64_tr_b16 v[46:47], v9 offset:12288
    s_waitcnt lgkmcnt(10)
    v_mfma_f32_16x16x32_bf16 a[0:3], v[48:51], v[72:75], a[0:3]
    v_mfma_f32_16x16x32_bf16 a[32:35], v[48:51], v[76:79], a[32:35]
    v_mfma_f32_16x16x32_bf16 a[64:67], v[48:51], v[36:39], a[64:67]
    ds_read_b64_tr_b16 v[48:49], v10 offset:8192
    ds_read_b64_tr_b16 v[50:51], v10 offset:12288
    s_waitcnt lgkmcnt(10)
    v_mfma_f32_16x16x32_bf16 a[4:7], v[52:55], v[72:75], a[4:7]
    v_mfma_f32_16x16x32_bf16 a[36:39], v[52:55], v[76:79], a[36:39]
    v_mfma_f32_16x16x32_bf16 a[68:71], v[52:55], v[36:39], a[68:71]
    ds_read_b64_tr_b16 v[52:53], v11 offset:8192
    ds_read_b64_tr_b16 v[54:55], v11 offset:12288
    s_waitcnt lgkmcnt(10)
    v_mfma_f32_16x16x32_bf16 a[8:11], v[56:59], v[72:75], a[8:11]
    v_mfma_f32_16x16x32_bf16 a[40:43], v[56:59], v[76:79], a[40:43]
    v_mfma_f32_16x16x32_bf16 a[72:75], v[36:39], v[72:75], a[72:75]
    v_mfma_f32_16x16x32_bf16 a[76:79], v[36:39], v[76:79], a[76:79]
    s_barrier
    ds_read_b128 v[64:67], v20 offset:32768
    ds_read_b128 v[68:71], v20 offset:34816
    ds_read_b64_tr_b16 v[56:57], v4 offset:32768
    ds_read_b64_tr_b16 v[58:59], v4 offset:36864
    s_waitcnt lgkmcnt(12)
    v_mfma_f32_16x16x32_bf16 a[12:15], v[60:63], v[72:75], a[12:15]
    v_mfma_f32_16x16x32_bf16 a[44:47], v[60:63], v[76:79], a[44:47]
    v_mfma_f32_16x16x32_bf16 a[80:83], v[72:75], v[72:75], a[80:83]
    v_mfma_f32_16x16x32_bf16 a[84:87], v[76:79], v[76:79], a[84:87]
    ds_read_b64_tr_b16 v[60:61], v5 offset:32768
    ds_read_b64_tr_b16 v[62:63], v5 offset:36864
    s_waitcnt lgkmcnt(12)
    v_mfma_f32_16x16x32_bf16 a[16:19], v[40:43], v[72:75], a[16:19]
    v_mfma_f32_16x16x32_bf16 a[48:51], v[40:43], v[76:79], a[48:51]
    ds_read_b64_tr_b16 v[40:41], v6 offset:32768
    ds_read_b64_tr_b16 v[42:43], v6 offset:36864
    s_waitcnt lgkmcnt(12)
    v_mfma_f32_16x16x32_bf16 a[20:23], v[44:47], v[72:75], a[20:23]
    v_mfma_f32_16x16x32_bf16 a[52:55], v[44:47], v[76:79], a[52:55]
    ds_read_b64_tr_b16 v[44:45], v7 offset:32768
    ds_read_b64_tr_b16 v[46:47], v7 offset:36864
    s_waitcnt lgkmcnt(12)
    v_mfma_f32_16x16x32_bf16 a[24:27], v[48:51], v[72:75], a[24:27]
    v_mfma_f32_16x16x32_bf16 a[56:59], v[48:51], v[76:79], a[56:59]
    ds_read_b64_tr_b16 v[48:49], v8 offset:32768
    ds_read_b64_tr_b16 v[50:51], v8 offset:36864
    s_waitcnt lgkmcnt(12)
    v_mfma_f32_16x16x32_bf16 a[28:31], v[52:55], v[72:75], a[28:31]
    v_mfma_f32_16x16x32_bf16 a[60:63], v[52:55], v[76:79], a[60:63]
    ds_read_b64_tr_b16 v[52:53], v9 offset:32768
    ds_read_b64_tr_b16 v[54:55], v9 offset:36864
    s_waitcnt lgkmcnt(10)
    v_mfma_f32_16x16x32_bf16 a[0:3], v[56:59], v[64:67], a[0:3]
    v_mfma_f32_16x16x32_bf16 a[32:35], v[56:59], v[68:71], a[32:35]
    v_mfma_f32_16x16x32_bf16 a[64:67], v[56:59], v[36:39], a[64:67]
    ds_read_b64_tr_b16 v[56:57], v10 offset:32768
    ds_read_b64_tr_b16 v[58:59], v10 offset:36864
    s_waitcnt lgkmcnt(10)
    v_mfma_f32_16x16x32_bf16 a[4:7], v[60:63], v[64:67], a[4:7]
    v_mfma_f32_16x16x32_bf16 a[36:39], v[60:63], v[68:71], a[36:39]
    v_mfma_f32_16x16x32_bf16 a[68:71], v[60:63], v[36:39], a[68:71]
    ds_read_b64_tr_b16 v[60:61], v11 offset:32768
    ds_read_b64_tr_b16 v[62:63], v11 offset:36864
    s_waitcnt lgkmcnt(10)
    v_mfma_f32_16x16x32_bf16 a[8:11], v[40:43], v[64:67], a[8:11]
    v_mfma_f32_16x16x32_bf16 a[40:43], v[40:43], v[68:71], a[40:43]
    v_mfma_f32_16x16x32_bf16 a[72:75], v[36:39], v[64:67], a[72:75]
    v_mfma_f32_16x16x32_bf16 a[76:79], v[36:39], v[68:71], a[76:79]
    ds_read_b128 v[72:75], v21 offset:32768
    ds_read_b128 v[76:79], v21 offset:34816
    ds_read_b64_tr_b16 v[40:41], v4 offset:40960
    ds_read_b64_tr_b16 v[42:43], v4 offset:45056
    s_waitcnt lgkmcnt(12)
    v_mfma_f32_16x16x32_bf16 a[12:15], v[44:47], v[64:67], a[12:15]
    v_mfma_f32_16x16x32_bf16 a[44:47], v[44:47], v[68:71], a[44:47]
    v_mfma_f32_16x16x32_bf16 a[80:83], v[64:67], v[64:67], a[80:83]
    v_mfma_f32_16x16x32_bf16 a[84:87], v[68:71], v[68:71], a[84:87]
    ds_read_b64_tr_b16 v[44:45], v5 offset:40960
    ds_read_b64_tr_b16 v[46:47], v5 offset:45056
    s_waitcnt lgkmcnt(12)
    v_mfma_f32_16x16x32_bf16 a[16:19], v[48:51], v[64:67], a[16:19]
    v_mfma_f32_16x16x32_bf16 a[48:51], v[48:51], v[68:71], a[48:51]
    ds_read_b64_tr_b16 v[48:49], v6 offset:40960
    ds_read_b64_tr_b16 v[50:51], v6 offset:45056
    s_waitcnt lgkmcnt(12)
    v_mfma_f32_16x16x32_bf16 a[20:23], v[52:55], v[64:67], a[20:23]
    v_mfma_f32_16x16x32_bf16 a[52:55], v[52:55], v[68:71], a[52:55]
    ds_read_b64_tr_b16 v[52:53], v7 offset:40960
    ds_read_b64_tr_b16 v[54:55], v7 offset:45056
    s_waitcnt lgkmcnt(12)
    v_mfma_f32_16x16x32_bf16 a[24:27], v[56:59], v[64:67], a[24:27]
    v_mfma_f32_16x16x32_bf16 a[56:59], v[56:59], v[68:71], a[56:59]
    ds_read_b64_tr_b16 v[56:57], v8 offset:40960
    ds_read_b64_tr_b16 v[58:59], v8 offset:45056
    s_waitcnt lgkmcnt(12)
    v_mfma_f32_16x16x32_bf16 a[28:31], v[60:63], v[64:67], a[28:31]
    v_mfma_f32_16x16x32_bf16 a[60:63], v[60:63], v[68:71], a[60:63]
    ds_read_b64_tr_b16 v[60:61], v9 offset:40960
    ds_read_b64_tr_b16 v[62:63], v9 offset:45056
    s_waitcnt lgkmcnt(10)
    v_mfma_f32_16x16x32_bf16 a[0:3], v[40:43], v[72:75], a[0:3]
    v_mfma_f32_16x16x32_bf16 a[32:35], v[40:43], v[76:79], a[32:35]
    v_mfma_f32_16x16x32_bf16 a[64:67], v[40:43], v[36:39], a[64:67]
    ds_read_b64_tr_b16 v[40:41], v10 offset:40960
    ds_read_b64_tr_b16 v[42:43], v10 offset:45056
    s_waitcnt lgkmcnt(10)
    v_mfma_f32_16x16x32_bf16 a[4:7], v[44:47], v[72:75], a[4:7]
    v_mfma_f32_16x16x32_bf16 a[36:39], v[44:47], v[76:79], a[36:39]
    v_mfma_f32_16x16x32_bf16 a[68:71], v[44:47], v[36:39], a[68:71]
    ds_read_b64_tr_b16 v[44:45], v11 offset:40960
    ds_read_b64_tr_b16 v[46:47], v11 offset:45056
    s_waitcnt lgkmcnt(10)
    v_mfma_f32_16x16x32_bf16 a[8:11], v[48:51], v[72:75], a[8:11]
    v_mfma_f32_16x16x32_bf16 a[40:43], v[48:51], v[76:79], a[40:43]
    v_mfma_f32_16x16x32_bf16 a[72:75], v[36:39], v[72:75], a[72:75]
    v_mfma_f32_16x16x32_bf16 a[76:79], v[36:39], v[76:79], a[76:79]
    s_barrier
    ds_read_b128 v[64:67], v22 offset:0
    ds_read_b128 v[68:71], v22 offset:2048
    ds_read_b64_tr_b16 v[48:49], v12 offset:0
    ds_read_b64_tr_b16 v[50:51], v12 offset:4096
    s_waitcnt lgkmcnt(12)
    v_mfma_f32_16x16x32_bf16 a[12:15], v[52:55], v[72:75], a[12:15]
    v_mfma_f32_16x16x32_bf16 a[44:47], v[52:55], v[76:79], a[44:47]
    v_mfma_f32_16x16x32_bf16 a[80:83], v[72:75], v[72:75], a[80:83]
    v_mfma_f32_16x16x32_bf16 a[84:87], v[76:79], v[76:79], a[84:87]
    ds_read_b64_tr_b16 v[52:53], v13 offset:0
    ds_read_b64_tr_b16 v[54:55], v13 offset:4096
    s_waitcnt lgkmcnt(12)
    v_mfma_f32_16x16x32_bf16 a[16:19], v[56:59], v[72:75], a[16:19]
    v_mfma_f32_16x16x32_bf16 a[48:51], v[56:59], v[76:79], a[48:51]
    ds_read_b64_tr_b16 v[56:57], v14 offset:0
    ds_read_b64_tr_b16 v[58:59], v14 offset:4096
    s_waitcnt lgkmcnt(12)
    v_mfma_f32_16x16x32_bf16 a[20:23], v[60:63], v[72:75], a[20:23]
    v_mfma_f32_16x16x32_bf16 a[52:55], v[60:63], v[76:79], a[52:55]
    ds_read_b64_tr_b16 v[60:61], v15 offset:0
    ds_read_b64_tr_b16 v[62:63], v15 offset:4096
    s_waitcnt lgkmcnt(12)
    v_mfma_f32_16x16x32_bf16 a[24:27], v[40:43], v[72:75], a[24:27]
    v_mfma_f32_16x16x32_bf16 a[56:59], v[40:43], v[76:79], a[56:59]
    ds_read_b64_tr_b16 v[40:41], v16 offset:0
    ds_read_b64_tr_b16 v[42:43], v16 offset:4096
    s_waitcnt lgkmcnt(12)
    v_mfma_f32_16x16x32_bf16 a[28:31], v[44:47], v[72:75], a[28:31]
    v_mfma_f32_16x16x32_bf16 a[60:63], v[44:47], v[76:79], a[60:63]
    ds_read_b64_tr_b16 v[44:45], v17 offset:0
    ds_read_b64_tr_b16 v[46:47], v17 offset:4096
    s_waitcnt lgkmcnt(10)
    v_mfma_f32_16x16x32_bf16 a[0:3], v[48:51], v[64:67], a[0:3]
    v_mfma_f32_16x16x32_bf16 a[32:35], v[48:51], v[68:71], a[32:35]
    v_mfma_f32_16x16x32_bf16 a[64:67], v[48:51], v[36:39], a[64:67]
    ds_read_b64_tr_b16 v[48:49], v18 offset:0
    ds_read_b64_tr_b16 v[50:51], v18 offset:4096
    s_waitcnt lgkmcnt(10)
    v_mfma_f32_16x16x32_bf16 a[4:7], v[52:55], v[64:67], a[4:7]
    v_mfma_f32_16x16x32_bf16 a[36:39], v[52:55], v[68:71], a[36:39]
    v_mfma_f32_16x16x32_bf16 a[68:71], v[52:55], v[36:39], a[68:71]
    ds_read_b64_tr_b16 v[52:53], v19 offset:0
    ds_read_b64_tr_b16 v[54:55], v19 offset:4096
    s_waitcnt lgkmcnt(10)
    v_mfma_f32_16x16x32_bf16 a[8:11], v[56:59], v[64:67], a[8:11]
    v_mfma_f32_16x16x32_bf16 a[40:43], v[56:59], v[68:71], a[40:43]
    v_mfma_f32_16x16x32_bf16 a[72:75], v[36:39], v[64:67], a[72:75]
    v_mfma_f32_16x16x32_bf16 a[76:79], v[36:39], v[68:71], a[76:79]
    ds_read_b128 v[72:75], v23 offset:0
    ds_read_b128 v[76:79], v23 offset:2048
    ds_read_b64_tr_b16 v[56:57], v12 offset:8192
    ds_read_b64_tr_b16 v[58:59], v12 offset:12288
    s_waitcnt lgkmcnt(12)
    v_mfma_f32_16x16x32_bf16 a[12:15], v[60:63], v[64:67], a[12:15]
    v_mfma_f32_16x16x32_bf16 a[44:47], v[60:63], v[68:71], a[44:47]
    v_mfma_f32_16x16x32_bf16 a[80:83], v[64:67], v[64:67], a[80:83]
    v_mfma_f32_16x16x32_bf16 a[84:87], v[68:71], v[68:71], a[84:87]
    ds_read_b64_tr_b16 v[60:61], v13 offset:8192
    ds_read_b64_tr_b16 v[62:63], v13 offset:12288
    s_waitcnt lgkmcnt(12)
    v_mfma_f32_16x16x32_bf16 a[16:19], v[40:43], v[64:67], a[16:19]
    v_mfma_f32_16x16x32_bf16 a[48:51], v[40:43], v[68:71], a[48:51]
    ds_read_b64_tr_b16 v[40:41], v14 offset:8192
    ds_read_b64_tr_b16 v[42:43], v14 offset:12288
    s_waitcnt lgkmcnt(12)
    v_mfma_f32_16x16x32_bf16 a[20:23], v[44:47], v[64:67], a[20:23]
    v_mfma_f32_16x16x32_bf16 a[52:55], v[44:47], v[68:71], a[52:55]
    ds_read_b64_tr_b16 v[44:45], v15 offset:8192
    ds_read_b64_tr_b16 v[46:47], v15 offset:12288
    s_waitcnt lgkmcnt(12)
    v_mfma_f32_16x16x32_bf16 a[24:27], v[48:51], v[64:67], a[24:27]
    v_mfma_f32_16x16x32_bf16 a[56:59], v[48:51], v[68:71], a[56:59]
    ds_read_b64_tr_b16 v[48:49], v16 offset:8192
    ds_read_b64_tr_b16 v[50:51], v16 offset:12288
    s_waitcnt lgkmcnt(12)
    v_mfma_f32_16x16x32_bf16 a[28:31], v[52:55], v[64:67], a[28:31]
    v_mfma_f32_16x16x32_bf16 a[60:63], v[52:55], v[68:71], a[60:63]
    ds_read_b64_tr_b16 v[52:53], v17 offset:8192
    ds_read_b64_tr_b16 v[54:55], v17 offset:12288
    s_waitcnt lgkmcnt(10)
    v_mfma_f32_16x16x32_bf16 a[0:3], v[56:59], v[72:75], a[0:3]
    v_mfma_f32_16x16x32_bf16 a[32:35], v[56:59], v[76:79], a[32:35]
    v_mfma_f32_16x16x32_bf16 a[64:67], v[56:59], v[36:39], a[64:67]
    ds_read_b64_tr_b16 v[56:57], v18 offset:8192
    ds_read_b64_tr_b16 v[58:59], v18 offset:12288
    s_waitcnt lgkmcnt(10)
    v_mfma_f32_16x16x32_bf16 a[4:7], v[60:63], v[72:75], a[4:7]
    v_mfma_f32_16x16x32_bf16 a[36:39], v[60:63], v[76:79], a[36:39]
    v_mfma_f32_16x16x32_bf16 a[68:71], v[60:63], v[36:39], a[68:71]
    ds_read_b64_tr_b16 v[60:61], v19 offset:8192
    ds_read_b64_tr_b16 v[62:63], v19 offset:12288
    s_waitcnt lgkmcnt(10)
    v_mfma_f32_16x16x32_bf16 a[8:11], v[40:43], v[72:75], a[8:11]
    v_mfma_f32_16x16x32_bf16 a[40:43], v[40:43], v[76:79], a[40:43]
    v_mfma_f32_16x16x32_bf16 a[72:75], v[36:39], v[72:75], a[72:75]
    v_mfma_f32_16x16x32_bf16 a[76:79], v[36:39], v[76:79], a[76:79]
    s_barrier
    ds_read_b128 v[64:67], v22 offset:32768
    ds_read_b128 v[68:71], v22 offset:34816
    ds_read_b64_tr_b16 v[40:41], v12 offset:32768
    ds_read_b64_tr_b16 v[42:43], v12 offset:36864
    s_waitcnt lgkmcnt(12)
    v_mfma_f32_16x16x32_bf16 a[12:15], v[44:47], v[72:75], a[12:15]
    v_mfma_f32_16x16x32_bf16 a[44:47], v[44:47], v[76:79], a[44:47]
    v_mfma_f32_16x16x32_bf16 a[80:83], v[72:75], v[72:75], a[80:83]
    v_mfma_f32_16x16x32_bf16 a[84:87], v[76:79], v[76:79], a[84:87]
    ds_read_b64_tr_b16 v[44:45], v13 offset:32768
    ds_read_b64_tr_b16 v[46:47], v13 offset:36864
    s_waitcnt lgkmcnt(12)
    v_mfma_f32_16x16x32_bf16 a[16:19], v[48:51], v[72:75], a[16:19]
    v_mfma_f32_16x16x32_bf16 a[48:51], v[48:51], v[76:79], a[48:51]
    ds_read_b64_tr_b16 v[48:49], v14 offset:32768
    ds_read_b64_tr_b16 v[50:51], v14 offset:36864
    s_waitcnt lgkmcnt(12)
    v_mfma_f32_16x16x32_bf16 a[20:23], v[52:55], v[72:75], a[20:23]
    v_mfma_f32_16x16x32_bf16 a[52:55], v[52:55], v[76:79], a[52:55]
    ds_read_b64_tr_b16 v[52:53], v15 offset:32768
    ds_read_b64_tr_b16 v[54:55], v15 offset:36864
    s_waitcnt lgkmcnt(12)
    v_mfma_f32_16x16x32_bf16 a[24:27], v[56:59], v[72:75], a[24:27]
    v_mfma_f32_16x16x32_bf16 a[56:59], v[56:59], v[76:79], a[56:59]
    ds_read_b64_tr_b16 v[56:57], v16 offset:32768
    ds_read_b64_tr_b16 v[58:59], v16 offset:36864
    s_waitcnt lgkmcnt(12)
    v_mfma_f32_16x16x32_bf16 a[28:31], v[60:63], v[72:75], a[28:31]
    v_mfma_f32_16x16x32_bf16 a[60:63], v[60:63], v[76:79], a[60:63]
    ds_read_b64_tr_b16 v[60:61], v17 offset:32768
    ds_read_b64_tr_b16 v[62:63], v17 offset:36864
    s_waitcnt lgkmcnt(10)
    v_mfma_f32_16x16x32_bf16 a[0:3], v[40:43], v[64:67], a[0:3]
    v_mfma_f32_16x16x32_bf16 a[32:35], v[40:43], v[68:71], a[32:35]
    v_mfma_f32_16x16x32_bf16 a[64:67], v[40:43], v[36:39], a[64:67]
    ds_read_b64_tr_b16 v[40:41], v18 offset:32768
    ds_read_b64_tr_b16 v[42:43], v18 offset:36864
    s_waitcnt lgkmcnt(10)
    v_mfma_f32_16x16x32_bf16 a[4:7], v[44:47], v[64:67], a[4:7]
    v_mfma_f32_16x16x32_bf16 a[36:39], v[44:47], v[68:71], a[36:39]
    v_mfma_f32_16x16x32_bf16 a[68:71], v[44:47], v[36:39], a[68:71]
    ds_read_b64_tr_b16 v[44:45], v19 offset:32768
    ds_read_b64_tr_b16 v[46:47], v19 offset:36864
    s_waitcnt lgkmcnt(10)
    v_mfma_f32_16x16x32_bf16 a[8:11], v[48:51], v[64:67], a[8:11]
    v_mfma_f32_16x16x32_bf16 a[40:43], v[48:51], v[68:71], a[40:43]
    v_mfma_f32_16x16x32_bf16 a[72:75], v[36:39], v[64:67], a[72:75]
    v_mfma_f32_16x16x32_bf16 a[76:79], v[36:39], v[68:71], a[76:79]
    ds_read_b128 v[72:75], v23 offset:32768
    ds_read_b128 v[76:79], v23 offset:34816
    ds_read_b64_tr_b16 v[48:49], v12 offset:40960
    ds_read_b64_tr_b16 v[50:51], v12 offset:45056
    s_waitcnt lgkmcnt(12)
    v_mfma_f32_16x16x32_bf16 a[12:15], v[52:55], v[64:67], a[12:15]
    v_mfma_f32_16x16x32_bf16 a[44:47], v[52:55], v[68:71], a[44:47]
    v_mfma_f32_16x16x32_bf16 a[80:83], v[64:67], v[64:67], a[80:83]
    v_mfma_f32_16x16x32_bf16 a[84:87], v[68:71], v[68:71], a[84:87]
    ds_read_b64_tr_b16 v[52:53], v13 offset:40960
    ds_read_b64_tr_b16 v[54:55], v13 offset:45056
    s_waitcnt lgkmcnt(12)
    v_mfma_f32_16x16x32_bf16 a[16:19], v[56:59], v[64:67], a[16:19]
    v_mfma_f32_16x16x32_bf16 a[48:51], v[56:59], v[68:71], a[48:51]
    ds_read_b64_tr_b16 v[56:57], v14 offset:40960
    ds_read_b64_tr_b16 v[58:59], v14 offset:45056
    s_waitcnt lgkmcnt(12)
    v_mfma_f32_16x16x32_bf16 a[20:23], v[60:63], v[64:67], a[20:23]
    v_mfma_f32_16x16x32_bf16 a[52:55], v[60:63], v[68:71], a[52:55]
    ds_read_b64_tr_b16 v[60:61], v15 offset:40960
    ds_read_b64_tr_b16 v[62:63], v15 offset:45056
    s_waitcnt lgkmcnt(12)
    v_mfma_f32_16x16x32_bf16 a[24:27], v[40:43], v[64:67], a[24:27]
    v_mfma_f32_16x16x32_bf16 a[56:59], v[40:43], v[68:71], a[56:59]
    ds_read_b64_tr_b16 v[40:41], v16 offset:40960
    ds_read_b64_tr_b16 v[42:43], v16 offset:45056
    s_waitcnt lgkmcnt(12)
    v_mfma_f32_16x16x32_bf16 a[28:31], v[44:47], v[64:67], a[28:31]
    v_mfma_f32_16x16x32_bf16 a[60:63], v[44:47], v[68:71], a[60:63]
    ds_read_b64_tr_b16 v[44:45], v17 offset:40960
    ds_read_b64_tr_b16 v[46:47], v17 offset:45056
    s_waitcnt lgkmcnt(10)
    v_mfma_f32_16x16x32_bf16 a[0:3], v[48:51], v[72:75], a[0:3]
    v_mfma_f32_16x16x32_bf16 a[32:35], v[48:51], v[76:79], a[32:35]
    v_mfma_f32_16x16x32_bf16 a[64:67], v[48:51], v[36:39], a[64:67]
    ds_read_b64_tr_b16 v[48:49], v18 offset:40960
    ds_read_b64_tr_b16 v[50:51], v18 offset:45056
    s_waitcnt lgkmcnt(10)
    v_mfma_f32_16x16x32_bf16 a[4:7], v[52:55], v[72:75], a[4:7]
    v_mfma_f32_16x16x32_bf16 a[36:39], v[52:55], v[76:79], a[36:39]
    v_mfma_f32_16x16x32_bf16 a[68:71], v[52:55], v[36:39], a[68:71]
    ds_read_b64_tr_b16 v[52:53], v19 offset:40960
    ds_read_b64_tr_b16 v[54:55], v19 offset:45056
    s_waitcnt lgkmcnt(10)
    v_mfma_f32_16x16x32_bf16 a[8:11], v[56:59], v[72:75], a[8:11]
    v_mfma_f32_16x16x32_bf16 a[40:43], v[56:59], v[76:79], a[40:43]
    v_mfma_f32_16x16x32_bf16 a[72:75], v[36:39], v[72:75], a[72:75]
    v_mfma_f32_16x16x32_bf16 a[76:79], v[36:39], v[76:79], a[76:79]
    s_barrier
    ds_read_b128 v[64:67], v20 offset:0
    ds_read_b128 v[68:71], v20 offset:2048
    ds_read_b64_tr_b16 v[56:57], v4 offset:0
    ds_read_b64_tr_b16 v[58:59], v4 offset:4096
    s_waitcnt lgkmcnt(12)
    v_mfma_f32_16x16x32_bf16 a[12:15], v[60:63], v[72:75], a[12:15]
    v_mfma_f32_16x16x32_bf16 a[44:47], v[60:63], v[76:79], a[44:47]
    v_mfma_f32_16x16x32_bf16 a[80:83], v[72:75], v[72:75], a[80:83]
    v_mfma_f32_16x16x32_bf16 a[84:87], v[76:79], v[76:79], a[84:87]
    ds_read_b64_tr_b16 v[60:61], v5 offset:0
    ds_read_b64_tr_b16 v[62:63], v5 offset:4096
    s_waitcnt lgkmcnt(12)
    v_mfma_f32_16x16x32_bf16 a[16:19], v[40:43], v[72:75], a[16:19]
    v_mfma_f32_16x16x32_bf16 a[48:51], v[40:43], v[76:79], a[48:51]
    ds_read_b64_tr_b16 v[40:41], v6 offset:0
    ds_read_b64_tr_b16 v[42:43], v6 offset:4096
    s_waitcnt lgkmcnt(12)
    v_mfma_f32_16x16x32_bf16 a[20:23], v[44:47], v[72:75], a[20:23]
    v_mfma_f32_16x16x32_bf16 a[52:55], v[44:47], v[76:79], a[52:55]
    ds_read_b64_tr_b16 v[44:45], v7 offset:0
    ds_read_b64_tr_b16 v[46:47], v7 offset:4096
    s_waitcnt lgkmcnt(12)
    v_mfma_f32_16x16x32_bf16 a[24:27], v[48:51], v[72:75], a[24:27]
    v_mfma_f32_16x16x32_bf16 a[56:59], v[48:51], v[76:79], a[56:59]
    ds_read_b64_tr_b16 v[48:49], v8 offset:0
    ds_read_b64_tr_b16 v[50:51], v8 offset:4096
    s_waitcnt lgkmcnt(12)
    v_mfma_f32_16x16x32_bf16 a[28:31], v[52:55], v[72:75], a[28:31]
    v_mfma_f32_16x16x32_bf16 a[60:63], v[52:55], v[76:79], a[60:63]
    ds_read_b64_tr_b16 v[52:53], v9 offset:0
    ds_read_b64_tr_b16 v[54:55], v9 offset:4096
    s_waitcnt lgkmcnt(10)
    v_mfma_f32_16x16x32_bf16 a[0:3], v[56:59], v[64:67], a[0:3]
    v_mfma_f32_16x16x32_bf16 a[32:35], v[56:59], v[68:71], a[32:35]
    v_mfma_f32_16x16x32_bf16 a[64:67], v[56:59], v[36:39], a[64:67]
    ds_read_b64_tr_b16 v[56:57], v10 offset:0
    ds_read_b64_tr_b16 v[58:59], v10 offset:4096
    s_waitcnt lgkmcnt(10)
    v_mfma_f32_16x16x32_bf16 a[4:7], v[60:63], v[64:67], a[4:7]
    v_mfma_f32_16x16x32_bf16 a[36:39], v[60:63], v[68:71], a[36:39]
    v_mfma_f32_16x16x32_bf16 a[68:71], v[60:63], v[36:39], a[68:71]
    ds_read_b64_tr_b16 v[60:61], v11 offset:0
    ds_read_b64_tr_b16 v[62:63], v11 offset:4096
    s_waitcnt lgkmcnt(10)
    v_mfma_f32_16x16x32_bf16 a[8:11], v[40:43], v[64:67], a[8:11]
    v_mfma_f32_16x16x32_bf16 a[40:43], v[40:43], v[68:71], a[40:43]
    v_mfma_f32_16x16x32_bf16 a[72:75], v[36:39], v[64:67], a[72:75]
    v_mfma_f32_16x16x32_bf16 a[76:79], v[36:39], v[68:71], a[76:79]
    ds_read_b128 v[72:75], v21 offset:0
    ds_read_b128 v[76:79], v21 offset:2048
    ds_read_b64_tr_b16 v[40:41], v4 offset:8192
    ds_read_b64_tr_b16 v[42:43], v4 offset:12288
    s_waitcnt lgkmcnt(12)
    v_mfma_f32_16x16x32_bf16 a[12:15], v[44:47], v[64:67], a[12:15]
    v_mfma_f32_16x16x32_bf16 a[44:47], v[44:47], v[68:71], a[44:47]
    v_mfma_f32_16x16x32_bf16 a[80:83], v[64:67], v[64:67], a[80:83]
    v_mfma_f32_16x16x32_bf16 a[84:87], v[68:71], v[68:71], a[84:87]
    ds_read_b64_tr_b16 v[44:45], v5 offset:8192
    ds_read_b64_tr_b16 v[46:47], v5 offset:12288
    s_waitcnt lgkmcnt(12)
    v_mfma_f32_16x16x32_bf16 a[16:19], v[48:51], v[64:67], a[16:19]
    v_mfma_f32_16x16x32_bf16 a[48:51], v[48:51], v[68:71], a[48:51]
    ds_read_b64_tr_b16 v[48:49], v6 offset:8192
    ds_read_b64_tr_b16 v[50:51], v6 offset:12288
    s_waitcnt lgkmcnt(12)
    v_mfma_f32_16x16x32_bf16 a[20:23], v[52:55], v[64:67], a[20:23]
    v_mfma_f32_16x16x32_bf16 a[52:55], v[52:55], v[68:71], a[52:55]
    ds_read_b64_tr_b16 v[52:53], v7 offset:8192
    ds_read_b64_tr_b16 v[54:55], v7 offset:12288
    s_waitcnt lgkmcnt(12)
    v_mfma_f32_16x16x32_bf16 a[24:27], v[56:59], v[64:67], a[24:27]
    v_mfma_f32_16x16x32_bf16 a[56:59], v[56:59], v[68:71], a[56:59]
    ds_read_b64_tr_b16 v[56:57], v8 offset:8192
    ds_read_b64_tr_b16 v[58:59], v8 offset:12288
    s_waitcnt lgkmcnt(12)
    v_mfma_f32_16x16x32_bf16 a[28:31], v[60:63], v[64:67], a[28:31]
    v_mfma_f32_16x16x32_bf16 a[60:63], v[60:63], v[68:71], a[60:63]
    ds_read_b64_tr_b16 v[60:61], v9 offset:8192
    ds_read_b64_tr_b16 v[62:63], v9 offset:12288
    s_waitcnt lgkmcnt(10)
    v_mfma_f32_16x16x32_bf16 a[0:3], v[40:43], v[72:75], a[0:3]
    v_mfma_f32_16x16x32_bf16 a[32:35], v[40:43], v[76:79], a[32:35]
    v_mfma_f32_16x16x32_bf16 a[64:67], v[40:43], v[36:39], a[64:67]
    ds_read_b64_tr_b16 v[40:41], v10 offset:8192
    ds_read_b64_tr_b16 v[42:43], v10 offset:12288
    s_waitcnt lgkmcnt(10)
    v_mfma_f32_16x16x32_bf16 a[4:7], v[44:47], v[72:75], a[4:7]
    v_mfma_f32_16x16x32_bf16 a[36:39], v[44:47], v[76:79], a[36:39]
    v_mfma_f32_16x16x32_bf16 a[68:71], v[44:47], v[36:39], a[68:71]
    ds_read_b64_tr_b16 v[44:45], v11 offset:8192
    ds_read_b64_tr_b16 v[46:47], v11 offset:12288
    s_waitcnt lgkmcnt(10)
    v_mfma_f32_16x16x32_bf16 a[8:11], v[48:51], v[72:75], a[8:11]
    v_mfma_f32_16x16x32_bf16 a[40:43], v[48:51], v[76:79], a[40:43]
    v_mfma_f32_16x16x32_bf16 a[72:75], v[36:39], v[72:75], a[72:75]
    v_mfma_f32_16x16x32_bf16 a[76:79], v[36:39], v[76:79], a[76:79]
    s_barrier
    ds_read_b128 v[64:67], v20 offset:32768
    ds_read_b128 v[68:71], v20 offset:34816
    ds_read_b64_tr_b16 v[48:49], v4 offset:32768
    ds_read_b64_tr_b16 v[50:51], v4 offset:36864
    s_waitcnt lgkmcnt(12)
    v_mfma_f32_16x16x32_bf16 a[12:15], v[52:55], v[72:75], a[12:15]
    v_mfma_f32_16x16x32_bf16 a[44:47], v[52:55], v[76:79], a[44:47]
    v_mfma_f32_16x16x32_bf16 a[80:83], v[72:75], v[72:75], a[80:83]
    v_mfma_f32_16x16x32_bf16 a[84:87], v[76:79], v[76:79], a[84:87]
    ds_read_b64_tr_b16 v[52:53], v5 offset:32768
    ds_read_b64_tr_b16 v[54:55], v5 offset:36864
    s_waitcnt lgkmcnt(12)
    v_mfma_f32_16x16x32_bf16 a[16:19], v[56:59], v[72:75], a[16:19]
    v_mfma_f32_16x16x32_bf16 a[48:51], v[56:59], v[76:79], a[48:51]
    ds_read_b64_tr_b16 v[56:57], v6 offset:32768
    ds_read_b64_tr_b16 v[58:59], v6 offset:36864
    s_waitcnt lgkmcnt(12)
    v_mfma_f32_16x16x32_bf16 a[20:23], v[60:63], v[72:75], a[20:23]
    v_mfma_f32_16x16x32_bf16 a[52:55], v[60:63], v[76:79], a[52:55]
    ds_read_b64_tr_b16 v[60:61], v7 offset:32768
    ds_read_b64_tr_b16 v[62:63], v7 offset:36864
    s_waitcnt lgkmcnt(12)
    v_mfma_f32_16x16x32_bf16 a[24:27], v[40:43], v[72:75], a[24:27]
    v_mfma_f32_16x16x32_bf16 a[56:59], v[40:43], v[76:79], a[56:59]
    ds_read_b64_tr_b16 v[40:41], v8 offset:32768
    ds_read_b64_tr_b16 v[42:43], v8 offset:36864
    s_waitcnt lgkmcnt(12)
    v_mfma_f32_16x16x32_bf16 a[28:31], v[44:47], v[72:75], a[28:31]
    v_mfma_f32_16x16x32_bf16 a[60:63], v[44:47], v[76:79], a[60:63]
    ds_read_b64_tr_b16 v[44:45], v9 offset:32768
    ds_read_b64_tr_b16 v[46:47], v9 offset:36864
    s_waitcnt lgkmcnt(10)
    v_mfma_f32_16x16x32_bf16 a[0:3], v[48:51], v[64:67], a[0:3]
    v_mfma_f32_16x16x32_bf16 a[32:35], v[48:51], v[68:71], a[32:35]
    v_mfma_f32_16x16x32_bf16 a[64:67], v[48:51], v[36:39], a[64:67]
    ds_read_b64_tr_b16 v[48:49], v10 offset:32768
    ds_read_b64_tr_b16 v[50:51], v10 offset:36864
    s_waitcnt lgkmcnt(10)
    v_mfma_f32_16x16x32_bf16 a[4:7], v[52:55], v[64:67], a[4:7]
    v_mfma_f32_16x16x32_bf16 a[36:39], v[52:55], v[68:71], a[36:39]
    v_mfma_f32_16x16x32_bf16 a[68:71], v[52:55], v[36:39], a[68:71]
    ds_read_b64_tr_b16 v[52:53], v11 offset:32768
    ds_read_b64_tr_b16 v[54:55], v11 offset:36864
    s_waitcnt lgkmcnt(10)
    v_mfma_f32_16x16x32_bf16 a[8:11], v[56:59], v[64:67], a[8:11]
    v_mfma_f32_16x16x32_bf16 a[40:43], v[56:59], v[68:71], a[40:43]
    v_mfma_f32_16x16x32_bf16 a[72:75], v[36:39], v[64:67], a[72:75]
    v_mfma_f32_16x16x32_bf16 a[76:79], v[36:39], v[68:71], a[76:79]
    ds_read_b128 v[72:75], v21 offset:32768
    ds_read_b128 v[76:79], v21 offset:34816
    ds_read_b64_tr_b16 v[56:57], v4 offset:40960
    ds_read_b64_tr_b16 v[58:59], v4 offset:45056
    s_waitcnt lgkmcnt(12)
    v_mfma_f32_16x16x32_bf16 a[12:15], v[60:63], v[64:67], a[12:15]
    v_mfma_f32_16x16x32_bf16 a[44:47], v[60:63], v[68:71], a[44:47]
    v_mfma_f32_16x16x32_bf16 a[80:83], v[64:67], v[64:67], a[80:83]
    v_mfma_f32_16x16x32_bf16 a[84:87], v[68:71], v[68:71], a[84:87]
    ds_read_b64_tr_b16 v[60:61], v5 offset:40960
    ds_read_b64_tr_b16 v[62:63], v5 offset:45056
    s_waitcnt lgkmcnt(12)
    v_mfma_f32_16x16x32_bf16 a[16:19], v[40:43], v[64:67], a[16:19]
    v_mfma_f32_16x16x32_bf16 a[48:51], v[40:43], v[68:71], a[48:51]
    ds_read_b64_tr_b16 v[40:41], v6 offset:40960
    ds_read_b64_tr_b16 v[42:43], v6 offset:45056
    s_waitcnt lgkmcnt(12)
    v_mfma_f32_16x16x32_bf16 a[20:23], v[44:47], v[64:67], a[20:23]
    v_mfma_f32_16x16x32_bf16 a[52:55], v[44:47], v[68:71], a[52:55]
    ds_read_b64_tr_b16 v[44:45], v7 offset:40960
    ds_read_b64_tr_b16 v[46:47], v7 offset:45056
    s_waitcnt lgkmcnt(12)
    v_mfma_f32_16x16x32_bf16 a[24:27], v[48:51], v[64:67], a[24:27]
    v_mfma_f32_16x16x32_bf16 a[56:59], v[48:51], v[68:71], a[56:59]
    ds_read_b64_tr_b16 v[48:49], v8 offset:40960
    ds_read_b64_tr_b16 v[50:51], v8 offset:45056
    s_waitcnt lgkmcnt(12)
    v_mfma_f32_16x16x32_bf16 a[28:31], v[52:55], v[64:67], a[28:31]
    v_mfma_f32_16x16x32_bf16 a[60:63], v[52:55], v[68:71], a[60:63]
    ds_read_b64_tr_b16 v[52:53], v9 offset:40960
    ds_read_b64_tr_b16 v[54:55], v9 offset:45056
    s_waitcnt lgkmcnt(10)
    v_mfma_f32_16x16x32_bf16 a[0:3], v[56:59], v[72:75], a[0:3]
    v_mfma_f32_16x16x32_bf16 a[32:35], v[56:59], v[76:79], a[32:35]
    v_mfma_f32_16x16x32_bf16 a[64:67], v[56:59], v[36:39], a[64:67]
    ds_read_b64_tr_b16 v[56:57], v10 offset:40960
    ds_read_b64_tr_b16 v[58:59], v10 offset:45056
    s_waitcnt lgkmcnt(10)
    v_mfma_f32_16x16x32_bf16 a[4:7], v[60:63], v[72:75], a[4:7]
    v_mfma_f32_16x16x32_bf16 a[36:39], v[60:63], v[76:79], a[36:39]
    v_mfma_f32_16x16x32_bf16 a[68:71], v[60:63], v[36:39], a[68:71]
    ds_read_b64_tr_b16 v[60:61], v11 offset:40960
    ds_read_b64_tr_b16 v[62:63], v11 offset:45056
    s_waitcnt lgkmcnt(10)
    v_mfma_f32_16x16x32_bf16 a[8:11], v[40:43], v[72:75], a[8:11]
    v_mfma_f32_16x16x32_bf16 a[40:43], v[40:43], v[76:79], a[40:43]
    v_mfma_f32_16x16x32_bf16 a[72:75], v[36:39], v[72:75], a[72:75]
    v_mfma_f32_16x16x32_bf16 a[76:79], v[36:39], v[76:79], a[76:79]
    s_barrier
    ds_read_b128 v[64:67], v22 offset:0
    ds_read_b128 v[68:71], v22 offset:2048
    ds_read_b64_tr_b16 v[40:41], v12 offset:0
    ds_read_b64_tr_b16 v[42:43], v12 offset:4096
    s_waitcnt lgkmcnt(12)
    v_mfma_f32_16x16x32_bf16 a[12:15], v[44:47], v[72:75], a[12:15]
    v_mfma_f32_16x16x32_bf16 a[44:47], v[44:47], v[76:79], a[44:47]
    v_mfma_f32_16x16x32_bf16 a[80:83], v[72:75], v[72:75], a[80:83]
    v_mfma_f32_16x16x32_bf16 a[84:87], v[76:79], v[76:79], a[84:87]
    ds_read_b64_tr_b16 v[44:45], v13 offset:0
    ds_read_b64_tr_b16 v[46:47], v13 offset:4096
    s_waitcnt lgkmcnt(12)
    v_mfma_f32_16x16x32_bf16 a[16:19], v[48:51], v[72:75], a[16:19]
    v_mfma_f32_16x16x32_bf16 a[48:51], v[48:51], v[76:79], a[48:51]
    ds_read_b64_tr_b16 v[48:49], v14 offset:0
    ds_read_b64_tr_b16 v[50:51], v14 offset:4096
    s_waitcnt lgkmcnt(12)
    v_mfma_f32_16x16x32_bf16 a[20:23], v[52:55], v[72:75], a[20:23]
    v_mfma_f32_16x16x32_bf16 a[52:55], v[52:55], v[76:79], a[52:55]
    ds_read_b64_tr_b16 v[52:53], v15 offset:0
    ds_read_b64_tr_b16 v[54:55], v15 offset:4096
    s_waitcnt lgkmcnt(12)
    v_mfma_f32_16x16x32_bf16 a[24:27], v[56:59], v[72:75], a[24:27]
    v_mfma_f32_16x16x32_bf16 a[56:59], v[56:59], v[76:79], a[56:59]
    ds_read_b64_tr_b16 v[56:57], v16 offset:0
    ds_read_b64_tr_b16 v[58:59], v16 offset:4096
    s_waitcnt lgkmcnt(12)
    v_mfma_f32_16x16x32_bf16 a[28:31], v[60:63], v[72:75], a[28:31]
    v_mfma_f32_16x16x32_bf16 a[60:63], v[60:63], v[76:79], a[60:63]
    ds_read_b64_tr_b16 v[60:61], v17 offset:0
    ds_read_b64_tr_b16 v[62:63], v17 offset:4096
    s_waitcnt lgkmcnt(10)
    v_mfma_f32_16x16x32_bf16 a[0:3], v[40:43], v[64:67], a[0:3]
    v_mfma_f32_16x16x32_bf16 a[32:35], v[40:43], v[68:71], a[32:35]
    v_mfma_f32_16x16x32_bf16 a[64:67], v[40:43], v[36:39], a[64:67]
    ds_read_b64_tr_b16 v[40:41], v18 offset:0
    ds_read_b64_tr_b16 v[42:43], v18 offset:4096
    s_waitcnt lgkmcnt(10)
    v_mfma_f32_16x16x32_bf16 a[4:7], v[44:47], v[64:67], a[4:7]
    v_mfma_f32_16x16x32_bf16 a[36:39], v[44:47], v[68:71], a[36:39]
    v_mfma_f32_16x16x32_bf16 a[68:71], v[44:47], v[36:39], a[68:71]
    ds_read_b64_tr_b16 v[44:45], v19 offset:0
    ds_read_b64_tr_b16 v[46:47], v19 offset:4096
    s_waitcnt lgkmcnt(10)
    v_mfma_f32_16x16x32_bf16 a[8:11], v[48:51], v[64:67], a[8:11]
    v_mfma_f32_16x16x32_bf16 a[40:43], v[48:51], v[68:71], a[40:43]
    v_mfma_f32_16x16x32_bf16 a[72:75], v[36:39], v[64:67], a[72:75]
    v_mfma_f32_16x16x32_bf16 a[76:79], v[36:39], v[68:71], a[76:79]
    ds_read_b128 v[72:75], v23 offset:0
    ds_read_b128 v[76:79], v23 offset:2048
    ds_read_b64_tr_b16 v[48:49], v12 offset:8192
    ds_read_b64_tr_b16 v[50:51], v12 offset:12288
    s_waitcnt lgkmcnt(12)
    v_mfma_f32_16x16x32_bf16 a[12:15], v[52:55], v[64:67], a[12:15]
    v_mfma_f32_16x16x32_bf16 a[44:47], v[52:55], v[68:71], a[44:47]
    v_mfma_f32_16x16x32_bf16 a[80:83], v[64:67], v[64:67], a[80:83]
    v_mfma_f32_16x16x32_bf16 a[84:87], v[68:71], v[68:71], a[84:87]
    ds_read_b64_tr_b16 v[52:53], v13 offset:8192
    ds_read_b64_tr_b16 v[54:55], v13 offset:12288
    s_waitcnt lgkmcnt(12)
    v_mfma_f32_16x16x32_bf16 a[16:19], v[56:59], v[64:67], a[16:19]
    v_mfma_f32_16x16x32_bf16 a[48:51], v[56:59], v[68:71], a[48:51]
    ds_read_b64_tr_b16 v[56:57], v14 offset:8192
    ds_read_b64_tr_b16 v[58:59], v14 offset:12288
    s_waitcnt lgkmcnt(12)
    v_mfma_f32_16x16x32_bf16 a[20:23], v[60:63], v[64:67], a[20:23]
    v_mfma_f32_16x16x32_bf16 a[52:55], v[60:63], v[68:71], a[52:55]
    ds_read_b64_tr_b16 v[60:61], v15 offset:8192
    ds_read_b64_tr_b16 v[62:63], v15 offset:12288
    s_waitcnt lgkmcnt(12)
    v_mfma_f32_16x16x32_bf16 a[24:27], v[40:43], v[64:67], a[24:27]
    v_mfma_f32_16x16x32_bf16 a[56:59], v[40:43], v[68:71], a[56:59]
    ds_read_b64_tr_b16 v[40:41], v16 offset:8192
    ds_read_b64_tr_b16 v[42:43], v16 offset:12288
    s_waitcnt lgkmcnt(12)
    v_mfma_f32_16x16x32_bf16 a[28:31], v[44:47], v[64:67], a[28:31]
    v_mfma_f32_16x16x32_bf16 a[60:63], v[44:47], v[68:71], a[60:63]
    ds_read_b64_tr_b16 v[44:45], v17 offset:8192
    ds_read_b64_tr_b16 v[46:47], v17 offset:12288
    s_waitcnt lgkmcnt(10)
    v_mfma_f32_16x16x32_bf16 a[0:3], v[48:51], v[72:75], a[0:3]
    v_mfma_f32_16x16x32_bf16 a[32:35], v[48:51], v[76:79], a[32:35]
    v_mfma_f32_16x16x32_bf16 a[64:67], v[48:51], v[36:39], a[64:67]
    ds_read_b64_tr_b16 v[48:49], v18 offset:8192
    ds_read_b64_tr_b16 v[50:51], v18 offset:12288
    s_waitcnt lgkmcnt(10)
    v_mfma_f32_16x16x32_bf16 a[4:7], v[52:55], v[72:75], a[4:7]
    v_mfma_f32_16x16x32_bf16 a[36:39], v[52:55], v[76:79], a[36:39]
    v_mfma_f32_16x16x32_bf16 a[68:71], v[52:55], v[36:39], a[68:71]
    ds_read_b64_tr_b16 v[52:53], v19 offset:8192
    ds_read_b64_tr_b16 v[54:55], v19 offset:12288
    s_waitcnt lgkmcnt(10)
    v_mfma_f32_16x16x32_bf16 a[8:11], v[56:59], v[72:75], a[8:11]
    v_mfma_f32_16x16x32_bf16 a[40:43], v[56:59], v[76:79], a[40:43]
    v_mfma_f32_16x16x32_bf16 a[72:75], v[36:39], v[72:75], a[72:75]
    v_mfma_f32_16x16x32_bf16 a[76:79], v[36:39], v[76:79], a[76:79]
    s_barrier
    ds_read_b128 v[64:67], v22 offset:32768
    ds_read_b128 v[68:71], v22 offset:34816
    ds_read_b64_tr_b16 v[56:57], v12 offset:32768
    ds_read_b64_tr_b16 v[58:59], v12 offset:36864
    s_waitcnt lgkmcnt(12)
    v_mfma_f32_16x16x32_bf16 a[12:15], v[60:63], v[72:75], a[12:15]
    v_mfma_f32_16x16x32_bf16 a[44:47], v[60:63], v[76:79], a[44:47]
    v_mfma_f32_16x16x32_bf16 a[80:83], v[72:75], v[72:75], a[80:83]
    v_mfma_f32_16x16x32_bf16 a[84:87], v[76:79], v[76:79], a[84:87]
    ds_read_b64_tr_b16 v[60:61], v13 offset:32768
    ds_read_b64_tr_b16 v[62:63], v13 offset:36864
    s_waitcnt lgkmcnt(12)
    v_mfma_f32_16x16x32_bf16 a[16:19], v[40:43], v[72:75], a[16:19]
    v_mfma_f32_16x16x32_bf16 a[48:51], v[40:43], v[76:79], a[48:51]
    ds_read_b64_tr_b16 v[40:41], v14 offset:32768
    ds_read_b64_tr_b16 v[42:43], v14 offset:36864
    s_waitcnt lgkmcnt(12)
    v_mfma_f32_16x16x32_bf16 a[20:23], v[44:47], v[72:75], a[20:23]
    v_mfma_f32_16x16x32_bf16 a[52:55], v[44:47], v[76:79], a[52:55]
    ds_read_b64_tr_b16 v[44:45], v15 offset:32768
    ds_read_b64_tr_b16 v[46:47], v15 offset:36864
    s_waitcnt lgkmcnt(12)
    v_mfma_f32_16x16x32_bf16 a[24:27], v[48:51], v[72:75], a[24:27]
    v_mfma_f32_16x16x32_bf16 a[56:59], v[48:51], v[76:79], a[56:59]
    ds_read_b64_tr_b16 v[48:49], v16 offset:32768
    ds_read_b64_tr_b16 v[50:51], v16 offset:36864
    s_waitcnt lgkmcnt(12)
    v_mfma_f32_16x16x32_bf16 a[28:31], v[52:55], v[72:75], a[28:31]
    v_mfma_f32_16x16x32_bf16 a[60:63], v[52:55], v[76:79], a[60:63]
    ds_read_b64_tr_b16 v[52:53], v17 offset:32768
    ds_read_b64_tr_b16 v[54:55], v17 offset:36864
    s_waitcnt lgkmcnt(10)
    v_mfma_f32_16x16x32_bf16 a[0:3], v[56:59], v[64:67], a[0:3]
    v_mfma_f32_16x16x32_bf16 a[32:35], v[56:59], v[68:71], a[32:35]
    v_mfma_f32_16x16x32_bf16 a[64:67], v[56:59], v[36:39], a[64:67]
    ds_read_b64_tr_b16 v[56:57], v18 offset:32768
    ds_read_b64_tr_b16 v[58:59], v18 offset:36864
    s_waitcnt lgkmcnt(10)
    v_mfma_f32_16x16x32_bf16 a[4:7], v[60:63], v[64:67], a[4:7]
    v_mfma_f32_16x16x32_bf16 a[36:39], v[60:63], v[68:71], a[36:39]
    v_mfma_f32_16x16x32_bf16 a[68:71], v[60:63], v[36:39], a[68:71]
    ds_read_b64_tr_b16 v[60:61], v19 offset:32768
    ds_read_b64_tr_b16 v[62:63], v19 offset:36864
    s_waitcnt lgkmcnt(10)
    v_mfma_f32_16x16x32_bf16 a[8:11], v[40:43], v[64:67], a[8:11]
    v_mfma_f32_16x16x32_bf16 a[40:43], v[40:43], v[68:71], a[40:43]
    v_mfma_f32_16x16x32_bf16 a[72:75], v[36:39], v[64:67], a[72:75]
    v_mfma_f32_16x16x32_bf16 a[76:79], v[36:39], v[68:71], a[76:79]
    ds_read_b128 v[72:75], v23 offset:32768
    ds_read_b128 v[76:79], v23 offset:34816
    ds_read_b64_tr_b16 v[40:41], v12 offset:40960
    ds_read_b64_tr_b16 v[42:43], v12 offset:45056
    s_waitcnt lgkmcnt(12)
    v_mfma_f32_16x16x32_bf16 a[12:15], v[44:47], v[64:67], a[12:15]
    v_mfma_f32_16x16x32_bf16 a[44:47], v[44:47], v[68:71], a[44:47]
    v_mfma_f32_16x16x32_bf16 a[80:83], v[64:67], v[64:67], a[80:83]
    v_mfma_f32_16x16x32_bf16 a[84:87], v[68:71], v[68:71], a[84:87]
    ds_read_b64_tr_b16 v[44:45], v13 offset:40960
    ds_read_b64_tr_b16 v[46:47], v13 offset:45056
    s_waitcnt lgkmcnt(12)
    v_mfma_f32_16x16x32_bf16 a[16:19], v[48:51], v[64:67], a[16:19]
    v_mfma_f32_16x16x32_bf16 a[48:51], v[48:51], v[68:71], a[48:51]
    ds_read_b64_tr_b16 v[48:49], v14 offset:40960
    ds_read_b64_tr_b16 v[50:51], v14 offset:45056
    s_waitcnt lgkmcnt(12)
    v_mfma_f32_16x16x32_bf16 a[20:23], v[52:55], v[64:67], a[20:23]
    v_mfma_f32_16x16x32_bf16 a[52:55], v[52:55], v[68:71], a[52:55]
    ds_read_b64_tr_b16 v[52:53], v15 offset:40960
    ds_read_b64_tr_b16 v[54:55], v15 offset:45056
    s_waitcnt lgkmcnt(12)
    v_mfma_f32_16x16x32_bf16 a[24:27], v[56:59], v[64:67], a[24:27]
    v_mfma_f32_16x16x32_bf16 a[56:59], v[56:59], v[68:71], a[56:59]
    ds_read_b64_tr_b16 v[56:57], v16 offset:40960
    ds_read_b64_tr_b16 v[58:59], v16 offset:45056
    s_waitcnt lgkmcnt(12)
    v_mfma_f32_16x16x32_bf16 a[28:31], v[60:63], v[64:67], a[28:31]
    v_mfma_f32_16x16x32_bf16 a[60:63], v[60:63], v[68:71], a[60:63]
    ds_read_b64_tr_b16 v[60:61], v17 offset:40960
    ds_read_b64_tr_b16 v[62:63], v17 offset:45056
    s_waitcnt lgkmcnt(10)
    v_mfma_f32_16x16x32_bf16 a[0:3], v[40:43], v[72:75], a[0:3]
    v_mfma_f32_16x16x32_bf16 a[32:35], v[40:43], v[76:79], a[32:35]
    v_mfma_f32_16x16x32_bf16 a[64:67], v[40:43], v[36:39], a[64:67]
    ds_read_b64_tr_b16 v[40:41], v18 offset:40960
    ds_read_b64_tr_b16 v[42:43], v18 offset:45056
    s_waitcnt lgkmcnt(10)
    v_mfma_f32_16x16x32_bf16 a[4:7], v[44:47], v[72:75], a[4:7]
    v_mfma_f32_16x16x32_bf16 a[36:39], v[44:47], v[76:79], a[36:39]
    v_mfma_f32_16x16x32_bf16 a[68:71], v[44:47], v[36:39], a[68:71]
    ds_read_b64_tr_b16 v[44:45], v19 offset:40960
    ds_read_b64_tr_b16 v[46:47], v19 offset:45056
    s_waitcnt lgkmcnt(10)
    v_mfma_f32_16x16x32_bf16 a[8:11], v[48:51], v[72:75], a[8:11]
    v_mfma_f32_16x16x32_bf16 a[40:43], v[48:51], v[76:79], a[40:43]
    v_mfma_f32_16x16x32_bf16 a[72:75], v[36:39], v[72:75], a[72:75]
    v_mfma_f32_16x16x32_bf16 a[76:79], v[36:39], v[76:79], a[76:79]
    s_barrier
    ds_read_b128 v[64:67], v20 offset:0
    ds_read_b128 v[68:71], v20 offset:2048
    ds_read_b64_tr_b16 v[48:49], v4 offset:0
    ds_read_b64_tr_b16 v[50:51], v4 offset:4096
    s_waitcnt lgkmcnt(12)
    v_mfma_f32_16x16x32_bf16 a[12:15], v[52:55], v[72:75], a[12:15]
    v_mfma_f32_16x16x32_bf16 a[44:47], v[52:55], v[76:79], a[44:47]
    v_mfma_f32_16x16x32_bf16 a[80:83], v[72:75], v[72:75], a[80:83]
    v_mfma_f32_16x16x32_bf16 a[84:87], v[76:79], v[76:79], a[84:87]
    ds_read_b64_tr_b16 v[52:53], v5 offset:0
    ds_read_b64_tr_b16 v[54:55], v5 offset:4096
    s_waitcnt lgkmcnt(12)
    v_mfma_f32_16x16x32_bf16 a[16:19], v[56:59], v[72:75], a[16:19]
    v_mfma_f32_16x16x32_bf16 a[48:51], v[56:59], v[76:79], a[48:51]
    ds_read_b64_tr_b16 v[56:57], v6 offset:0
    ds_read_b64_tr_b16 v[58:59], v6 offset:4096
    s_waitcnt lgkmcnt(12)
    v_mfma_f32_16x16x32_bf16 a[20:23], v[60:63], v[72:75], a[20:23]
    v_mfma_f32_16x16x32_bf16 a[52:55], v[60:63], v[76:79], a[52:55]
    ds_read_b64_tr_b16 v[60:61], v7 offset:0
    ds_read_b64_tr_b16 v[62:63], v7 offset:4096
    s_waitcnt lgkmcnt(12)
    v_mfma_f32_16x16x32_bf16 a[24:27], v[40:43], v[72:75], a[24:27]
    v_mfma_f32_16x16x32_bf16 a[56:59], v[40:43], v[76:79], a[56:59]
    ds_read_b64_tr_b16 v[40:41], v8 offset:0
    ds_read_b64_tr_b16 v[42:43], v8 offset:4096
    s_waitcnt lgkmcnt(12)
    v_mfma_f32_16x16x32_bf16 a[28:31], v[44:47], v[72:75], a[28:31]
    v_mfma_f32_16x16x32_bf16 a[60:63], v[44:47], v[76:79], a[60:63]
    ds_read_b64_tr_b16 v[44:45], v9 offset:0
    ds_read_b64_tr_b16 v[46:47], v9 offset:4096
    s_waitcnt lgkmcnt(10)
    v_mfma_f32_16x16x32_bf16 a[0:3], v[48:51], v[64:67], a[0:3]
    v_mfma_f32_16x16x32_bf16 a[32:35], v[48:51], v[68:71], a[32:35]
    v_mfma_f32_16x16x32_bf16 a[64:67], v[48:51], v[36:39], a[64:67]
    ds_read_b64_tr_b16 v[48:49], v10 offset:0
    ds_read_b64_tr_b16 v[50:51], v10 offset:4096
    s_waitcnt lgkmcnt(10)
    v_mfma_f32_16x16x32_bf16 a[4:7], v[52:55], v[64:67], a[4:7]
    v_mfma_f32_16x16x32_bf16 a[36:39], v[52:55], v[68:71], a[36:39]
    v_mfma_f32_16x16x32_bf16 a[68:71], v[52:55], v[36:39], a[68:71]
    ds_read_b64_tr_b16 v[52:53], v11 offset:0
    ds_read_b64_tr_b16 v[54:55], v11 offset:4096
    s_waitcnt lgkmcnt(10)
    v_mfma_f32_16x16x32_bf16 a[8:11], v[56:59], v[64:67], a[8:11]
    v_mfma_f32_16x16x32_bf16 a[40:43], v[56:59], v[68:71], a[40:43]
    v_mfma_f32_16x16x32_bf16 a[72:75], v[36:39], v[64:67], a[72:75]
    v_mfma_f32_16x16x32_bf16 a[76:79], v[36:39], v[68:71], a[76:79]
    ds_read_b128 v[72:75], v21 offset:0
    ds_read_b128 v[76:79], v21 offset:2048
    ds_read_b64_tr_b16 v[56:57], v4 offset:8192
    ds_read_b64_tr_b16 v[58:59], v4 offset:12288
    s_waitcnt lgkmcnt(12)
    v_mfma_f32_16x16x32_bf16 a[12:15], v[60:63], v[64:67], a[12:15]
    v_mfma_f32_16x16x32_bf16 a[44:47], v[60:63], v[68:71], a[44:47]
    v_mfma_f32_16x16x32_bf16 a[80:83], v[64:67], v[64:67], a[80:83]
    v_mfma_f32_16x16x32_bf16 a[84:87], v[68:71], v[68:71], a[84:87]
    ds_read_b64_tr_b16 v[60:61], v5 offset:8192
    ds_read_b64_tr_b16 v[62:63], v5 offset:12288
    s_waitcnt lgkmcnt(12)
    v_mfma_f32_16x16x32_bf16 a[16:19], v[40:43], v[64:67], a[16:19]
    v_mfma_f32_16x16x32_bf16 a[48:51], v[40:43], v[68:71], a[48:51]
    ds_read_b64_tr_b16 v[40:41], v6 offset:8192
    ds_read_b64_tr_b16 v[42:43], v6 offset:12288
    s_waitcnt lgkmcnt(12)
    v_mfma_f32_16x16x32_bf16 a[20:23], v[44:47], v[64:67], a[20:23]
    v_mfma_f32_16x16x32_bf16 a[52:55], v[44:47], v[68:71], a[52:55]
    ds_read_b64_tr_b16 v[44:45], v7 offset:8192
    ds_read_b64_tr_b16 v[46:47], v7 offset:12288
    s_waitcnt lgkmcnt(12)
    v_mfma_f32_16x16x32_bf16 a[24:27], v[48:51], v[64:67], a[24:27]
    v_mfma_f32_16x16x32_bf16 a[56:59], v[48:51], v[68:71], a[56:59]
    ds_read_b64_tr_b16 v[48:49], v8 offset:8192
    ds_read_b64_tr_b16 v[50:51], v8 offset:12288
    s_waitcnt lgkmcnt(12)
    v_mfma_f32_16x16x32_bf16 a[28:31], v[52:55], v[64:67], a[28:31]
    v_mfma_f32_16x16x32_bf16 a[60:63], v[52:55], v[68:71], a[60:63]
    ds_read_b64_tr_b16 v[52:53], v9 offset:8192
    ds_read_b64_tr_b16 v[54:55], v9 offset:12288
    s_waitcnt lgkmcnt(10)
    v_mfma_f32_16x16x32_bf16 a[0:3], v[56:59], v[72:75], a[0:3]
    v_mfma_f32_16x16x32_bf16 a[32:35], v[56:59], v[76:79], a[32:35]
    v_mfma_f32_16x16x32_bf16 a[64:67], v[56:59], v[36:39], a[64:67]
    ds_read_b64_tr_b16 v[56:57], v10 offset:8192
    ds_read_b64_tr_b16 v[58:59], v10 offset:12288
    s_waitcnt lgkmcnt(10)
    v_mfma_f32_16x16x32_bf16 a[4:7], v[60:63], v[72:75], a[4:7]
    v_mfma_f32_16x16x32_bf16 a[36:39], v[60:63], v[76:79], a[36:39]
    v_mfma_f32_16x16x32_bf16 a[68:71], v[60:63], v[36:39], a[68:71]
    ds_read_b64_tr_b16 v[60:61], v11 offset:8192
    ds_read_b64_tr_b16 v[62:63], v11 offset:12288
    s_waitcnt lgkmcnt(10)
    v_mfma_f32_16x16x32_bf16 a[8:11], v[40:43], v[72:75], a[8:11]
    v_mfma_f32_16x16x32_bf16 a[40:43], v[40:43], v[76:79], a[40:43]
    v_mfma_f32_16x16x32_bf16 a[72:75], v[36:39], v[72:75], a[72:75]
    v_mfma_f32_16x16x32_bf16 a[76:79], v[36:39], v[76:79], a[76:79]
    s_barrier
    ds_read_b128 v[64:67], v20 offset:32768
    ds_read_b128 v[68:71], v20 offset:34816
    ds_read_b64_tr_b16 v[40:41], v4 offset:32768
    ds_read_b64_tr_b16 v[42:43], v4 offset:36864
    s_waitcnt lgkmcnt(12)
    v_mfma_f32_16x16x32_bf16 a[12:15], v[44:47], v[72:75], a[12:15]
    v_mfma_f32_16x16x32_bf16 a[44:47], v[44:47], v[76:79], a[44:47]
    v_mfma_f32_16x16x32_bf16 a[80:83], v[72:75], v[72:75], a[80:83]
    v_mfma_f32_16x16x32_bf16 a[84:87], v[76:79], v[76:79], a[84:87]
    ds_read_b64_tr_b16 v[44:45], v5 offset:32768
    ds_read_b64_tr_b16 v[46:47], v5 offset:36864
    s_waitcnt lgkmcnt(12)
    v_mfma_f32_16x16x32_bf16 a[16:19], v[48:51], v[72:75], a[16:19]
    v_mfma_f32_16x16x32_bf16 a[48:51], v[48:51], v[76:79], a[48:51]
    ds_read_b64_tr_b16 v[48:49], v6 offset:32768
    ds_read_b64_tr_b16 v[50:51], v6 offset:36864
    s_waitcnt lgkmcnt(12)
    v_mfma_f32_16x16x32_bf16 a[20:23], v[52:55], v[72:75], a[20:23]
    v_mfma_f32_16x16x32_bf16 a[52:55], v[52:55], v[76:79], a[52:55]
    ds_read_b64_tr_b16 v[52:53], v7 offset:32768
    ds_read_b64_tr_b16 v[54:55], v7 offset:36864
    s_waitcnt lgkmcnt(12)
    v_mfma_f32_16x16x32_bf16 a[24:27], v[56:59], v[72:75], a[24:27]
    v_mfma_f32_16x16x32_bf16 a[56:59], v[56:59], v[76:79], a[56:59]
    ds_read_b64_tr_b16 v[56:57], v8 offset:32768
    ds_read_b64_tr_b16 v[58:59], v8 offset:36864
    s_waitcnt lgkmcnt(12)
    v_mfma_f32_16x16x32_bf16 a[28:31], v[60:63], v[72:75], a[28:31]
    v_mfma_f32_16x16x32_bf16 a[60:63], v[60:63], v[76:79], a[60:63]
    ds_read_b64_tr_b16 v[60:61], v9 offset:32768
    ds_read_b64_tr_b16 v[62:63], v9 offset:36864
    s_waitcnt lgkmcnt(10)
    v_mfma_f32_16x16x32_bf16 a[0:3], v[40:43], v[64:67], a[0:3]
    v_mfma_f32_16x16x32_bf16 a[32:35], v[40:43], v[68:71], a[32:35]
    v_mfma_f32_16x16x32_bf16 a[64:67], v[40:43], v[36:39], a[64:67]
    ds_read_b64_tr_b16 v[40:41], v10 offset:32768
    ds_read_b64_tr_b16 v[42:43], v10 offset:36864
    s_waitcnt lgkmcnt(10)
    v_mfma_f32_16x16x32_bf16 a[4:7], v[44:47], v[64:67], a[4:7]
    v_mfma_f32_16x16x32_bf16 a[36:39], v[44:47], v[68:71], a[36:39]
    v_mfma_f32_16x16x32_bf16 a[68:71], v[44:47], v[36:39], a[68:71]
    ds_read_b64_tr_b16 v[44:45], v11 offset:32768
    ds_read_b64_tr_b16 v[46:47], v11 offset:36864
    s_waitcnt lgkmcnt(10)
    v_mfma_f32_16x16x32_bf16 a[8:11], v[48:51], v[64:67], a[8:11]
    v_mfma_f32_16x16x32_bf16 a[40:43], v[48:51], v[68:71], a[40:43]
    v_mfma_f32_16x16x32_bf16 a[72:75], v[36:39], v[64:67], a[72:75]
    v_mfma_f32_16x16x32_bf16 a[76:79], v[36:39], v[68:71], a[76:79]
    ds_read_b128 v[72:75], v21 offset:32768
    ds_read_b128 v[76:79], v21 offset:34816
    ds_read_b64_tr_b16 v[48:49], v4 offset:40960
    ds_read_b64_tr_b16 v[50:51], v4 offset:45056
    s_waitcnt lgkmcnt(12)
    v_mfma_f32_16x16x32_bf16 a[12:15], v[52:55], v[64:67], a[12:15]
    v_mfma_f32_16x16x32_bf16 a[44:47], v[52:55], v[68:71], a[44:47]
    v_mfma_f32_16x16x32_bf16 a[80:83], v[64:67], v[64:67], a[80:83]
    v_mfma_f32_16x16x32_bf16 a[84:87], v[68:71], v[68:71], a[84:87]
    ds_read_b64_tr_b16 v[52:53], v5 offset:40960
    ds_read_b64_tr_b16 v[54:55], v5 offset:45056
    s_waitcnt lgkmcnt(12)
    v_mfma_f32_16x16x32_bf16 a[16:19], v[56:59], v[64:67], a[16:19]
    v_mfma_f32_16x16x32_bf16 a[48:51], v[56:59], v[68:71], a[48:51]
    ds_read_b64_tr_b16 v[56:57], v6 offset:40960
    ds_read_b64_tr_b16 v[58:59], v6 offset:45056
    s_waitcnt lgkmcnt(12)
    v_mfma_f32_16x16x32_bf16 a[20:23], v[60:63], v[64:67], a[20:23]
    v_mfma_f32_16x16x32_bf16 a[52:55], v[60:63], v[68:71], a[52:55]
    ds_read_b64_tr_b16 v[60:61], v7 offset:40960
    ds_read_b64_tr_b16 v[62:63], v7 offset:45056
    s_waitcnt lgkmcnt(12)
    v_mfma_f32_16x16x32_bf16 a[24:27], v[40:43], v[64:67], a[24:27]
    v_mfma_f32_16x16x32_bf16 a[56:59], v[40:43], v[68:71], a[56:59]
    ds_read_b64_tr_b16 v[40:41], v8 offset:40960
    ds_read_b64_tr_b16 v[42:43], v8 offset:45056
    s_waitcnt lgkmcnt(12)
    v_mfma_f32_16x16x32_bf16 a[28:31], v[44:47], v[64:67], a[28:31]
    v_mfma_f32_16x16x32_bf16 a[60:63], v[44:47], v[68:71], a[60:63]
    ds_read_b64_tr_b16 v[44:45], v9 offset:40960
    ds_read_b64_tr_b16 v[46:47], v9 offset:45056
    s_waitcnt lgkmcnt(10)
    v_mfma_f32_16x16x32_bf16 a[0:3], v[48:51], v[72:75], a[0:3]
    v_mfma_f32_16x16x32_bf16 a[32:35], v[48:51], v[76:79], a[32:35]
    v_mfma_f32_16x16x32_bf16 a[64:67], v[48:51], v[36:39], a[64:67]
    ds_read_b64_tr_b16 v[48:49], v10 offset:40960
    ds_read_b64_tr_b16 v[50:51], v10 offset:45056
    s_waitcnt lgkmcnt(10)
    v_mfma_f32_16x16x32_bf16 a[4:7], v[52:55], v[72:75], a[4:7]
    v_mfma_f32_16x16x32_bf16 a[36:39], v[52:55], v[76:79], a[36:39]
    v_mfma_f32_16x16x32_bf16 a[68:71], v[52:55], v[36:39], a[68:71]
    ds_read_b64_tr_b16 v[52:53], v11 offset:40960
    ds_read_b64_tr_b16 v[54:55], v11 offset:45056
    s_waitcnt lgkmcnt(10)
    v_mfma_f32_16x16x32_bf16 a[8:11], v[56:59], v[72:75], a[8:11]
    v_mfma_f32_16x16x32_bf16 a[40:43], v[56:59], v[76:79], a[40:43]
    v_mfma_f32_16x16x32_bf16 a[72:75], v[36:39], v[72:75], a[72:75]
    v_mfma_f32_16x16x32_bf16 a[76:79], v[36:39], v[76:79], a[76:79]
    s_waitcnt lgkmcnt(8)
    v_mfma_f32_16x16x32_bf16 a[12:15], v[60:63], v[72:75], a[12:15]
    v_mfma_f32_16x16x32_bf16 a[44:47], v[60:63], v[76:79], a[44:47]
    v_mfma_f32_16x16x32_bf16 a[80:83], v[72:75], v[72:75], a[80:83]
    v_mfma_f32_16x16x32_bf16 a[84:87], v[76:79], v[76:79], a[84:87]
    s_waitcnt lgkmcnt(6)
    v_mfma_f32_16x16x32_bf16 a[16:19], v[40:43], v[72:75], a[16:19]
    v_mfma_f32_16x16x32_bf16 a[48:51], v[40:43], v[76:79], a[48:51]
    s_waitcnt lgkmcnt(4)
    v_mfma_f32_16x16x32_bf16 a[20:23], v[44:47], v[72:75], a[20:23]
    v_mfma_f32_16x16x32_bf16 a[52:55], v[44:47], v[76:79], a[52:55]
    s_waitcnt lgkmcnt(2)
    v_mfma_f32_16x16x32_bf16 a[24:27], v[48:51], v[72:75], a[24:27]
    v_mfma_f32_16x16x32_bf16 a[56:59], v[48:51], v[76:79], a[56:59]
    s_waitcnt lgkmcnt(0)
    v_mfma_f32_16x16x32_bf16 a[28:31], v[52:55], v[72:75], a[28:31]
    v_mfma_f32_16x16x32_bf16 a[60:63], v[52:55], v[76:79], a[60:63]
    s_nop 7
    s_nop 1
    v_lshlrev_b32 v112, 4, v3
    v_cmp_eq_u32 vcc, 0, v2
    v_add_u32 v112, 0x20000, v112
    s_lshl_b32 s37, s48, 6
    v_add_u32 v83, s37, v112
    s_lshl_b32 s37, s49, 6
    v_add_u32 v87, s37, v112
    s_lshl_b32 s37, s50, 6
    v_add_u32 v91, s37, v112
    s_lshl_b32 s37, s51, 6
    v_add_u32 v95, s37, v112
    s_lshl_b32 s37, s52, 6
    v_add_u32 v99, s37, v112
    s_lshl_b32 s37, s53, 6
    v_add_u32 v103, s37, v112
    s_lshl_b32 s37, s54, 6
    v_add_u32 v107, s37, v112
    s_lshl_b32 s37, s55, 6
    v_add_u32 v111, s37, v112
    s_and_saveexec_b64 s[44:45], vcc
    v_accvgpr_read_b32 v116, a64
    v_accvgpr_read_b32 v117, a65
    v_accvgpr_read_b32 v118, a66
    v_accvgpr_read_b32 v119, a67
    ds_write_b128 v83, v[116:119]
    v_accvgpr_read_b32 v116, a68
    v_accvgpr_read_b32 v117, a69
    v_accvgpr_read_b32 v118, a70
    v_accvgpr_read_b32 v119, a71
    ds_write_b128 v87, v[116:119]
    s_mov_b64 exec, s[44:45]
    s_mov_b32 s37, 0x3acccccd
    s_mov_b32 s38, 0x3727c5ac
    v_and_b32 v33, 3, v2
    v_lshrrev_b32 v32, 2, v2
    v_cmp_eq_u32 s[44:45], v32, v3
    v_add_u32 v34, s56, v2
    v_lshlrev_b32 v35, 2, v34
    v_add_u32 v35, 0x20400, v35
    v_accvgpr_read_b32 v40, a72
    v_accvgpr_read_b32 v41, a80
    v_accvgpr_read_b32 v30, a81
    v_cmp_eq_u32 vcc, 1, v33
    s_nop 1
    v_cndmask_b32 v41, v41, v30, vcc
    v_accvgpr_read_b32 v30, a82
    v_cmp_eq_u32 vcc, 2, v33
    s_nop 1
    v_cndmask_b32 v41, v41, v30, vcc
    v_accvgpr_read_b32 v30, a83
    v_cmp_eq_u32 vcc, 3, v33
    s_nop 1
    v_cndmask_b32 v41, v41, v30, vcc
    v_mul_f32 v40, s37, v40
    v_mul_f32 v41, s37, v41
    v_fma_f32 v41, -v40, v40, v41
    v_max_f32 v41, 0, v41
    v_cvt_pk_bf16_f32 v24, v40, v40
    v_lshlrev_b32 v42, 16, v24
    v_cvt_pk_bf16_f32 v24, v41, v41
    v_lshlrev_b32 v25, 16, v24
    v_add_f32 v25, s38, v25
    v_cvt_pk_bf16_f32 v24, v25, v25
    v_lshlrev_b32 v25, 16, v24
    v_sqrt_f32 v25, v25
    s_nop 0
    v_cvt_pk_bf16_f32 v24, v25, v25
    v_lshlrev_b32 v25, 16, v24
    v_rcp_f32 v43, v25
    s_nop 0
    v_mov_b32 v28, v43
    v_mul_f32 v29, v42, v43
    s_mov_b64 s[90:91], exec
    s_mov_b64 exec, s[44:45]
    ds_write_b32 v35, v28 offset:0
    ds_write_b32 v35, v29 offset:512
    s_mov_b64 exec, s[90:91]
    v_accvgpr_read_b32 v40, a76
    v_accvgpr_read_b32 v41, a84
    v_accvgpr_read_b32 v30, a85
    v_cmp_eq_u32 vcc, 1, v33
    s_nop 1
    v_cndmask_b32 v41, v41, v30, vcc
    v_accvgpr_read_b32 v30, a86
    v_cmp_eq_u32 vcc, 2, v33
    s_nop 1
    v_cndmask_b32 v41, v41, v30, vcc
    v_accvgpr_read_b32 v30, a87
    v_cmp_eq_u32 vcc, 3, v33
    s_nop 1
    v_cndmask_b32 v41, v41, v30, vcc
    v_mul_f32 v40, s37, v40
    v_mul_f32 v41, s37, v41
    v_fma_f32 v41, -v40, v40, v41
    v_max_f32 v41, 0, v41
    v_cvt_pk_bf16_f32 v24, v40, v40
    v_lshlrev_b32 v42, 16, v24
    v_cvt_pk_bf16_f32 v24, v41, v41
    v_lshlrev_b32 v25, 16, v24
    v_add_f32 v25, s38, v25
    v_cvt_pk_bf16_f32 v24, v25, v25
    v_lshlrev_b32 v25, 16, v24
    v_sqrt_f32 v25, v25
    s_nop 0
    v_cvt_pk_bf16_f32 v24, v25, v25
    v_lshlrev_b32 v25, 16, v24
    v_rcp_f32 v43, v25
    s_nop 0
    v_mov_b32 v28, v43
    v_mul_f32 v29, v42, v43
    s_mov_b64 s[90:91], exec
    s_mov_b64 exec, s[44:45]
    ds_write_b32 v35, v28 offset:64
    ds_write_b32 v35, v29 offset:576
    s_mov_b64 exec, s[90:91]
    s_waitcnt lgkmcnt(0)
    s_barrier
    ds_read_b128 v[80:83], v83
    ds_read_b128 v[84:87], v87
    ds_read_b128 v[88:91], v91
    ds_read_b128 v[92:95], v95
    ds_read_b128 v[96:99], v99
    ds_read_b128 v[100:103], v103
    ds_read_b128 v[104:107], v107
    ds_read_b128 v[108:111], v111
    v_add_u32 v112, s56, v2
    v_lshlrev_b32 v112, 2, v112
    v_add_u32 v112, 0x20400, v112
    ds_read_b32 v136, v112 offset:0
    ds_read_b32 v144, v112 offset:512
    ds_read_b32 v140, v112 offset:64
    ds_read_b32 v148, v112 offset:576
    s_waitcnt lgkmcnt(0)
    v_mov_b32 v137, v136
    v_sub_f32 v144, 0, v144
    v_mov_b32 v145, v144
    v_mov_b32 v141, v140
    v_sub_f32 v148, 0, v148
    v_mov_b32 v149, v148
    v_add_u32 v112, s56, v2
    v_mul_u32_u24 v112, 272, v112
    v_lshl_add_u32 v112, v3, 3, v112
    s_mul_i32 s37, s48, 32
    v_add_u32 v113, s37, v112
    v_accvgpr_read_b32 v116, a0
    v_accvgpr_read_b32 v117, a1
    v_accvgpr_read_b32 v118, a2
    v_accvgpr_read_b32 v119, a3
    v_pk_mul_f32 v[116:117], v[116:117], v[136:137]
    v_pk_mul_f32 v[118:119], v[118:119], v[136:137]
    v_pk_fma_f32 v[116:117], v[144:145], v[80:81], v[116:117]
    v_pk_fma_f32 v[118:119], v[144:145], v[82:83], v[118:119]
    v_cvt_pk_bf16_f32 v120, v116, v117
    v_cvt_pk_bf16_f32 v121, v118, v119
    ds_write_b64 v113, v[120:121] offset:0
    v_accvgpr_read_b32 v124, a32
    v_accvgpr_read_b32 v125, a33
    v_accvgpr_read_b32 v126, a34
    v_accvgpr_read_b32 v127, a35
    v_pk_mul_f32 v[124:125], v[124:125], v[140:141]
    v_pk_mul_f32 v[126:127], v[126:127], v[140:141]
    v_pk_fma_f32 v[124:125], v[148:149], v[80:81], v[124:125]
    v_pk_fma_f32 v[126:127], v[148:149], v[82:83], v[126:127]
    v_cvt_pk_bf16_f32 v128, v124, v125
    v_cvt_pk_bf16_f32 v129, v126, v127
    ds_write_b64 v113, v[128:129] offset:4352
    s_mul_i32 s37, s49, 32
    v_add_u32 v113, s37, v112
    v_accvgpr_read_b32 v116, a4
    v_accvgpr_read_b32 v117, a5
    v_accvgpr_read_b32 v118, a6
    v_accvgpr_read_b32 v119, a7
    v_pk_mul_f32 v[116:117], v[116:117], v[136:137]
    v_pk_mul_f32 v[118:119], v[118:119], v[136:137]
    v_pk_fma_f32 v[116:117], v[144:145], v[84:85], v[116:117]
    v_pk_fma_f32 v[118:119], v[144:145], v[86:87], v[118:119]
    v_cvt_pk_bf16_f32 v120, v116, v117
    v_cvt_pk_bf16_f32 v121, v118, v119
    ds_write_b64 v113, v[120:121] offset:0
    v_accvgpr_read_b32 v124, a36
    v_accvgpr_read_b32 v125, a37
    v_accvgpr_read_b32 v126, a38
    v_accvgpr_read_b32 v127, a39
    v_pk_mul_f32 v[124:125], v[124:125], v[140:141]
    v_pk_mul_f32 v[126:127], v[126:127], v[140:141]
    v_pk_fma_f32 v[124:125], v[148:149], v[84:85], v[124:125]
    v_pk_fma_f32 v[126:127], v[148:149], v[86:87], v[126:127]
    v_cvt_pk_bf16_f32 v128, v124, v125
    v_cvt_pk_bf16_f32 v129, v126, v127
    ds_write_b64 v113, v[128:129] offset:4352
    s_mul_i32 s37, s50, 32
    v_add_u32 v113, s37, v112
    v_accvgpr_read_b32 v116, a8
    v_accvgpr_read_b32 v117, a9
    v_accvgpr_read_b32 v118, a10
    v_accvgpr_read_b32 v119, a11
    v_pk_mul_f32 v[116:117], v[116:117], v[136:137]
    v_pk_mul_f32 v[118:119], v[118:119], v[136:137]
    v_pk_fma_f32 v[116:117], v[144:145], v[88:89], v[116:117]
    v_pk_fma_f32 v[118:119], v[144:145], v[90:91], v[118:119]
    v_cvt_pk_bf16_f32 v120, v116, v117
    v_cvt_pk_bf16_f32 v121, v118, v119
    ds_write_b64 v113, v[120:121] offset:0
    v_accvgpr_read_b32 v124, a40
    v_accvgpr_read_b32 v125, a41
    v_accvgpr_read_b32 v126, a42
    v_accvgpr_read_b32 v127, a43
    v_pk_mul_f32 v[124:125], v[124:125], v[140:141]
    v_pk_mul_f32 v[126:127], v[126:127], v[140:141]
    v_pk_fma_f32 v[124:125], v[148:149], v[88:89], v[124:125]
    v_pk_fma_f32 v[126:127], v[148:149], v[90:91], v[126:127]
    v_cvt_pk_bf16_f32 v128, v124, v125
    v_cvt_pk_bf16_f32 v129, v126, v127
    ds_write_b64 v113, v[128:129] offset:4352
    s_mul_i32 s37, s51, 32
    v_add_u32 v113, s37, v112
    v_accvgpr_read_b32 v116, a12
    v_accvgpr_read_b32 v117, a13
    v_accvgpr_read_b32 v118, a14
    v_accvgpr_read_b32 v119, a15
    v_pk_mul_f32 v[116:117], v[116:117], v[136:137]
    v_pk_mul_f32 v[118:119], v[118:119], v[136:137]
    v_pk_fma_f32 v[116:117], v[144:145], v[92:93], v[116:117]
    v_pk_fma_f32 v[118:119], v[144:145], v[94:95], v[118:119]
    v_cvt_pk_bf16_f32 v120, v116, v117
    v_cvt_pk_bf16_f32 v121, v118, v119
    ds_write_b64 v113, v[120:121] offset:0
    v_accvgpr_read_b32 v124, a44
    v_accvgpr_read_b32 v125, a45
    v_accvgpr_read_b32 v126, a46
    v_accvgpr_read_b32 v127, a47
    v_pk_mul_f32 v[124:125], v[124:125], v[140:141]
    v_pk_mul_f32 v[126:127], v[126:127], v[140:141]
    v_pk_fma_f32 v[124:125], v[148:149], v[92:93], v[124:125]
    v_pk_fma_f32 v[126:127], v[148:149], v[94:95], v[126:127]
    v_cvt_pk_bf16_f32 v128, v124, v125
    v_cvt_pk_bf16_f32 v129, v126, v127
    ds_write_b64 v113, v[128:129] offset:4352
    s_mul_i32 s37, s52, 32
    v_add_u32 v113, s37, v112
    v_accvgpr_read_b32 v116, a16
    v_accvgpr_read_b32 v117, a17
    v_accvgpr_read_b32 v118, a18
    v_accvgpr_read_b32 v119, a19
    v_pk_mul_f32 v[116:117], v[116:117], v[136:137]
    v_pk_mul_f32 v[118:119], v[118:119], v[136:137]
    v_pk_fma_f32 v[116:117], v[144:145], v[96:97], v[116:117]
    v_pk_fma_f32 v[118:119], v[144:145], v[98:99], v[118:119]
    v_cvt_pk_bf16_f32 v120, v116, v117
    v_cvt_pk_bf16_f32 v121, v118, v119
    ds_write_b64 v113, v[120:121] offset:0
    v_accvgpr_read_b32 v124, a48
    v_accvgpr_read_b32 v125, a49
    v_accvgpr_read_b32 v126, a50
    v_accvgpr_read_b32 v127, a51
    v_pk_mul_f32 v[124:125], v[124:125], v[140:141]
    v_pk_mul_f32 v[126:127], v[126:127], v[140:141]
    v_pk_fma_f32 v[124:125], v[148:149], v[96:97], v[124:125]
    v_pk_fma_f32 v[126:127], v[148:149], v[98:99], v[126:127]
    v_cvt_pk_bf16_f32 v128, v124, v125
    v_cvt_pk_bf16_f32 v129, v126, v127
    ds_write_b64 v113, v[128:129] offset:4352
    s_mul_i32 s37, s53, 32
    v_add_u32 v113, s37, v112
    v_accvgpr_read_b32 v116, a20
    v_accvgpr_read_b32 v117, a21
    v_accvgpr_read_b32 v118, a22
    v_accvgpr_read_b32 v119, a23
    v_pk_mul_f32 v[116:117], v[116:117], v[136:137]
    v_pk_mul_f32 v[118:119], v[118:119], v[136:137]
    v_pk_fma_f32 v[116:117], v[144:145], v[100:101], v[116:117]
    v_pk_fma_f32 v[118:119], v[144:145], v[102:103], v[118:119]
    v_cvt_pk_bf16_f32 v120, v116, v117
    v_cvt_pk_bf16_f32 v121, v118, v119
    ds_write_b64 v113, v[120:121] offset:0
    v_accvgpr_read_b32 v124, a52
    v_accvgpr_read_b32 v125, a53
    v_accvgpr_read_b32 v126, a54
    v_accvgpr_read_b32 v127, a55
    v_pk_mul_f32 v[124:125], v[124:125], v[140:141]
    v_pk_mul_f32 v[126:127], v[126:127], v[140:141]
    v_pk_fma_f32 v[124:125], v[148:149], v[100:101], v[124:125]
    v_pk_fma_f32 v[126:127], v[148:149], v[102:103], v[126:127]
    v_cvt_pk_bf16_f32 v128, v124, v125
    v_cvt_pk_bf16_f32 v129, v126, v127
    ds_write_b64 v113, v[128:129] offset:4352
    s_mul_i32 s37, s54, 32
    v_add_u32 v113, s37, v112
    v_accvgpr_read_b32 v116, a24
    v_accvgpr_read_b32 v117, a25
    v_accvgpr_read_b32 v118, a26
    v_accvgpr_read_b32 v119, a27
    v_pk_mul_f32 v[116:117], v[116:117], v[136:137]
    v_pk_mul_f32 v[118:119], v[118:119], v[136:137]
    v_pk_fma_f32 v[116:117], v[144:145], v[104:105], v[116:117]
    v_pk_fma_f32 v[118:119], v[144:145], v[106:107], v[118:119]
    v_cvt_pk_bf16_f32 v120, v116, v117
    v_cvt_pk_bf16_f32 v121, v118, v119
    ds_write_b64 v113, v[120:121] offset:0
    v_accvgpr_read_b32 v124, a56
    v_accvgpr_read_b32 v125, a57
    v_accvgpr_read_b32 v126, a58
    v_accvgpr_read_b32 v127, a59
    v_pk_mul_f32 v[124:125], v[124:125], v[140:141]
    v_pk_mul_f32 v[126:127], v[126:127], v[140:141]
    v_pk_fma_f32 v[124:125], v[148:149], v[104:105], v[124:125]
    v_pk_fma_f32 v[126:127], v[148:149], v[106:107], v[126:127]
    v_cvt_pk_bf16_f32 v128, v124, v125
    v_cvt_pk_bf16_f32 v129, v126, v127
    ds_write_b64 v113, v[128:129] offset:4352
    s_mul_i32 s37, s55, 32
    v_add_u32 v113, s37, v112
    v_accvgpr_read_b32 v116, a28
    v_accvgpr_read_b32 v117, a29
    v_accvgpr_read_b32 v118, a30
    v_accvgpr_read_b32 v119, a31
    v_pk_mul_f32 v[116:117], v[116:117], v[136:137]
    v_pk_mul_f32 v[118:119], v[118:119], v[136:137]
    v_pk_fma_f32 v[116:117], v[144:145], v[108:109], v[116:117]
    v_pk_fma_f32 v[118:119], v[144:145], v[110:111], v[118:119]
    v_cvt_pk_bf16_f32 v120, v116, v117
    v_cvt_pk_bf16_f32 v121, v118, v119
    ds_write_b64 v113, v[120:121] offset:0
    v_accvgpr_read_b32 v124, a60
    v_accvgpr_read_b32 v125, a61
    v_accvgpr_read_b32 v126, a62
    v_accvgpr_read_b32 v127, a63
    v_pk_mul_f32 v[124:125], v[124:125], v[140:141]
    v_pk_mul_f32 v[126:127], v[126:127], v[140:141]
    v_pk_fma_f32 v[124:125], v[148:149], v[108:109], v[124:125]
    v_pk_fma_f32 v[126:127], v[148:149], v[110:111], v[126:127]
    v_cvt_pk_bf16_f32 v128, v124, v125
    v_cvt_pk_bf16_f32 v129, v126, v127
    ds_write_b64 v113, v[128:129] offset:4352
    s_waitcnt lgkmcnt(0)
    s_branch k1_kernel_phase2
k1_kernel_vpath:
    s_barrier
    ds_read_b128 v[64:67], v20 offset:0
    ds_read_b128 v[68:71], v20 offset:2048
    ds_read_b64_tr_b16 v[40:41], v4 offset:0
    ds_read_b64_tr_b16 v[42:43], v4 offset:4096
    ds_read_b64_tr_b16 v[44:45], v5 offset:0
    ds_read_b64_tr_b16 v[46:47], v5 offset:4096
    ds_read_b64_tr_b16 v[48:49], v6 offset:0
    ds_read_b64_tr_b16 v[50:51], v6 offset:4096
    ds_read_b64_tr_b16 v[52:53], v7 offset:0
    ds_read_b64_tr_b16 v[54:55], v7 offset:4096
    ds_read_b64_tr_b16 v[56:57], v8 offset:0
    ds_read_b64_tr_b16 v[58:59], v8 offset:4096
    ds_read_b64_tr_b16 v[60:61], v9 offset:0
    ds_read_b64_tr_b16 v[62:63], v9 offset:4096
    s_waitcnt lgkmcnt(10)
    v_mfma_f32_16x16x32_bf16 a[0:3], v[64:67], v[40:43], a[0:3]
    v_mfma_f32_16x16x32_bf16 a[32:35], v[68:71], v[40:43], a[32:35]
    v_mfma_f32_16x16x32_bf16 a[64:67], v[36:39], v[40:43], a[64:67]
    ds_read_b64_tr_b16 v[40:41], v10 offset:0
    ds_read_b64_tr_b16 v[42:43], v10 offset:4096
    s_waitcnt lgkmcnt(10)
    v_mfma_f32_16x16x32_bf16 a[4:7], v[64:67], v[44:47], a[4:7]
    v_mfma_f32_16x16x32_bf16 a[36:39], v[68:71], v[44:47], a[36:39]
    v_mfma_f32_16x16x32_bf16 a[68:71], v[36:39], v[44:47], a[68:71]
    ds_read_b64_tr_b16 v[44:45], v11 offset:0
    ds_read_b64_tr_b16 v[46:47], v11 offset:4096
    s_waitcnt lgkmcnt(10)
    v_mfma_f32_16x16x32_bf16 a[8:11], v[64:67], v[48:51], a[8:11]
    v_mfma_f32_16x16x32_bf16 a[40:43], v[68:71], v[48:51], a[40:43]
    v_mfma_f32_16x16x32_bf16 a[72:75], v[36:39], v[64:67], a[72:75]
    v_mfma_f32_16x16x32_bf16 a[76:79], v[36:39], v[68:71], a[76:79]
    ds_read_b128 v[72:75], v21 offset:0
    ds_read_b128 v[76:79], v21 offset:2048
    ds_read_b64_tr_b16 v[48:49], v4 offset:8192
    ds_read_b64_tr_b16 v[50:51], v4 offset:12288
    s_waitcnt lgkmcnt(12)
    v_mfma_f32_16x16x32_bf16 a[12:15], v[64:67], v[52:55], a[12:15]
    v_mfma_f32_16x16x32_bf16 a[44:47], v[68:71], v[52:55], a[44:47]
    v_mfma_f32_16x16x32_bf16 a[80:83], v[64:67], v[64:67], a[80:83]
    v_mfma_f32_16x16x32_bf16 a[84:87], v[68:71], v[68:71], a[84:87]
    ds_read_b64_tr_b16 v[52:53], v5 offset:8192
    ds_read_b64_tr_b16 v[54:55], v5 offset:12288
    s_waitcnt lgkmcnt(12)
    v_mfma_f32_16x16x32_bf16 a[16:19], v[64:67], v[56:59], a[16:19]
    v_mfma_f32_16x16x32_bf16 a[48:51], v[68:71], v[56:59], a[48:51]
    ds_read_b64_tr_b16 v[56:57], v6 offset:8192
    ds_read_b64_tr_b16 v[58:59], v6 offset:12288
    s_waitcnt lgkmcnt(12)
    v_mfma_f32_16x16x32_bf16 a[20:23], v[64:67], v[60:63], a[20:23]
    v_mfma_f32_16x16x32_bf16 a[52:55], v[68:71], v[60:63], a[52:55]
    ds_read_b64_tr_b16 v[60:61], v7 offset:8192
    ds_read_b64_tr_b16 v[62:63], v7 offset:12288
    s_waitcnt lgkmcnt(12)
    v_mfma_f32_16x16x32_bf16 a[24:27], v[64:67], v[40:43], a[24:27]
    v_mfma_f32_16x16x32_bf16 a[56:59], v[68:71], v[40:43], a[56:59]
    ds_read_b64_tr_b16 v[40:41], v8 offset:8192
    ds_read_b64_tr_b16 v[42:43], v8 offset:12288
    s_waitcnt lgkmcnt(12)
    v_mfma_f32_16x16x32_bf16 a[28:31], v[64:67], v[44:47], a[28:31]
    v_mfma_f32_16x16x32_bf16 a[60:63], v[68:71], v[44:47], a[60:63]
    ds_read_b64_tr_b16 v[44:45], v9 offset:8192
    ds_read_b64_tr_b16 v[46:47], v9 offset:12288
    s_waitcnt lgkmcnt(10)
    v_mfma_f32_16x16x32_bf16 a[0:3], v[72:75], v[48:51], a[0:3]
    v_mfma_f32_16x16x32_bf16 a[32:35], v[76:79], v[48:51], a[32:35]
    v_mfma_f32_16x16x32_bf16 a[64:67], v[36:39], v[48:51], a[64:67]
    ds_read_b64_tr_b16 v[48:49], v10 offset:8192
    ds_read_b64_tr_b16 v[50:51], v10 offset:12288
    s_waitcnt lgkmcnt(10)
    v_mfma_f32_16x16x32_bf16 a[4:7], v[72:75], v[52:55], a[4:7]
    v_mfma_f32_16x16x32_bf16 a[36:39], v[76:79], v[52:55], a[36:39]
    v_mfma_f32_16x16x32_bf16 a[68:71], v[36:39], v[52:55], a[68:71]
    ds_read_b64_tr_b16 v[52:53], v11 offset:8192
    ds_read_b64_tr_b16 v[54:55], v11 offset:12288
    s_waitcnt lgkmcnt(10)
    v_mfma_f32_16x16x32_bf16 a[8:11], v[72:75], v[56:59], a[8:11]
    v_mfma_f32_16x16x32_bf16 a[40:43], v[76:79], v[56:59], a[40:43]
    v_mfma_f32_16x16x32_bf16 a[72:75], v[36:39], v[72:75], a[72:75]
    v_mfma_f32_16x16x32_bf16 a[76:79], v[36:39], v[76:79], a[76:79]
    s_barrier
    ds_read_b128 v[64:67], v20 offset:32768
    ds_read_b128 v[68:71], v20 offset:34816
    ds_read_b64_tr_b16 v[56:57], v4 offset:32768
    ds_read_b64_tr_b16 v[58:59], v4 offset:36864
    s_waitcnt lgkmcnt(12)
    v_mfma_f32_16x16x32_bf16 a[12:15], v[72:75], v[60:63], a[12:15]
    v_mfma_f32_16x16x32_bf16 a[44:47], v[76:79], v[60:63], a[44:47]
    v_mfma_f32_16x16x32_bf16 a[80:83], v[72:75], v[72:75], a[80:83]
    v_mfma_f32_16x16x32_bf16 a[84:87], v[76:79], v[76:79], a[84:87]
    ds_read_b64_tr_b16 v[60:61], v5 offset:32768
    ds_read_b64_tr_b16 v[62:63], v5 offset:36864
    s_waitcnt lgkmcnt(12)
    v_mfma_f32_16x16x32_bf16 a[16:19], v[72:75], v[40:43], a[16:19]
    v_mfma_f32_16x16x32_bf16 a[48:51], v[76:79], v[40:43], a[48:51]
    ds_read_b64_tr_b16 v[40:41], v6 offset:32768
    ds_read_b64_tr_b16 v[42:43], v6 offset:36864
    s_waitcnt lgkmcnt(12)
    v_mfma_f32_16x16x32_bf16 a[20:23], v[72:75], v[44:47], a[20:23]
    v_mfma_f32_16x16x32_bf16 a[52:55], v[76:79], v[44:47], a[52:55]
    ds_read_b64_tr_b16 v[44:45], v7 offset:32768
    ds_read_b64_tr_b16 v[46:47], v7 offset:36864
    s_waitcnt lgkmcnt(12)
    v_mfma_f32_16x16x32_bf16 a[24:27], v[72:75], v[48:51], a[24:27]
    v_mfma_f32_16x16x32_bf16 a[56:59], v[76:79], v[48:51], a[56:59]
    ds_read_b64_tr_b16 v[48:49], v8 offset:32768
    ds_read_b64_tr_b16 v[50:51], v8 offset:36864
    s_waitcnt lgkmcnt(12)
    v_mfma_f32_16x16x32_bf16 a[28:31], v[72:75], v[52:55], a[28:31]
    v_mfma_f32_16x16x32_bf16 a[60:63], v[76:79], v[52:55], a[60:63]
    ds_read_b64_tr_b16 v[52:53], v9 offset:32768
    ds_read_b64_tr_b16 v[54:55], v9 offset:36864
    s_waitcnt lgkmcnt(10)
    v_mfma_f32_16x16x32_bf16 a[0:3], v[64:67], v[56:59], a[0:3]
    v_mfma_f32_16x16x32_bf16 a[32:35], v[68:71], v[56:59], a[32:35]
    v_mfma_f32_16x16x32_bf16 a[64:67], v[36:39], v[56:59], a[64:67]
    ds_read_b64_tr_b16 v[56:57], v10 offset:32768
    ds_read_b64_tr_b16 v[58:59], v10 offset:36864
    s_waitcnt lgkmcnt(10)
    v_mfma_f32_16x16x32_bf16 a[4:7], v[64:67], v[60:63], a[4:7]
    v_mfma_f32_16x16x32_bf16 a[36:39], v[68:71], v[60:63], a[36:39]
    v_mfma_f32_16x16x32_bf16 a[68:71], v[36:39], v[60:63], a[68:71]
    ds_read_b64_tr_b16 v[60:61], v11 offset:32768
    ds_read_b64_tr_b16 v[62:63], v11 offset:36864
    s_waitcnt lgkmcnt(10)
    v_mfma_f32_16x16x32_bf16 a[8:11], v[64:67], v[40:43], a[8:11]
    v_mfma_f32_16x16x32_bf16 a[40:43], v[68:71], v[40:43], a[40:43]
    v_mfma_f32_16x16x32_bf16 a[72:75], v[36:39], v[64:67], a[72:75]
    v_mfma_f32_16x16x32_bf16 a[76:79], v[36:39], v[68:71], a[76:79]
    ds_read_b128 v[72:75], v21 offset:32768
    ds_read_b128 v[76:79], v21 offset:34816
    ds_read_b64_tr_b16 v[40:41], v4 offset:40960
    ds_read_b64_tr_b16 v[42:43], v4 offset:45056
    s_waitcnt lgkmcnt(12)
    v_mfma_f32_16x16x32_bf16 a[12:15], v[64:67], v[44:47], a[12:15]
    v_mfma_f32_16x16x32_bf16 a[44:47], v[68:71], v[44:47], a[44:47]
    v_mfma_f32_16x16x32_bf16 a[80:83], v[64:67], v[64:67], a[80:83]
    v_mfma_f32_16x16x32_bf16 a[84:87], v[68:71], v[68:71], a[84:87]
    ds_read_b64_tr_b16 v[44:45], v5 offset:40960
    ds_read_b64_tr_b16 v[46:47], v5 offset:45056
    s_waitcnt lgkmcnt(12)
    v_mfma_f32_16x16x32_bf16 a[16:19], v[64:67], v[48:51], a[16:19]
    v_mfma_f32_16x16x32_bf16 a[48:51], v[68:71], v[48:51], a[48:51]
    ds_read_b64_tr_b16 v[48:49], v6 offset:40960
    ds_read_b64_tr_b16 v[50:51], v6 offset:45056
    s_waitcnt lgkmcnt(12)
    v_mfma_f32_16x16x32_bf16 a[20:23], v[64:67], v[52:55], a[20:23]
    v_mfma_f32_16x16x32_bf16 a[52:55], v[68:71], v[52:55], a[52:55]
    ds_read_b64_tr_b16 v[52:53], v7 offset:40960
    ds_read_b64_tr_b16 v[54:55], v7 offset:45056
    s_waitcnt lgkmcnt(12)
    v_mfma_f32_16x16x32_bf16 a[24:27], v[64:67], v[56:59], a[24:27]
    v_mfma_f32_16x16x32_bf16 a[56:59], v[68:71], v[56:59], a[56:59]
    ds_read_b64_tr_b16 v[56:57], v8 offset:40960
    ds_read_b64_tr_b16 v[58:59], v8 offset:45056
    s_waitcnt lgkmcnt(12)
    v_mfma_f32_16x16x32_bf16 a[28:31], v[64:67], v[60:63], a[28:31]
    v_mfma_f32_16x16x32_bf16 a[60:63], v[68:71], v[60:63], a[60:63]
    ds_read_b64_tr_b16 v[60:61], v9 offset:40960
    ds_read_b64_tr_b16 v[62:63], v9 offset:45056
    s_waitcnt lgkmcnt(10)
    v_mfma_f32_16x16x32_bf16 a[0:3], v[72:75], v[40:43], a[0:3]
    v_mfma_f32_16x16x32_bf16 a[32:35], v[76:79], v[40:43], a[32:35]
    v_mfma_f32_16x16x32_bf16 a[64:67], v[36:39], v[40:43], a[64:67]
    ds_read_b64_tr_b16 v[40:41], v10 offset:40960
    ds_read_b64_tr_b16 v[42:43], v10 offset:45056
    s_waitcnt lgkmcnt(10)
    v_mfma_f32_16x16x32_bf16 a[4:7], v[72:75], v[44:47], a[4:7]
    v_mfma_f32_16x16x32_bf16 a[36:39], v[76:79], v[44:47], a[36:39]
    v_mfma_f32_16x16x32_bf16 a[68:71], v[36:39], v[44:47], a[68:71]
    ds_read_b64_tr_b16 v[44:45], v11 offset:40960
    ds_read_b64_tr_b16 v[46:47], v11 offset:45056
    s_waitcnt lgkmcnt(10)
    v_mfma_f32_16x16x32_bf16 a[8:11], v[72:75], v[48:51], a[8:11]
    v_mfma_f32_16x16x32_bf16 a[40:43], v[76:79], v[48:51], a[40:43]
    v_mfma_f32_16x16x32_bf16 a[72:75], v[36:39], v[72:75], a[72:75]
    v_mfma_f32_16x16x32_bf16 a[76:79], v[36:39], v[76:79], a[76:79]
    s_barrier
    ds_read_b128 v[64:67], v22 offset:0
    ds_read_b128 v[68:71], v22 offset:2048
    ds_read_b64_tr_b16 v[48:49], v12 offset:0
    ds_read_b64_tr_b16 v[50:51], v12 offset:4096
    s_waitcnt lgkmcnt(12)
    v_mfma_f32_16x16x32_bf16 a[12:15], v[72:75], v[52:55], a[12:15]
    v_mfma_f32_16x16x32_bf16 a[44:47], v[76:79], v[52:55], a[44:47]
    v_mfma_f32_16x16x32_bf16 a[80:83], v[72:75], v[72:75], a[80:83]
    v_mfma_f32_16x16x32_bf16 a[84:87], v[76:79], v[76:79], a[84:87]
    ds_read_b64_tr_b16 v[52:53], v13 offset:0
    ds_read_b64_tr_b16 v[54:55], v13 offset:4096
    s_waitcnt lgkmcnt(12)
    v_mfma_f32_16x16x32_bf16 a[16:19], v[72:75], v[56:59], a[16:19]
    v_mfma_f32_16x16x32_bf16 a[48:51], v[76:79], v[56:59], a[48:51]
    ds_read_b64_tr_b16 v[56:57], v14 offset:0
    ds_read_b64_tr_b16 v[58:59], v14 offset:4096
    s_waitcnt lgkmcnt(12)
    v_mfma_f32_16x16x32_bf16 a[20:23], v[72:75], v[60:63], a[20:23]
    v_mfma_f32_16x16x32_bf16 a[52:55], v[76:79], v[60:63], a[52:55]
    ds_read_b64_tr_b16 v[60:61], v15 offset:0
    ds_read_b64_tr_b16 v[62:63], v15 offset:4096
    s_waitcnt lgkmcnt(12)
    v_mfma_f32_16x16x32_bf16 a[24:27], v[72:75], v[40:43], a[24:27]
    v_mfma_f32_16x16x32_bf16 a[56:59], v[76:79], v[40:43], a[56:59]
    ds_read_b64_tr_b16 v[40:41], v16 offset:0
    ds_read_b64_tr_b16 v[42:43], v16 offset:4096
    s_waitcnt lgkmcnt(12)
    v_mfma_f32_16x16x32_bf16 a[28:31], v[72:75], v[44:47], a[28:31]
    v_mfma_f32_16x16x32_bf16 a[60:63], v[76:79], v[44:47], a[60:63]
    ds_read_b64_tr_b16 v[44:45], v17 offset:0
    ds_read_b64_tr_b16 v[46:47], v17 offset:4096
    s_waitcnt lgkmcnt(10)
    v_mfma_f32_16x16x32_bf16 a[0:3], v[64:67], v[48:51], a[0:3]
    v_mfma_f32_16x16x32_bf16 a[32:35], v[68:71], v[48:51], a[32:35]
    v_mfma_f32_16x16x32_bf16 a[64:67], v[36:39], v[48:51], a[64:67]
    ds_read_b64_tr_b16 v[48:49], v18 offset:0
    ds_read_b64_tr_b16 v[50:51], v18 offset:4096
    s_waitcnt lgkmcnt(10)
    v_mfma_f32_16x16x32_bf16 a[4:7], v[64:67], v[52:55], a[4:7]
    v_mfma_f32_16x16x32_bf16 a[36:39], v[68:71], v[52:55], a[36:39]
    v_mfma_f32_16x16x32_bf16 a[68:71], v[36:39], v[52:55], a[68:71]
    ds_read_b64_tr_b16 v[52:53], v19 offset:0
    ds_read_b64_tr_b16 v[54:55], v19 offset:4096
    s_waitcnt lgkmcnt(10)
    v_mfma_f32_16x16x32_bf16 a[8:11], v[64:67], v[56:59], a[8:11]
    v_mfma_f32_16x16x32_bf16 a[40:43], v[68:71], v[56:59], a[40:43]
    v_mfma_f32_16x16x32_bf16 a[72:75], v[36:39], v[64:67], a[72:75]
    v_mfma_f32_16x16x32_bf16 a[76:79], v[36:39], v[68:71], a[76:79]
    ds_read_b128 v[72:75], v23 offset:0
    ds_read_b128 v[76:79], v23 offset:2048
    ds_read_b64_tr_b16 v[56:57], v12 offset:8192
    ds_read_b64_tr_b16 v[58:59], v12 offset:12288
    s_waitcnt lgkmcnt(12)
    v_mfma_f32_16x16x32_bf16 a[12:15], v[64:67], v[60:63], a[12:15]
    v_mfma_f32_16x16x32_bf16 a[44:47], v[68:71], v[60:63], a[44:47]
    v_mfma_f32_16x16x32_bf16 a[80:83], v[64:67], v[64:67], a[80:83]
    v_mfma_f32_16x16x32_bf16 a[84:87], v[68:71], v[68:71], a[84:87]
    ds_read_b64_tr_b16 v[60:61], v13 offset:8192
    ds_read_b64_tr_b16 v[62:63], v13 offset:12288
    s_waitcnt lgkmcnt(12)
    v_mfma_f32_16x16x32_bf16 a[16:19], v[64:67], v[40:43], a[16:19]
    v_mfma_f32_16x16x32_bf16 a[48:51], v[68:71], v[40:43], a[48:51]
    ds_read_b64_tr_b16 v[40:41], v14 offset:8192
    ds_read_b64_tr_b16 v[42:43], v14 offset:12288
    s_waitcnt lgkmcnt(12)
    v_mfma_f32_16x16x32_bf16 a[20:23], v[64:67], v[44:47], a[20:23]
    v_mfma_f32_16x16x32_bf16 a[52:55], v[68:71], v[44:47], a[52:55]
    ds_read_b64_tr_b16 v[44:45], v15 offset:8192
    ds_read_b64_tr_b16 v[46:47], v15 offset:12288
    s_waitcnt lgkmcnt(12)
    v_mfma_f32_16x16x32_bf16 a[24:27], v[64:67], v[48:51], a[24:27]
    v_mfma_f32_16x16x32_bf16 a[56:59], v[68:71], v[48:51], a[56:59]
    ds_read_b64_tr_b16 v[48:49], v16 offset:8192
    ds_read_b64_tr_b16 v[50:51], v16 offset:12288
    s_waitcnt lgkmcnt(12)
    v_mfma_f32_16x16x32_bf16 a[28:31], v[64:67], v[52:55], a[28:31]
    v_mfma_f32_16x16x32_bf16 a[60:63], v[68:71], v[52:55], a[60:63]
    ds_read_b64_tr_b16 v[52:53], v17 offset:8192
    ds_read_b64_tr_b16 v[54:55], v17 offset:12288
    s_waitcnt lgkmcnt(10)
    v_mfma_f32_16x16x32_bf16 a[0:3], v[72:75], v[56:59], a[0:3]
    v_mfma_f32_16x16x32_bf16 a[32:35], v[76:79], v[56:59], a[32:35]
    v_mfma_f32_16x16x32_bf16 a[64:67], v[36:39], v[56:59], a[64:67]
    ds_read_b64_tr_b16 v[56:57], v18 offset:8192
    ds_read_b64_tr_b16 v[58:59], v18 offset:12288
    s_waitcnt lgkmcnt(10)
    v_mfma_f32_16x16x32_bf16 a[4:7], v[72:75], v[60:63], a[4:7]
    v_mfma_f32_16x16x32_bf16 a[36:39], v[76:79], v[60:63], a[36:39]
    v_mfma_f32_16x16x32_bf16 a[68:71], v[36:39], v[60:63], a[68:71]
    ds_read_b64_tr_b16 v[60:61], v19 offset:8192
    ds_read_b64_tr_b16 v[62:63], v19 offset:12288
    s_waitcnt lgkmcnt(10)
    v_mfma_f32_16x16x32_bf16 a[8:11], v[72:75], v[40:43], a[8:11]
    v_mfma_f32_16x16x32_bf16 a[40:43], v[76:79], v[40:43], a[40:43]
    v_mfma_f32_16x16x32_bf16 a[72:75], v[36:39], v[72:75], a[72:75]
    v_mfma_f32_16x16x32_bf16 a[76:79], v[36:39], v[76:79], a[76:79]
    s_barrier
    ds_read_b128 v[64:67], v22 offset:32768
    ds_read_b128 v[68:71], v22 offset:34816
    ds_read_b64_tr_b16 v[40:41], v12 offset:32768
    ds_read_b64_tr_b16 v[42:43], v12 offset:36864
    s_waitcnt lgkmcnt(12)
    v_mfma_f32_16x16x32_bf16 a[12:15], v[72:75], v[44:47], a[12:15]
    v_mfma_f32_16x16x32_bf16 a[44:47], v[76:79], v[44:47], a[44:47]
    v_mfma_f32_16x16x32_bf16 a[80:83], v[72:75], v[72:75], a[80:83]
    v_mfma_f32_16x16x32_bf16 a[84:87], v[76:79], v[76:79], a[84:87]
    ds_read_b64_tr_b16 v[44:45], v13 offset:32768
    ds_read_b64_tr_b16 v[46:47], v13 offset:36864
    s_waitcnt lgkmcnt(12)
    v_mfma_f32_16x16x32_bf16 a[16:19], v[72:75], v[48:51], a[16:19]
    v_mfma_f32_16x16x32_bf16 a[48:51], v[76:79], v[48:51], a[48:51]
    ds_read_b64_tr_b16 v[48:49], v14 offset:32768
    ds_read_b64_tr_b16 v[50:51], v14 offset:36864
    s_waitcnt lgkmcnt(12)
    v_mfma_f32_16x16x32_bf16 a[20:23], v[72:75], v[52:55], a[20:23]
    v_mfma_f32_16x16x32_bf16 a[52:55], v[76:79], v[52:55], a[52:55]
    ds_read_b64_tr_b16 v[52:53], v15 offset:32768
    ds_read_b64_tr_b16 v[54:55], v15 offset:36864
    s_waitcnt lgkmcnt(12)
    v_mfma_f32_16x16x32_bf16 a[24:27], v[72:75], v[56:59], a[24:27]
    v_mfma_f32_16x16x32_bf16 a[56:59], v[76:79], v[56:59], a[56:59]
    ds_read_b64_tr_b16 v[56:57], v16 offset:32768
    ds_read_b64_tr_b16 v[58:59], v16 offset:36864
    s_waitcnt lgkmcnt(12)
    v_mfma_f32_16x16x32_bf16 a[28:31], v[72:75], v[60:63], a[28:31]
    v_mfma_f32_16x16x32_bf16 a[60:63], v[76:79], v[60:63], a[60:63]
    ds_read_b64_tr_b16 v[60:61], v17 offset:32768
    ds_read_b64_tr_b16 v[62:63], v17 offset:36864
    s_waitcnt lgkmcnt(10)
    v_mfma_f32_16x16x32_bf16 a[0:3], v[64:67], v[40:43], a[0:3]
    v_mfma_f32_16x16x32_bf16 a[32:35], v[68:71], v[40:43], a[32:35]
    v_mfma_f32_16x16x32_bf16 a[64:67], v[36:39], v[40:43], a[64:67]
    ds_read_b64_tr_b16 v[40:41], v18 offset:32768
    ds_read_b64_tr_b16 v[42:43], v18 offset:36864
    s_waitcnt lgkmcnt(10)
    v_mfma_f32_16x16x32_bf16 a[4:7], v[64:67], v[44:47], a[4:7]
    v_mfma_f32_16x16x32_bf16 a[36:39], v[68:71], v[44:47], a[36:39]
    v_mfma_f32_16x16x32_bf16 a[68:71], v[36:39], v[44:47], a[68:71]
    ds_read_b64_tr_b16 v[44:45], v19 offset:32768
    ds_read_b64_tr_b16 v[46:47], v19 offset:36864
    s_waitcnt lgkmcnt(10)
    v_mfma_f32_16x16x32_bf16 a[8:11], v[64:67], v[48:51], a[8:11]
    v_mfma_f32_16x16x32_bf16 a[40:43], v[68:71], v[48:51], a[40:43]
    v_mfma_f32_16x16x32_bf16 a[72:75], v[36:39], v[64:67], a[72:75]
    v_mfma_f32_16x16x32_bf16 a[76:79], v[36:39], v[68:71], a[76:79]
    ds_read_b128 v[72:75], v23 offset:32768
    ds_read_b128 v[76:79], v23 offset:34816
    ds_read_b64_tr_b16 v[48:49], v12 offset:40960
    ds_read_b64_tr_b16 v[50:51], v12 offset:45056
    s_waitcnt lgkmcnt(12)
    v_mfma_f32_16x16x32_bf16 a[12:15], v[64:67], v[52:55], a[12:15]
    v_mfma_f32_16x16x32_bf16 a[44:47], v[68:71], v[52:55], a[44:47]
    v_mfma_f32_16x16x32_bf16 a[80:83], v[64:67], v[64:67], a[80:83]
    v_mfma_f32_16x16x32_bf16 a[84:87], v[68:71], v[68:71], a[84:87]
    ds_read_b64_tr_b16 v[52:53], v13 offset:40960
    ds_read_b64_tr_b16 v[54:55], v13 offset:45056
    s_waitcnt lgkmcnt(12)
    v_mfma_f32_16x16x32_bf16 a[16:19], v[64:67], v[56:59], a[16:19]
    v_mfma_f32_16x16x32_bf16 a[48:51], v[68:71], v[56:59], a[48:51]
    ds_read_b64_tr_b16 v[56:57], v14 offset:40960
    ds_read_b64_tr_b16 v[58:59], v14 offset:45056
    s_waitcnt lgkmcnt(12)
    v_mfma_f32_16x16x32_bf16 a[20:23], v[64:67], v[60:63], a[20:23]
    v_mfma_f32_16x16x32_bf16 a[52:55], v[68:71], v[60:63], a[52:55]
    ds_read_b64_tr_b16 v[60:61], v15 offset:40960
    ds_read_b64_tr_b16 v[62:63], v15 offset:45056
    s_waitcnt lgkmcnt(12)
    v_mfma_f32_16x16x32_bf16 a[24:27], v[64:67], v[40:43], a[24:27]
    v_mfma_f32_16x16x32_bf16 a[56:59], v[68:71], v[40:43], a[56:59]
    ds_read_b64_tr_b16 v[40:41], v16 offset:40960
    ds_read_b64_tr_b16 v[42:43], v16 offset:45056
    s_waitcnt lgkmcnt(12)
    v_mfma_f32_16x16x32_bf16 a[28:31], v[64:67], v[44:47], a[28:31]
    v_mfma_f32_16x16x32_bf16 a[60:63], v[68:71], v[44:47], a[60:63]
    ds_read_b64_tr_b16 v[44:45], v17 offset:40960
    ds_read_b64_tr_b16 v[46:47], v17 offset:45056
    s_waitcnt lgkmcnt(10)
    v_mfma_f32_16x16x32_bf16 a[0:3], v[72:75], v[48:51], a[0:3]
    v_mfma_f32_16x16x32_bf16 a[32:35], v[76:79], v[48:51], a[32:35]
    v_mfma_f32_16x16x32_bf16 a[64:67], v[36:39], v[48:51], a[64:67]
    ds_read_b64_tr_b16 v[48:49], v18 offset:40960
    ds_read_b64_tr_b16 v[50:51], v18 offset:45056
    s_waitcnt lgkmcnt(10)
    v_mfma_f32_16x16x32_bf16 a[4:7], v[72:75], v[52:55], a[4:7]
    v_mfma_f32_16x16x32_bf16 a[36:39], v[76:79], v[52:55], a[36:39]
    v_mfma_f32_16x16x32_bf16 a[68:71], v[36:39], v[52:55], a[68:71]
    ds_read_b64_tr_b16 v[52:53], v19 offset:40960
    ds_read_b64_tr_b16 v[54:55], v19 offset:45056
    s_waitcnt lgkmcnt(10)
    v_mfma_f32_16x16x32_bf16 a[8:11], v[72:75], v[56:59], a[8:11]
    v_mfma_f32_16x16x32_bf16 a[40:43], v[76:79], v[56:59], a[40:43]
    v_mfma_f32_16x16x32_bf16 a[72:75], v[36:39], v[72:75], a[72:75]
    v_mfma_f32_16x16x32_bf16 a[76:79], v[36:39], v[76:79], a[76:79]
    s_barrier
    ds_read_b128 v[64:67], v20 offset:0
    ds_read_b128 v[68:71], v20 offset:2048
    ds_read_b64_tr_b16 v[56:57], v4 offset:0
    ds_read_b64_tr_b16 v[58:59], v4 offset:4096
    s_waitcnt lgkmcnt(12)
    v_mfma_f32_16x16x32_bf16 a[12:15], v[72:75], v[60:63], a[12:15]
    v_mfma_f32_16x16x32_bf16 a[44:47], v[76:79], v[60:63], a[44:47]
    v_mfma_f32_16x16x32_bf16 a[80:83], v[72:75], v[72:75], a[80:83]
    v_mfma_f32_16x16x32_bf16 a[84:87], v[76:79], v[76:79], a[84:87]
    ds_read_b64_tr_b16 v[60:61], v5 offset:0
    ds_read_b64_tr_b16 v[62:63], v5 offset:4096
    s_waitcnt lgkmcnt(12)
    v_mfma_f32_16x16x32_bf16 a[16:19], v[72:75], v[40:43], a[16:19]
    v_mfma_f32_16x16x32_bf16 a[48:51], v[76:79], v[40:43], a[48:51]
    ds_read_b64_tr_b16 v[40:41], v6 offset:0
    ds_read_b64_tr_b16 v[42:43], v6 offset:4096
    s_waitcnt lgkmcnt(12)
    v_mfma_f32_16x16x32_bf16 a[20:23], v[72:75], v[44:47], a[20:23]
    v_mfma_f32_16x16x32_bf16 a[52:55], v[76:79], v[44:47], a[52:55]
    ds_read_b64_tr_b16 v[44:45], v7 offset:0
    ds_read_b64_tr_b16 v[46:47], v7 offset:4096
    s_waitcnt lgkmcnt(12)
    v_mfma_f32_16x16x32_bf16 a[24:27], v[72:75], v[48:51], a[24:27]
    v_mfma_f32_16x16x32_bf16 a[56:59], v[76:79], v[48:51], a[56:59]
    ds_read_b64_tr_b16 v[48:49], v8 offset:0
    ds_read_b64_tr_b16 v[50:51], v8 offset:4096
    s_waitcnt lgkmcnt(12)
    v_mfma_f32_16x16x32_bf16 a[28:31], v[72:75], v[52:55], a[28:31]
    v_mfma_f32_16x16x32_bf16 a[60:63], v[76:79], v[52:55], a[60:63]
    ds_read_b64_tr_b16 v[52:53], v9 offset:0
    ds_read_b64_tr_b16 v[54:55], v9 offset:4096
    s_waitcnt lgkmcnt(10)
    v_mfma_f32_16x16x32_bf16 a[0:3], v[64:67], v[56:59], a[0:3]
    v_mfma_f32_16x16x32_bf16 a[32:35], v[68:71], v[56:59], a[32:35]
    v_mfma_f32_16x16x32_bf16 a[64:67], v[36:39], v[56:59], a[64:67]
    ds_read_b64_tr_b16 v[56:57], v10 offset:0
    ds_read_b64_tr_b16 v[58:59], v10 offset:4096
    s_waitcnt lgkmcnt(10)
    v_mfma_f32_16x16x32_bf16 a[4:7], v[64:67], v[60:63], a[4:7]
    v_mfma_f32_16x16x32_bf16 a[36:39], v[68:71], v[60:63], a[36:39]
    v_mfma_f32_16x16x32_bf16 a[68:71], v[36:39], v[60:63], a[68:71]
    ds_read_b64_tr_b16 v[60:61], v11 offset:0
    ds_read_b64_tr_b16 v[62:63], v11 offset:4096
    s_waitcnt lgkmcnt(10)
    v_mfma_f32_16x16x32_bf16 a[8:11], v[64:67], v[40:43], a[8:11]
    v_mfma_f32_16x16x32_bf16 a[40:43], v[68:71], v[40:43], a[40:43]
    v_mfma_f32_16x16x32_bf16 a[72:75], v[36:39], v[64:67], a[72:75]
    v_mfma_f32_16x16x32_bf16 a[76:79], v[36:39], v[68:71], a[76:79]
    ds_read_b128 v[72:75], v21 offset:0
    ds_read_b128 v[76:79], v21 offset:2048
    ds_read_b64_tr_b16 v[40:41], v4 offset:8192
    ds_read_b64_tr_b16 v[42:43], v4 offset:12288
    s_waitcnt lgkmcnt(12)
    v_mfma_f32_16x16x32_bf16 a[12:15], v[64:67], v[44:47], a[12:15]
    v_mfma_f32_16x16x32_bf16 a[44:47], v[68:71], v[44:47], a[44:47]
    v_mfma_f32_16x16x32_bf16 a[80:83], v[64:67], v[64:67], a[80:83]
    v_mfma_f32_16x16x32_bf16 a[84:87], v[68:71], v[68:71], a[84:87]
    ds_read_b64_tr_b16 v[44:45], v5 offset:8192
    ds_read_b64_tr_b16 v[46:47], v5 offset:12288
    s_waitcnt lgkmcnt(12)
    v_mfma_f32_16x16x32_bf16 a[16:19], v[64:67], v[48:51], a[16:19]
    v_mfma_f32_16x16x32_bf16 a[48:51], v[68:71], v[48:51], a[48:51]
    ds_read_b64_tr_b16 v[48:49], v6 offset:8192
    ds_read_b64_tr_b16 v[50:51], v6 offset:12288
    s_waitcnt lgkmcnt(12)
    v_mfma_f32_16x16x32_bf16 a[20:23], v[64:67], v[52:55], a[20:23]
    v_mfma_f32_16x16x32_bf16 a[52:55], v[68:71], v[52:55], a[52:55]
    ds_read_b64_tr_b16 v[52:53], v7 offset:8192
    ds_read_b64_tr_b16 v[54:55], v7 offset:12288
    s_waitcnt lgkmcnt(12)
    v_mfma_f32_16x16x32_bf16 a[24:27], v[64:67], v[56:59], a[24:27]
    v_mfma_f32_16x16x32_bf16 a[56:59], v[68:71], v[56:59], a[56:59]
    ds_read_b64_tr_b16 v[56:57], v8 offset:8192
    ds_read_b64_tr_b16 v[58:59], v8 offset:12288
    s_waitcnt lgkmcnt(12)
    v_mfma_f32_16x16x32_bf16 a[28:31], v[64:67], v[60:63], a[28:31]
    v_mfma_f32_16x16x32_bf16 a[60:63], v[68:71], v[60:63], a[60:63]
    ds_read_b64_tr_b16 v[60:61], v9 offset:8192
    ds_read_b64_tr_b16 v[62:63], v9 offset:12288
    s_waitcnt lgkmcnt(10)
    v_mfma_f32_16x16x32_bf16 a[0:3], v[72:75], v[40:43], a[0:3]
    v_mfma_f32_16x16x32_bf16 a[32:35], v[76:79], v[40:43], a[32:35]
    v_mfma_f32_16x16x32_bf16 a[64:67], v[36:39], v[40:43], a[64:67]
    ds_read_b64_tr_b16 v[40:41], v10 offset:8192
    ds_read_b64_tr_b16 v[42:43], v10 offset:12288
    s_waitcnt lgkmcnt(10)
    v_mfma_f32_16x16x32_bf16 a[4:7], v[72:75], v[44:47], a[4:7]
    v_mfma_f32_16x16x32_bf16 a[36:39], v[76:79], v[44:47], a[36:39]
    v_mfma_f32_16x16x32_bf16 a[68:71], v[36:39], v[44:47], a[68:71]
    ds_read_b64_tr_b16 v[44:45], v11 offset:8192
    ds_read_b64_tr_b16 v[46:47], v11 offset:12288
    s_waitcnt lgkmcnt(10)
    v_mfma_f32_16x16x32_bf16 a[8:11], v[72:75], v[48:51], a[8:11]
    v_mfma_f32_16x16x32_bf16 a[40:43], v[76:79], v[48:51], a[40:43]
    v_mfma_f32_16x16x32_bf16 a[72:75], v[36:39], v[72:75], a[72:75]
    v_mfma_f32_16x16x32_bf16 a[76:79], v[36:39], v[76:79], a[76:79]
    s_barrier
    ds_read_b128 v[64:67], v20 offset:32768
    ds_read_b128 v[68:71], v20 offset:34816
    ds_read_b64_tr_b16 v[48:49], v4 offset:32768
    ds_read_b64_tr_b16 v[50:51], v4 offset:36864
    s_waitcnt lgkmcnt(12)
    v_mfma_f32_16x16x32_bf16 a[12:15], v[72:75], v[52:55], a[12:15]
    v_mfma_f32_16x16x32_bf16 a[44:47], v[76:79], v[52:55], a[44:47]
    v_mfma_f32_16x16x32_bf16 a[80:83], v[72:75], v[72:75], a[80:83]
    v_mfma_f32_16x16x32_bf16 a[84:87], v[76:79], v[76:79], a[84:87]
    ds_read_b64_tr_b16 v[52:53], v5 offset:32768
    ds_read_b64_tr_b16 v[54:55], v5 offset:36864
    s_waitcnt lgkmcnt(12)
    v_mfma_f32_16x16x32_bf16 a[16:19], v[72:75], v[56:59], a[16:19]
    v_mfma_f32_16x16x32_bf16 a[48:51], v[76:79], v[56:59], a[48:51]
    ds_read_b64_tr_b16 v[56:57], v6 offset:32768
    ds_read_b64_tr_b16 v[58:59], v6 offset:36864
    s_waitcnt lgkmcnt(12)
    v_mfma_f32_16x16x32_bf16 a[20:23], v[72:75], v[60:63], a[20:23]
    v_mfma_f32_16x16x32_bf16 a[52:55], v[76:79], v[60:63], a[52:55]
    ds_read_b64_tr_b16 v[60:61], v7 offset:32768
    ds_read_b64_tr_b16 v[62:63], v7 offset:36864
    s_waitcnt lgkmcnt(12)
    v_mfma_f32_16x16x32_bf16 a[24:27], v[72:75], v[40:43], a[24:27]
    v_mfma_f32_16x16x32_bf16 a[56:59], v[76:79], v[40:43], a[56:59]
    ds_read_b64_tr_b16 v[40:41], v8 offset:32768
    ds_read_b64_tr_b16 v[42:43], v8 offset:36864
    s_waitcnt lgkmcnt(12)
    v_mfma_f32_16x16x32_bf16 a[28:31], v[72:75], v[44:47], a[28:31]
    v_mfma_f32_16x16x32_bf16 a[60:63], v[76:79], v[44:47], a[60:63]
    ds_read_b64_tr_b16 v[44:45], v9 offset:32768
    ds_read_b64_tr_b16 v[46:47], v9 offset:36864
    s_waitcnt lgkmcnt(10)
    v_mfma_f32_16x16x32_bf16 a[0:3], v[64:67], v[48:51], a[0:3]
    v_mfma_f32_16x16x32_bf16 a[32:35], v[68:71], v[48:51], a[32:35]
    v_mfma_f32_16x16x32_bf16 a[64:67], v[36:39], v[48:51], a[64:67]
    ds_read_b64_tr_b16 v[48:49], v10 offset:32768
    ds_read_b64_tr_b16 v[50:51], v10 offset:36864
    s_waitcnt lgkmcnt(10)
    v_mfma_f32_16x16x32_bf16 a[4:7], v[64:67], v[52:55], a[4:7]
    v_mfma_f32_16x16x32_bf16 a[36:39], v[68:71], v[52:55], a[36:39]
    v_mfma_f32_16x16x32_bf16 a[68:71], v[36:39], v[52:55], a[68:71]
    ds_read_b64_tr_b16 v[52:53], v11 offset:32768
    ds_read_b64_tr_b16 v[54:55], v11 offset:36864
    s_waitcnt lgkmcnt(10)
    v_mfma_f32_16x16x32_bf16 a[8:11], v[64:67], v[56:59], a[8:11]
    v_mfma_f32_16x16x32_bf16 a[40:43], v[68:71], v[56:59], a[40:43]
    v_mfma_f32_16x16x32_bf16 a[72:75], v[36:39], v[64:67], a[72:75]
    v_mfma_f32_16x16x32_bf16 a[76:79], v[36:39], v[68:71], a[76:79]
    ds_read_b128 v[72:75], v21 offset:32768
    ds_read_b128 v[76:79], v21 offset:34816
    ds_read_b64_tr_b16 v[56:57], v4 offset:40960
    ds_read_b64_tr_b16 v[58:59], v4 offset:45056
    s_waitcnt lgkmcnt(12)
    v_mfma_f32_16x16x32_bf16 a[12:15], v[64:67], v[60:63], a[12:15]
    v_mfma_f32_16x16x32_bf16 a[44:47], v[68:71], v[60:63], a[44:47]
    v_mfma_f32_16x16x32_bf16 a[80:83], v[64:67], v[64:67], a[80:83]
    v_mfma_f32_16x16x32_bf16 a[84:87], v[68:71], v[68:71], a[84:87]
    ds_read_b64_tr_b16 v[60:61], v5 offset:40960
    ds_read_b64_tr_b16 v[62:63], v5 offset:45056
    s_waitcnt lgkmcnt(12)
    v_mfma_f32_16x16x32_bf16 a[16:19], v[64:67], v[40:43], a[16:19]
    v_mfma_f32_16x16x32_bf16 a[48:51], v[68:71], v[40:43], a[48:51]
    ds_read_b64_tr_b16 v[40:41], v6 offset:40960
    ds_read_b64_tr_b16 v[42:43], v6 offset:45056
    s_waitcnt lgkmcnt(12)
    v_mfma_f32_16x16x32_bf16 a[20:23], v[64:67], v[44:47], a[20:23]
    v_mfma_f32_16x16x32_bf16 a[52:55], v[68:71], v[44:47], a[52:55]
    ds_read_b64_tr_b16 v[44:45], v7 offset:40960
    ds_read_b64_tr_b16 v[46:47], v7 offset:45056
    s_waitcnt lgkmcnt(12)
    v_mfma_f32_16x16x32_bf16 a[24:27], v[64:67], v[48:51], a[24:27]
    v_mfma_f32_16x16x32_bf16 a[56:59], v[68:71], v[48:51], a[56:59]
    ds_read_b64_tr_b16 v[48:49], v8 offset:40960
    ds_read_b64_tr_b16 v[50:51], v8 offset:45056
    s_waitcnt lgkmcnt(12)
    v_mfma_f32_16x16x32_bf16 a[28:31], v[64:67], v[52:55], a[28:31]
    v_mfma_f32_16x16x32_bf16 a[60:63], v[68:71], v[52:55], a[60:63]
    ds_read_b64_tr_b16 v[52:53], v9 offset:40960
    ds_read_b64_tr_b16 v[54:55], v9 offset:45056
    s_waitcnt lgkmcnt(10)
    v_mfma_f32_16x16x32_bf16 a[0:3], v[72:75], v[56:59], a[0:3]
    v_mfma_f32_16x16x32_bf16 a[32:35], v[76:79], v[56:59], a[32:35]
    v_mfma_f32_16x16x32_bf16 a[64:67], v[36:39], v[56:59], a[64:67]
    ds_read_b64_tr_b16 v[56:57], v10 offset:40960
    ds_read_b64_tr_b16 v[58:59], v10 offset:45056
    s_waitcnt lgkmcnt(10)
    v_mfma_f32_16x16x32_bf16 a[4:7], v[72:75], v[60:63], a[4:7]
    v_mfma_f32_16x16x32_bf16 a[36:39], v[76:79], v[60:63], a[36:39]
    v_mfma_f32_16x16x32_bf16 a[68:71], v[36:39], v[60:63], a[68:71]
    ds_read_b64_tr_b16 v[60:61], v11 offset:40960
    ds_read_b64_tr_b16 v[62:63], v11 offset:45056
    s_waitcnt lgkmcnt(10)
    v_mfma_f32_16x16x32_bf16 a[8:11], v[72:75], v[40:43], a[8:11]
    v_mfma_f32_16x16x32_bf16 a[40:43], v[76:79], v[40:43], a[40:43]
    v_mfma_f32_16x16x32_bf16 a[72:75], v[36:39], v[72:75], a[72:75]
    v_mfma_f32_16x16x32_bf16 a[76:79], v[36:39], v[76:79], a[76:79]
    s_barrier
    ds_read_b128 v[64:67], v22 offset:0
    ds_read_b128 v[68:71], v22 offset:2048
    ds_read_b64_tr_b16 v[40:41], v12 offset:0
    ds_read_b64_tr_b16 v[42:43], v12 offset:4096
    s_waitcnt lgkmcnt(12)
    v_mfma_f32_16x16x32_bf16 a[12:15], v[72:75], v[44:47], a[12:15]
    v_mfma_f32_16x16x32_bf16 a[44:47], v[76:79], v[44:47], a[44:47]
    v_mfma_f32_16x16x32_bf16 a[80:83], v[72:75], v[72:75], a[80:83]
    v_mfma_f32_16x16x32_bf16 a[84:87], v[76:79], v[76:79], a[84:87]
    ds_read_b64_tr_b16 v[44:45], v13 offset:0
    ds_read_b64_tr_b16 v[46:47], v13 offset:4096
    s_waitcnt lgkmcnt(12)
    v_mfma_f32_16x16x32_bf16 a[16:19], v[72:75], v[48:51], a[16:19]
    v_mfma_f32_16x16x32_bf16 a[48:51], v[76:79], v[48:51], a[48:51]
    ds_read_b64_tr_b16 v[48:49], v14 offset:0
    ds_read_b64_tr_b16 v[50:51], v14 offset:4096
    s_waitcnt lgkmcnt(12)
    v_mfma_f32_16x16x32_bf16 a[20:23], v[72:75], v[52:55], a[20:23]
    v_mfma_f32_16x16x32_bf16 a[52:55], v[76:79], v[52:55], a[52:55]
    ds_read_b64_tr_b16 v[52:53], v15 offset:0
    ds_read_b64_tr_b16 v[54:55], v15 offset:4096
    s_waitcnt lgkmcnt(12)
    v_mfma_f32_16x16x32_bf16 a[24:27], v[72:75], v[56:59], a[24:27]
    v_mfma_f32_16x16x32_bf16 a[56:59], v[76:79], v[56:59], a[56:59]
    ds_read_b64_tr_b16 v[56:57], v16 offset:0
    ds_read_b64_tr_b16 v[58:59], v16 offset:4096
    s_waitcnt lgkmcnt(12)
    v_mfma_f32_16x16x32_bf16 a[28:31], v[72:75], v[60:63], a[28:31]
    v_mfma_f32_16x16x32_bf16 a[60:63], v[76:79], v[60:63], a[60:63]
    ds_read_b64_tr_b16 v[60:61], v17 offset:0
    ds_read_b64_tr_b16 v[62:63], v17 offset:4096
    s_waitcnt lgkmcnt(10)
    v_mfma_f32_16x16x32_bf16 a[0:3], v[64:67], v[40:43], a[0:3]
    v_mfma_f32_16x16x32_bf16 a[32:35], v[68:71], v[40:43], a[32:35]
    v_mfma_f32_16x16x32_bf16 a[64:67], v[36:39], v[40:43], a[64:67]
    ds_read_b64_tr_b16 v[40:41], v18 offset:0
    ds_read_b64_tr_b16 v[42:43], v18 offset:4096
    s_waitcnt lgkmcnt(10)
    v_mfma_f32_16x16x32_bf16 a[4:7], v[64:67], v[44:47], a[4:7]
    v_mfma_f32_16x16x32_bf16 a[36:39], v[68:71], v[44:47], a[36:39]
    v_mfma_f32_16x16x32_bf16 a[68:71], v[36:39], v[44:47], a[68:71]
    ds_read_b64_tr_b16 v[44:45], v19 offset:0
    ds_read_b64_tr_b16 v[46:47], v19 offset:4096
    s_waitcnt lgkmcnt(10)
    v_mfma_f32_16x16x32_bf16 a[8:11], v[64:67], v[48:51], a[8:11]
    v_mfma_f32_16x16x32_bf16 a[40:43], v[68:71], v[48:51], a[40:43]
    v_mfma_f32_16x16x32_bf16 a[72:75], v[36:39], v[64:67], a[72:75]
    v_mfma_f32_16x16x32_bf16 a[76:79], v[36:39], v[68:71], a[76:79]
    ds_read_b128 v[72:75], v23 offset:0
    ds_read_b128 v[76:79], v23 offset:2048
    ds_read_b64_tr_b16 v[48:49], v12 offset:8192
    ds_read_b64_tr_b16 v[50:51], v12 offset:12288
    s_waitcnt lgkmcnt(12)
    v_mfma_f32_16x16x32_bf16 a[12:15], v[64:67], v[52:55], a[12:15]
    v_mfma_f32_16x16x32_bf16 a[44:47], v[68:71], v[52:55], a[44:47]
    v_mfma_f32_16x16x32_bf16 a[80:83], v[64:67], v[64:67], a[80:83]
    v_mfma_f32_16x16x32_bf16 a[84:87], v[68:71], v[68:71], a[84:87]
    ds_read_b64_tr_b16 v[52:53], v13 offset:8192
    ds_read_b64_tr_b16 v[54:55], v13 offset:12288
    s_waitcnt lgkmcnt(12)
    v_mfma_f32_16x16x32_bf16 a[16:19], v[64:67], v[56:59], a[16:19]
    v_mfma_f32_16x16x32_bf16 a[48:51], v[68:71], v[56:59], a[48:51]
    ds_read_b64_tr_b16 v[56:57], v14 offset:8192
    ds_read_b64_tr_b16 v[58:59], v14 offset:12288
    s_waitcnt lgkmcnt(12)
    v_mfma_f32_16x16x32_bf16 a[20:23], v[64:67], v[60:63], a[20:23]
    v_mfma_f32_16x16x32_bf16 a[52:55], v[68:71], v[60:63], a[52:55]
    ds_read_b64_tr_b16 v[60:61], v15 offset:8192
    ds_read_b64_tr_b16 v[62:63], v15 offset:12288
    s_waitcnt lgkmcnt(12)
    v_mfma_f32_16x16x32_bf16 a[24:27], v[64:67], v[40:43], a[24:27]
    v_mfma_f32_16x16x32_bf16 a[56:59], v[68:71], v[40:43], a[56:59]
    ds_read_b64_tr_b16 v[40:41], v16 offset:8192
    ds_read_b64_tr_b16 v[42:43], v16 offset:12288
    s_waitcnt lgkmcnt(12)
    v_mfma_f32_16x16x32_bf16 a[28:31], v[64:67], v[44:47], a[28:31]
    v_mfma_f32_16x16x32_bf16 a[60:63], v[68:71], v[44:47], a[60:63]
    ds_read_b64_tr_b16 v[44:45], v17 offset:8192
    ds_read_b64_tr_b16 v[46:47], v17 offset:12288
    s_waitcnt lgkmcnt(10)
    v_mfma_f32_16x16x32_bf16 a[0:3], v[72:75], v[48:51], a[0:3]
    v_mfma_f32_16x16x32_bf16 a[32:35], v[76:79], v[48:51], a[32:35]
    v_mfma_f32_16x16x32_bf16 a[64:67], v[36:39], v[48:51], a[64:67]
    ds_read_b64_tr_b16 v[48:49], v18 offset:8192
    ds_read_b64_tr_b16 v[50:51], v18 offset:12288
    s_waitcnt lgkmcnt(10)
    v_mfma_f32_16x16x32_bf16 a[4:7], v[72:75], v[52:55], a[4:7]
    v_mfma_f32_16x16x32_bf16 a[36:39], v[76:79], v[52:55], a[36:39]
    v_mfma_f32_16x16x32_bf16 a[68:71], v[36:39], v[52:55], a[68:71]
    ds_read_b64_tr_b16 v[52:53], v19 offset:8192
    ds_read_b64_tr_b16 v[54:55], v19 offset:12288
    s_waitcnt lgkmcnt(10)
    v_mfma_f32_16x16x32_bf16 a[8:11], v[72:75], v[56:59], a[8:11]
    v_mfma_f32_16x16x32_bf16 a[40:43], v[76:79], v[56:59], a[40:43]
    v_mfma_f32_16x16x32_bf16 a[72:75], v[36:39], v[72:75], a[72:75]
    v_mfma_f32_16x16x32_bf16 a[76:79], v[36:39], v[76:79], a[76:79]
    s_barrier
    ds_read_b128 v[64:67], v22 offset:32768
    ds_read_b128 v[68:71], v22 offset:34816
    ds_read_b64_tr_b16 v[56:57], v12 offset:32768
    ds_read_b64_tr_b16 v[58:59], v12 offset:36864
    s_waitcnt lgkmcnt(12)
    v_mfma_f32_16x16x32_bf16 a[12:15], v[72:75], v[60:63], a[12:15]
    v_mfma_f32_16x16x32_bf16 a[44:47], v[76:79], v[60:63], a[44:47]
    v_mfma_f32_16x16x32_bf16 a[80:83], v[72:75], v[72:75], a[80:83]
    v_mfma_f32_16x16x32_bf16 a[84:87], v[76:79], v[76:79], a[84:87]
    ds_read_b64_tr_b16 v[60:61], v13 offset:32768
    ds_read_b64_tr_b16 v[62:63], v13 offset:36864
    s_waitcnt lgkmcnt(12)
    v_mfma_f32_16x16x32_bf16 a[16:19], v[72:75], v[40:43], a[16:19]
    v_mfma_f32_16x16x32_bf16 a[48:51], v[76:79], v[40:43], a[48:51]
    ds_read_b64_tr_b16 v[40:41], v14 offset:32768
    ds_read_b64_tr_b16 v[42:43], v14 offset:36864
    s_waitcnt lgkmcnt(12)
    v_mfma_f32_16x16x32_bf16 a[20:23], v[72:75], v[44:47], a[20:23]
    v_mfma_f32_16x16x32_bf16 a[52:55], v[76:79], v[44:47], a[52:55]
    ds_read_b64_tr_b16 v[44:45], v15 offset:32768
    ds_read_b64_tr_b16 v[46:47], v15 offset:36864
    s_waitcnt lgkmcnt(12)
    v_mfma_f32_16x16x32_bf16 a[24:27], v[72:75], v[48:51], a[24:27]
    v_mfma_f32_16x16x32_bf16 a[56:59], v[76:79], v[48:51], a[56:59]
    ds_read_b64_tr_b16 v[48:49], v16 offset:32768
    ds_read_b64_tr_b16 v[50:51], v16 offset:36864
    s_waitcnt lgkmcnt(12)
    v_mfma_f32_16x16x32_bf16 a[28:31], v[72:75], v[52:55], a[28:31]
    v_mfma_f32_16x16x32_bf16 a[60:63], v[76:79], v[52:55], a[60:63]
    ds_read_b64_tr_b16 v[52:53], v17 offset:32768
    ds_read_b64_tr_b16 v[54:55], v17 offset:36864
    s_waitcnt lgkmcnt(10)
    v_mfma_f32_16x16x32_bf16 a[0:3], v[64:67], v[56:59], a[0:3]
    v_mfma_f32_16x16x32_bf16 a[32:35], v[68:71], v[56:59], a[32:35]
    v_mfma_f32_16x16x32_bf16 a[64:67], v[36:39], v[56:59], a[64:67]
    ds_read_b64_tr_b16 v[56:57], v18 offset:32768
    ds_read_b64_tr_b16 v[58:59], v18 offset:36864
    s_waitcnt lgkmcnt(10)
    v_mfma_f32_16x16x32_bf16 a[4:7], v[64:67], v[60:63], a[4:7]
    v_mfma_f32_16x16x32_bf16 a[36:39], v[68:71], v[60:63], a[36:39]
    v_mfma_f32_16x16x32_bf16 a[68:71], v[36:39], v[60:63], a[68:71]
    ds_read_b64_tr_b16 v[60:61], v19 offset:32768
    ds_read_b64_tr_b16 v[62:63], v19 offset:36864
    s_waitcnt lgkmcnt(10)
    v_mfma_f32_16x16x32_bf16 a[8:11], v[64:67], v[40:43], a[8:11]
    v_mfma_f32_16x16x32_bf16 a[40:43], v[68:71], v[40:43], a[40:43]
    v_mfma_f32_16x16x32_bf16 a[72:75], v[36:39], v[64:67], a[72:75]
    v_mfma_f32_16x16x32_bf16 a[76:79], v[36:39], v[68:71], a[76:79]
    ds_read_b128 v[72:75], v23 offset:32768
    ds_read_b128 v[76:79], v23 offset:34816
    ds_read_b64_tr_b16 v[40:41], v12 offset:40960
    ds_read_b64_tr_b16 v[42:43], v12 offset:45056
    s_waitcnt lgkmcnt(12)
    v_mfma_f32_16x16x32_bf16 a[12:15], v[64:67], v[44:47], a[12:15]
    v_mfma_f32_16x16x32_bf16 a[44:47], v[68:71], v[44:47], a[44:47]
    v_mfma_f32_16x16x32_bf16 a[80:83], v[64:67], v[64:67], a[80:83]
    v_mfma_f32_16x16x32_bf16 a[84:87], v[68:71], v[68:71], a[84:87]
    ds_read_b64_tr_b16 v[44:45], v13 offset:40960
    ds_read_b64_tr_b16 v[46:47], v13 offset:45056
    s_waitcnt lgkmcnt(12)
    v_mfma_f32_16x16x32_bf16 a[16:19], v[64:67], v[48:51], a[16:19]
    v_mfma_f32_16x16x32_bf16 a[48:51], v[68:71], v[48:51], a[48:51]
    ds_read_b64_tr_b16 v[48:49], v14 offset:40960
    ds_read_b64_tr_b16 v[50:51], v14 offset:45056
    s_waitcnt lgkmcnt(12)
    v_mfma_f32_16x16x32_bf16 a[20:23], v[64:67], v[52:55], a[20:23]
    v_mfma_f32_16x16x32_bf16 a[52:55], v[68:71], v[52:55], a[52:55]
    ds_read_b64_tr_b16 v[52:53], v15 offset:40960
    ds_read_b64_tr_b16 v[54:55], v15 offset:45056
    s_waitcnt lgkmcnt(12)
    v_mfma_f32_16x16x32_bf16 a[24:27], v[64:67], v[56:59], a[24:27]
    v_mfma_f32_16x16x32_bf16 a[56:59], v[68:71], v[56:59], a[56:59]
    ds_read_b64_tr_b16 v[56:57], v16 offset:40960
    ds_read_b64_tr_b16 v[58:59], v16 offset:45056
    s_waitcnt lgkmcnt(12)
    v_mfma_f32_16x16x32_bf16 a[28:31], v[64:67], v[60:63], a[28:31]
    v_mfma_f32_16x16x32_bf16 a[60:63], v[68:71], v[60:63], a[60:63]
    ds_read_b64_tr_b16 v[60:61], v17 offset:40960
    ds_read_b64_tr_b16 v[62:63], v17 offset:45056
    s_waitcnt lgkmcnt(10)
    v_mfma_f32_16x16x32_bf16 a[0:3], v[72:75], v[40:43], a[0:3]
    v_mfma_f32_16x16x32_bf16 a[32:35], v[76:79], v[40:43], a[32:35]
    v_mfma_f32_16x16x32_bf16 a[64:67], v[36:39], v[40:43], a[64:67]
    ds_read_b64_tr_b16 v[40:41], v18 offset:40960
    ds_read_b64_tr_b16 v[42:43], v18 offset:45056
    s_waitcnt lgkmcnt(10)
    v_mfma_f32_16x16x32_bf16 a[4:7], v[72:75], v[44:47], a[4:7]
    v_mfma_f32_16x16x32_bf16 a[36:39], v[76:79], v[44:47], a[36:39]
    v_mfma_f32_16x16x32_bf16 a[68:71], v[36:39], v[44:47], a[68:71]
    ds_read_b64_tr_b16 v[44:45], v19 offset:40960
    ds_read_b64_tr_b16 v[46:47], v19 offset:45056
    s_waitcnt lgkmcnt(10)
    v_mfma_f32_16x16x32_bf16 a[8:11], v[72:75], v[48:51], a[8:11]
    v_mfma_f32_16x16x32_bf16 a[40:43], v[76:79], v[48:51], a[40:43]
    v_mfma_f32_16x16x32_bf16 a[72:75], v[36:39], v[72:75], a[72:75]
    v_mfma_f32_16x16x32_bf16 a[76:79], v[36:39], v[76:79], a[76:79]
    s_barrier
    ds_read_b128 v[64:67], v20 offset:0
    ds_read_b128 v[68:71], v20 offset:2048
    ds_read_b64_tr_b16 v[48:49], v4 offset:0
    ds_read_b64_tr_b16 v[50:51], v4 offset:4096
    s_waitcnt lgkmcnt(12)
    v_mfma_f32_16x16x32_bf16 a[12:15], v[72:75], v[52:55], a[12:15]
    v_mfma_f32_16x16x32_bf16 a[44:47], v[76:79], v[52:55], a[44:47]
    v_mfma_f32_16x16x32_bf16 a[80:83], v[72:75], v[72:75], a[80:83]
    v_mfma_f32_16x16x32_bf16 a[84:87], v[76:79], v[76:79], a[84:87]
    ds_read_b64_tr_b16 v[52:53], v5 offset:0
    ds_read_b64_tr_b16 v[54:55], v5 offset:4096
    s_waitcnt lgkmcnt(12)
    v_mfma_f32_16x16x32_bf16 a[16:19], v[72:75], v[56:59], a[16:19]
    v_mfma_f32_16x16x32_bf16 a[48:51], v[76:79], v[56:59], a[48:51]
    ds_read_b64_tr_b16 v[56:57], v6 offset:0
    ds_read_b64_tr_b16 v[58:59], v6 offset:4096
    s_waitcnt lgkmcnt(12)
    v_mfma_f32_16x16x32_bf16 a[20:23], v[72:75], v[60:63], a[20:23]
    v_mfma_f32_16x16x32_bf16 a[52:55], v[76:79], v[60:63], a[52:55]
    ds_read_b64_tr_b16 v[60:61], v7 offset:0
    ds_read_b64_tr_b16 v[62:63], v7 offset:4096
    s_waitcnt lgkmcnt(12)
    v_mfma_f32_16x16x32_bf16 a[24:27], v[72:75], v[40:43], a[24:27]
    v_mfma_f32_16x16x32_bf16 a[56:59], v[76:79], v[40:43], a[56:59]
    ds_read_b64_tr_b16 v[40:41], v8 offset:0
    ds_read_b64_tr_b16 v[42:43], v8 offset:4096
    s_waitcnt lgkmcnt(12)
    v_mfma_f32_16x16x32_bf16 a[28:31], v[72:75], v[44:47], a[28:31]
    v_mfma_f32_16x16x32_bf16 a[60:63], v[76:79], v[44:47], a[60:63]
    ds_read_b64_tr_b16 v[44:45], v9 offset:0
    ds_read_b64_tr_b16 v[46:47], v9 offset:4096
    s_waitcnt lgkmcnt(10)
    v_mfma_f32_16x16x32_bf16 a[0:3], v[64:67], v[48:51], a[0:3]
    v_mfma_f32_16x16x32_bf16 a[32:35], v[68:71], v[48:51], a[32:35]
    v_mfma_f32_16x16x32_bf16 a[64:67], v[36:39], v[48:51], a[64:67]
    ds_read_b64_tr_b16 v[48:49], v10 offset:0
    ds_read_b64_tr_b16 v[50:51], v10 offset:4096
    s_waitcnt lgkmcnt(10)
    v_mfma_f32_16x16x32_bf16 a[4:7], v[64:67], v[52:55], a[4:7]
    v_mfma_f32_16x16x32_bf16 a[36:39], v[68:71], v[52:55], a[36:39]
    v_mfma_f32_16x16x32_bf16 a[68:71], v[36:39], v[52:55], a[68:71]
    ds_read_b64_tr_b16 v[52:53], v11 offset:0
    ds_read_b64_tr_b16 v[54:55], v11 offset:4096
    s_waitcnt lgkmcnt(10)
    v_mfma_f32_16x16x32_bf16 a[8:11], v[64:67], v[56:59], a[8:11]
    v_mfma_f32_16x16x32_bf16 a[40:43], v[68:71], v[56:59], a[40:43]
    v_mfma_f32_16x16x32_bf16 a[72:75], v[36:39], v[64:67], a[72:75]
    v_mfma_f32_16x16x32_bf16 a[76:79], v[36:39], v[68:71], a[76:79]
    ds_read_b128 v[72:75], v21 offset:0
    ds_read_b128 v[76:79], v21 offset:2048
    ds_read_b64_tr_b16 v[56:57], v4 offset:8192
    ds_read_b64_tr_b16 v[58:59], v4 offset:12288
    s_waitcnt lgkmcnt(12)
    v_mfma_f32_16x16x32_bf16 a[12:15], v[64:67], v[60:63], a[12:15]
    v_mfma_f32_16x16x32_bf16 a[44:47], v[68:71], v[60:63], a[44:47]
    v_mfma_f32_16x16x32_bf16 a[80:83], v[64:67], v[64:67], a[80:83]
    v_mfma_f32_16x16x32_bf16 a[84:87], v[68:71], v[68:71], a[84:87]
    ds_read_b64_tr_b16 v[60:61], v5 offset:8192
    ds_read_b64_tr_b16 v[62:63], v5 offset:12288
    s_waitcnt lgkmcnt(12)
    v_mfma_f32_16x16x32_bf16 a[16:19], v[64:67], v[40:43], a[16:19]
    v_mfma_f32_16x16x32_bf16 a[48:51], v[68:71], v[40:43], a[48:51]
    ds_read_b64_tr_b16 v[40:41], v6 offset:8192
    ds_read_b64_tr_b16 v[42:43], v6 offset:12288
    s_waitcnt lgkmcnt(12)
    v_mfma_f32_16x16x32_bf16 a[20:23], v[64:67], v[44:47], a[20:23]
    v_mfma_f32_16x16x32_bf16 a[52:55], v[68:71], v[44:47], a[52:55]
    ds_read_b64_tr_b16 v[44:45], v7 offset:8192
    ds_read_b64_tr_b16 v[46:47], v7 offset:12288
    s_waitcnt lgkmcnt(12)
    v_mfma_f32_16x16x32_bf16 a[24:27], v[64:67], v[48:51], a[24:27]
    v_mfma_f32_16x16x32_bf16 a[56:59], v[68:71], v[48:51], a[56:59]
    ds_read_b64_tr_b16 v[48:49], v8 offset:8192
    ds_read_b64_tr_b16 v[50:51], v8 offset:12288
    s_waitcnt lgkmcnt(12)
    v_mfma_f32_16x16x32_bf16 a[28:31], v[64:67], v[52:55], a[28:31]
    v_mfma_f32_16x16x32_bf16 a[60:63], v[68:71], v[52:55], a[60:63]
    ds_read_b64_tr_b16 v[52:53], v9 offset:8192
    ds_read_b64_tr_b16 v[54:55], v9 offset:12288
    s_waitcnt lgkmcnt(10)
    v_mfma_f32_16x16x32_bf16 a[0:3], v[72:75], v[56:59], a[0:3]
    v_mfma_f32_16x16x32_bf16 a[32:35], v[76:79], v[56:59], a[32:35]
    v_mfma_f32_16x16x32_bf16 a[64:67], v[36:39], v[56:59], a[64:67]
    ds_read_b64_tr_b16 v[56:57], v10 offset:8192
    ds_read_b64_tr_b16 v[58:59], v10 offset:12288
    s_waitcnt lgkmcnt(10)
    v_mfma_f32_16x16x32_bf16 a[4:7], v[72:75], v[60:63], a[4:7]
    v_mfma_f32_16x16x32_bf16 a[36:39], v[76:79], v[60:63], a[36:39]
    v_mfma_f32_16x16x32_bf16 a[68:71], v[36:39], v[60:63], a[68:71]
    ds_read_b64_tr_b16 v[60:61], v11 offset:8192
    ds_read_b64_tr_b16 v[62:63], v11 offset:12288
    s_waitcnt lgkmcnt(10)
    v_mfma_f32_16x16x32_bf16 a[8:11], v[72:75], v[40:43], a[8:11]
    v_mfma_f32_16x16x32_bf16 a[40:43], v[76:79], v[40:43], a[40:43]
    v_mfma_f32_16x16x32_bf16 a[72:75], v[36:39], v[72:75], a[72:75]
    v_mfma_f32_16x16x32_bf16 a[76:79], v[36:39], v[76:79], a[76:79]
    s_barrier
    ds_read_b128 v[64:67], v20 offset:32768
    ds_read_b128 v[68:71], v20 offset:34816
    ds_read_b64_tr_b16 v[40:41], v4 offset:32768
    ds_read_b64_tr_b16 v[42:43], v4 offset:36864
    s_waitcnt lgkmcnt(12)
    v_mfma_f32_16x16x32_bf16 a[12:15], v[72:75], v[44:47], a[12:15]
    v_mfma_f32_16x16x32_bf16 a[44:47], v[76:79], v[44:47], a[44:47]
    v_mfma_f32_16x16x32_bf16 a[80:83], v[72:75], v[72:75], a[80:83]
    v_mfma_f32_16x16x32_bf16 a[84:87], v[76:79], v[76:79], a[84:87]
    ds_read_b64_tr_b16 v[44:45], v5 offset:32768
    ds_read_b64_tr_b16 v[46:47], v5 offset:36864
    s_waitcnt lgkmcnt(12)
    v_mfma_f32_16x16x32_bf16 a[16:19], v[72:75], v[48:51], a[16:19]
    v_mfma_f32_16x16x32_bf16 a[48:51], v[76:79], v[48:51], a[48:51]
    ds_read_b64_tr_b16 v[48:49], v6 offset:32768
    ds_read_b64_tr_b16 v[50:51], v6 offset:36864
    s_waitcnt lgkmcnt(12)
    v_mfma_f32_16x16x32_bf16 a[20:23], v[72:75], v[52:55], a[20:23]
    v_mfma_f32_16x16x32_bf16 a[52:55], v[76:79], v[52:55], a[52:55]
    ds_read_b64_tr_b16 v[52:53], v7 offset:32768
    ds_read_b64_tr_b16 v[54:55], v7 offset:36864
    s_waitcnt lgkmcnt(12)
    v_mfma_f32_16x16x32_bf16 a[24:27], v[72:75], v[56:59], a[24:27]
    v_mfma_f32_16x16x32_bf16 a[56:59], v[76:79], v[56:59], a[56:59]
    ds_read_b64_tr_b16 v[56:57], v8 offset:32768
    ds_read_b64_tr_b16 v[58:59], v8 offset:36864
    s_waitcnt lgkmcnt(12)
    v_mfma_f32_16x16x32_bf16 a[28:31], v[72:75], v[60:63], a[28:31]
    v_mfma_f32_16x16x32_bf16 a[60:63], v[76:79], v[60:63], a[60:63]
    ds_read_b64_tr_b16 v[60:61], v9 offset:32768
    ds_read_b64_tr_b16 v[62:63], v9 offset:36864
    s_waitcnt lgkmcnt(10)
    v_mfma_f32_16x16x32_bf16 a[0:3], v[64:67], v[40:43], a[0:3]
    v_mfma_f32_16x16x32_bf16 a[32:35], v[68:71], v[40:43], a[32:35]
    v_mfma_f32_16x16x32_bf16 a[64:67], v[36:39], v[40:43], a[64:67]
    ds_read_b64_tr_b16 v[40:41], v10 offset:32768
    ds_read_b64_tr_b16 v[42:43], v10 offset:36864
    s_waitcnt lgkmcnt(10)
    v_mfma_f32_16x16x32_bf16 a[4:7], v[64:67], v[44:47], a[4:7]
    v_mfma_f32_16x16x32_bf16 a[36:39], v[68:71], v[44:47], a[36:39]
    v_mfma_f32_16x16x32_bf16 a[68:71], v[36:39], v[44:47], a[68:71]
    ds_read_b64_tr_b16 v[44:45], v11 offset:32768
    ds_read_b64_tr_b16 v[46:47], v11 offset:36864
    s_waitcnt lgkmcnt(10)
    v_mfma_f32_16x16x32_bf16 a[8:11], v[64:67], v[48:51], a[8:11]
    v_mfma_f32_16x16x32_bf16 a[40:43], v[68:71], v[48:51], a[40:43]
    v_mfma_f32_16x16x32_bf16 a[72:75], v[36:39], v[64:67], a[72:75]
    v_mfma_f32_16x16x32_bf16 a[76:79], v[36:39], v[68:71], a[76:79]
    ds_read_b128 v[72:75], v21 offset:32768
    ds_read_b128 v[76:79], v21 offset:34816
    ds_read_b64_tr_b16 v[48:49], v4 offset:40960
    ds_read_b64_tr_b16 v[50:51], v4 offset:45056
    s_waitcnt lgkmcnt(12)
    v_mfma_f32_16x16x32_bf16 a[12:15], v[64:67], v[52:55], a[12:15]
    v_mfma_f32_16x16x32_bf16 a[44:47], v[68:71], v[52:55], a[44:47]
    v_mfma_f32_16x16x32_bf16 a[80:83], v[64:67], v[64:67], a[80:83]
    v_mfma_f32_16x16x32_bf16 a[84:87], v[68:71], v[68:71], a[84:87]
    ds_read_b64_tr_b16 v[52:53], v5 offset:40960
    ds_read_b64_tr_b16 v[54:55], v5 offset:45056
    s_waitcnt lgkmcnt(12)
    v_mfma_f32_16x16x32_bf16 a[16:19], v[64:67], v[56:59], a[16:19]
    v_mfma_f32_16x16x32_bf16 a[48:51], v[68:71], v[56:59], a[48:51]
    ds_read_b64_tr_b16 v[56:57], v6 offset:40960
    ds_read_b64_tr_b16 v[58:59], v6 offset:45056
    s_waitcnt lgkmcnt(12)
    v_mfma_f32_16x16x32_bf16 a[20:23], v[64:67], v[60:63], a[20:23]
    v_mfma_f32_16x16x32_bf16 a[52:55], v[68:71], v[60:63], a[52:55]
    ds_read_b64_tr_b16 v[60:61], v7 offset:40960
    ds_read_b64_tr_b16 v[62:63], v7 offset:45056
    s_waitcnt lgkmcnt(12)
    v_mfma_f32_16x16x32_bf16 a[24:27], v[64:67], v[40:43], a[24:27]
    v_mfma_f32_16x16x32_bf16 a[56:59], v[68:71], v[40:43], a[56:59]
    ds_read_b64_tr_b16 v[40:41], v8 offset:40960
    ds_read_b64_tr_b16 v[42:43], v8 offset:45056
    s_waitcnt lgkmcnt(12)
    v_mfma_f32_16x16x32_bf16 a[28:31], v[64:67], v[44:47], a[28:31]
    v_mfma_f32_16x16x32_bf16 a[60:63], v[68:71], v[44:47], a[60:63]
    ds_read_b64_tr_b16 v[44:45], v9 offset:40960
    ds_read_b64_tr_b16 v[46:47], v9 offset:45056
    s_waitcnt lgkmcnt(10)
    v_mfma_f32_16x16x32_bf16 a[0:3], v[72:75], v[48:51], a[0:3]
    v_mfma_f32_16x16x32_bf16 a[32:35], v[76:79], v[48:51], a[32:35]
    v_mfma_f32_16x16x32_bf16 a[64:67], v[36:39], v[48:51], a[64:67]
    ds_read_b64_tr_b16 v[48:49], v10 offset:40960
    ds_read_b64_tr_b16 v[50:51], v10 offset:45056
    s_waitcnt lgkmcnt(10)
    v_mfma_f32_16x16x32_bf16 a[4:7], v[72:75], v[52:55], a[4:7]
    v_mfma_f32_16x16x32_bf16 a[36:39], v[76:79], v[52:55], a[36:39]
    v_mfma_f32_16x16x32_bf16 a[68:71], v[36:39], v[52:55], a[68:71]
    ds_read_b64_tr_b16 v[52:53], v11 offset:40960
    ds_read_b64_tr_b16 v[54:55], v11 offset:45056
    s_waitcnt lgkmcnt(10)
    v_mfma_f32_16x16x32_bf16 a[8:11], v[72:75], v[56:59], a[8:11]
    v_mfma_f32_16x16x32_bf16 a[40:43], v[76:79], v[56:59], a[40:43]
    v_mfma_f32_16x16x32_bf16 a[72:75], v[36:39], v[72:75], a[72:75]
    v_mfma_f32_16x16x32_bf16 a[76:79], v[36:39], v[76:79], a[76:79]
    s_waitcnt lgkmcnt(8)
    v_mfma_f32_16x16x32_bf16 a[12:15], v[72:75], v[60:63], a[12:15]
    v_mfma_f32_16x16x32_bf16 a[44:47], v[76:79], v[60:63], a[44:47]
    v_mfma_f32_16x16x32_bf16 a[80:83], v[72:75], v[72:75], a[80:83]
    v_mfma_f32_16x16x32_bf16 a[84:87], v[76:79], v[76:79], a[84:87]
    s_waitcnt lgkmcnt(6)
    v_mfma_f32_16x16x32_bf16 a[16:19], v[72:75], v[40:43], a[16:19]
    v_mfma_f32_16x16x32_bf16 a[48:51], v[76:79], v[40:43], a[48:51]
    s_waitcnt lgkmcnt(4)
    v_mfma_f32_16x16x32_bf16 a[20:23], v[72:75], v[44:47], a[20:23]
    v_mfma_f32_16x16x32_bf16 a[52:55], v[76:79], v[44:47], a[52:55]
    s_waitcnt lgkmcnt(2)
    v_mfma_f32_16x16x32_bf16 a[24:27], v[72:75], v[48:51], a[24:27]
    v_mfma_f32_16x16x32_bf16 a[56:59], v[76:79], v[48:51], a[56:59]
    s_waitcnt lgkmcnt(0)
    v_mfma_f32_16x16x32_bf16 a[28:31], v[72:75], v[52:55], a[28:31]
    v_mfma_f32_16x16x32_bf16 a[60:63], v[76:79], v[52:55], a[60:63]
    s_nop 7
    s_nop 1
    v_lshlrev_b32 v112, 2, v2
    v_cmp_eq_u32 vcc, 0, v3
    v_add_u32 v112, 0x20000, v112
    s_lshl_b32 s37, s48, 6
    v_add_u32 v83, s37, v112
    s_lshl_b32 s37, s49, 6
    v_add_u32 v87, s37, v112
    s_lshl_b32 s37, s50, 6
    v_add_u32 v91, s37, v112
    s_lshl_b32 s37, s51, 6
    v_add_u32 v95, s37, v112
    s_lshl_b32 s37, s52, 6
    v_add_u32 v99, s37, v112
    s_lshl_b32 s37, s53, 6
    v_add_u32 v103, s37, v112
    s_lshl_b32 s37, s54, 6
    v_add_u32 v107, s37, v112
    s_lshl_b32 s37, s55, 6
    v_add_u32 v111, s37, v112
    s_and_saveexec_b64 s[44:45], vcc
    v_accvgpr_read_b32 v116, a64
    ds_write_b32 v83, v116
    v_accvgpr_read_b32 v116, a68
    ds_write_b32 v87, v116
    s_mov_b64 exec, s[44:45]
    s_mov_b32 s37, 0x3acccccd
    s_mov_b32 s38, 0x3727c5ac
    v_and_b32 v33, 3, v2
    v_lshrrev_b32 v32, 2, v2
    v_cmp_eq_u32 s[44:45], v32, v3
    v_add_u32 v34, s56, v2
    v_lshlrev_b32 v35, 2, v34
    v_add_u32 v35, 0x20400, v35
    v_accvgpr_read_b32 v40, a72
    v_accvgpr_read_b32 v41, a80
    v_accvgpr_read_b32 v30, a81
    v_cmp_eq_u32 vcc, 1, v33
    s_nop 1
    v_cndmask_b32 v41, v41, v30, vcc
    v_accvgpr_read_b32 v30, a82
    v_cmp_eq_u32 vcc, 2, v33
    s_nop 1
    v_cndmask_b32 v41, v41, v30, vcc
    v_accvgpr_read_b32 v30, a83
    v_cmp_eq_u32 vcc, 3, v33
    s_nop 1
    v_cndmask_b32 v41, v41, v30, vcc
    v_mul_f32 v40, s37, v40
    v_mul_f32 v41, s37, v41
    v_fma_f32 v41, -v40, v40, v41
    v_max_f32 v41, 0, v41
    v_cvt_pk_bf16_f32 v24, v40, v40
    v_lshlrev_b32 v42, 16, v24
    v_cvt_pk_bf16_f32 v24, v41, v41
    v_lshlrev_b32 v25, 16, v24
    v_add_f32 v25, s38, v25
    v_cvt_pk_bf16_f32 v24, v25, v25
    v_lshlrev_b32 v25, 16, v24
    v_sqrt_f32 v25, v25
    s_nop 0
    v_cvt_pk_bf16_f32 v24, v25, v25
    v_lshlrev_b32 v25, 16, v24
    v_rcp_f32 v43, v25
    s_nop 0
    v_mov_b32 v28, v43
    v_mul_f32 v29, v42, v43
    s_mov_b64 s[90:91], exec
    s_mov_b64 exec, s[44:45]
    ds_write_b32 v35, v28 offset:0
    ds_write_b32 v35, v29 offset:512
    s_mov_b64 exec, s[90:91]
    v_accvgpr_read_b32 v40, a76
    v_accvgpr_read_b32 v41, a84
    v_accvgpr_read_b32 v30, a85
    v_cmp_eq_u32 vcc, 1, v33
    s_nop 1
    v_cndmask_b32 v41, v41, v30, vcc
    v_accvgpr_read_b32 v30, a86
    v_cmp_eq_u32 vcc, 2, v33
    s_nop 1
    v_cndmask_b32 v41, v41, v30, vcc
    v_accvgpr_read_b32 v30, a87
    v_cmp_eq_u32 vcc, 3, v33
    s_nop 1
    v_cndmask_b32 v41, v41, v30, vcc
    v_mul_f32 v40, s37, v40
    v_mul_f32 v41, s37, v41
    v_fma_f32 v41, -v40, v40, v41
    v_max_f32 v41, 0, v41
    v_cvt_pk_bf16_f32 v24, v40, v40
    v_lshlrev_b32 v42, 16, v24
    v_cvt_pk_bf16_f32 v24, v41, v41
    v_lshlrev_b32 v25, 16, v24
    v_add_f32 v25, s38, v25
    v_cvt_pk_bf16_f32 v24, v25, v25
    v_lshlrev_b32 v25, 16, v24
    v_sqrt_f32 v25, v25
    s_nop 0
    v_cvt_pk_bf16_f32 v24, v25, v25
    v_lshlrev_b32 v25, 16, v24
    v_rcp_f32 v43, v25
    s_nop 0
    v_mov_b32 v28, v43
    v_mul_f32 v29, v42, v43
    s_mov_b64 s[90:91], exec
    s_mov_b64 exec, s[44:45]
    ds_write_b32 v35, v28 offset:64
    ds_write_b32 v35, v29 offset:576
    s_mov_b64 exec, s[90:91]
    s_waitcnt lgkmcnt(0)
    s_barrier
    ds_read_b32 v80, v83
    ds_read_b32 v84, v87
    ds_read_b32 v88, v91
    ds_read_b32 v92, v95
    ds_read_b32 v96, v99
    ds_read_b32 v100, v103
    ds_read_b32 v104, v107
    ds_read_b32 v108, v111
    v_lshl_add_u32 v112, v3, 2, s56
    v_lshlrev_b32 v112, 2, v112
    v_add_u32 v112, 0x20400, v112
    ds_read_b128 v[136:139], v112 offset:0
    ds_read_b128 v[144:147], v112 offset:512
    ds_read_b128 v[140:143], v112 offset:64
    ds_read_b128 v[148:151], v112 offset:576
    s_waitcnt lgkmcnt(0)
    v_mul_u32_u24 v112, 272, v2
    v_lshl_add_u32 v112, v3, 3, v112
    v_lshl_add_u32 v112, s56, 1, v112
    s_mul_i32 s37, s48, 4352
    v_add_u32 v113, s37, v112
    v_accvgpr_read_b32 v116, a0
    v_accvgpr_read_b32 v117, a1
    v_accvgpr_read_b32 v118, a2
    v_accvgpr_read_b32 v119, a3
    v_mul_f32 v116, v116, v136
    v_mul_f32 v117, v117, v137
    v_mul_f32 v118, v118, v138
    v_mul_f32 v119, v119, v139
    v_fma_f32 v116, -v144, v80, v116
    v_fma_f32 v117, -v145, v80, v117
    v_fma_f32 v118, -v146, v80, v118
    v_fma_f32 v119, -v147, v80, v119
    v_cvt_pk_bf16_f32 v120, v116, v117
    v_cvt_pk_bf16_f32 v121, v118, v119
    ds_write_b64 v113, v[120:121] offset:0
    v_accvgpr_read_b32 v124, a32
    v_accvgpr_read_b32 v125, a33
    v_accvgpr_read_b32 v126, a34
    v_accvgpr_read_b32 v127, a35
    v_mul_f32 v124, v124, v140
    v_mul_f32 v125, v125, v141
    v_mul_f32 v126, v126, v142
    v_mul_f32 v127, v127, v143
    v_fma_f32 v124, -v148, v80, v124
    v_fma_f32 v125, -v149, v80, v125
    v_fma_f32 v126, -v150, v80, v126
    v_fma_f32 v127, -v151, v80, v127
    v_cvt_pk_bf16_f32 v128, v124, v125
    v_cvt_pk_bf16_f32 v129, v126, v127
    ds_write_b64 v113, v[128:129] offset:32
    s_mul_i32 s37, s49, 4352
    v_add_u32 v113, s37, v112
    v_accvgpr_read_b32 v116, a4
    v_accvgpr_read_b32 v117, a5
    v_accvgpr_read_b32 v118, a6
    v_accvgpr_read_b32 v119, a7
    v_mul_f32 v116, v116, v136
    v_mul_f32 v117, v117, v137
    v_mul_f32 v118, v118, v138
    v_mul_f32 v119, v119, v139
    v_fma_f32 v116, -v144, v84, v116
    v_fma_f32 v117, -v145, v84, v117
    v_fma_f32 v118, -v146, v84, v118
    v_fma_f32 v119, -v147, v84, v119
    v_cvt_pk_bf16_f32 v120, v116, v117
    v_cvt_pk_bf16_f32 v121, v118, v119
    ds_write_b64 v113, v[120:121] offset:0
    v_accvgpr_read_b32 v124, a36
    v_accvgpr_read_b32 v125, a37
    v_accvgpr_read_b32 v126, a38
    v_accvgpr_read_b32 v127, a39
    v_mul_f32 v124, v124, v140
    v_mul_f32 v125, v125, v141
    v_mul_f32 v126, v126, v142
    v_mul_f32 v127, v127, v143
    v_fma_f32 v124, -v148, v84, v124
    v_fma_f32 v125, -v149, v84, v125
    v_fma_f32 v126, -v150, v84, v126
    v_fma_f32 v127, -v151, v84, v127
    v_cvt_pk_bf16_f32 v128, v124, v125
    v_cvt_pk_bf16_f32 v129, v126, v127
    ds_write_b64 v113, v[128:129] offset:32
    s_mul_i32 s37, s50, 4352
    v_add_u32 v113, s37, v112
    v_accvgpr_read_b32 v116, a8
    v_accvgpr_read_b32 v117, a9
    v_accvgpr_read_b32 v118, a10
    v_accvgpr_read_b32 v119, a11
    v_mul_f32 v116, v116, v136
    v_mul_f32 v117, v117, v137
    v_mul_f32 v118, v118, v138
    v_mul_f32 v119, v119, v139
    v_fma_f32 v116, -v144, v88, v116
    v_fma_f32 v117, -v145, v88, v117
    v_fma_f32 v118, -v146, v88, v118
    v_fma_f32 v119, -v147, v88, v119
    v_cvt_pk_bf16_f32 v120, v116, v117
    v_cvt_pk_bf16_f32 v121, v118, v119
    ds_write_b64 v113, v[120:121] offset:0
    v_accvgpr_read_b32 v124, a40
    v_accvgpr_read_b32 v125, a41
    v_accvgpr_read_b32 v126, a42
    v_accvgpr_read_b32 v127, a43
    v_mul_f32 v124, v124, v140
    v_mul_f32 v125, v125, v141
    v_mul_f32 v126, v126, v142
    v_mul_f32 v127, v127, v143
    v_fma_f32 v124, -v148, v88, v124
    v_fma_f32 v125, -v149, v88, v125
    v_fma_f32 v126, -v150, v88, v126
    v_fma_f32 v127, -v151, v88, v127
    v_cvt_pk_bf16_f32 v128, v124, v125
    v_cvt_pk_bf16_f32 v129, v126, v127
    ds_write_b64 v113, v[128:129] offset:32
    s_mul_i32 s37, s51, 4352
    v_add_u32 v113, s37, v112
    v_accvgpr_read_b32 v116, a12
    v_accvgpr_read_b32 v117, a13
    v_accvgpr_read_b32 v118, a14
    v_accvgpr_read_b32 v119, a15
    v_mul_f32 v116, v116, v136
    v_mul_f32 v117, v117, v137
    v_mul_f32 v118, v118, v138
    v_mul_f32 v119, v119, v139
    v_fma_f32 v116, -v144, v92, v116
    v_fma_f32 v117, -v145, v92, v117
    v_fma_f32 v118, -v146, v92, v118
    v_fma_f32 v119, -v147, v92, v119
    v_cvt_pk_bf16_f32 v120, v116, v117
    v_cvt_pk_bf16_f32 v121, v118, v119
    ds_write_b64 v113, v[120:121] offset:0
    v_accvgpr_read_b32 v124, a44
    v_accvgpr_read_b32 v125, a45
    v_accvgpr_read_b32 v126, a46
    v_accvgpr_read_b32 v127, a47
    v_mul_f32 v124, v124, v140
    v_mul_f32 v125, v125, v141
    v_mul_f32 v126, v126, v142
    v_mul_f32 v127, v127, v143
    v_fma_f32 v124, -v148, v92, v124
    v_fma_f32 v125, -v149, v92, v125
    v_fma_f32 v126, -v150, v92, v126
    v_fma_f32 v127, -v151, v92, v127
    v_cvt_pk_bf16_f32 v128, v124, v125
    v_cvt_pk_bf16_f32 v129, v126, v127
    ds_write_b64 v113, v[128:129] offset:32
    s_mul_i32 s37, s52, 4352
    v_add_u32 v113, s37, v112
    v_accvgpr_read_b32 v116, a16
    v_accvgpr_read_b32 v117, a17
    v_accvgpr_read_b32 v118, a18
    v_accvgpr_read_b32 v119, a19
    v_mul_f32 v116, v116, v136
    v_mul_f32 v117, v117, v137
    v_mul_f32 v118, v118, v138
    v_mul_f32 v119, v119, v139
    v_fma_f32 v116, -v144, v96, v116
    v_fma_f32 v117, -v145, v96, v117
    v_fma_f32 v118, -v146, v96, v118
    v_fma_f32 v119, -v147, v96, v119
    v_cvt_pk_bf16_f32 v120, v116, v117
    v_cvt_pk_bf16_f32 v121, v118, v119
    ds_write_b64 v113, v[120:121] offset:0
    v_accvgpr_read_b32 v124, a48
    v_accvgpr_read_b32 v125, a49
    v_accvgpr_read_b32 v126, a50
    v_accvgpr_read_b32 v127, a51
    v_mul_f32 v124, v124, v140
    v_mul_f32 v125, v125, v141
    v_mul_f32 v126, v126, v142
    v_mul_f32 v127, v127, v143
    v_fma_f32 v124, -v148, v96, v124
    v_fma_f32 v125, -v149, v96, v125
    v_fma_f32 v126, -v150, v96, v126
    v_fma_f32 v127, -v151, v96, v127
    v_cvt_pk_bf16_f32 v128, v124, v125
    v_cvt_pk_bf16_f32 v129, v126, v127
    ds_write_b64 v113, v[128:129] offset:32
    s_mul_i32 s37, s53, 4352
    v_add_u32 v113, s37, v112
    v_accvgpr_read_b32 v116, a20
    v_accvgpr_read_b32 v117, a21
    v_accvgpr_read_b32 v118, a22
    v_accvgpr_read_b32 v119, a23
    v_mul_f32 v116, v116, v136
    v_mul_f32 v117, v117, v137
    v_mul_f32 v118, v118, v138
    v_mul_f32 v119, v119, v139
    v_fma_f32 v116, -v144, v100, v116
    v_fma_f32 v117, -v145, v100, v117
    v_fma_f32 v118, -v146, v100, v118
    v_fma_f32 v119, -v147, v100, v119
    v_cvt_pk_bf16_f32 v120, v116, v117
    v_cvt_pk_bf16_f32 v121, v118, v119
    ds_write_b64 v113, v[120:121] offset:0
    v_accvgpr_read_b32 v124, a52
    v_accvgpr_read_b32 v125, a53
    v_accvgpr_read_b32 v126, a54
    v_accvgpr_read_b32 v127, a55
    v_mul_f32 v124, v124, v140
    v_mul_f32 v125, v125, v141
    v_mul_f32 v126, v126, v142
    v_mul_f32 v127, v127, v143
    v_fma_f32 v124, -v148, v100, v124
    v_fma_f32 v125, -v149, v100, v125
    v_fma_f32 v126, -v150, v100, v126
    v_fma_f32 v127, -v151, v100, v127
    v_cvt_pk_bf16_f32 v128, v124, v125
    v_cvt_pk_bf16_f32 v129, v126, v127
    ds_write_b64 v113, v[128:129] offset:32
    s_mul_i32 s37, s54, 4352
    v_add_u32 v113, s37, v112
    v_accvgpr_read_b32 v116, a24
    v_accvgpr_read_b32 v117, a25
    v_accvgpr_read_b32 v118, a26
    v_accvgpr_read_b32 v119, a27
    v_mul_f32 v116, v116, v136
    v_mul_f32 v117, v117, v137
    v_mul_f32 v118, v118, v138
    v_mul_f32 v119, v119, v139
    v_fma_f32 v116, -v144, v104, v116
    v_fma_f32 v117, -v145, v104, v117
    v_fma_f32 v118, -v146, v104, v118
    v_fma_f32 v119, -v147, v104, v119
    v_cvt_pk_bf16_f32 v120, v116, v117
    v_cvt_pk_bf16_f32 v121, v118, v119
    ds_write_b64 v113, v[120:121] offset:0
    v_accvgpr_read_b32 v124, a56
    v_accvgpr_read_b32 v125, a57
    v_accvgpr_read_b32 v126, a58
    v_accvgpr_read_b32 v127, a59
    v_mul_f32 v124, v124, v140
    v_mul_f32 v125, v125, v141
    v_mul_f32 v126, v126, v142
    v_mul_f32 v127, v127, v143
    v_fma_f32 v124, -v148, v104, v124
    v_fma_f32 v125, -v149, v104, v125
    v_fma_f32 v126, -v150, v104, v126
    v_fma_f32 v127, -v151, v104, v127
    v_cvt_pk_bf16_f32 v128, v124, v125
    v_cvt_pk_bf16_f32 v129, v126, v127
    ds_write_b64 v113, v[128:129] offset:32
    s_mul_i32 s37, s55, 4352
    v_add_u32 v113, s37, v112
    v_accvgpr_read_b32 v116, a28
    v_accvgpr_read_b32 v117, a29
    v_accvgpr_read_b32 v118, a30
    v_accvgpr_read_b32 v119, a31
    v_mul_f32 v116, v116, v136
    v_mul_f32 v117, v117, v137
    v_mul_f32 v118, v118, v138
    v_mul_f32 v119, v119, v139
    v_fma_f32 v116, -v144, v108, v116
    v_fma_f32 v117, -v145, v108, v117
    v_fma_f32 v118, -v146, v108, v118
    v_fma_f32 v119, -v147, v108, v119
    v_cvt_pk_bf16_f32 v120, v116, v117
    v_cvt_pk_bf16_f32 v121, v118, v119
    ds_write_b64 v113, v[120:121] offset:0
    v_accvgpr_read_b32 v124, a60
    v_accvgpr_read_b32 v125, a61
    v_accvgpr_read_b32 v126, a62
    v_accvgpr_read_b32 v127, a63
    v_mul_f32 v124, v124, v140
    v_mul_f32 v125, v125, v141
    v_mul_f32 v126, v126, v142
    v_mul_f32 v127, v127, v143
    v_fma_f32 v124, -v148, v108, v124
    v_fma_f32 v125, -v149, v108, v125
    v_fma_f32 v126, -v150, v108, v126
    v_fma_f32 v127, -v151, v108, v127
    v_cvt_pk_bf16_f32 v128, v124, v125
    v_cvt_pk_bf16_f32 v129, v126, v127
    ds_write_b64 v113, v[128:129] offset:32
    s_waitcnt lgkmcnt(0)
k1_kernel_phase2:
    s_barrier
    s_cmp_ge_u32 s34, 10
    s_cbranch_scc1 k1_kernel_v2
    s_cmp_ge_u32 s34, 5
    s_cselect_b32 s37, 640, 0
    s_cselect_b32 s46, 0x400000, 0
    s_sub_u32 s37, s36, s37
    s_mov_b32 s38, 3277
    v_and_b32 v112, 31, v1
    v_lshrrev_b32 v113, 5, v1
    v_lshl_add_u32 v113, s43, 4, v113
    v_mul_u32_u24 v114, 272, v113
    v_lshl_add_u32 v114, v112, 3, v114
    v_lshl_add_u32 v112, v112, 2, s37
    v_mul_lo_u32 v115, v112, s38
    v_lshrrev_b32 v115, 16, v115
    v_mul_u32_u24 v116, 20, v115
    v_sub_u32 v112, v112, v116
    v_lshlrev_b32 v115, 11, v115
    v_add3_u32 v115, v115, v113, s35
    v_mul_u32_u24 v115, 40, v115
    v_lshl_add_u32 v115, v112, 1, v115
    v_add_u32 v115, s46, v115
    ds_read_b64 v[116:117], v114 offset:0
    ds_read_b64 v[118:119], v114 offset:544
    ds_read_b64 v[120:121], v114 offset:1088
    ds_read_b64 v[122:123], v114 offset:1632
    ds_read_b64 v[124:125], v114 offset:2176
    ds_read_b64 v[126:127], v114 offset:2720
    ds_read_b64 v[128:129], v114 offset:3264
    ds_read_b64 v[130:131], v114 offset:3808
    s_waitcnt lgkmcnt(7)
    buffer_store_dwordx2 v[116:117], v115, s[16:19], 0 offen offset:0
    s_waitcnt lgkmcnt(6)
    buffer_store_dwordx2 v[118:119], v115, s[16:19], 0 offen offset:80
    s_waitcnt lgkmcnt(5)
    buffer_store_dwordx2 v[120:121], v115, s[16:19], 0 offen offset:160
    s_waitcnt lgkmcnt(4)
    buffer_store_dwordx2 v[122:123], v115, s[16:19], 0 offen offset:240
    s_waitcnt lgkmcnt(3)
    buffer_store_dwordx2 v[124:125], v115, s[16:19], 0 offen offset:320
    s_waitcnt lgkmcnt(2)
    buffer_store_dwordx2 v[126:127], v115, s[16:19], 0 offen offset:400
    s_waitcnt lgkmcnt(1)
    buffer_store_dwordx2 v[128:129], v115, s[16:19], 0 offen offset:480
    s_waitcnt lgkmcnt(0)
    buffer_store_dwordx2 v[130:131], v115, s[16:19], 0 offen offset:560
    s_endpgm
k1_kernel_v2:
    v_lshrrev_b32 v112, 4, v1
    v_lshl_add_u32 v112, s43, 4, v112
    v_mul_u32_u24 v113, 272, v112
    v_lshl_add_u32 v113, v2, 4, v113
    s_sub_u32 s37, s36, 1280
    v_add_u32 v112, s37, v112
    v_lshlrev_b32 v112, 12, v112
    v_lshl_add_u32 v112, v2, 4, v112
    s_lshl_b32 s37, s35, 1
    s_add_u32 s37, s37, 0x800000
    v_add_u32 v112, s37, v112
    ds_read_b128 v[116:119], v113 offset:0
    ds_read_b128 v[120:123], v113 offset:1088
    ds_read_b128 v[124:127], v113 offset:2176
    ds_read_b128 v[128:131], v113 offset:3264
    s_waitcnt lgkmcnt(3)
    buffer_store_dwordx4 v[116:119], v112, s[16:19], 0 offen
    v_add_u32 v112, 0x4000, v112
    s_waitcnt lgkmcnt(2)
    buffer_store_dwordx4 v[120:123], v112, s[16:19], 0 offen
    v_add_u32 v112, 0x4000, v112
    s_waitcnt lgkmcnt(1)
    buffer_store_dwordx4 v[124:127], v112, s[16:19], 0 offen
    v_add_u32 v112, 0x4000, v112
    s_waitcnt lgkmcnt(0)
    buffer_store_dwordx4 v[128:131], v112, s[16:19], 0 offen
    v_add_u32 v112, 0x4000, v112
k1_kernel_end:
    s_endpgm
.p2align 8
.globl k2_kernel
.type k2_kernel,@function
k2_kernel:
    s_cmp_ge_u32 s2, 512
    s_cbranch_scc1 k2_kernel_end
    s_load_dwordx2 s[4:5], s[0:1], 80
    s_load_dwordx2 s[24:25], s[0:1], 16
    s_load_dwordx8 s[84:91], s[0:1], 32
    s_and_b32 s35, s2, 7
    s_lshr_b32 s36, s2, 3
    s_lshr_b32 s33, s36, 1
    s_and_b32 s34, s36, 1
    s_lshl_b32 s35, s35, 1
    s_add_u32 s34, s34, s35
    s_lshl_b32 s34, s34, 7
    v_and_b32 v1, 63, v0
    v_lshrrev_b32 v4, 6, v0
    v_and_b32 v2, 15, v0
    v_bfe_u32 v3, v0, 4, 2
    v_readfirstlane_b32 s32, v4
    s_waitcnt lgkmcnt(0)
    s_mov_b32 s8, s4
    s_and_b32 s9, s5, 0xffff
    s_mov_b32 s10, 0x280000
    s_mov_b32 s11, 0x00020000
    s_add_u32 s12, s4, 0x400000
    s_addc_u32 s13, s5, 0
    s_and_b32 s13, s13, 0xffff
    s_mov_b32 s14, 0x280000
    s_mov_b32 s15, 0x00020000
    s_add_u32 s16, s4, 0x800000
    s_addc_u32 s17, s5, 0
    s_and_b32 s17, s17, 0xffff
    s_mov_b32 s18, 0x280000
    s_mov_b32 s19, 0x00020000
    s_add_u32 s20, s4, 0xa80000
    s_addc_u32 s21, s5, 0
    s_and_b32 s21, s21, 0xffff
    s_mov_b32 s22, 0x280000
    s_mov_b32 s23, 0x00020000
    s_lshl_b32 s35, s33, 11
    s_add_u32 s35, s35, s34
    s_sub_u32 s35, s35, 256
    s_mul_i32 s36, s32, 96
    s_add_u32 s35, s35, s36
    s_mul_i32 s37, s35, 40
    v_lshrrev_b32 v4, 2, v1
    v_mul_u32_u24 v4, 40, v4
    v_add_u32 v4, s37, v4
    v_and_b32 v5, 3, v1
    v_mov_b32 v10, 0x7fffff00
    v_lshl_add_u32 v6, v5, 4, v4
    v_cmp_eq_u32 vcc, 3, v5
    v_xor_b32 v5, 2, v5
    v_lshl_add_u32 v7, v5, 4, v4
    v_cndmask_b32 v6, v6, v10, vcc
    v_cmp_eq_u32 vcc, 3, v5
    s_mul_i32 s36, s32, 6144
    s_nop 0
    v_cndmask_b32 v7, v7, v10, vcc
    s_add_u32 m0, s36, 0
    v_add_u32 v8, 0, v6
    buffer_load_dwordx4 v8, s[12:15], 0 offen lds
    s_add_u32 m0, s36, 1024
    v_add_u32 v9, 640, v7
    buffer_load_dwordx4 v9, s[12:15], 0 offen lds
    s_add_u32 m0, s36, 2048
    v_add_u32 v8, 1280, v6
    buffer_load_dwordx4 v8, s[12:15], 0 offen lds
    s_add_u32 m0, s36, 3072
    v_add_u32 v9, 1920, v7
    buffer_load_dwordx4 v9, s[12:15], 0 offen lds
    s_add_u32 m0, s36, 4096
    v_add_u32 v8, 2560, v6
    buffer_load_dwordx4 v8, s[12:15], 0 offen lds
    s_add_u32 m0, s36, 5120
    v_add_u32 v9, 3200, v7
    buffer_load_dwordx4 v9, s[12:15], 0 offen lds
    s_lshl_b32 s35, s33, 11
    s_add_u32 s35, s35, s34
    s_lshl_b32 s36, s32, 5
    s_add_u32 s35, s35, s36
    v_add_u32 v4, s35, v2
    v_mul_u32_u24 v4, 40, v4
    v_lshl_add_u32 v4, v3, 4, v4
    buffer_load_dwordx4 v[20:23], v4, s[8:11], 0 offen
    buffer_load_dwordx4 v[24:27], v4, s[8:11], 0 offen offset:640
    s_mul_i32 s35, s33, 20
    s_lshl_b32 s35, s35, 12
    s_lshl_b32 s36, s34, 1
    s_add_u32 s35, s35, s36
    s_sub_u32 s35, s35, 512
    s_lshl_b32 s36, s32, 8
    s_mov_b32 s38, 1311
    v_add_u32 v4, s36, v1
    v_mul_lo_u32 v5, v4, s38
    v_lshrrev_b32 v5, 16, v5
    v_mul_u32_u24 v6, 50, v5
    v_sub_u32 v6, v4, v6
    v_lshlrev_b32 v7, 12, v5
    v_lshl_add_u32 v7, v6, 4, v7
    v_add_u32 v7, s35, v7
    v_cmp_le_u32 vcc, 20, v5
    v_cmp_le_u32 s[40:41], 48, v6
    s_or_b64 vcc, vcc, s[40:41]
    v_mov_b32 v8, 0x7fffff00
    s_lshl_b32 m0, s32, 12
    v_cndmask_b32 v7, v7, v8, vcc
    s_add_u32 m0, m0, 24576
    s_nop 0
    buffer_load_dwordx4 v7, s[16:19], 0 offen lds
    v_add_u32 v4, s36, v1
    v_add_u32 v4, 64, v4
    v_mul_lo_u32 v5, v4, s38
    v_lshrrev_b32 v5, 16, v5
    v_mul_u32_u24 v6, 50, v5
    v_sub_u32 v6, v4, v6
    v_lshlrev_b32 v7, 12, v5
    v_lshl_add_u32 v7, v6, 4, v7
    v_add_u32 v7, s35, v7
    v_cmp_le_u32 vcc, 20, v5
    v_cmp_le_u32 s[40:41], 48, v6
    s_or_b64 vcc, vcc, s[40:41]
    v_mov_b32 v8, 0x7fffff00
    s_lshl_b32 m0, s32, 12
    v_cndmask_b32 v7, v7, v8, vcc
    s_add_u32 m0, m0, 25600
    s_nop 0
    buffer_load_dwordx4 v7, s[16:19], 0 offen lds
    v_add_u32 v4, s36, v1
    v_add_u32 v4, 128, v4
    v_mul_lo_u32 v5, v4, s38
    v_lshrrev_b32 v5, 16, v5
    v_mul_u32_u24 v6, 50, v5
    v_sub_u32 v6, v4, v6
    v_lshlrev_b32 v7, 12, v5
    v_lshl_add_u32 v7, v6, 4, v7
    v_add_u32 v7, s35, v7
    v_cmp_le_u32 vcc, 20, v5
    v_cmp_le_u32 s[40:41], 48, v6
    s_or_b64 vcc, vcc, s[40:41]
    v_mov_b32 v8, 0x7fffff00
    s_lshl_b32 m0, s32, 12
    v_cndmask_b32 v7, v7, v8, vcc
    s_add_u32 m0, m0, 26624
    s_nop 0
    buffer_load_dwordx4 v7, s[16:19], 0 offen lds
    v_add_u32 v4, s36, v1
    v_add_u32 v4, 192, v4
    v_mul_lo_u32 v5, v4, s38
    v_lshrrev_b32 v5, 16, v5
    v_mul_u32_u24 v6, 50, v5
    v_sub_u32 v6, v4, v6
    v_lshlrev_b32 v7, 12, v5
    v_lshl_add_u32 v7, v6, 4, v7
    v_add_u32 v7, s35, v7
    v_cmp_le_u32 vcc, 20, v5
    v_cmp_le_u32 s[40:41], 48, v6
    s_or_b64 vcc, vcc, s[40:41]
    v_mov_b32 v8, 0x7fffff00
    s_lshl_b32 m0, s32, 12
    v_cndmask_b32 v7, v7, v8, vcc
    s_add_u32 m0, m0, 27648
    s_nop 0
    buffer_load_dwordx4 v7, s[16:19], 0 offen lds
    v_lshrrev_b32 v4, 2, v2
    v_and_b32 v5, 3, v2
    v_lshl_add_u32 v4, v4, 3, v5
    v_bfe_u32 v5, v4, 4, 1
    v_lshlrev_b32 v5, 1, v5
    v_xor_b32 v5, v5, v3
    v_lshlrev_b32 v4, 6, v4
    v_lshl_add_u32 v4, v5, 4, v4
    s_lshl_b32 s35, s32, 11
    v_add_u32 v12, s35, v4
    v_add_u32 v13, 256, v12
    v_mul_u32_u24 v4, 800, v2
    v_lshl_add_u32 v4, v3, 4, v4
    s_lshl_b32 s35, s32, 6
    s_add_u32 s35, s35, 24576
    v_add_u32 v14, s35, v4
    v_add_u32 v4, 16, v2
    v_add_u32 v5, 17, v2
    v_min_u32 v5, 22, v5
    v_cmp_gt_u32 vcc, 4, v2
    s_nop 1
    v_cndmask_b32 v4, v5, v4, vcc
    v_mul_u32_u24 v4, 800, v4
    v_lshl_add_u32 v4, v3, 4, v4
    v_add_u32 v15, s35, v4
    v_lshlrev_b32 v4, 3, v3
    v_sub_u32 v16, v2, v4
    v_xor_b32 v4, 16, v1
    v_lshlrev_b32 v17, 2, v4
    v_xor_b32 v4, 32, v1
    v_lshlrev_b32 v18, 2, v4
    v_add_u32 v4, 16, v2
    v_lshlrev_b32 v19, 2, v4
    v_mov_b32 v28, 0
    v_mov_b32 v29, 0
    v_mov_b32 v30, 0
    v_mov_b32 v31, 0
    v_mov_b32 v32, 0
    v_mov_b32 v33, 0
    v_mov_b32 v34, 0
    v_mov_b32 v35, 0
    v_mov_b32 v36, 0
    v_mov_b32 v37, 0
    v_mov_b32 v38, 0
    v_mov_b32 v39, 0
    v_mov_b32 v40, 0
    v_mov_b32 v41, 0
    v_mov_b32 v42, 0
    v_mov_b32 v43, 0
    v_cmp_gt_u32 vcc, 48, v1
    s_and_saveexec_b64 s[40:41], vcc
    s_cmp_lt_u32 s32, 2
    s_cbranch_scc0 L_ones_1
    s_cmp_eq_u32 s32, 0
    s_cselect_b32 s35, 0x3f803f80, 0
    v_mov_b32 v8, s35
    v_mov_b32 v9, s35
    v_mov_b32 v10, s35
    v_mov_b32 v11, s35
    s_mul_i32 s35, s32, 800
    s_add_u32 s35, s35, 41376
    v_lshlrev_b32 v4, 4, v1
    v_add_u32 v4, s35, v4
    ds_write_b128 v4, v[8:11]
L_ones_1:
    s_mov_b64 exec, s[40:41]
    s_lshl_b32 s44, s2, 2
    s_add_u32 s44, s44, s32
    s_mov_b32 s51, 6554
    s_mov_b32 s52, 1280
    s_sub_u32 s45, s44, 0
    s_cmp_lt_u32 s45, 800
    s_cselect_b32 s45, s45, 0x100000
    s_mul_hi_u32 s47, s45, 0xccccccd
    s_mul_i32 s49, s47, 20
    s_sub_u32 s48, s45, s49
    s_lshl_b32 s48, s48, 6
    v_add_u32 v4, s48, v1
    v_mul_lo_u32 v5, v4, s51
    v_lshrrev_b32 v5, 16, v5
    v_mul_u32_u24 v6, 10, v5
    v_sub_u32 v6, v4, v6
    v_lshrrev_b32 v7, 1, v6
    v_and_b32 v6, 1, v6
    v_and_b32 v8, 7, v5
    v_bfe_u32 v8, v5, 2, 2
    v_bfe_u32 v9, v5, 4, 1
    v_and_b32 v10, 0xffe3, v5
    v_lshl_add_u32 v10, v8, 3, v10
    v_lshl_add_u32 v10, v9, 2, v10
    v_mul_lo_u32 v10, v10, s52
    v_lshlrev_b32 v7, 5, v7
    v_lshl_add_u32 v7, v6, 4, v7
    v_add_u32 v11, v10, v7
    s_mul_hi_u32 s46, s47, 0x33333334
    s_mul_i32 s49, s46, 5
    s_sub_u32 s47, s47, s49
    s_mul_i32 s47, s47, 163840
    s_mul_i32 s46, s46, 160
    s_add_u32 s47, s47, s46
    s_cmp_lt_u32 s45, 800
    s_cselect_b32 s47, s47, 0x7ff00000
    v_add_u32 v224, s47, v11
    s_lshl_b32 s50, s45, 10
    s_add_u32 s50, s50, 0x0
    v_lshl_add_u32 v244, v1, 4, s50
    s_mov_b32 s51, 6554
    s_mov_b32 s52, 1280
    s_sub_u32 s45, s44, 800
    s_cmp_lt_u32 s45, 800
    s_cselect_b32 s45, s45, 0x100000
    s_mul_hi_u32 s47, s45, 0xccccccd
    s_mul_i32 s49, s47, 20
    s_sub_u32 s48, s45, s49
    s_lshl_b32 s48, s48, 6
    v_add_u32 v4, s48, v1
    v_mul_lo_u32 v5, v4, s51
    v_lshrrev_b32 v5, 16, v5
    v_mul_u32_u24 v6, 10, v5
    v_sub_u32 v6, v4, v6
    v_lshrrev_b32 v7, 1, v6
    v_and_b32 v6, 1, v6
    v_and_b32 v8, 7, v5
    v_bfe_u32 v8, v5, 2, 2
    v_bfe_u32 v9, v5, 4, 1
    v_and_b32 v10, 0xffe3, v5
    v_lshl_add_u32 v10, v8, 3, v10
    v_lshl_add_u32 v10, v9, 2, v10
    v_mul_lo_u32 v10, v10, s52
    v_lshlrev_b32 v7, 5, v7
    v_lshl_add_u32 v7, v6, 4, v7
    v_add_u32 v11, v10, v7
    s_mul_hi_u32 s46, s47, 0x33333334
    s_mul_i32 s49, s46, 5
    s_sub_u32 s47, s47, s49
    s_mul_i32 s47, s47, 163840
    s_mul_i32 s46, s46, 160
    s_add_u32 s47, s47, s46
    s_cmp_lt_u32 s45, 800
    s_cselect_b32 s47, s47, 0x7ff00000
    v_add_u32 v228, s47, v11
    s_lshl_b32 s50, s45, 10
    s_add_u32 s50, s50, 0xc8000
    v_lshl_add_u32 v245, v1, 4, s50
    s_mov_b32 s51, 6554
    s_mov_b32 s52, 1280
    s_sub_u32 s45, s44, 1240
    s_cmp_lt_u32 s45, 800
    s_cselect_b32 s45, s45, 0x100000
    s_mul_hi_u32 s47, s45, 0xccccccd
    s_mul_i32 s49, s47, 20
    s_sub_u32 s48, s45, s49
    s_lshl_b32 s48, s48, 6
    v_add_u32 v4, s48, v1
    v_mul_lo_u32 v5, v4, s51
    v_lshrrev_b32 v5, 16, v5
    v_mul_u32_u24 v6, 10, v5
    v_sub_u32 v6, v4, v6
    v_lshrrev_b32 v7, 1, v6
    v_and_b32 v6, 1, v6
    v_and_b32 v8, 7, v5
    v_bfe_u32 v8, v5, 2, 2
    v_bfe_u32 v9, v5, 4, 1
    v_and_b32 v10, 0xffe3, v5
    v_lshl_add_u32 v10, v8, 3, v10
    v_lshl_add_u32 v10, v9, 2, v10
    v_mul_lo_u32 v10, v10, s52
    v_lshlrev_b32 v7, 5, v7
    v_lshl_add_u32 v7, v6, 4, v7
    v_add_u32 v11, v10, v7
    s_mul_hi_u32 s46, s47, 0x33333334
    s_mul_i32 s49, s46, 5
    s_sub_u32 s47, s47, s49
    s_mul_i32 s47, s47, 163840
    s_mul_i32 s46, s46, 160
    s_add_u32 s47, s47, s46
    s_cmp_lt_u32 s45, 800
    s_cselect_b32 s47, s47, 0x7ff00000
    v_add_u32 v232, s47, v11
    s_lshl_b32 s50, s45, 10
    s_add_u32 s50, s50, 0x190000
    v_lshl_add_u32 v246, v1, 4, s50
    s_mov_b32 s51, 5462
    s_mov_b32 s52, 3072
    s_sub_u32 s45, s44, 0
    s_cmp_lt_u32 s45, 1920
    s_cselect_b32 s45, s45, 0x100000
    s_mul_hi_u32 s47, s45, 0x15555556
    s_mul_i32 s49, s47, 12
    s_sub_u32 s48, s45, s49
    s_lshl_b32 s48, s48, 6
    v_add_u32 v4, s48, v1
    v_mul_lo_u32 v5, v4, s51
    v_lshrrev_b32 v5, 16, v5
    v_mul_u32_u24 v6, 12, v5
    v_sub_u32 v6, v4, v6
    v_lshrrev_b32 v7, 1, v6
    v_and_b32 v6, 1, v6
    v_and_b32 v8, 7, v5
    v_lshrrev_b32 v8, 2, v8
    v_sub_u32 v7, v7, v8
    v_add_u32 v8, 6, v7
    v_min_u32 v7, v7, v8
    v_bfe_u32 v8, v5, 2, 2
    v_bfe_u32 v9, v5, 4, 1
    v_and_b32 v10, 0xffe3, v5
    v_lshl_add_u32 v10, v8, 3, v10
    v_lshl_add_u32 v10, v9, 2, v10
    v_mul_lo_u32 v10, v10, s52
    v_lshlrev_b32 v7, 5, v7
    v_lshl_add_u32 v7, v6, 4, v7
    v_add_u32 v11, v10, v7
    s_mul_hi_u32 s46, s47, 0x1999999a
    s_mul_i32 s49, s46, 10
    s_sub_u32 s47, s47, s49
    s_mul_i32 s47, s47, 196608
    s_mul_i32 s46, s46, 192
    s_add_u32 s47, s47, s46
    s_cmp_lt_u32 s45, 1920
    s_cselect_b32 s47, s47, 0x7ff00000
    v_add_u32 v236, s47, v11
    s_lshl_b32 s50, s45, 10
    s_add_u32 s50, s50, 0x258000
    v_lshl_add_u32 v247, v1, 4, s50
    s_mov_b32 s51, 6554
    s_mov_b32 s52, 1280
    s_sub_u32 s45, s44, 0
    s_cmp_lt_u32 s45, 1920
    s_cselect_b32 s45, s45, 0x100000
    s_mul_hi_u32 s47, s45, 0xccccccd
    s_mul_i32 s49, s47, 20
    s_sub_u32 s48, s45, s49
    s_lshl_b32 s48, s48, 6
    v_add_u32 v4, s48, v1
    v_mul_lo_u32 v5, v4, s51
    v_lshrrev_b32 v5, 16, v5
    v_mul_u32_u24 v6, 10, v5
    v_sub_u32 v6, v4, v6
    v_lshrrev_b32 v7, 1, v6
    v_and_b32 v6, 1, v6
    v_and_b32 v8, 7, v5
    v_bfe_u32 v8, v5, 2, 2
    v_bfe_u32 v9, v5, 4, 1
    v_and_b32 v10, 0xffe3, v5
    v_lshl_add_u32 v10, v8, 3, v10
    v_lshl_add_u32 v10, v9, 2, v10
    v_mul_lo_u32 v10, v10, s52
    v_lshlrev_b32 v7, 5, v7
    v_lshl_add_u32 v7, v6, 4, v7
    v_add_u32 v11, v10, v7
    s_mul_hi_u32 s46, s47, 0x15555556
    s_mul_i32 s49, s46, 12
    s_sub_u32 s47, s47, s49
    s_mul_i32 s47, s47, 163840
    s_mul_i32 s46, s46, 160
    s_add_u32 s47, s47, s46
    s_cmp_lt_u32 s45, 1920
    s_cselect_b32 s47, s47, 0x7ff00000
    v_add_u32 v240, s47, v11
    s_lshl_b32 s50, s45, 10
    s_add_u32 s50, s50, 0x438000
    v_lshl_add_u32 v248, v1, 4, s50
    v_cmp_gt_u32 vcc, 2, v3
    v_cmp_gt_u32 s[40:41], 3, v3
    s_waitcnt lgkmcnt(0)
    s_waitcnt vmcnt(4)
    s_barrier
    s_mov_b32 s56, s24
    s_and_b32 s57, s25, 0xffff
    s_mov_b32 s58, 0xc8000
    s_mov_b32 s59, 0x00020000
    buffer_load_dwordx4 v[224:227], v224, s[56:59], 0 offen
    s_mov_b32 s56, s84
    s_and_b32 s57, s85, 0xffff
    s_mov_b32 s58, 0xc8000
    s_mov_b32 s59, 0x00020000
    buffer_load_dwordx4 v[228:231], v228, s[56:59], 0 offen
    s_mov_b32 s56, s86
    s_and_b32 s57, s87, 0xffff
    s_mov_b32 s58, 0xc8000
    s_mov_b32 s59, 0x00020000
    buffer_load_dwordx4 v[232:235], v232, s[56:59], 0 offen
    s_mov_b32 s56, s88
    s_and_b32 s57, s89, 0xffff
    s_mov_b32 s58, 0x1e0000
    s_mov_b32 s59, 0x00020000
    buffer_load_dwordx4 v[236:239], v236, s[56:59], 0 offen
    s_mov_b32 s56, s90
    s_and_b32 s57, s91, 0xffff
    s_mov_b32 s58, 0x1e0000
    s_mov_b32 s59, 0x00020000
    buffer_load_dwordx4 v[240:243], v240, s[56:59], 0 offen
    v_cndmask_b32 v20, 0, v20, s[40:41]
    v_cndmask_b32 v21, 0, v21, s[40:41]
    v_cndmask_b32 v22, 0, v22, vcc
    v_cndmask_b32 v23, 0, v23, vcc
    v_cndmask_b32 v24, 0, v24, s[40:41]
    v_cndmask_b32 v25, 0, v25, s[40:41]
    v_cndmask_b32 v26, 0, v26, vcc
    v_cndmask_b32 v27, 0, v27, vcc
    ds_read_b128 v[44:47], v12 offset:0
    ds_read_b128 v[48:51], v13 offset:0
    ds_read_b128 v[52:55], v12 offset:2048
    ds_read_b128 v[56:59], v13 offset:2048
    s_waitcnt lgkmcnt(2)
    v_mfma_f32_16x16x32_bf16 v[80:83], v[44:47], v[20:23], 0
    v_mfma_f32_16x16x32_bf16 v[84:87], v[48:51], v[20:23], 0
    v_mfma_f32_16x16x32_bf16 v[88:91], v[44:47], v[24:27], 0
    v_mfma_f32_16x16x32_bf16 v[92:95], v[48:51], v[24:27], 0
    ds_read_b128 v[44:47], v12 offset:4096
    ds_read_b128 v[48:51], v13 offset:4096
    s_waitcnt lgkmcnt(2)
    v_mfma_f32_16x16x32_bf16 v[96:99], v[52:55], v[20:23], 0
    v_mfma_f32_16x16x32_bf16 v[100:103], v[56:59], v[20:23], 0
    v_mfma_f32_16x16x32_bf16 v[104:107], v[52:55], v[24:27], 0
    v_mfma_f32_16x16x32_bf16 v[108:111], v[56:59], v[24:27], 0
    ds_read_b128 v[52:55], v12 offset:6144
    ds_read_b128 v[56:59], v13 offset:6144
    s_waitcnt lgkmcnt(2)
    v_mfma_f32_16x16x32_bf16 v[112:115], v[44:47], v[20:23], 0
    v_mfma_f32_16x16x32_bf16 v[116:119], v[48:51], v[20:23], 0
    v_mfma_f32_16x16x32_bf16 v[120:123], v[44:47], v[24:27], 0
    v_mfma_f32_16x16x32_bf16 v[124:127], v[48:51], v[24:27], 0
    ds_read_b128 v[44:47], v12 offset:8192
    ds_read_b128 v[48:51], v13 offset:8192
    s_waitcnt lgkmcnt(2)
    v_mfma_f32_16x16x32_bf16 v[128:131], v[52:55], v[20:23], 0
    v_mfma_f32_16x16x32_bf16 v[132:135], v[56:59], v[20:23], 0
    v_mfma_f32_16x16x32_bf16 v[136:139], v[52:55], v[24:27], 0
    v_mfma_f32_16x16x32_bf16 v[140:143], v[56:59], v[24:27], 0
    ds_read_b128 v[52:55], v12 offset:10240
    ds_read_b128 v[56:59], v13 offset:10240
    s_waitcnt lgkmcnt(2)
    v_mfma_f32_16x16x32_bf16 v[144:147], v[44:47], v[20:23], 0
    v_mfma_f32_16x16x32_bf16 v[148:151], v[48:51], v[20:23], 0
    v_mfma_f32_16x16x32_bf16 v[152:155], v[44:47], v[24:27], 0
    v_mfma_f32_16x16x32_bf16 v[156:159], v[48:51], v[24:27], 0
    ds_read_b128 v[44:47], v12 offset:12288
    ds_read_b128 v[48:51], v13 offset:12288
    s_waitcnt lgkmcnt(2)
    v_mfma_f32_16x16x32_bf16 v[160:163], v[52:55], v[20:23], 0
    v_mfma_f32_16x16x32_bf16 v[164:167], v[56:59], v[20:23], 0
    v_mfma_f32_16x16x32_bf16 v[168:171], v[52:55], v[24:27], 0
    v_mfma_f32_16x16x32_bf16 v[172:175], v[56:59], v[24:27], 0
    ds_read_b128 v[52:55], v12 offset:14336
    ds_read_b128 v[56:59], v13 offset:14336
    s_waitcnt lgkmcnt(2)
    v_mfma_f32_16x16x32_bf16 v[176:179], v[44:47], v[20:23], 0
    v_mfma_f32_16x16x32_bf16 v[180:183], v[48:51], v[20:23], 0
    v_mfma_f32_16x16x32_bf16 v[184:187], v[44:47], v[24:27], 0
    v_mfma_f32_16x16x32_bf16 v[188:191], v[48:51], v[24:27], 0
    ds_read_b128 v[44:47], v12 offset:16384
    ds_read_b128 v[48:51], v13 offset:16384
    s_waitcnt lgkmcnt(2)
    v_mfma_f32_16x16x32_bf16 v[192:195], v[52:55], v[20:23], 0
    v_mfma_f32_16x16x32_bf16 v[196:199], v[56:59], v[20:23], 0
    v_mfma_f32_16x16x32_bf16 v[200:203], v[52:55], v[24:27], 0
    v_mfma_f32_16x16x32_bf16 v[204:207], v[56:59], v[24:27], 0
    s_waitcnt lgkmcnt(0)
    v_mfma_f32_16x16x32_bf16 v[208:211], v[44:47], v[20:23], 0
    v_mfma_f32_16x16x32_bf16 v[212:215], v[48:51], v[20:23], 0
    v_mfma_f32_16x16x32_bf16 v[216:219], v[44:47], v[24:27], 0
    v_mfma_f32_16x16x32_bf16 v[220:223], v[48:51], v[24:27], 0
    s_waitcnt lgkmcnt(0)
    s_nop 7
    s_nop 3
    v_mov_b32 v78, 0xf149f2ca
    v_cmp_gt_i32 vcc, 0, v16
    s_nop 1
    v_cndmask_b32 v80, v78, v80, vcc
    v_cndmask_b32 v208, v208, v78, vcc
    v_cmp_gt_i32 vcc, 1, v16
    s_nop 1
    v_cndmask_b32 v81, v78, v81, vcc
    v_cndmask_b32 v209, v209, v78, vcc
    v_cmp_gt_i32 vcc, 2, v16
    s_nop 1
    v_cndmask_b32 v82, v78, v82, vcc
    v_cndmask_b32 v210, v210, v78, vcc
    v_cmp_gt_i32 vcc, 3, v16
    s_nop 1
    v_cndmask_b32 v83, v78, v83, vcc
    v_cndmask_b32 v211, v211, v78, vcc
    v_cmp_gt_i32 vcc, 4, v16
    s_nop 1
    v_cndmask_b32 v84, v78, v84, vcc
    v_cndmask_b32 v212, v212, v78, vcc
    v_cmp_gt_i32 vcc, 5, v16
    s_nop 1
    v_cndmask_b32 v85, v78, v85, vcc
    v_cndmask_b32 v213, v213, v78, vcc
    v_cmp_gt_i32 vcc, 6, v16
    s_nop 1
    v_cndmask_b32 v86, v78, v86, vcc
    v_cndmask_b32 v214, v214, v78, vcc
    v_cmp_gt_i32 vcc, 7, v16
    s_nop 1
    v_cndmask_b32 v87, v78, v87, vcc
    v_cndmask_b32 v215, v215, v78, vcc
    v_cmp_gt_i32 vcc, -16, v16
    s_nop 1
    v_cndmask_b32 v88, v78, v88, vcc
    v_cndmask_b32 v216, v216, v78, vcc
    v_cmp_gt_i32 vcc, -15, v16
    s_nop 1
    v_cndmask_b32 v89, v78, v89, vcc
    v_cndmask_b32 v217, v217, v78, vcc
    v_cmp_gt_i32 vcc, -14, v16
    s_nop 1
    v_cndmask_b32 v90, v78, v90, vcc
    v_cndmask_b32 v218, v218, v78, vcc
    v_cmp_gt_i32 vcc, -13, v16
    s_nop 1
    v_cndmask_b32 v91, v78, v91, vcc
    v_cndmask_b32 v219, v219, v78, vcc
    v_cmp_gt_i32 vcc, -12, v16
    s_nop 1
    v_cndmask_b32 v92, v78, v92, vcc
    v_cndmask_b32 v220, v220, v78, vcc
    v_cmp_gt_i32 vcc, -11, v16
    s_nop 1
    v_cndmask_b32 v93, v78, v93, vcc
    v_cndmask_b32 v221, v221, v78, vcc
    v_cmp_gt_i32 vcc, -10, v16
    s_nop 1
    v_cndmask_b32 v94, v78, v94, vcc
    v_cndmask_b32 v222, v222, v78, vcc
    v_cmp_gt_i32 vcc, -9, v16
    s_nop 1
    v_cndmask_b32 v95, v78, v95, vcc
    v_cndmask_b32 v223, v223, v78, vcc
    s_lshl_b32 s35, s32, 5
    s_add_u32 s35, s35, s34
    s_cmp_lt_i32 s35, 256
    s_cbranch_scc0 L_neg_2
    v_mov_b32 v80, v78
    v_mov_b32 v81, v78
    v_mov_b32 v82, v78
    v_mov_b32 v83, v78
    v_mov_b32 v84, v78
    v_mov_b32 v85, v78
    v_mov_b32 v86, v78
    v_mov_b32 v87, v78
    v_mov_b32 v88, v78
    v_mov_b32 v89, v78
    v_mov_b32 v90, v78
    v_mov_b32 v91, v78
    v_mov_b32 v92, v78
    v_mov_b32 v93, v78
    v_mov_b32 v94, v78
    v_mov_b32 v95, v78
L_neg_2:
    s_cmp_lt_i32 s35, 224
    s_cbranch_scc0 L_neg_3
    v_mov_b32 v96, v78
    v_mov_b32 v97, v78
    v_mov_b32 v98, v78
    v_mov_b32 v99, v78
    v_mov_b32 v100, v78
    v_mov_b32 v101, v78
    v_mov_b32 v102, v78
    v_mov_b32 v103, v78
    v_mov_b32 v104, v78
    v_mov_b32 v105, v78
    v_mov_b32 v106, v78
    v_mov_b32 v107, v78
    v_mov_b32 v108, v78
    v_mov_b32 v109, v78
    v_mov_b32 v110, v78
    v_mov_b32 v111, v78
L_neg_3:
    s_cmp_lt_i32 s35, 192
    s_cbranch_scc0 L_neg_4
    v_mov_b32 v112, v78
    v_mov_b32 v113, v78
    v_mov_b32 v114, v78
    v_mov_b32 v115, v78
    v_mov_b32 v116, v78
    v_mov_b32 v117, v78
    v_mov_b32 v118, v78
    v_mov_b32 v119, v78
    v_mov_b32 v120, v78
    v_mov_b32 v121, v78
    v_mov_b32 v122, v78
    v_mov_b32 v123, v78
    v_mov_b32 v124, v78
    v_mov_b32 v125, v78
    v_mov_b32 v126, v78
    v_mov_b32 v127, v78
L_neg_4:
    s_cmp_lt_i32 s35, 160
    s_cbranch_scc0 L_neg_5
    v_mov_b32 v128, v78
    v_mov_b32 v129, v78
    v_mov_b32 v130, v78
    v_mov_b32 v131, v78
    v_mov_b32 v132, v78
    v_mov_b32 v133, v78
    v_mov_b32 v134, v78
    v_mov_b32 v135, v78
    v_mov_b32 v136, v78
    v_mov_b32 v137, v78
    v_mov_b32 v138, v78
    v_mov_b32 v139, v78
    v_mov_b32 v140, v78
    v_mov_b32 v141, v78
    v_mov_b32 v142, v78
    v_mov_b32 v143, v78
L_neg_5:
    s_cmp_lt_i32 s35, 128
    s_cbranch_scc0 L_neg_6
    v_mov_b32 v144, v78
    v_mov_b32 v145, v78
    v_mov_b32 v146, v78
    v_mov_b32 v147, v78
    v_mov_b32 v148, v78
    v_mov_b32 v149, v78
    v_mov_b32 v150, v78
    v_mov_b32 v151, v78
    v_mov_b32 v152, v78
    v_mov_b32 v153, v78
    v_mov_b32 v154, v78
    v_mov_b32 v155, v78
    v_mov_b32 v156, v78
    v_mov_b32 v157, v78
    v_mov_b32 v158, v78
    v_mov_b32 v159, v78
L_neg_6:
    s_cmp_lt_i32 s35, 96
    s_cbranch_scc0 L_neg_7
    v_mov_b32 v160, v78
    v_mov_b32 v161, v78
    v_mov_b32 v162, v78
    v_mov_b32 v163, v78
    v_mov_b32 v164, v78
    v_mov_b32 v165, v78
    v_mov_b32 v166, v78
    v_mov_b32 v167, v78
    v_mov_b32 v168, v78
    v_mov_b32 v169, v78
    v_mov_b32 v170, v78
    v_mov_b32 v171, v78
    v_mov_b32 v172, v78
    v_mov_b32 v173, v78
    v_mov_b32 v174, v78
    v_mov_b32 v175, v78
L_neg_7:
    s_cmp_lt_i32 s35, 64
    s_cbranch_scc0 L_neg_8
    v_mov_b32 v176, v78
    v_mov_b32 v177, v78
    v_mov_b32 v178, v78
    v_mov_b32 v179, v78
    v_mov_b32 v180, v78
    v_mov_b32 v181, v78
    v_mov_b32 v182, v78
    v_mov_b32 v183, v78
    v_mov_b32 v184, v78
    v_mov_b32 v185, v78
    v_mov_b32 v186, v78
    v_mov_b32 v187, v78
    v_mov_b32 v188, v78
    v_mov_b32 v189, v78
    v_mov_b32 v190, v78
    v_mov_b32 v191, v78
L_neg_8:
    s_cmp_lt_i32 s35, 32
    s_cbranch_scc0 L_neg_9
    v_mov_b32 v192, v78
    v_mov_b32 v193, v78
    v_mov_b32 v194, v78
    v_mov_b32 v195, v78
    v_mov_b32 v196, v78
    v_mov_b32 v197, v78
    v_mov_b32 v198, v78
    v_mov_b32 v199, v78
    v_mov_b32 v200, v78
    v_mov_b32 v201, v78
    v_mov_b32 v202, v78
    v_mov_b32 v203, v78
    v_mov_b32 v204, v78
    v_mov_b32 v205, v78
    v_mov_b32 v206, v78
    v_mov_b32 v207, v78
L_neg_9:
    v_max3_f32 v76, v80, v81, v82
    v_max3_f32 v76, v76, v83, v84
    v_max3_f32 v76, v76, v85, v86
    v_max3_f32 v76, v76, v87, v96
    v_max3_f32 v76, v76, v97, v98
    v_max3_f32 v76, v76, v99, v100
    v_max3_f32 v76, v76, v101, v102
    v_max3_f32 v76, v76, v103, v112
    v_max3_f32 v76, v76, v113, v114
    v_max3_f32 v76, v76, v115, v116
    v_max3_f32 v76, v76, v117, v118
    v_max3_f32 v76, v76, v119, v128
    v_max3_f32 v76, v76, v129, v130
    v_max3_f32 v76, v76, v131, v132
    v_max3_f32 v76, v76, v133, v134
    v_max3_f32 v76, v76, v135, v144
    v_max3_f32 v76, v76, v145, v146
    v_max3_f32 v76, v76, v147, v148
    v_max3_f32 v76, v76, v149, v150
    v_max3_f32 v76, v76, v151, v160
    v_max3_f32 v76, v76, v161, v162
    v_max3_f32 v76, v76, v163, v164
    v_max3_f32 v76, v76, v165, v166
    v_max3_f32 v76, v76, v167, v176
    v_max3_f32 v76, v76, v177, v178
    v_max3_f32 v76, v76, v179, v180
    v_max3_f32 v76, v76, v181, v182
    v_max3_f32 v76, v76, v183, v192
    v_max3_f32 v76, v76, v193, v194
    v_max3_f32 v76, v76, v195, v196
    v_max3_f32 v76, v76, v197, v198
    v_max3_f32 v76, v76, v199, v208
    v_max3_f32 v76, v76, v209, v210
    v_max3_f32 v76, v76, v211, v212
    v_max3_f32 v76, v76, v213, v214
    v_max_f32 v76, v76, v215
    v_max3_f32 v77, v88, v89, v90
    v_max3_f32 v77, v77, v91, v92
    v_max3_f32 v77, v77, v93, v94
    v_max3_f32 v77, v77, v95, v104
    v_max3_f32 v77, v77, v105, v106
    v_max3_f32 v77, v77, v107, v108
    v_max3_f32 v77, v77, v109, v110
    v_max3_f32 v77, v77, v111, v120
    v_max3_f32 v77, v77, v121, v122
    v_max3_f32 v77, v77, v123, v124
    v_max3_f32 v77, v77, v125, v126
    v_max3_f32 v77, v77, v127, v136
    v_max3_f32 v77, v77, v137, v138
    v_max3_f32 v77, v77, v139, v140
    v_max3_f32 v77, v77, v141, v142
    v_max3_f32 v77, v77, v143, v152
    v_max3_f32 v77, v77, v153, v154
    v_max3_f32 v77, v77, v155, v156
    v_max3_f32 v77, v77, v157, v158
    v_max3_f32 v77, v77, v159, v168
    v_max3_f32 v77, v77, v169, v170
    v_max3_f32 v77, v77, v171, v172
    v_max3_f32 v77, v77, v173, v174
    v_max3_f32 v77, v77, v175, v184
    v_max3_f32 v77, v77, v185, v186
    v_max3_f32 v77, v77, v187, v188
    v_max3_f32 v77, v77, v189, v190
    v_max3_f32 v77, v77, v191, v200
    v_max3_f32 v77, v77, v201, v202
    v_max3_f32 v77, v77, v203, v204
    v_max3_f32 v77, v77, v205, v206
    v_max3_f32 v77, v77, v207, v216
    v_max3_f32 v77, v77, v217, v218
    v_max3_f32 v77, v77, v219, v220
    v_max3_f32 v77, v77, v221, v222
    v_max_f32 v77, v77, v223
    ds_bpermute_b32 v78, v17, v76
    ds_bpermute_b32 v79, v17, v77
    s_waitcnt lgkmcnt(0)
    v_max_f32 v76, v76, v78
    v_max_f32 v77, v77, v79
    ds_bpermute_b32 v78, v18, v76
    ds_bpermute_b32 v79, v18, v77
    s_waitcnt lgkmcnt(0)
    v_max_f32 v76, v76, v78
    v_max_f32 v77, v77, v79
    s_mov_b32 s38, 0x3ea52b5c
    v_mul_f32 v76, s38, v76
    v_mul_f32 v77, s38, v77
    v_mov_b32 v44, s38
    v_mov_b32 v45, s38
    v_sub_f32 v46, 0, v76
    v_sub_f32 v47, 0, v76
    v_sub_f32 v48, 0, v77
    v_sub_f32 v49, 0, v77
    s_waitcnt vmcnt(5)
    s_barrier
    ds_read_b128 v[60:63], v14 offset:0
    ds_read_b128 v[64:67], v15 offset:0
    v_pk_fma_f32 v[80:81], v[80:81], v[44:45], v[46:47]
    v_pk_fma_f32 v[82:83], v[82:83], v[44:45], v[46:47]
    v_pk_fma_f32 v[84:85], v[84:85], v[44:45], v[46:47]
    v_pk_fma_f32 v[86:87], v[86:87], v[44:45], v[46:47]
    v_exp_f32 v80, v80
    v_exp_f32 v81, v81
    v_exp_f32 v82, v82
    v_exp_f32 v83, v83
    v_exp_f32 v84, v84
    v_exp_f32 v85, v85
    v_exp_f32 v86, v86
    v_exp_f32 v87, v87
    s_nop 0
    v_cvt_pk_bf16_f32 v80, v80, v81
    v_cvt_pk_bf16_f32 v81, v82, v83
    v_cvt_pk_bf16_f32 v82, v84, v85
    v_cvt_pk_bf16_f32 v83, v86, v87
    v_pk_fma_f32 v[88:89], v[88:89], v[44:45], v[48:49]
    v_pk_fma_f32 v[90:91], v[90:91], v[44:45], v[48:49]
    v_pk_fma_f32 v[92:93], v[92:93], v[44:45], v[48:49]
    v_pk_fma_f32 v[94:95], v[94:95], v[44:45], v[48:49]
    v_exp_f32 v88, v88
    v_exp_f32 v89, v89
    v_exp_f32 v90, v90
    v_exp_f32 v91, v91
    v_exp_f32 v92, v92
    v_exp_f32 v93, v93
    v_exp_f32 v94, v94
    v_exp_f32 v95, v95
    s_nop 0
    v_cvt_pk_bf16_f32 v88, v88, v89
    v_cvt_pk_bf16_f32 v89, v90, v91
    v_cvt_pk_bf16_f32 v90, v92, v93
    v_cvt_pk_bf16_f32 v91, v94, v95
    ds_read_b128 v[68:71], v14 offset:64
    ds_read_b128 v[72:75], v15 offset:64
    s_waitcnt lgkmcnt(2)
    s_nop 1
    v_mfma_f32_16x16x32_bf16 v[28:31], v[60:63], v[80:83], v[28:31]
    v_mfma_f32_16x16x32_bf16 v[32:35], v[60:63], v[88:91], v[32:35]
    v_mfma_f32_16x16x32_bf16 v[36:39], v[64:67], v[80:83], v[36:39]
    v_mfma_f32_16x16x32_bf16 v[40:43], v[64:67], v[88:91], v[40:43]
    v_pk_fma_f32 v[96:97], v[96:97], v[44:45], v[46:47]
    v_pk_fma_f32 v[98:99], v[98:99], v[44:45], v[46:47]
    v_pk_fma_f32 v[100:101], v[100:101], v[44:45], v[46:47]
    v_pk_fma_f32 v[102:103], v[102:103], v[44:45], v[46:47]
    v_exp_f32 v96, v96
    v_exp_f32 v97, v97
    v_exp_f32 v98, v98
    v_exp_f32 v99, v99
    v_exp_f32 v100, v100
    v_exp_f32 v101, v101
    v_exp_f32 v102, v102
    v_exp_f32 v103, v103
    s_nop 0
    v_cvt_pk_bf16_f32 v96, v96, v97
    v_cvt_pk_bf16_f32 v97, v98, v99
    v_cvt_pk_bf16_f32 v98, v100, v101
    v_cvt_pk_bf16_f32 v99, v102, v103
    v_pk_fma_f32 v[104:105], v[104:105], v[44:45], v[48:49]
    v_pk_fma_f32 v[106:107], v[106:107], v[44:45], v[48:49]
    v_pk_fma_f32 v[108:109], v[108:109], v[44:45], v[48:49]
    v_pk_fma_f32 v[110:111], v[110:111], v[44:45], v[48:49]
    v_exp_f32 v104, v104
    v_exp_f32 v105, v105
    v_exp_f32 v106, v106
    v_exp_f32 v107, v107
    v_exp_f32 v108, v108
    v_exp_f32 v109, v109
    v_exp_f32 v110, v110
    v_exp_f32 v111, v111
    s_nop 0
    v_cvt_pk_bf16_f32 v104, v104, v105
    v_cvt_pk_bf16_f32 v105, v106, v107
    v_cvt_pk_bf16_f32 v106, v108, v109
    v_cvt_pk_bf16_f32 v107, v110, v111
    ds_read_b128 v[60:63], v14 offset:128
    ds_read_b128 v[64:67], v15 offset:128
    s_waitcnt lgkmcnt(2)
    s_nop 1
    v_mfma_f32_16x16x32_bf16 v[28:31], v[68:71], v[96:99], v[28:31]
    v_mfma_f32_16x16x32_bf16 v[32:35], v[68:71], v[104:107], v[32:35]
    v_mfma_f32_16x16x32_bf16 v[36:39], v[72:75], v[96:99], v[36:39]
    v_mfma_f32_16x16x32_bf16 v[40:43], v[72:75], v[104:107], v[40:43]
    v_pk_fma_f32 v[112:113], v[112:113], v[44:45], v[46:47]
    v_pk_fma_f32 v[114:115], v[114:115], v[44:45], v[46:47]
    v_pk_fma_f32 v[116:117], v[116:117], v[44:45], v[46:47]
    v_pk_fma_f32 v[118:119], v[118:119], v[44:45], v[46:47]
    v_exp_f32 v112, v112
    v_exp_f32 v113, v113
    v_exp_f32 v114, v114
    v_exp_f32 v115, v115
    v_exp_f32 v116, v116
    v_exp_f32 v117, v117
    v_exp_f32 v118, v118
    v_exp_f32 v119, v119
    s_nop 0
    v_cvt_pk_bf16_f32 v112, v112, v113
    v_cvt_pk_bf16_f32 v113, v114, v115
    v_cvt_pk_bf16_f32 v114, v116, v117
    v_cvt_pk_bf16_f32 v115, v118, v119
    v_pk_fma_f32 v[120:121], v[120:121], v[44:45], v[48:49]
    v_pk_fma_f32 v[122:123], v[122:123], v[44:45], v[48:49]
    v_pk_fma_f32 v[124:125], v[124:125], v[44:45], v[48:49]
    v_pk_fma_f32 v[126:127], v[126:127], v[44:45], v[48:49]
    v_exp_f32 v120, v120
    v_exp_f32 v121, v121
    v_exp_f32 v122, v122
    v_exp_f32 v123, v123
    v_exp_f32 v124, v124
    v_exp_f32 v125, v125
    v_exp_f32 v126, v126
    v_exp_f32 v127, v127
    s_nop 0
    v_cvt_pk_bf16_f32 v120, v120, v121
    v_cvt_pk_bf16_f32 v121, v122, v123
    v_cvt_pk_bf16_f32 v122, v124, v125
    v_cvt_pk_bf16_f32 v123, v126, v127
    ds_read_b128 v[68:71], v14 offset:192
    ds_read_b128 v[72:75], v15 offset:192
    s_waitcnt lgkmcnt(2)
    s_nop 1
    v_mfma_f32_16x16x32_bf16 v[28:31], v[60:63], v[112:115], v[28:31]
    v_mfma_f32_16x16x32_bf16 v[32:35], v[60:63], v[120:123], v[32:35]
    v_mfma_f32_16x16x32_bf16 v[36:39], v[64:67], v[112:115], v[36:39]
    v_mfma_f32_16x16x32_bf16 v[40:43], v[64:67], v[120:123], v[40:43]
    v_pk_fma_f32 v[128:129], v[128:129], v[44:45], v[46:47]
    v_pk_fma_f32 v[130:131], v[130:131], v[44:45], v[46:47]
    v_pk_fma_f32 v[132:133], v[132:133], v[44:45], v[46:47]
    v_pk_fma_f32 v[134:135], v[134:135], v[44:45], v[46:47]
    v_exp_f32 v128, v128
    v_exp_f32 v129, v129
    v_exp_f32 v130, v130
    v_exp_f32 v131, v131
    v_exp_f32 v132, v132
    v_exp_f32 v133, v133
    v_exp_f32 v134, v134
    v_exp_f32 v135, v135
    s_nop 0
    v_cvt_pk_bf16_f32 v128, v128, v129
    v_cvt_pk_bf16_f32 v129, v130, v131
    v_cvt_pk_bf16_f32 v130, v132, v133
    v_cvt_pk_bf16_f32 v131, v134, v135
    v_pk_fma_f32 v[136:137], v[136:137], v[44:45], v[48:49]
    v_pk_fma_f32 v[138:139], v[138:139], v[44:45], v[48:49]
    v_pk_fma_f32 v[140:141], v[140:141], v[44:45], v[48:49]
    v_pk_fma_f32 v[142:143], v[142:143], v[44:45], v[48:49]
    v_exp_f32 v136, v136
    v_exp_f32 v137, v137
    v_exp_f32 v138, v138
    v_exp_f32 v139, v139
    v_exp_f32 v140, v140
    v_exp_f32 v141, v141
    v_exp_f32 v142, v142
    v_exp_f32 v143, v143
    s_nop 0
    v_cvt_pk_bf16_f32 v136, v136, v137
    v_cvt_pk_bf16_f32 v137, v138, v139
    v_cvt_pk_bf16_f32 v138, v140, v141
    v_cvt_pk_bf16_f32 v139, v142, v143
    ds_read_b128 v[60:63], v14 offset:256
    ds_read_b128 v[64:67], v15 offset:256
    s_add_u32 s56, s4, 0x1a84000
    s_addc_u32 s57, s5, 0
    s_and_b32 s57, s57, 0xffff
    s_mov_b32 s58, 0x618000
    s_mov_b32 s59, 0x00020000
    s_waitcnt vmcnt(0)
    buffer_store_dwordx4 v[224:227], v244, s[56:59], 0 offen
    buffer_store_dwordx4 v[228:231], v245, s[56:59], 0 offen
    buffer_store_dwordx4 v[232:235], v246, s[56:59], 0 offen
    buffer_store_dwordx4 v[236:239], v247, s[56:59], 0 offen
    buffer_store_dwordx4 v[240:243], v248, s[56:59], 0 offen
    s_waitcnt lgkmcnt(2)
    s_nop 1
    v_mfma_f32_16x16x32_bf16 v[28:31], v[68:71], v[128:131], v[28:31]
    v_mfma_f32_16x16x32_bf16 v[32:35], v[68:71], v[136:139], v[32:35]
    v_mfma_f32_16x16x32_bf16 v[36:39], v[72:75], v[128:131], v[36:39]
    v_mfma_f32_16x16x32_bf16 v[40:43], v[72:75], v[136:139], v[40:43]
    v_pk_fma_f32 v[144:145], v[144:145], v[44:45], v[46:47]
    v_pk_fma_f32 v[146:147], v[146:147], v[44:45], v[46:47]
    v_pk_fma_f32 v[148:149], v[148:149], v[44:45], v[46:47]
    v_pk_fma_f32 v[150:151], v[150:151], v[44:45], v[46:47]
    v_exp_f32 v144, v144
    v_exp_f32 v145, v145
    v_exp_f32 v146, v146
    v_exp_f32 v147, v147
    v_exp_f32 v148, v148
    v_exp_f32 v149, v149
    v_exp_f32 v150, v150
    v_exp_f32 v151, v151
    s_nop 0
    v_cvt_pk_bf16_f32 v144, v144, v145
    v_cvt_pk_bf16_f32 v145, v146, v147
    v_cvt_pk_bf16_f32 v146, v148, v149
    v_cvt_pk_bf16_f32 v147, v150, v151
    v_pk_fma_f32 v[152:153], v[152:153], v[44:45], v[48:49]
    v_pk_fma_f32 v[154:155], v[154:155], v[44:45], v[48:49]
    v_pk_fma_f32 v[156:157], v[156:157], v[44:45], v[48:49]
    v_pk_fma_f32 v[158:159], v[158:159], v[44:45], v[48:49]
    v_exp_f32 v152, v152
    v_exp_f32 v153, v153
    v_exp_f32 v154, v154
    v_exp_f32 v155, v155
    v_exp_f32 v156, v156
    v_exp_f32 v157, v157
    v_exp_f32 v158, v158
    v_exp_f32 v159, v159
    s_nop 0
    v_cvt_pk_bf16_f32 v152, v152, v153
    v_cvt_pk_bf16_f32 v153, v154, v155
    v_cvt_pk_bf16_f32 v154, v156, v157
    v_cvt_pk_bf16_f32 v155, v158, v159
    ds_read_b128 v[68:71], v14 offset:320
    ds_read_b128 v[72:75], v15 offset:320
    s_waitcnt lgkmcnt(2)
    s_nop 1
    v_mfma_f32_16x16x32_bf16 v[28:31], v[60:63], v[144:147], v[28:31]
    v_mfma_f32_16x16x32_bf16 v[32:35], v[60:63], v[152:155], v[32:35]
    v_mfma_f32_16x16x32_bf16 v[36:39], v[64:67], v[144:147], v[36:39]
    v_mfma_f32_16x16x32_bf16 v[40:43], v[64:67], v[152:155], v[40:43]
    v_pk_fma_f32 v[160:161], v[160:161], v[44:45], v[46:47]
    v_pk_fma_f32 v[162:163], v[162:163], v[44:45], v[46:47]
    v_pk_fma_f32 v[164:165], v[164:165], v[44:45], v[46:47]
    v_pk_fma_f32 v[166:167], v[166:167], v[44:45], v[46:47]
    v_exp_f32 v160, v160
    v_exp_f32 v161, v161
    v_exp_f32 v162, v162
    v_exp_f32 v163, v163
    v_exp_f32 v164, v164
    v_exp_f32 v165, v165
    v_exp_f32 v166, v166
    v_exp_f32 v167, v167
    s_nop 0
    v_cvt_pk_bf16_f32 v160, v160, v161
    v_cvt_pk_bf16_f32 v161, v162, v163
    v_cvt_pk_bf16_f32 v162, v164, v165
    v_cvt_pk_bf16_f32 v163, v166, v167
    v_pk_fma_f32 v[168:169], v[168:169], v[44:45], v[48:49]
    v_pk_fma_f32 v[170:171], v[170:171], v[44:45], v[48:49]
    v_pk_fma_f32 v[172:173], v[172:173], v[44:45], v[48:49]
    v_pk_fma_f32 v[174:175], v[174:175], v[44:45], v[48:49]
    v_exp_f32 v168, v168
    v_exp_f32 v169, v169
    v_exp_f32 v170, v170
    v_exp_f32 v171, v171
    v_exp_f32 v172, v172
    v_exp_f32 v173, v173
    v_exp_f32 v174, v174
    v_exp_f32 v175, v175
    s_nop 0
    v_cvt_pk_bf16_f32 v168, v168, v169
    v_cvt_pk_bf16_f32 v169, v170, v171
    v_cvt_pk_bf16_f32 v170, v172, v173
    v_cvt_pk_bf16_f32 v171, v174, v175
    ds_read_b128 v[60:63], v14 offset:384
    ds_read_b128 v[64:67], v15 offset:384
    s_waitcnt lgkmcnt(2)
    s_nop 1
    v_mfma_f32_16x16x32_bf16 v[28:31], v[68:71], v[160:163], v[28:31]
    v_mfma_f32_16x16x32_bf16 v[32:35], v[68:71], v[168:171], v[32:35]
    v_mfma_f32_16x16x32_bf16 v[36:39], v[72:75], v[160:163], v[36:39]
    v_mfma_f32_16x16x32_bf16 v[40:43], v[72:75], v[168:171], v[40:43]
    v_pk_fma_f32 v[176:177], v[176:177], v[44:45], v[46:47]
    v_pk_fma_f32 v[178:179], v[178:179], v[44:45], v[46:47]
    v_pk_fma_f32 v[180:181], v[180:181], v[44:45], v[46:47]
    v_pk_fma_f32 v[182:183], v[182:183], v[44:45], v[46:47]
    v_exp_f32 v176, v176
    v_exp_f32 v177, v177
    v_exp_f32 v178, v178
    v_exp_f32 v179, v179
    v_exp_f32 v180, v180
    v_exp_f32 v181, v181
    v_exp_f32 v182, v182
    v_exp_f32 v183, v183
    s_nop 0
    v_cvt_pk_bf16_f32 v176, v176, v177
    v_cvt_pk_bf16_f32 v177, v178, v179
    v_cvt_pk_bf16_f32 v178, v180, v181
    v_cvt_pk_bf16_f32 v179, v182, v183
    v_pk_fma_f32 v[184:185], v[184:185], v[44:45], v[48:49]
    v_pk_fma_f32 v[186:187], v[186:187], v[44:45], v[48:49]
    v_pk_fma_f32 v[188:189], v[188:189], v[44:45], v[48:49]
    v_pk_fma_f32 v[190:191], v[190:191], v[44:45], v[48:49]
    v_exp_f32 v184, v184
    v_exp_f32 v185, v185
    v_exp_f32 v186, v186
    v_exp_f32 v187, v187
    v_exp_f32 v188, v188
    v_exp_f32 v189, v189
    v_exp_f32 v190, v190
    v_exp_f32 v191, v191
    s_nop 0
    v_cvt_pk_bf16_f32 v184, v184, v185
    v_cvt_pk_bf16_f32 v185, v186, v187
    v_cvt_pk_bf16_f32 v186, v188, v189
    v_cvt_pk_bf16_f32 v187, v190, v191
    ds_read_b128 v[68:71], v14 offset:448
    ds_read_b128 v[72:75], v15 offset:448
    s_waitcnt lgkmcnt(2)
    s_nop 1
    v_mfma_f32_16x16x32_bf16 v[28:31], v[60:63], v[176:179], v[28:31]
    v_mfma_f32_16x16x32_bf16 v[32:35], v[60:63], v[184:187], v[32:35]
    v_mfma_f32_16x16x32_bf16 v[36:39], v[64:67], v[176:179], v[36:39]
    v_mfma_f32_16x16x32_bf16 v[40:43], v[64:67], v[184:187], v[40:43]
    v_pk_fma_f32 v[192:193], v[192:193], v[44:45], v[46:47]
    v_pk_fma_f32 v[194:195], v[194:195], v[44:45], v[46:47]
    v_pk_fma_f32 v[196:197], v[196:197], v[44:45], v[46:47]
    v_pk_fma_f32 v[198:199], v[198:199], v[44:45], v[46:47]
    v_exp_f32 v192, v192
    v_exp_f32 v193, v193
    v_exp_f32 v194, v194
    v_exp_f32 v195, v195
    v_exp_f32 v196, v196
    v_exp_f32 v197, v197
    v_exp_f32 v198, v198
    v_exp_f32 v199, v199
    s_nop 0
    v_cvt_pk_bf16_f32 v192, v192, v193
    v_cvt_pk_bf16_f32 v193, v194, v195
    v_cvt_pk_bf16_f32 v194, v196, v197
    v_cvt_pk_bf16_f32 v195, v198, v199
    v_pk_fma_f32 v[200:201], v[200:201], v[44:45], v[48:49]
    v_pk_fma_f32 v[202:203], v[202:203], v[44:45], v[48:49]
    v_pk_fma_f32 v[204:205], v[204:205], v[44:45], v[48:49]
    v_pk_fma_f32 v[206:207], v[206:207], v[44:45], v[48:49]
    v_exp_f32 v200, v200
    v_exp_f32 v201, v201
    v_exp_f32 v202, v202
    v_exp_f32 v203, v203
    v_exp_f32 v204, v204
    v_exp_f32 v205, v205
    v_exp_f32 v206, v206
    v_exp_f32 v207, v207
    s_nop 0
    v_cvt_pk_bf16_f32 v200, v200, v201
    v_cvt_pk_bf16_f32 v201, v202, v203
    v_cvt_pk_bf16_f32 v202, v204, v205
    v_cvt_pk_bf16_f32 v203, v206, v207
    ds_read_b128 v[60:63], v14 offset:512
    ds_read_b128 v[64:67], v15 offset:512
    s_waitcnt lgkmcnt(2)
    s_nop 1
    v_mfma_f32_16x16x32_bf16 v[28:31], v[68:71], v[192:195], v[28:31]
    v_mfma_f32_16x16x32_bf16 v[32:35], v[68:71], v[200:203], v[32:35]
    v_mfma_f32_16x16x32_bf16 v[36:39], v[72:75], v[192:195], v[36:39]
    v_mfma_f32_16x16x32_bf16 v[40:43], v[72:75], v[200:203], v[40:43]
    v_pk_fma_f32 v[208:209], v[208:209], v[44:45], v[46:47]
    v_pk_fma_f32 v[210:211], v[210:211], v[44:45], v[46:47]
    v_pk_fma_f32 v[212:213], v[212:213], v[44:45], v[46:47]
    v_pk_fma_f32 v[214:215], v[214:215], v[44:45], v[46:47]
    v_exp_f32 v208, v208
    v_exp_f32 v209, v209
    v_exp_f32 v210, v210
    v_exp_f32 v211, v211
    v_exp_f32 v212, v212
    v_exp_f32 v213, v213
    v_exp_f32 v214, v214
    v_exp_f32 v215, v215
    s_nop 0
    v_cvt_pk_bf16_f32 v208, v208, v209
    v_cvt_pk_bf16_f32 v209, v210, v211
    v_cvt_pk_bf16_f32 v210, v212, v213
    v_cvt_pk_bf16_f32 v211, v214, v215
    v_pk_fma_f32 v[216:217], v[216:217], v[44:45], v[48:49]
    v_pk_fma_f32 v[218:219], v[218:219], v[44:45], v[48:49]
    v_pk_fma_f32 v[220:221], v[220:221], v[44:45], v[48:49]
    v_pk_fma_f32 v[222:223], v[222:223], v[44:45], v[48:49]
    v_exp_f32 v216, v216
    v_exp_f32 v217, v217
    v_exp_f32 v218, v218
    v_exp_f32 v219, v219
    v_exp_f32 v220, v220
    v_exp_f32 v221, v221
    v_exp_f32 v222, v222
    v_exp_f32 v223, v223
    s_nop 0
    v_cvt_pk_bf16_f32 v216, v216, v217
    v_cvt_pk_bf16_f32 v217, v218, v219
    v_cvt_pk_bf16_f32 v218, v220, v221
    v_cvt_pk_bf16_f32 v219, v222, v223
    s_waitcnt lgkmcnt(0)
    s_nop 1
    v_mfma_f32_16x16x32_bf16 v[28:31], v[60:63], v[208:211], v[28:31]
    v_mfma_f32_16x16x32_bf16 v[32:35], v[60:63], v[216:219], v[32:35]
    v_mfma_f32_16x16x32_bf16 v[36:39], v[64:67], v[208:211], v[36:39]
    v_mfma_f32_16x16x32_bf16 v[40:43], v[64:67], v[216:219], v[40:43]
    s_nop 7
    s_nop 3
    ds_bpermute_b32 v76, v19, v36
    ds_bpermute_b32 v77, v19, v40
    s_lshl_b32 s35, s32, 5
    s_add_u32 s35, s35, s34
    v_add_u32 v4, s35, v2
    s_movk_i32 s36, 1280
    v_mul_lo_u32 v4, v4, s36
    v_lshl_add_u32 v4, v3, 3, v4
    s_mul_i32 s35, s33, 40
    v_add_u32 v4, s35, v4
    v_add_u32 v5, 20480, v4
    s_waitcnt lgkmcnt(0)
    v_rcp_f32 v76, v76
    v_rcp_f32 v77, v77
    s_nop 0
    v_mul_f32 v28, v28, v76
    v_mul_f32 v29, v29, v76
    v_mul_f32 v30, v30, v76
    v_mul_f32 v31, v31, v76
    v_cvt_pk_bf16_f32 v28, v28, v29
    v_cvt_pk_bf16_f32 v29, v30, v31
    v_mul_f32 v36, v36, v76
    v_mul_f32 v37, v37, v76
    v_mul_f32 v38, v38, v76
    v_mul_f32 v39, v39, v76
    v_cvt_pk_bf16_f32 v36, v36, v37
    v_cvt_pk_bf16_f32 v37, v38, v39
    v_mul_f32 v32, v32, v77
    v_mul_f32 v33, v33, v77
    v_mul_f32 v34, v34, v77
    v_mul_f32 v35, v35, v77
    v_cvt_pk_bf16_f32 v32, v32, v33
    v_cvt_pk_bf16_f32 v33, v34, v35
    v_mul_f32 v40, v40, v77
    v_mul_f32 v41, v41, v77
    v_mul_f32 v42, v42, v77
    v_mul_f32 v43, v43, v77
    v_cvt_pk_bf16_f32 v40, v40, v41
    v_cvt_pk_bf16_f32 v41, v42, v43
    buffer_store_dwordx2 v[28:29], v4, s[20:23], 0 offen offset:0
    buffer_store_dwordx2 v[32:33], v5, s[20:23], 0 offen offset:0
    v_cmp_eq_u32 vcc, 0, v3
    s_and_saveexec_b64 s[40:41], vcc
    buffer_store_dwordx2 v[36:37], v4, s[20:23], 0 offen offset:32
    buffer_store_dwordx2 v[40:41], v5, s[20:23], 0 offen offset:32
    s_mov_b64 exec, s[40:41]
k2_kernel_end:
    s_endpgm
.p2align 8
.globl k3_kernel
.type k3_kernel,@function
k3_kernel:
    s_cmp_ge_u32 s2, 256
    s_cbranch_scc1 k3_kernel_end
    s_load_dwordx2 s[4:5], s[0:1], 80
    s_load_dwordx2 s[20:21], s[0:1], 0
    s_and_b32 s37, s2, 7
    s_lshr_b32 s38, s2, 3
    s_lshr_b32 s33, s38, 3
    s_and_b32 s34, s38, 7
    s_mul_i32 s37, s37, 4
    s_add_u32 s33, s33, s37
    s_mul_i32 s35, s33, 64
    s_mul_i32 s36, s34, 80
    v_and_b32 v1, 63, v0
    v_lshrrev_b32 v31, 6, v0
    v_and_b32 v2, 15, v0
    v_bfe_u32 v3, v0, 4, 2
    v_readfirstlane_b32 s43, v31
    s_and_b32 s32, s43, 3
    s_mul_i32 s56, s32, 16
    s_cmp_lt_u32 s43, 4
    s_cbranch_scc1 k3_kernel_cons
    v_lshrrev_b32 v31, 4, v1
    v_and_b32 v32, 15, v1
    v_add_u32 v31, s56, v31
    s_mov_b32 s38, 1280
    v_add_u32 v33, 0, v31
    v_and_b32 v34, 15, v33
    v_xor_b32 v34, v34, v32
    v_add_u32 v33, s35, v33
    v_mul_lo_u32 v33, v33, s38
    v_lshl_add_u32 v4, v34, 4, v33
    v_add_u32 v33, 4, v31
    v_and_b32 v34, 15, v33
    v_xor_b32 v34, v34, v32
    v_add_u32 v33, s35, v33
    v_mul_lo_u32 v33, v33, s38
    v_lshl_add_u32 v5, v34, 4, v33
    v_add_u32 v33, 8, v31
    v_and_b32 v34, 15, v33
    v_xor_b32 v34, v34, v32
    v_add_u32 v33, s35, v33
    v_mul_lo_u32 v33, v33, s38
    v_lshl_add_u32 v6, v34, 4, v33
    v_add_u32 v33, 12, v31
    v_and_b32 v34, 15, v33
    v_xor_b32 v34, v34, v32
    v_add_u32 v33, s35, v33
    v_mul_lo_u32 v33, v33, s38
    v_lshl_add_u32 v7, v34, 4, v33
    s_mul_i32 s37, s34, 102400
    s_mul_i32 s38, s32, 5120
    s_add_u32 s37, s37, s38
    v_lshl_add_u32 v8, v1, 4, s37
    s_waitcnt lgkmcnt(0)
    s_add_u32 s12, s4, 0x1a84000
    s_addc_u32 s13, s5, 0
    s_and_b32 s13, s13, 0xffff
    s_mov_b32 s14, 0xc8000
    s_mov_b32 s15, 0x00020000
    s_add_u32 s8, s4, 0xa80000
    s_addc_u32 s9, s5, 0
    s_and_b32 s9, s9, 0xffff
    s_mov_b32 s10, 0x280000
    s_mov_b32 s11, 0x00020000
    s_mul_i32 s39, s32, 4096
    s_mul_i32 s40, s32, 5120
    s_mov_b32 s46, 0x7ff00000
    s_mov_b32 s41, 0x0
    s_add_u32 m0, s39, 0x0
    s_nop 0
    buffer_load_dwordx4 v4, s[8:11], s41 offen lds
    s_add_u32 m0, s39, 0x400
    s_nop 0
    buffer_load_dwordx4 v5, s[8:11], s41 offen lds
    s_add_u32 m0, s39, 0x800
    s_nop 0
    buffer_load_dwordx4 v6, s[8:11], s41 offen lds
    s_add_u32 m0, s39, 0xc00
    s_nop 0
    buffer_load_dwordx4 v7, s[8:11], s41 offen lds
    s_add_u32 m0, s40, 0x4000
    s_mov_b32 s42, 0x0
    buffer_load_dwordx4 v8, s[12:15], s42 offen lds
    s_add_u32 m0, s40, 0x4400
    s_mov_b32 s42, 0x400
    buffer_load_dwordx4 v8, s[12:15], s42 offen lds
    s_add_u32 m0, s40, 0x4800
    s_mov_b32 s42, 0x800
    buffer_load_dwordx4 v8, s[12:15], s42 offen lds
    s_add_u32 m0, s40, 0x4c00
    s_mov_b32 s42, 0xc00
    buffer_load_dwordx4 v8, s[12:15], s42 offen lds
    s_add_u32 m0, s40, 0x5000
    s_mov_b32 s42, 0x1000
    buffer_load_dwordx4 v8, s[12:15], s42 offen lds
    s_mov_b32 s41, 0x100
    s_add_u32 m0, s39, 0x9000
    s_nop 0
    buffer_load_dwordx4 v4, s[8:11], s41 offen lds
    s_add_u32 m0, s39, 0x9400
    s_nop 0
    buffer_load_dwordx4 v5, s[8:11], s41 offen lds
    s_add_u32 m0, s39, 0x9800
    s_nop 0
    buffer_load_dwordx4 v6, s[8:11], s41 offen lds
    s_add_u32 m0, s39, 0x9c00
    s_nop 0
    buffer_load_dwordx4 v7, s[8:11], s41 offen lds
    s_add_u32 m0, s40, 0xd000
    s_mov_b32 s42, 0x5000
    buffer_load_dwordx4 v8, s[12:15], s42 offen lds
    s_add_u32 m0, s40, 0xd400
    s_mov_b32 s42, 0x5400
    buffer_load_dwordx4 v8, s[12:15], s42 offen lds
    s_add_u32 m0, s40, 0xd800
    s_mov_b32 s42, 0x5800
    buffer_load_dwordx4 v8, s[12:15], s42 offen lds
    s_add_u32 m0, s40, 0xdc00
    s_mov_b32 s42, 0x5c00
    buffer_load_dwordx4 v8, s[12:15], s42 offen lds
    s_add_u32 m0, s40, 0xe000
    s_mov_b32 s42, 0x6000
    buffer_load_dwordx4 v8, s[12:15], s42 offen lds
    s_mov_b32 s41, 0x200
    s_add_u32 m0, s39, 0x12000
    s_nop 0
    buffer_load_dwordx4 v4, s[8:11], s41 offen lds
    s_add_u32 m0, s39, 0x12400
    s_nop 0
    buffer_load_dwordx4 v5, s[8:11], s41 offen lds
    s_add_u32 m0, s39, 0x12800
    s_nop 0
    buffer_load_dwordx4 v6, s[8:11], s41 offen lds
    s_add_u32 m0, s39, 0x12c00
    s_nop 0
    buffer_load_dwordx4 v7, s[8:11], s41 offen lds
    s_add_u32 m0, s40, 0x16000
    s_mov_b32 s42, 0xa000
    buffer_load_dwordx4 v8, s[12:15], s42 offen lds
    s_add_u32 m0, s40, 0x16400
    s_mov_b32 s42, 0xa400
    buffer_load_dwordx4 v8, s[12:15], s42 offen lds
    s_add_u32 m0, s40, 0x16800
    s_mov_b32 s42, 0xa800
    buffer_load_dwordx4 v8, s[12:15], s42 offen lds
    s_add_u32 m0, s40, 0x16c00
    s_mov_b32 s42, 0xac00
    buffer_load_dwordx4 v8, s[12:15], s42 offen lds
    s_add_u32 m0, s40, 0x17000
    s_mov_b32 s42, 0xb000
    buffer_load_dwordx4 v8, s[12:15], s42 offen lds
    s_add_u32 s16, s4, 0xd00000
    s_addc_u32 s17, s5, 0
    s_and_b32 s17, s17, 0xffff
    s_mov_b32 s18, 0x280000
    s_mov_b32 s19, 0x00020000
    s_and_b32 s21, s21, 0xffff
    s_mov_b32 s22, 0x280000
    s_mov_b32 s23, 0x00020000
    s_mov_b32 s38, 6554
    s_mul_i32 s37, s43, 128
    v_add_u32 v31, s37, v1
    v_mul_lo_u32 v32, v31, s38
    v_lshrrev_b32 v32, 16, v32
    v_mul_u32_u24 v33, 10, v32
    v_sub_u32 v33, v31, v33
    v_mul_u32_u24 v34, 176, v32
    v_lshl_add_u32 v134, v33, 4, v34
    v_add_u32 v34, s35, v32
    v_mul_u32_u24 v34, 1280, v34
    v_lshl_add_u32 v34, v33, 4, v34
    v_lshl_add_u32 v132, s36, 1, v34
    v_cmp_le_u32 vcc, 640, v31
    v_mov_b32 v35, 0x7fffff00
    v_mov_b32 v36, 0
    v_cndmask_b32 v132, v132, v35, vcc
    v_cndmask_b32 v134, v134, v36, vcc
    v_add_u32 v31, s37, v1
    v_add_u32 v31, 64, v31
    v_mul_lo_u32 v32, v31, s38
    v_lshrrev_b32 v32, 16, v32
    v_mul_u32_u24 v33, 10, v32
    v_sub_u32 v33, v31, v33
    v_mul_u32_u24 v34, 176, v32
    v_lshl_add_u32 v135, v33, 4, v34
    v_add_u32 v34, s35, v32
    v_mul_u32_u24 v34, 1280, v34
    v_lshl_add_u32 v34, v33, 4, v34
    v_lshl_add_u32 v133, s36, 1, v34
    v_cmp_le_u32 vcc, 640, v31
    v_mov_b32 v35, 0x7fffff00
    v_mov_b32 v36, 0
    v_cndmask_b32 v133, v133, v35, vcc
    v_cndmask_b32 v135, v135, v36, vcc
    s_waitcnt vmcnt(18)
    s_barrier
    s_mov_b32 s41, 0x300
    s_add_u32 m0, s39, 0x1b000
    s_nop 0
    buffer_load_dwordx4 v4, s[8:11], s41 offen lds
    s_add_u32 m0, s39, 0x1b400
    s_nop 0
    buffer_load_dwordx4 v5, s[8:11], s41 offen lds
    s_add_u32 m0, s39, 0x1b800
    s_nop 0
    buffer_load_dwordx4 v6, s[8:11], s41 offen lds
    s_add_u32 m0, s39, 0x1bc00
    s_nop 0
    buffer_load_dwordx4 v7, s[8:11], s41 offen lds
    s_add_u32 m0, s40, 0x1f000
    s_mov_b32 s42, 0xf000
    buffer_load_dwordx4 v8, s[12:15], s42 offen lds
    s_add_u32 m0, s40, 0x1f400
    s_mov_b32 s42, 0xf400
    buffer_load_dwordx4 v8, s[12:15], s42 offen lds
    s_add_u32 m0, s40, 0x1f800
    s_mov_b32 s42, 0xf800
    buffer_load_dwordx4 v8, s[12:15], s42 offen lds
    s_add_u32 m0, s40, 0x1fc00
    s_mov_b32 s42, 0xfc00
    buffer_load_dwordx4 v8, s[12:15], s42 offen lds
    s_add_u32 m0, s40, 0x20000
    s_mov_b32 s42, 0x10000
    buffer_load_dwordx4 v8, s[12:15], s42 offen lds
    s_waitcnt vmcnt(18)
    s_barrier
    s_mov_b32 s41, 0x400
    s_add_u32 m0, s39, 0x0
    s_nop 0
    buffer_load_dwordx4 v4, s[8:11], s41 offen lds
    s_add_u32 m0, s39, 0x400
    s_nop 0
    buffer_load_dwordx4 v5, s[8:11], s41 offen lds
    s_add_u32 m0, s39, 0x800
    s_nop 0
    buffer_load_dwordx4 v6, s[8:11], s41 offen lds
    s_add_u32 m0, s39, 0xc00
    s_nop 0
    buffer_load_dwordx4 v7, s[8:11], s41 offen lds
    s_add_u32 m0, s40, 0x4000
    s_mov_b32 s42, 0x14000
    buffer_load_dwordx4 v8, s[12:15], s42 offen lds
    s_add_u32 m0, s40, 0x4400
    s_mov_b32 s42, 0x14400
    buffer_load_dwordx4 v8, s[12:15], s42 offen lds
    s_add_u32 m0, s40, 0x4800
    s_mov_b32 s42, 0x14800
    buffer_load_dwordx4 v8, s[12:15], s42 offen lds
    s_add_u32 m0, s40, 0x4c00
    s_mov_b32 s42, 0x14c00
    buffer_load_dwordx4 v8, s[12:15], s42 offen lds
    s_add_u32 m0, s40, 0x5000
    s_mov_b32 s42, 0x15000
    buffer_load_dwordx4 v8, s[12:15], s42 offen lds
    s_waitcnt vmcnt(18)
    s_barrier
    s_waitcnt vmcnt(9)
    s_barrier
    buffer_load_dwordx4 v[136:139], v132, s[20:23], 0 offen
    buffer_load_dwordx4 v[140:143], v133, s[20:23], 0 offen
    s_waitcnt vmcnt(2)
    s_barrier
    s_barrier
    s_branch k3_kernel_phase2
k3_kernel_cons:
    s_waitcnt lgkmcnt(0)
    s_add_u32 s16, s4, 0xd00000
    s_addc_u32 s17, s5, 0
    s_and_b32 s17, s17, 0xffff
    s_mov_b32 s18, 0x280000
    s_mov_b32 s19, 0x00020000
    s_and_b32 s21, s21, 0xffff
    s_mov_b32 s22, 0x280000
    s_mov_b32 s23, 0x00020000
    s_mov_b32 s48, 0
    s_mov_b32 s49, 1
    s_mov_b32 s50, 2
    s_mov_b32 s51, 3
    s_mov_b32 s52, 4
    v_lshrrev_b32 v31, 2, v2
    v_lshl_add_u32 v32, v3, 2, v31
    v_mul_u32_u24 v33, 160, v32
    v_and_b32 v34, 3, v2
    v_lshl_add_u32 v33, v34, 3, v33
    v_add_u32 v33, 16384, v33
    v_and_b32 v32, 7, v32
    s_lshl_b32 s37, s48, 5
    v_add_u32 v4, s37, v33
    s_lshl_b32 s37, s49, 5
    v_add_u32 v5, s37, v33
    s_lshl_b32 s37, s50, 5
    v_add_u32 v6, s37, v33
    s_lshl_b32 s37, s51, 5
    v_add_u32 v7, s37, v33
    s_lshl_b32 s37, s52, 5
    v_add_u32 v8, s37, v33
    v_add_u32 v31, s56, v2
    v_mul_u32_u24 v31, 256, v31
    v_xor_b32 v32, v2, v3
    v_xor_b32 v33, 0, v32
    v_lshl_add_u32 v19, v33, 4, v31
    v_xor_b32 v33, 4, v32
    v_lshl_add_u32 v20, v33, 4, v31
    v_xor_b32 v33, 8, v32
    v_lshl_add_u32 v21, v33, 4, v31
    v_xor_b32 v33, 12, v32
    v_lshl_add_u32 v22, v33, 4, v31
    v_add_u32 v9, 0x10000, v4
    v_add_u32 v10, 0x10000, v5
    v_add_u32 v11, 0x10000, v6
    v_add_u32 v12, 0x10000, v7
    v_add_u32 v13, 0x10000, v8
    v_add_u32 v23, 0x10000, v19
    v_add_u32 v24, 0x10000, v20
    v_add_u32 v25, 0x10000, v21
    v_add_u32 v26, 0x10000, v22
    v_add_u32 v14, 0x20000, v4
    v_add_u32 v15, 0x20000, v5
    v_add_u32 v16, 0x20000, v6
    v_add_u32 v17, 0x20000, v7
    v_add_u32 v18, 0x20000, v8
    v_add_u32 v27, 0x20000, v19
    v_add_u32 v28, 0x20000, v20
    v_add_u32 v29, 0x20000, v21
    v_add_u32 v30, 0x20000, v22
    v_mov_b32 v44, 0x3f803f80
    v_mov_b32 v45, 0x3f803f80
    v_mov_b32 v46, 0x3f803f80
    v_mov_b32 v47, 0x3f803f80
    v_accvgpr_write_b32 a0, 0
    v_accvgpr_write_b32 a1, 0
    v_accvgpr_write_b32 a2, 0
    v_accvgpr_write_b32 a3, 0
    v_accvgpr_write_b32 a4, 0
    v_accvgpr_write_b32 a5, 0
    v_accvgpr_write_b32 a6, 0
    v_accvgpr_write_b32 a7, 0
    v_accvgpr_write_b32 a8, 0
    v_accvgpr_write_b32 a9, 0
    v_accvgpr_write_b32 a10, 0
    v_accvgpr_write_b32 a11, 0
    v_accvgpr_write_b32 a12, 0
    v_accvgpr_write_b32 a13, 0
    v_accvgpr_write_b32 a14, 0
    v_accvgpr_write_b32 a15, 0
    v_accvgpr_write_b32 a16, 0
    v_accvgpr_write_b32 a17, 0
    v_accvgpr_write_b32 a18, 0
    v_accvgpr_write_b32 a19, 0
    s_mov_b32 s38, 6554
    s_mul_i32 s37, s43, 128
    v_add_u32 v31, s37, v1
    v_mul_lo_u32 v32, v31, s38
    v_lshrrev_b32 v32, 16, v32
    v_mul_u32_u24 v33, 10, v32
    v_sub_u32 v33, v31, v33
    v_mul_u32_u24 v34, 176, v32
    v_lshl_add_u32 v134, v33, 4, v34
    v_add_u32 v34, s35, v32
    v_mul_u32_u24 v34, 1280, v34
    v_lshl_add_u32 v34, v33, 4, v34
    v_lshl_add_u32 v132, s36, 1, v34
    v_cmp_le_u32 vcc, 640, v31
    v_mov_b32 v35, 0x7fffff00
    v_mov_b32 v36, 0
    v_cndmask_b32 v132, v132, v35, vcc
    v_cndmask_b32 v134, v134, v36, vcc
    v_add_u32 v31, s37, v1
    v_add_u32 v31, 64, v31
    v_mul_lo_u32 v32, v31, s38
    v_lshrrev_b32 v32, 16, v32
    v_mul_u32_u24 v33, 10, v32
    v_sub_u32 v33, v31, v33
    v_mul_u32_u24 v34, 176, v32
    v_lshl_add_u32 v135, v33, 4, v34
    v_add_u32 v34, s35, v32
    v_mul_u32_u24 v34, 1280, v34
    v_lshl_add_u32 v34, v33, 4, v34
    v_lshl_add_u32 v133, s36, 1, v34
    v_cmp_le_u32 vcc, 640, v31
    v_mov_b32 v35, 0x7fffff00
    v_mov_b32 v36, 0
    v_cndmask_b32 v133, v133, v35, vcc
    v_cndmask_b32 v135, v135, v36, vcc
    s_barrier
    ds_read_b128 v[72:75], v19 offset:0
    ds_read_b64_tr_b16 v[48:49], v4 offset:0
    ds_read_b64_tr_b16 v[50:51], v4 offset:2560
    ds_read_b64_tr_b16 v[52:53], v5 offset:0
    ds_read_b64_tr_b16 v[54:55], v5 offset:2560
    ds_read_b64_tr_b16 v[56:57], v6 offset:0
    ds_read_b64_tr_b16 v[58:59], v6 offset:2560
    ds_read_b64_tr_b16 v[60:61], v7 offset:0
    ds_read_b64_tr_b16 v[62:63], v7 offset:2560
    ds_read_b64_tr_b16 v[64:65], v8 offset:0
    ds_read_b64_tr_b16 v[66:67], v8 offset:2560
    ds_read_b128 v[76:79], v20 offset:0
    ds_read_b64_tr_b16 v[68:69], v4 offset:5120
    ds_read_b64_tr_b16 v[70:71], v4 offset:7680
    s_waitcnt lgkmcnt(11)
    v_mfma_f32_16x16x32_bf16 a[0:3], v[48:51], v[72:75], a[0:3]
    ds_read_b64_tr_b16 v[48:49], v5 offset:5120
    ds_read_b64_tr_b16 v[50:51], v5 offset:7680
    s_waitcnt lgkmcnt(11)
    v_mfma_f32_16x16x32_bf16 a[4:7], v[52:55], v[72:75], a[4:7]
    ds_read_b64_tr_b16 v[52:53], v6 offset:5120
    ds_read_b64_tr_b16 v[54:55], v6 offset:7680
    s_waitcnt lgkmcnt(11)
    v_mfma_f32_16x16x32_bf16 a[8:11], v[56:59], v[72:75], a[8:11]
    ds_read_b64_tr_b16 v[56:57], v7 offset:5120
    ds_read_b64_tr_b16 v[58:59], v7 offset:7680
    s_waitcnt lgkmcnt(11)
    v_mfma_f32_16x16x32_bf16 a[12:15], v[60:63], v[72:75], a[12:15]
    ds_read_b64_tr_b16 v[60:61], v8 offset:5120
    ds_read_b64_tr_b16 v[62:63], v8 offset:7680
    s_waitcnt lgkmcnt(11)
    v_mfma_f32_16x16x32_bf16 a[16:19], v[64:67], v[72:75], a[16:19]
    ds_read_b128 v[72:75], v21 offset:0
    ds_read_b64_tr_b16 v[64:65], v4 offset:10240
    ds_read_b64_tr_b16 v[66:67], v4 offset:12800
    s_waitcnt lgkmcnt(11)
    v_mfma_f32_16x16x32_bf16 a[0:3], v[68:71], v[76:79], a[0:3]
    ds_read_b64_tr_b16 v[68:69], v5 offset:10240
    ds_read_b64_tr_b16 v[70:71], v5 offset:12800
    s_waitcnt lgkmcnt(11)
    v_mfma_f32_16x16x32_bf16 a[4:7], v[48:51], v[76:79], a[4:7]
    ds_read_b64_tr_b16 v[48:49], v6 offset:10240
    ds_read_b64_tr_b16 v[50:51], v6 offset:12800
    s_waitcnt lgkmcnt(11)
    v_mfma_f32_16x16x32_bf16 a[8:11], v[52:55], v[76:79], a[8:11]
    ds_read_b64_tr_b16 v[52:53], v7 offset:10240
    ds_read_b64_tr_b16 v[54:55], v7 offset:12800
    s_waitcnt lgkmcnt(11)
    v_mfma_f32_16x16x32_bf16 a[12:15], v[56:59], v[76:79], a[12:15]
    ds_read_b64_tr_b16 v[56:57], v8 offset:10240
    ds_read_b64_tr_b16 v[58:59], v8 offset:12800
    s_waitcnt lgkmcnt(11)
    v_mfma_f32_16x16x32_bf16 a[16:19], v[60:63], v[76:79], a[16:19]
    ds_read_b128 v[76:79], v22 offset:0
    ds_read_b64_tr_b16 v[60:61], v4 offset:15360
    ds_read_b64_tr_b16 v[62:63], v4 offset:17920
    s_waitcnt lgkmcnt(11)
    v_mfma_f32_16x16x32_bf16 a[0:3], v[64:67], v[72:75], a[0:3]
    ds_read_b64_tr_b16 v[64:65], v5 offset:15360
    ds_read_b64_tr_b16 v[66:67], v5 offset:17920
    s_waitcnt lgkmcnt(11)
    v_mfma_f32_16x16x32_bf16 a[4:7], v[68:71], v[72:75], a[4:7]
    ds_read_b64_tr_b16 v[68:69], v6 offset:15360
    ds_read_b64_tr_b16 v[70:71], v6 offset:17920
    s_waitcnt lgkmcnt(11)
    v_mfma_f32_16x16x32_bf16 a[8:11], v[48:51], v[72:75], a[8:11]
    ds_read_b64_tr_b16 v[48:49], v7 offset:15360
    ds_read_b64_tr_b16 v[50:51], v7 offset:17920
    s_waitcnt lgkmcnt(11)
    v_mfma_f32_16x16x32_bf16 a[12:15], v[52:55], v[72:75], a[12:15]
    ds_read_b64_tr_b16 v[52:53], v8 offset:15360
    ds_read_b64_tr_b16 v[54:55], v8 offset:17920
    s_waitcnt lgkmcnt(11)
    v_mfma_f32_16x16x32_bf16 a[16:19], v[56:59], v[72:75], a[16:19]
    s_waitcnt lgkmcnt(8)
    v_mfma_f32_16x16x32_bf16 a[0:3], v[60:63], v[76:79], a[0:3]
    s_waitcnt lgkmcnt(6)
    v_mfma_f32_16x16x32_bf16 a[4:7], v[64:67], v[76:79], a[4:7]
    s_waitcnt lgkmcnt(4)
    v_mfma_f32_16x16x32_bf16 a[8:11], v[68:71], v[76:79], a[8:11]
    s_waitcnt lgkmcnt(2)
    v_mfma_f32_16x16x32_bf16 a[12:15], v[48:51], v[76:79], a[12:15]
    s_waitcnt lgkmcnt(0)
    v_mfma_f32_16x16x32_bf16 a[16:19], v[52:55], v[76:79], a[16:19]
    s_barrier
    ds_read_b128 v[72:75], v19 offset:36864
    ds_read_b64_tr_b16 v[56:57], v4 offset:36864
    ds_read_b64_tr_b16 v[58:59], v4 offset:39424
    ds_read_b64_tr_b16 v[60:61], v5 offset:36864
    ds_read_b64_tr_b16 v[62:63], v5 offset:39424
    ds_read_b64_tr_b16 v[64:65], v6 offset:36864
    ds_read_b64_tr_b16 v[66:67], v6 offset:39424
    ds_read_b64_tr_b16 v[68:69], v7 offset:36864
    ds_read_b64_tr_b16 v[70:71], v7 offset:39424
    ds_read_b64_tr_b16 v[48:49], v8 offset:36864
    ds_read_b64_tr_b16 v[50:51], v8 offset:39424
    ds_read_b128 v[76:79], v20 offset:36864
    ds_read_b64_tr_b16 v[52:53], v4 offset:41984
    ds_read_b64_tr_b16 v[54:55], v4 offset:44544
    s_waitcnt lgkmcnt(11)
    v_mfma_f32_16x16x32_bf16 a[0:3], v[56:59], v[72:75], a[0:3]
    ds_read_b64_tr_b16 v[56:57], v5 offset:41984
    ds_read_b64_tr_b16 v[58:59], v5 offset:44544
    s_waitcnt lgkmcnt(11)
    v_mfma_f32_16x16x32_bf16 a[4:7], v[60:63], v[72:75], a[4:7]
    ds_read_b64_tr_b16 v[60:61], v6 offset:41984
    ds_read_b64_tr_b16 v[62:63], v6 offset:44544
    s_waitcnt lgkmcnt(11)
    v_mfma_f32_16x16x32_bf16 a[8:11], v[64:67], v[72:75], a[8:11]
    ds_read_b64_tr_b16 v[64:65], v7 offset:41984
    ds_read_b64_tr_b16 v[66:67], v7 offset:44544
    s_waitcnt lgkmcnt(11)
    v_mfma_f32_16x16x32_bf16 a[12:15], v[68:71], v[72:75], a[12:15]
    ds_read_b64_tr_b16 v[68:69], v8 offset:41984
    ds_read_b64_tr_b16 v[70:71], v8 offset:44544
    s_waitcnt lgkmcnt(11)
    v_mfma_f32_16x16x32_bf16 a[16:19], v[48:51], v[72:75], a[16:19]
    ds_read_b128 v[72:75], v21 offset:36864
    ds_read_b64_tr_b16 v[48:49], v4 offset:47104
    ds_read_b64_tr_b16 v[50:51], v4 offset:49664
    s_waitcnt lgkmcnt(11)
    v_mfma_f32_16x16x32_bf16 a[0:3], v[52:55], v[76:79], a[0:3]
    ds_read_b64_tr_b16 v[52:53], v5 offset:47104
    ds_read_b64_tr_b16 v[54:55], v5 offset:49664
    s_waitcnt lgkmcnt(11)
    v_mfma_f32_16x16x32_bf16 a[4:7], v[56:59], v[76:79], a[4:7]
    ds_read_b64_tr_b16 v[56:57], v6 offset:47104
    ds_read_b64_tr_b16 v[58:59], v6 offset:49664
    s_waitcnt lgkmcnt(11)
    v_mfma_f32_16x16x32_bf16 a[8:11], v[60:63], v[76:79], a[8:11]
    ds_read_b64_tr_b16 v[60:61], v7 offset:47104
    ds_read_b64_tr_b16 v[62:63], v7 offset:49664
    s_waitcnt lgkmcnt(11)
    v_mfma_f32_16x16x32_bf16 a[12:15], v[64:67], v[76:79], a[12:15]
    ds_read_b64_tr_b16 v[64:65], v8 offset:47104
    ds_read_b64_tr_b16 v[66:67], v8 offset:49664
    s_waitcnt lgkmcnt(11)
    v_mfma_f32_16x16x32_bf16 a[16:19], v[68:71], v[76:79], a[16:19]
    ds_read_b128 v[76:79], v22 offset:36864
    ds_read_b64_tr_b16 v[68:69], v4 offset:52224
    ds_read_b64_tr_b16 v[70:71], v4 offset:54784
    s_waitcnt lgkmcnt(11)
    v_mfma_f32_16x16x32_bf16 a[0:3], v[48:51], v[72:75], a[0:3]
    ds_read_b64_tr_b16 v[48:49], v5 offset:52224
    ds_read_b64_tr_b16 v[50:51], v5 offset:54784
    s_waitcnt lgkmcnt(11)
    v_mfma_f32_16x16x32_bf16 a[4:7], v[52:55], v[72:75], a[4:7]
    ds_read_b64_tr_b16 v[52:53], v6 offset:52224
    ds_read_b64_tr_b16 v[54:55], v6 offset:54784
    s_waitcnt lgkmcnt(11)
    v_mfma_f32_16x16x32_bf16 a[8:11], v[56:59], v[72:75], a[8:11]
    ds_read_b64_tr_b16 v[56:57], v7 offset:52224
    ds_read_b64_tr_b16 v[58:59], v7 offset:54784
    s_waitcnt lgkmcnt(11)
    v_mfma_f32_16x16x32_bf16 a[12:15], v[60:63], v[72:75], a[12:15]
    ds_read_b64_tr_b16 v[60:61], v8 offset:52224
    ds_read_b64_tr_b16 v[62:63], v8 offset:54784
    s_waitcnt lgkmcnt(11)
    v_mfma_f32_16x16x32_bf16 a[16:19], v[64:67], v[72:75], a[16:19]
    s_waitcnt lgkmcnt(8)
    v_mfma_f32_16x16x32_bf16 a[0:3], v[68:71], v[76:79], a[0:3]
    s_waitcnt lgkmcnt(6)
    v_mfma_f32_16x16x32_bf16 a[4:7], v[48:51], v[76:79], a[4:7]
    s_waitcnt lgkmcnt(4)
    v_mfma_f32_16x16x32_bf16 a[8:11], v[52:55], v[76:79], a[8:11]
    s_waitcnt lgkmcnt(2)
    v_mfma_f32_16x16x32_bf16 a[12:15], v[56:59], v[76:79], a[12:15]
    s_waitcnt lgkmcnt(0)
    v_mfma_f32_16x16x32_bf16 a[16:19], v[60:63], v[76:79], a[16:19]
    s_barrier
    ds_read_b128 v[72:75], v23 offset:8192
    ds_read_b64_tr_b16 v[64:65], v9 offset:8192
    ds_read_b64_tr_b16 v[66:67], v9 offset:10752
    ds_read_b64_tr_b16 v[68:69], v10 offset:8192
    ds_read_b64_tr_b16 v[70:71], v10 offset:10752
    ds_read_b64_tr_b16 v[48:49], v11 offset:8192
    ds_read_b64_tr_b16 v[50:51], v11 offset:10752
    ds_read_b64_tr_b16 v[52:53], v12 offset:8192
    ds_read_b64_tr_b16 v[54:55], v12 offset:10752
    ds_read_b64_tr_b16 v[56:57], v13 offset:8192
    ds_read_b64_tr_b16 v[58:59], v13 offset:10752
    ds_read_b128 v[76:79], v24 offset:8192
    ds_read_b64_tr_b16 v[60:61], v9 offset:13312
    ds_read_b64_tr_b16 v[62:63], v9 offset:15872
    s_waitcnt lgkmcnt(11)
    v_mfma_f32_16x16x32_bf16 a[0:3], v[64:67], v[72:75], a[0:3]
    ds_read_b64_tr_b16 v[64:65], v10 offset:13312
    ds_read_b64_tr_b16 v[66:67], v10 offset:15872
    s_waitcnt lgkmcnt(11)
    v_mfma_f32_16x16x32_bf16 a[4:7], v[68:71], v[72:75], a[4:7]
    ds_read_b64_tr_b16 v[68:69], v11 offset:13312
    ds_read_b64_tr_b16 v[70:71], v11 offset:15872
    s_waitcnt lgkmcnt(11)
    v_mfma_f32_16x16x32_bf16 a[8:11], v[48:51], v[72:75], a[8:11]
    ds_read_b64_tr_b16 v[48:49], v12 offset:13312
    ds_read_b64_tr_b16 v[50:51], v12 offset:15872
    s_waitcnt lgkmcnt(11)
    v_mfma_f32_16x16x32_bf16 a[12:15], v[52:55], v[72:75], a[12:15]
    ds_read_b64_tr_b16 v[52:53], v13 offset:13312
    ds_read_b64_tr_b16 v[54:55], v13 offset:15872
    s_waitcnt lgkmcnt(11)
    v_mfma_f32_16x16x32_bf16 a[16:19], v[56:59], v[72:75], a[16:19]
    ds_read_b128 v[72:75], v25 offset:8192
    ds_read_b64_tr_b16 v[56:57], v9 offset:18432
    ds_read_b64_tr_b16 v[58:59], v9 offset:20992
    s_waitcnt lgkmcnt(11)
    v_mfma_f32_16x16x32_bf16 a[0:3], v[60:63], v[76:79], a[0:3]
    ds_read_b64_tr_b16 v[60:61], v10 offset:18432
    ds_read_b64_tr_b16 v[62:63], v10 offset:20992
    s_waitcnt lgkmcnt(11)
    v_mfma_f32_16x16x32_bf16 a[4:7], v[64:67], v[76:79], a[4:7]
    ds_read_b64_tr_b16 v[64:65], v11 offset:18432
    ds_read_b64_tr_b16 v[66:67], v11 offset:20992
    s_waitcnt lgkmcnt(11)
    v_mfma_f32_16x16x32_bf16 a[8:11], v[68:71], v[76:79], a[8:11]
    ds_read_b64_tr_b16 v[68:69], v12 offset:18432
    ds_read_b64_tr_b16 v[70:71], v12 offset:20992
    s_waitcnt lgkmcnt(11)
    v_mfma_f32_16x16x32_bf16 a[12:15], v[48:51], v[76:79], a[12:15]
    ds_read_b64_tr_b16 v[48:49], v13 offset:18432
    ds_read_b64_tr_b16 v[50:51], v13 offset:20992
    s_waitcnt lgkmcnt(11)
    v_mfma_f32_16x16x32_bf16 a[16:19], v[52:55], v[76:79], a[16:19]
    ds_read_b128 v[76:79], v26 offset:8192
    ds_read_b64_tr_b16 v[52:53], v9 offset:23552
    ds_read_b64_tr_b16 v[54:55], v9 offset:26112
    s_waitcnt lgkmcnt(11)
    v_mfma_f32_16x16x32_bf16 a[0:3], v[56:59], v[72:75], a[0:3]
    ds_read_b64_tr_b16 v[56:57], v10 offset:23552
    ds_read_b64_tr_b16 v[58:59], v10 offset:26112
    s_waitcnt lgkmcnt(11)
    v_mfma_f32_16x16x32_bf16 a[4:7], v[60:63], v[72:75], a[4:7]
    ds_read_b64_tr_b16 v[60:61], v11 offset:23552
    ds_read_b64_tr_b16 v[62:63], v11 offset:26112
    s_waitcnt lgkmcnt(11)
    v_mfma_f32_16x16x32_bf16 a[8:11], v[64:67], v[72:75], a[8:11]
    ds_read_b64_tr_b16 v[64:65], v12 offset:23552
    ds_read_b64_tr_b16 v[66:67], v12 offset:26112
    s_waitcnt lgkmcnt(11)
    v_mfma_f32_16x16x32_bf16 a[12:15], v[68:71], v[72:75], a[12:15]
    ds_read_b64_tr_b16 v[68:69], v13 offset:23552
    ds_read_b64_tr_b16 v[70:71], v13 offset:26112
    s_waitcnt lgkmcnt(11)
    v_mfma_f32_16x16x32_bf16 a[16:19], v[48:51], v[72:75], a[16:19]
    s_waitcnt lgkmcnt(8)
    v_mfma_f32_16x16x32_bf16 a[0:3], v[52:55], v[76:79], a[0:3]
    s_waitcnt lgkmcnt(6)
    v_mfma_f32_16x16x32_bf16 a[4:7], v[56:59], v[76:79], a[4:7]
    s_waitcnt lgkmcnt(4)
    v_mfma_f32_16x16x32_bf16 a[8:11], v[60:63], v[76:79], a[8:11]
    s_waitcnt lgkmcnt(2)
    v_mfma_f32_16x16x32_bf16 a[12:15], v[64:67], v[76:79], a[12:15]
    s_waitcnt lgkmcnt(0)
    v_mfma_f32_16x16x32_bf16 a[16:19], v[68:71], v[76:79], a[16:19]
    s_barrier
    buffer_load_dwordx4 v[136:139], v132, s[20:23], 0 offen
    buffer_load_dwordx4 v[140:143], v133, s[20:23], 0 offen
    ds_read_b128 v[72:75], v23 offset:45056
    ds_read_b64_tr_b16 v[48:49], v9 offset:45056
    ds_read_b64_tr_b16 v[50:51], v9 offset:47616
    ds_read_b64_tr_b16 v[52:53], v10 offset:45056
    ds_read_b64_tr_b16 v[54:55], v10 offset:47616
    ds_read_b64_tr_b16 v[56:57], v11 offset:45056
    ds_read_b64_tr_b16 v[58:59], v11 offset:47616
    ds_read_b64_tr_b16 v[60:61], v12 offset:45056
    ds_read_b64_tr_b16 v[62:63], v12 offset:47616
    ds_read_b64_tr_b16 v[64:65], v13 offset:45056
    ds_read_b64_tr_b16 v[66:67], v13 offset:47616
    ds_read_b128 v[76:79], v24 offset:45056
    ds_read_b64_tr_b16 v[68:69], v9 offset:50176
    ds_read_b64_tr_b16 v[70:71], v9 offset:52736
    s_waitcnt lgkmcnt(11)
    v_mfma_f32_16x16x32_bf16 a[0:3], v[48:51], v[72:75], a[0:3]
    ds_read_b64_tr_b16 v[48:49], v10 offset:50176
    ds_read_b64_tr_b16 v[50:51], v10 offset:52736
    s_waitcnt lgkmcnt(11)
    v_mfma_f32_16x16x32_bf16 a[4:7], v[52:55], v[72:75], a[4:7]
    ds_read_b64_tr_b16 v[52:53], v11 offset:50176
    ds_read_b64_tr_b16 v[54:55], v11 offset:52736
    s_waitcnt lgkmcnt(11)
    v_mfma_f32_16x16x32_bf16 a[8:11], v[56:59], v[72:75], a[8:11]
    ds_read_b64_tr_b16 v[56:57], v12 offset:50176
    ds_read_b64_tr_b16 v[58:59], v12 offset:52736
    s_waitcnt lgkmcnt(11)
    v_mfma_f32_16x16x32_bf16 a[12:15], v[60:63], v[72:75], a[12:15]
    ds_read_b64_tr_b16 v[60:61], v13 offset:50176
    ds_read_b64_tr_b16 v[62:63], v13 offset:52736
    s_waitcnt lgkmcnt(11)
    v_mfma_f32_16x16x32_bf16 a[16:19], v[64:67], v[72:75], a[16:19]
    ds_read_b128 v[72:75], v25 offset:45056
    ds_read_b64_tr_b16 v[64:65], v9 offset:55296
    ds_read_b64_tr_b16 v[66:67], v9 offset:57856
    s_waitcnt lgkmcnt(11)
    v_mfma_f32_16x16x32_bf16 a[0:3], v[68:71], v[76:79], a[0:3]
    ds_read_b64_tr_b16 v[68:69], v10 offset:55296
    ds_read_b64_tr_b16 v[70:71], v10 offset:57856
    s_waitcnt lgkmcnt(11)
    v_mfma_f32_16x16x32_bf16 a[4:7], v[48:51], v[76:79], a[4:7]
    ds_read_b64_tr_b16 v[48:49], v11 offset:55296
    ds_read_b64_tr_b16 v[50:51], v11 offset:57856
    s_waitcnt lgkmcnt(11)
    v_mfma_f32_16x16x32_bf16 a[8:11], v[52:55], v[76:79], a[8:11]
    ds_read_b64_tr_b16 v[52:53], v12 offset:55296
    ds_read_b64_tr_b16 v[54:55], v12 offset:57856
    s_waitcnt lgkmcnt(11)
    v_mfma_f32_16x16x32_bf16 a[12:15], v[56:59], v[76:79], a[12:15]
    ds_read_b64_tr_b16 v[56:57], v13 offset:55296
    ds_read_b64_tr_b16 v[58:59], v13 offset:57856
    s_waitcnt lgkmcnt(11)
    v_mfma_f32_16x16x32_bf16 a[16:19], v[60:63], v[76:79], a[16:19]
    ds_read_b128 v[76:79], v26 offset:45056
    ds_read_b64_tr_b16 v[60:61], v9 offset:60416
    ds_read_b64_tr_b16 v[62:63], v9 offset:62976
    s_waitcnt lgkmcnt(11)
    v_mfma_f32_16x16x32_bf16 a[0:3], v[64:67], v[72:75], a[0:3]
    ds_read_b64_tr_b16 v[64:65], v10 offset:60416
    ds_read_b64_tr_b16 v[66:67], v10 offset:62976
    s_waitcnt lgkmcnt(11)
    v_mfma_f32_16x16x32_bf16 a[4:7], v[68:71], v[72:75], a[4:7]
    ds_read_b64_tr_b16 v[68:69], v11 offset:60416
    ds_read_b64_tr_b16 v[70:71], v11 offset:62976
    s_waitcnt lgkmcnt(11)
    v_mfma_f32_16x16x32_bf16 a[8:11], v[48:51], v[72:75], a[8:11]
    ds_read_b64_tr_b16 v[48:49], v12 offset:60416
    ds_read_b64_tr_b16 v[50:51], v12 offset:62976
    s_waitcnt lgkmcnt(11)
    v_mfma_f32_16x16x32_bf16 a[12:15], v[52:55], v[72:75], a[12:15]
    ds_read_b64_tr_b16 v[52:53], v13 offset:60416
    ds_read_b64_tr_b16 v[54:55], v13 offset:62976
    s_waitcnt lgkmcnt(11)
    v_mfma_f32_16x16x32_bf16 a[16:19], v[56:59], v[72:75], a[16:19]
    s_waitcnt lgkmcnt(8)
    v_mfma_f32_16x16x32_bf16 a[0:3], v[60:63], v[76:79], a[0:3]
    s_waitcnt lgkmcnt(6)
    v_mfma_f32_16x16x32_bf16 a[4:7], v[64:67], v[76:79], a[4:7]
    s_waitcnt lgkmcnt(4)
    v_mfma_f32_16x16x32_bf16 a[8:11], v[68:71], v[76:79], a[8:11]
    s_waitcnt lgkmcnt(2)
    v_mfma_f32_16x16x32_bf16 a[12:15], v[48:51], v[76:79], a[12:15]
    s_waitcnt lgkmcnt(0)
    v_mfma_f32_16x16x32_bf16 a[16:19], v[52:55], v[76:79], a[16:19]
    s_barrier
    ds_read_b128 v[72:75], v19 offset:0
    ds_read_b64_tr_b16 v[56:57], v4 offset:0
    ds_read_b64_tr_b16 v[58:59], v4 offset:2560
    ds_read_b64_tr_b16 v[60:61], v5 offset:0
    ds_read_b64_tr_b16 v[62:63], v5 offset:2560
    ds_read_b64_tr_b16 v[64:65], v6 offset:0
    ds_read_b64_tr_b16 v[66:67], v6 offset:2560
    ds_read_b64_tr_b16 v[68:69], v7 offset:0
    ds_read_b64_tr_b16 v[70:71], v7 offset:2560
    ds_read_b64_tr_b16 v[48:49], v8 offset:0
    ds_read_b64_tr_b16 v[50:51], v8 offset:2560
    ds_read_b128 v[76:79], v20 offset:0
    ds_read_b64_tr_b16 v[52:53], v4 offset:5120
    ds_read_b64_tr_b16 v[54:55], v4 offset:7680
    s_waitcnt lgkmcnt(11)
    v_mfma_f32_16x16x32_bf16 a[0:3], v[56:59], v[72:75], a[0:3]
    ds_read_b64_tr_b16 v[56:57], v5 offset:5120
    ds_read_b64_tr_b16 v[58:59], v5 offset:7680
    s_waitcnt lgkmcnt(11)
    v_mfma_f32_16x16x32_bf16 a[4:7], v[60:63], v[72:75], a[4:7]
    ds_read_b64_tr_b16 v[60:61], v6 offset:5120
    ds_read_b64_tr_b16 v[62:63], v6 offset:7680
    s_waitcnt lgkmcnt(11)
    v_mfma_f32_16x16x32_bf16 a[8:11], v[64:67], v[72:75], a[8:11]
    ds_read_b64_tr_b16 v[64:65], v7 offset:5120
    ds_read_b64_tr_b16 v[66:67], v7 offset:7680
    s_waitcnt lgkmcnt(11)
    v_mfma_f32_16x16x32_bf16 a[12:15], v[68:71], v[72:75], a[12:15]
    ds_read_b64_tr_b16 v[68:69], v8 offset:5120
    ds_read_b64_tr_b16 v[70:71], v8 offset:7680
    s_waitcnt lgkmcnt(11)
    v_mfma_f32_16x16x32_bf16 a[16:19], v[48:51], v[72:75], a[16:19]
    ds_read_b128 v[72:75], v21 offset:0
    ds_read_b64_tr_b16 v[48:49], v4 offset:10240
    ds_read_b64_tr_b16 v[50:51], v4 offset:12800
    s_waitcnt lgkmcnt(11)
    v_mfma_f32_16x16x32_bf16 a[0:3], v[52:55], v[76:79], a[0:3]
    ds_read_b64_tr_b16 v[52:53], v5 offset:10240
    ds_read_b64_tr_b16 v[54:55], v5 offset:12800
    s_waitcnt lgkmcnt(11)
    v_mfma_f32_16x16x32_bf16 a[4:7], v[56:59], v[76:79], a[4:7]
    ds_read_b64_tr_b16 v[56:57], v6 offset:10240
    ds_read_b64_tr_b16 v[58:59], v6 offset:12800
    s_waitcnt lgkmcnt(11)
    v_mfma_f32_16x16x32_bf16 a[8:11], v[60:63], v[76:79], a[8:11]
    ds_read_b64_tr_b16 v[60:61], v7 offset:10240
    ds_read_b64_tr_b16 v[62:63], v7 offset:12800
    s_waitcnt lgkmcnt(11)
    v_mfma_f32_16x16x32_bf16 a[12:15], v[64:67], v[76:79], a[12:15]
    ds_read_b64_tr_b16 v[64:65], v8 offset:10240
    ds_read_b64_tr_b16 v[66:67], v8 offset:12800
    s_waitcnt lgkmcnt(11)
    v_mfma_f32_16x16x32_bf16 a[16:19], v[68:71], v[76:79], a[16:19]
    ds_read_b128 v[76:79], v22 offset:0
    ds_read_b64_tr_b16 v[68:69], v4 offset:15360
    ds_read_b64_tr_b16 v[70:71], v4 offset:17920
    s_waitcnt lgkmcnt(11)
    v_mfma_f32_16x16x32_bf16 a[0:3], v[48:51], v[72:75], a[0:3]
    ds_read_b64_tr_b16 v[48:49], v5 offset:15360
    ds_read_b64_tr_b16 v[50:51], v5 offset:17920
    s_waitcnt lgkmcnt(11)
    v_mfma_f32_16x16x32_bf16 a[4:7], v[52:55], v[72:75], a[4:7]
    ds_read_b64_tr_b16 v[52:53], v6 offset:15360
    ds_read_b64_tr_b16 v[54:55], v6 offset:17920
    s_waitcnt lgkmcnt(11)
    v_mfma_f32_16x16x32_bf16 a[8:11], v[56:59], v[72:75], a[8:11]
    ds_read_b64_tr_b16 v[56:57], v7 offset:15360
    ds_read_b64_tr_b16 v[58:59], v7 offset:17920
    s_waitcnt lgkmcnt(11)
    v_mfma_f32_16x16x32_bf16 a[12:15], v[60:63], v[72:75], a[12:15]
    ds_read_b64_tr_b16 v[60:61], v8 offset:15360
    ds_read_b64_tr_b16 v[62:63], v8 offset:17920
    s_waitcnt lgkmcnt(11)
    v_mfma_f32_16x16x32_bf16 a[16:19], v[64:67], v[72:75], a[16:19]
    s_waitcnt lgkmcnt(8)
    v_mfma_f32_16x16x32_bf16 a[0:3], v[68:71], v[76:79], a[0:3]
    s_waitcnt lgkmcnt(6)
    v_mfma_f32_16x16x32_bf16 a[4:7], v[48:51], v[76:79], a[4:7]
    s_waitcnt lgkmcnt(4)
    v_mfma_f32_16x16x32_bf16 a[8:11], v[52:55], v[76:79], a[8:11]
    s_waitcnt lgkmcnt(2)
    v_mfma_f32_16x16x32_bf16 a[12:15], v[56:59], v[76:79], a[12:15]
    s_waitcnt lgkmcnt(0)
    v_mfma_f32_16x16x32_bf16 a[16:19], v[60:63], v[76:79], a[16:19]
    s_nop 7
    s_nop 1
    s_waitcnt lgkmcnt(0)
    s_barrier
    v_add_u32 v100, s56, v2
    v_mul_u32_u24 v100, 176, v100
    v_lshl_add_u32 v100, v3, 3, v100
    s_mul_i32 s37, s48, 32
    v_add_u32 v101, s37, v100
    v_accvgpr_read_b32 v104, a0
    v_accvgpr_read_b32 v105, a1
    v_accvgpr_read_b32 v106, a2
    v_accvgpr_read_b32 v107, a3
    v_cvt_pk_bf16_f32 v108, v104, v105
    v_cvt_pk_bf16_f32 v109, v106, v107
    ds_write_b64 v101, v[108:109] offset:0
    s_mul_i32 s37, s49, 32
    v_add_u32 v101, s37, v100
    v_accvgpr_read_b32 v104, a4
    v_accvgpr_read_b32 v105, a5
    v_accvgpr_read_b32 v106, a6
    v_accvgpr_read_b32 v107, a7
    v_cvt_pk_bf16_f32 v108, v104, v105
    v_cvt_pk_bf16_f32 v109, v106, v107
    ds_write_b64 v101, v[108:109] offset:0
    s_mul_i32 s37, s50, 32
    v_add_u32 v101, s37, v100
    v_accvgpr_read_b32 v104, a8
    v_accvgpr_read_b32 v105, a9
    v_accvgpr_read_b32 v106, a10
    v_accvgpr_read_b32 v107, a11
    v_cvt_pk_bf16_f32 v108, v104, v105
    v_cvt_pk_bf16_f32 v109, v106, v107
    ds_write_b64 v101, v[108:109] offset:0
    s_mul_i32 s37, s51, 32
    v_add_u32 v101, s37, v100
    v_accvgpr_read_b32 v104, a12
    v_accvgpr_read_b32 v105, a13
    v_accvgpr_read_b32 v106, a14
    v_accvgpr_read_b32 v107, a15
    v_cvt_pk_bf16_f32 v108, v104, v105
    v_cvt_pk_bf16_f32 v109, v106, v107
    ds_write_b64 v101, v[108:109] offset:0
    s_mul_i32 s37, s52, 32
    v_add_u32 v101, s37, v100
    v_accvgpr_read_b32 v104, a16
    v_accvgpr_read_b32 v105, a17
    v_accvgpr_read_b32 v106, a18
    v_accvgpr_read_b32 v107, a19
    v_cvt_pk_bf16_f32 v108, v104, v105
    v_cvt_pk_bf16_f32 v109, v106, v107
    ds_write_b64 v101, v[108:109] offset:0
    s_waitcnt lgkmcnt(0)
k3_kernel_phase2:
    s_barrier
    ds_read_b128 v[80:83], v134
    ds_read_b128 v[84:87], v135
    s_waitcnt vmcnt(0)
    s_waitcnt lgkmcnt(1)
    v_lshlrev_b32 v104, 16, v80
    v_and_b32 v105, 0xffff0000, v80
    v_lshlrev_b32 v106, 16, v81
    v_and_b32 v107, 0xffff0000, v81
    v_lshlrev_b32 v108, 16, v82
    v_and_b32 v109, 0xffff0000, v82
    v_lshlrev_b32 v110, 16, v83
    v_and_b32 v111, 0xffff0000, v83
    v_lshlrev_b32 v112, 16, v136
    v_and_b32 v113, 0xffff0000, v136
    v_lshlrev_b32 v114, 16, v137
    v_and_b32 v115, 0xffff0000, v137
    v_lshlrev_b32 v116, 16, v138
    v_and_b32 v117, 0xffff0000, v138
    v_lshlrev_b32 v118, 16, v139
    v_and_b32 v119, 0xffff0000, v139
    v_pk_add_f32 v[104:105], v[104:105], v[112:113]
    v_pk_add_f32 v[106:107], v[106:107], v[114:115]
    v_pk_add_f32 v[108:109], v[108:109], v[116:117]
    v_pk_add_f32 v[110:111], v[110:111], v[118:119]
    v_cvt_pk_bf16_f32 v80, v104, v105
    v_cvt_pk_bf16_f32 v81, v106, v107
    v_cvt_pk_bf16_f32 v82, v108, v109
    v_cvt_pk_bf16_f32 v83, v110, v111
    buffer_store_dwordx4 v[80:83], v132, s[16:19], 0 offen
    s_waitcnt lgkmcnt(0)
    v_lshlrev_b32 v104, 16, v84
    v_and_b32 v105, 0xffff0000, v84
    v_lshlrev_b32 v106, 16, v85
    v_and_b32 v107, 0xffff0000, v85
    v_lshlrev_b32 v108, 16, v86
    v_and_b32 v109, 0xffff0000, v86
    v_lshlrev_b32 v110, 16, v87
    v_and_b32 v111, 0xffff0000, v87
    v_lshlrev_b32 v112, 16, v140
    v_and_b32 v113, 0xffff0000, v140
    v_lshlrev_b32 v114, 16, v141
    v_and_b32 v115, 0xffff0000, v141
    v_lshlrev_b32 v116, 16, v142
    v_and_b32 v117, 0xffff0000, v142
    v_lshlrev_b32 v118, 16, v143
    v_and_b32 v119, 0xffff0000, v143
    v_pk_add_f32 v[104:105], v[104:105], v[112:113]
    v_pk_add_f32 v[106:107], v[106:107], v[114:115]
    v_pk_add_f32 v[108:109], v[108:109], v[116:117]
    v_pk_add_f32 v[110:111], v[110:111], v[118:119]
    v_cvt_pk_bf16_f32 v84, v104, v105
    v_cvt_pk_bf16_f32 v85, v106, v107
    v_cvt_pk_bf16_f32 v86, v108, v109
    v_cvt_pk_bf16_f32 v87, v110, v111
    buffer_store_dwordx4 v[84:87], v133, s[16:19], 0 offen
k3_kernel_end:
    s_endpgm
.p2align 8
.globl k4_kernel
.type k4_kernel,@function
k4_kernel:
    s_cmp_ge_u32 s2, 256
    s_cbranch_scc1 k4_kernel_end
    s_load_dwordx2 s[4:5], s[0:1], 80
    s_and_b32 s37, s2, 7
    s_lshr_b32 s38, s2, 3
    s_lshr_b32 s33, s38, 3
    s_and_b32 s34, s38, 7
    s_mul_i32 s37, s37, 4
    s_add_u32 s33, s33, s37
    s_mul_i32 s35, s33, 64
    s_mul_i32 s36, s34, 80
    v_and_b32 v1, 63, v0
    v_lshrrev_b32 v31, 6, v0
    v_and_b32 v2, 15, v0
    v_bfe_u32 v3, v0, 4, 2
    v_readfirstlane_b32 s43, v31
    s_and_b32 s32, s43, 3
    s_mul_i32 s56, s32, 16
    s_cmp_lt_u32 s43, 4
    s_cbranch_scc1 k4_kernel_cons
    v_lshrrev_b32 v31, 4, v1
    v_and_b32 v32, 15, v1
    v_add_u32 v31, s56, v31
    s_mov_b32 s38, 1280
    v_add_u32 v33, 0, v31
    v_and_b32 v34, 15, v33
    v_xor_b32 v34, v34, v32
    v_add_u32 v33, s35, v33
    v_mul_lo_u32 v33, v33, s38
    v_lshl_add_u32 v4, v34, 4, v33
    v_add_u32 v33, 4, v31
    v_and_b32 v34, 15, v33
    v_xor_b32 v34, v34, v32
    v_add_u32 v33, s35, v33
    v_mul_lo_u32 v33, v33, s38
    v_lshl_add_u32 v5, v34, 4, v33
    v_add_u32 v33, 8, v31
    v_and_b32 v34, 15, v33
    v_xor_b32 v34, v34, v32
    v_add_u32 v33, s35, v33
    v_mul_lo_u32 v33, v33, s38
    v_lshl_add_u32 v6, v34, 4, v33
    v_add_u32 v33, 12, v31
    v_and_b32 v34, 15, v33
    v_xor_b32 v34, v34, v32
    v_add_u32 v33, s35, v33
    v_mul_lo_u32 v33, v33, s38
    v_lshl_add_u32 v7, v34, 4, v33
    s_mul_i32 s37, s34, 102400
    s_mul_i32 s38, s32, 5120
    s_add_u32 s37, s37, s38
    v_lshl_add_u32 v8, v1, 4, s37
    s_waitcnt lgkmcnt(0)
    s_add_u32 s12, s4, 0x1b4c000
    s_addc_u32 s13, s5, 0
    s_and_b32 s13, s13, 0xffff
    s_mov_b32 s14, 0xc8000
    s_mov_b32 s15, 0x00020000
    s_add_u32 s8, s4, 0xd00000
    s_addc_u32 s9, s5, 0
    s_and_b32 s9, s9, 0xffff
    s_mov_b32 s10, 0x280000
    s_mov_b32 s11, 0x00020000
    s_mul_i32 s39, s32, 4096
    s_mul_i32 s40, s32, 5120
    s_mov_b32 s46, 0x7ff00000
    s_mov_b32 s41, 0x0
    s_add_u32 m0, s39, 0x0
    s_nop 0
    buffer_load_dwordx4 v4, s[8:11], s41 offen lds
    s_add_u32 m0, s39, 0x400
    s_nop 0
    buffer_load_dwordx4 v5, s[8:11], s41 offen lds
    s_add_u32 m0, s39, 0x800
    s_nop 0
    buffer_load_dwordx4 v6, s[8:11], s41 offen lds
    s_add_u32 m0, s39, 0xc00
    s_nop 0
    buffer_load_dwordx4 v7, s[8:11], s41 offen lds
    s_add_u32 m0, s40, 0x4000
    s_mov_b32 s42, 0x0
    buffer_load_dwordx4 v8, s[12:15], s42 offen lds
    s_add_u32 m0, s40, 0x4400
    s_mov_b32 s42, 0x400
    buffer_load_dwordx4 v8, s[12:15], s42 offen lds
    s_add_u32 m0, s40, 0x4800
    s_mov_b32 s42, 0x800
    buffer_load_dwordx4 v8, s[12:15], s42 offen lds
    s_add_u32 m0, s40, 0x4c00
    s_mov_b32 s42, 0xc00
    buffer_load_dwordx4 v8, s[12:15], s42 offen lds
    s_add_u32 m0, s40, 0x5000
    s_mov_b32 s42, 0x1000
    buffer_load_dwordx4 v8, s[12:15], s42 offen lds
    s_mov_b32 s41, 0x100
    s_add_u32 m0, s39, 0x9000
    s_nop 0
    buffer_load_dwordx4 v4, s[8:11], s41 offen lds
    s_add_u32 m0, s39, 0x9400
    s_nop 0
    buffer_load_dwordx4 v5, s[8:11], s41 offen lds
    s_add_u32 m0, s39, 0x9800
    s_nop 0
    buffer_load_dwordx4 v6, s[8:11], s41 offen lds
    s_add_u32 m0, s39, 0x9c00
    s_nop 0
    buffer_load_dwordx4 v7, s[8:11], s41 offen lds
    s_add_u32 m0, s40, 0xd000
    s_mov_b32 s42, 0x5000
    buffer_load_dwordx4 v8, s[12:15], s42 offen lds
    s_add_u32 m0, s40, 0xd400
    s_mov_b32 s42, 0x5400
    buffer_load_dwordx4 v8, s[12:15], s42 offen lds
    s_add_u32 m0, s40, 0xd800
    s_mov_b32 s42, 0x5800
    buffer_load_dwordx4 v8, s[12:15], s42 offen lds
    s_add_u32 m0, s40, 0xdc00
    s_mov_b32 s42, 0x5c00
    buffer_load_dwordx4 v8, s[12:15], s42 offen lds
    s_add_u32 m0, s40, 0xe000
    s_mov_b32 s42, 0x6000
    buffer_load_dwordx4 v8, s[12:15], s42 offen lds
    s_mov_b32 s41, 0x200
    s_add_u32 m0, s39, 0x12000
    s_nop 0
    buffer_load_dwordx4 v4, s[8:11], s41 offen lds
    s_add_u32 m0, s39, 0x12400
    s_nop 0
    buffer_load_dwordx4 v5, s[8:11], s41 offen lds
    s_add_u32 m0, s39, 0x12800
    s_nop 0
    buffer_load_dwordx4 v6, s[8:11], s41 offen lds
    s_add_u32 m0, s39, 0x12c00
    s_nop 0
    buffer_load_dwordx4 v7, s[8:11], s41 offen lds
    s_add_u32 m0, s40, 0x16000
    s_mov_b32 s42, 0xa000
    buffer_load_dwordx4 v8, s[12:15], s42 offen lds
    s_add_u32 m0, s40, 0x16400
    s_mov_b32 s42, 0xa400
    buffer_load_dwordx4 v8, s[12:15], s42 offen lds
    s_add_u32 m0, s40, 0x16800
    s_mov_b32 s42, 0xa800
    buffer_load_dwordx4 v8, s[12:15], s42 offen lds
    s_add_u32 m0, s40, 0x16c00
    s_mov_b32 s42, 0xac00
    buffer_load_dwordx4 v8, s[12:15], s42 offen lds
    s_add_u32 m0, s40, 0x17000
    s_mov_b32 s42, 0xb000
    buffer_load_dwordx4 v8, s[12:15], s42 offen lds
    s_add_u32 s16, s4, 0xf80000
    s_addc_u32 s17, s5, 0
    s_and_b32 s17, s17, 0xffff
    s_mov_b32 s18, 0x280000
    s_mov_b32 s19, 0x00020000
    s_add_u32 s28, s4, 0x1a80000
    s_addc_u32 s29, s5, 0
    s_and_b32 s29, s29, 0xffff
    s_mov_b32 s30, 0x4000
    s_mov_b32 s31, 0x00020000
    s_mov_b32 s38, 6554
    s_mul_i32 s37, s43, 128
    v_add_u32 v31, s37, v1
    v_mul_lo_u32 v32, v31, s38
    v_lshrrev_b32 v32, 16, v32
    v_mul_u32_u24 v33, 10, v32
    v_sub_u32 v33, v31, v33
    v_mul_u32_u24 v34, 176, v32
    v_lshl_add_u32 v134, v33, 4, v34
    v_add_u32 v34, s35, v32
    v_mul_u32_u24 v34, 1280, v34
    v_lshl_add_u32 v34, v33, 4, v34
    v_lshl_add_u32 v132, s36, 1, v34
    v_cmp_le_u32 vcc, 640, v31
    v_mov_b32 v35, 0x7fffff00
    v_mov_b32 v36, 0
    v_cndmask_b32 v132, v132, v35, vcc
    v_cndmask_b32 v134, v134, v36, vcc
    v_add_u32 v31, s37, v1
    v_add_u32 v31, 64, v31
    v_mul_lo_u32 v32, v31, s38
    v_lshrrev_b32 v32, 16, v32
    v_mul_u32_u24 v33, 10, v32
    v_sub_u32 v33, v31, v33
    v_mul_u32_u24 v34, 176, v32
    v_lshl_add_u32 v135, v33, 4, v34
    v_add_u32 v34, s35, v32
    v_mul_u32_u24 v34, 1280, v34
    v_lshl_add_u32 v34, v33, 4, v34
    v_lshl_add_u32 v133, s36, 1, v34
    v_cmp_le_u32 vcc, 640, v31
    v_mov_b32 v35, 0x7fffff00
    v_mov_b32 v36, 0
    v_cndmask_b32 v133, v133, v35, vcc
    v_cndmask_b32 v135, v135, v36, vcc
    s_waitcnt vmcnt(18)
    s_barrier
    s_mov_b32 s41, 0x300
    s_add_u32 m0, s39, 0x1b000
    s_nop 0
    buffer_load_dwordx4 v4, s[8:11], s41 offen lds
    s_add_u32 m0, s39, 0x1b400
    s_nop 0
    buffer_load_dwordx4 v5, s[8:11], s41 offen lds
    s_add_u32 m0, s39, 0x1b800
    s_nop 0
    buffer_load_dwordx4 v6, s[8:11], s41 offen lds
    s_add_u32 m0, s39, 0x1bc00
    s_nop 0
    buffer_load_dwordx4 v7, s[8:11], s41 offen lds
    s_add_u32 m0, s40, 0x1f000
    s_mov_b32 s42, 0xf000
    buffer_load_dwordx4 v8, s[12:15], s42 offen lds
    s_add_u32 m0, s40, 0x1f400
    s_mov_b32 s42, 0xf400
    buffer_load_dwordx4 v8, s[12:15], s42 offen lds
    s_add_u32 m0, s40, 0x1f800
    s_mov_b32 s42, 0xf800
    buffer_load_dwordx4 v8, s[12:15], s42 offen lds
    s_add_u32 m0, s40, 0x1fc00
    s_mov_b32 s42, 0xfc00
    buffer_load_dwordx4 v8, s[12:15], s42 offen lds
    s_add_u32 m0, s40, 0x20000
    s_mov_b32 s42, 0x10000
    buffer_load_dwordx4 v8, s[12:15], s42 offen lds
    s_waitcnt vmcnt(18)
    s_barrier
    s_mov_b32 s41, 0x400
    s_add_u32 m0, s39, 0x0
    s_nop 0
    buffer_load_dwordx4 v4, s[8:11], s41 offen lds
    s_add_u32 m0, s39, 0x400
    s_nop 0
    buffer_load_dwordx4 v5, s[8:11], s41 offen lds
    s_add_u32 m0, s39, 0x800
    s_nop 0
    buffer_load_dwordx4 v6, s[8:11], s41 offen lds
    s_add_u32 m0, s39, 0xc00
    s_nop 0
    buffer_load_dwordx4 v7, s[8:11], s41 offen lds
    s_add_u32 m0, s40, 0x4000
    s_mov_b32 s42, 0x14000
    buffer_load_dwordx4 v8, s[12:15], s42 offen lds
    s_add_u32 m0, s40, 0x4400
    s_mov_b32 s42, 0x14400
    buffer_load_dwordx4 v8, s[12:15], s42 offen lds
    s_add_u32 m0, s40, 0x4800
    s_mov_b32 s42, 0x14800
    buffer_load_dwordx4 v8, s[12:15], s42 offen lds
    s_add_u32 m0, s40, 0x4c00
    s_mov_b32 s42, 0x14c00
    buffer_load_dwordx4 v8, s[12:15], s42 offen lds
    s_add_u32 m0, s40, 0x5000
    s_mov_b32 s42, 0x15000
    buffer_load_dwordx4 v8, s[12:15], s42 offen lds
    s_waitcnt vmcnt(18)
    s_barrier
    s_waitcnt vmcnt(9)
    s_barrier
    s_waitcnt vmcnt(0)
    s_barrier
    s_barrier
    s_branch k4_kernel_phase2
k4_kernel_cons:
    s_waitcnt lgkmcnt(0)
    s_add_u32 s16, s4, 0xf80000
    s_addc_u32 s17, s5, 0
    s_and_b32 s17, s17, 0xffff
    s_mov_b32 s18, 0x280000
    s_mov_b32 s19, 0x00020000
    s_add_u32 s28, s4, 0x1a80000
    s_addc_u32 s29, s5, 0
    s_and_b32 s29, s29, 0xffff
    s_mov_b32 s30, 0x4000
    s_mov_b32 s31, 0x00020000
    s_mul_i32 s48, s32, 1
    s_add_u32 s48, s48, 0
    s_cmp_ge_u32 s48, 5
    s_cselect_b32 s37, 5, 0
    s_sub_u32 s48, s48, s37
    s_mul_i32 s49, s32, 1
    s_add_u32 s49, s49, 1
    s_cmp_ge_u32 s49, 5
    s_cselect_b32 s37, 5, 0
    s_sub_u32 s49, s49, s37
    s_mul_i32 s50, s32, 1
    s_add_u32 s50, s50, 2
    s_cmp_ge_u32 s50, 5
    s_cselect_b32 s37, 5, 0
    s_sub_u32 s50, s50, s37
    s_mul_i32 s51, s32, 1
    s_add_u32 s51, s51, 3
    s_cmp_ge_u32 s51, 5
    s_cselect_b32 s37, 5, 0
    s_sub_u32 s51, s51, s37
    s_mul_i32 s52, s32, 1
    s_add_u32 s52, s52, 4
    s_cmp_ge_u32 s52, 5
    s_cselect_b32 s37, 5, 0
    s_sub_u32 s52, s52, s37
    v_lshrrev_b32 v31, 2, v2
    v_lshl_add_u32 v32, v3, 2, v31
    v_mul_u32_u24 v33, 160, v32
    v_and_b32 v34, 3, v2
    v_lshl_add_u32 v33, v34, 3, v33
    v_add_u32 v33, 16384, v33
    v_and_b32 v32, 7, v32
    s_lshl_b32 s37, s48, 5
    v_add_u32 v4, s37, v33
    s_lshl_b32 s37, s49, 5
    v_add_u32 v5, s37, v33
    s_lshl_b32 s37, s50, 5
    v_add_u32 v6, s37, v33
    s_lshl_b32 s37, s51, 5
    v_add_u32 v7, s37, v33
    s_lshl_b32 s37, s52, 5
    v_add_u32 v8, s37, v33
    v_add_u32 v31, s56, v2
    v_mul_u32_u24 v31, 256, v31
    v_xor_b32 v32, v2, v3
    v_xor_b32 v33, 0, v32
    v_lshl_add_u32 v19, v33, 4, v31
    v_xor_b32 v33, 4, v32
    v_lshl_add_u32 v20, v33, 4, v31
    v_xor_b32 v33, 8, v32
    v_lshl_add_u32 v21, v33, 4, v31
    v_xor_b32 v33, 12, v32
    v_lshl_add_u32 v22, v33, 4, v31
    v_add_u32 v9, 0x10000, v4
    v_add_u32 v10, 0x10000, v5
    v_add_u32 v11, 0x10000, v6
    v_add_u32 v12, 0x10000, v7
    v_add_u32 v13, 0x10000, v8
    v_add_u32 v23, 0x10000, v19
    v_add_u32 v24, 0x10000, v20
    v_add_u32 v25, 0x10000, v21
    v_add_u32 v26, 0x10000, v22
    v_add_u32 v14, 0x20000, v4
    v_add_u32 v15, 0x20000, v5
    v_add_u32 v16, 0x20000, v6
    v_add_u32 v17, 0x20000, v7
    v_add_u32 v18, 0x20000, v8
    v_add_u32 v27, 0x20000, v19
    v_add_u32 v28, 0x20000, v20
    v_add_u32 v29, 0x20000, v21
    v_add_u32 v30, 0x20000, v22
    v_mov_b32 v44, 0x3f803f80
    v_mov_b32 v45, 0x3f803f80
    v_mov_b32 v46, 0x3f803f80
    v_mov_b32 v47, 0x3f803f80
    v_accvgpr_write_b32 a0, 0
    v_accvgpr_write_b32 a1, 0
    v_accvgpr_write_b32 a2, 0
    v_accvgpr_write_b32 a3, 0
    v_accvgpr_write_b32 a4, 0
    v_accvgpr_write_b32 a5, 0
    v_accvgpr_write_b32 a6, 0
    v_accvgpr_write_b32 a7, 0
    v_accvgpr_write_b32 a8, 0
    v_accvgpr_write_b32 a9, 0
    v_accvgpr_write_b32 a10, 0
    v_accvgpr_write_b32 a11, 0
    v_accvgpr_write_b32 a12, 0
    v_accvgpr_write_b32 a13, 0
    v_accvgpr_write_b32 a14, 0
    v_accvgpr_write_b32 a15, 0
    v_accvgpr_write_b32 a16, 0
    v_accvgpr_write_b32 a17, 0
    v_accvgpr_write_b32 a18, 0
    v_accvgpr_write_b32 a19, 0
    v_accvgpr_write_b32 a20, 0
    v_accvgpr_write_b32 a21, 0
    v_accvgpr_write_b32 a22, 0
    v_accvgpr_write_b32 a23, 0
    v_accvgpr_write_b32 a24, 0
    v_accvgpr_write_b32 a25, 0
    v_accvgpr_write_b32 a26, 0
    v_accvgpr_write_b32 a27, 0
    v_accvgpr_write_b32 a28, 0
    v_accvgpr_write_b32 a29, 0
    v_accvgpr_write_b32 a30, 0
    v_accvgpr_write_b32 a31, 0
    v_accvgpr_write_b32 a32, 0
    v_accvgpr_write_b32 a33, 0
    v_accvgpr_write_b32 a34, 0
    v_accvgpr_write_b32 a35, 0
    s_mov_b32 s38, 6554
    s_mul_i32 s37, s43, 128
    v_add_u32 v31, s37, v1
    v_mul_lo_u32 v32, v31, s38
    v_lshrrev_b32 v32, 16, v32
    v_mul_u32_u24 v33, 10, v32
    v_sub_u32 v33, v31, v33
    v_mul_u32_u24 v34, 176, v32
    v_lshl_add_u32 v134, v33, 4, v34
    v_add_u32 v34, s35, v32
    v_mul_u32_u24 v34, 1280, v34
    v_lshl_add_u32 v34, v33, 4, v34
    v_lshl_add_u32 v132, s36, 1, v34
    v_cmp_le_u32 vcc, 640, v31
    v_mov_b32 v35, 0x7fffff00
    v_mov_b32 v36, 0
    v_cndmask_b32 v132, v132, v35, vcc
    v_cndmask_b32 v134, v134, v36, vcc
    v_add_u32 v31, s37, v1
    v_add_u32 v31, 64, v31
    v_mul_lo_u32 v32, v31, s38
    v_lshrrev_b32 v32, 16, v32
    v_mul_u32_u24 v33, 10, v32
    v_sub_u32 v33, v31, v33
    v_mul_u32_u24 v34, 176, v32
    v_lshl_add_u32 v135, v33, 4, v34
    v_add_u32 v34, s35, v32
    v_mul_u32_u24 v34, 1280, v34
    v_lshl_add_u32 v34, v33, 4, v34
    v_lshl_add_u32 v133, s36, 1, v34
    v_cmp_le_u32 vcc, 640, v31
    v_mov_b32 v35, 0x7fffff00
    v_mov_b32 v36, 0
    v_cndmask_b32 v133, v133, v35, vcc
    v_cndmask_b32 v135, v135, v36, vcc
    s_barrier
    ds_read_b128 v[72:75], v19 offset:0
    ds_read_b64_tr_b16 v[48:49], v4 offset:0
    ds_read_b64_tr_b16 v[50:51], v4 offset:2560
    ds_read_b64_tr_b16 v[52:53], v5 offset:0
    ds_read_b64_tr_b16 v[54:55], v5 offset:2560
    ds_read_b64_tr_b16 v[56:57], v6 offset:0
    ds_read_b64_tr_b16 v[58:59], v6 offset:2560
    ds_read_b64_tr_b16 v[60:61], v7 offset:0
    ds_read_b64_tr_b16 v[62:63], v7 offset:2560
    ds_read_b64_tr_b16 v[64:65], v8 offset:0
    ds_read_b64_tr_b16 v[66:67], v8 offset:2560
    ds_read_b128 v[76:79], v20 offset:0
    ds_read_b64_tr_b16 v[68:69], v4 offset:5120
    ds_read_b64_tr_b16 v[70:71], v4 offset:7680
    s_waitcnt lgkmcnt(11)
    v_mfma_f32_16x16x32_bf16 a[0:3], v[48:51], v[72:75], a[0:3]
    v_mfma_f32_16x16x32_bf16 a[20:23], v[48:51], v[44:47], a[20:23]
    ds_read_b64_tr_b16 v[48:49], v5 offset:5120
    ds_read_b64_tr_b16 v[50:51], v5 offset:7680
    s_waitcnt lgkmcnt(11)
    v_mfma_f32_16x16x32_bf16 a[4:7], v[52:55], v[72:75], a[4:7]
    v_mfma_f32_16x16x32_bf16 a[24:27], v[52:55], v[44:47], a[24:27]
    ds_read_b64_tr_b16 v[52:53], v6 offset:5120
    ds_read_b64_tr_b16 v[54:55], v6 offset:7680
    s_waitcnt lgkmcnt(11)
    v_mfma_f32_16x16x32_bf16 a[8:11], v[56:59], v[72:75], a[8:11]
    v_mfma_f32_16x16x32_bf16 a[28:31], v[44:47], v[72:75], a[28:31]
    ds_read_b64_tr_b16 v[56:57], v7 offset:5120
    ds_read_b64_tr_b16 v[58:59], v7 offset:7680
    s_waitcnt lgkmcnt(11)
    v_mfma_f32_16x16x32_bf16 a[12:15], v[60:63], v[72:75], a[12:15]
    v_mfma_f32_16x16x32_bf16 a[32:35], v[72:75], v[72:75], a[32:35]
    ds_read_b64_tr_b16 v[60:61], v8 offset:5120
    ds_read_b64_tr_b16 v[62:63], v8 offset:7680
    s_waitcnt lgkmcnt(11)
    v_mfma_f32_16x16x32_bf16 a[16:19], v[64:67], v[72:75], a[16:19]
    ds_read_b128 v[72:75], v21 offset:0
    ds_read_b64_tr_b16 v[64:65], v4 offset:10240
    ds_read_b64_tr_b16 v[66:67], v4 offset:12800
    s_waitcnt lgkmcnt(11)
    v_mfma_f32_16x16x32_bf16 a[0:3], v[68:71], v[76:79], a[0:3]
    v_mfma_f32_16x16x32_bf16 a[20:23], v[68:71], v[44:47], a[20:23]
    ds_read_b64_tr_b16 v[68:69], v5 offset:10240
    ds_read_b64_tr_b16 v[70:71], v5 offset:12800
    s_waitcnt lgkmcnt(11)
    v_mfma_f32_16x16x32_bf16 a[4:7], v[48:51], v[76:79], a[4:7]
    v_mfma_f32_16x16x32_bf16 a[24:27], v[48:51], v[44:47], a[24:27]
    ds_read_b64_tr_b16 v[48:49], v6 offset:10240
    ds_read_b64_tr_b16 v[50:51], v6 offset:12800
    s_waitcnt lgkmcnt(11)
    v_mfma_f32_16x16x32_bf16 a[8:11], v[52:55], v[76:79], a[8:11]
    v_mfma_f32_16x16x32_bf16 a[28:31], v[44:47], v[76:79], a[28:31]
    ds_read_b64_tr_b16 v[52:53], v7 offset:10240
    ds_read_b64_tr_b16 v[54:55], v7 offset:12800
    s_waitcnt lgkmcnt(11)
    v_mfma_f32_16x16x32_bf16 a[12:15], v[56:59], v[76:79], a[12:15]
    v_mfma_f32_16x16x32_bf16 a[32:35], v[76:79], v[76:79], a[32:35]
    ds_read_b64_tr_b16 v[56:57], v8 offset:10240
    ds_read_b64_tr_b16 v[58:59], v8 offset:12800
    s_waitcnt lgkmcnt(11)
    v_mfma_f32_16x16x32_bf16 a[16:19], v[60:63], v[76:79], a[16:19]
    ds_read_b128 v[76:79], v22 offset:0
    ds_read_b64_tr_b16 v[60:61], v4 offset:15360
    ds_read_b64_tr_b16 v[62:63], v4 offset:17920
    s_waitcnt lgkmcnt(11)
    v_mfma_f32_16x16x32_bf16 a[0:3], v[64:67], v[72:75], a[0:3]
    v_mfma_f32_16x16x32_bf16 a[20:23], v[64:67], v[44:47], a[20:23]
    ds_read_b64_tr_b16 v[64:65], v5 offset:15360
    ds_read_b64_tr_b16 v[66:67], v5 offset:17920
    s_waitcnt lgkmcnt(11)
    v_mfma_f32_16x16x32_bf16 a[4:7], v[68:71], v[72:75], a[4:7]
    v_mfma_f32_16x16x32_bf16 a[24:27], v[68:71], v[44:47], a[24:27]
    ds_read_b64_tr_b16 v[68:69], v6 offset:15360
    ds_read_b64_tr_b16 v[70:71], v6 offset:17920
    s_waitcnt lgkmcnt(11)
    v_mfma_f32_16x16x32_bf16 a[8:11], v[48:51], v[72:75], a[8:11]
    v_mfma_f32_16x16x32_bf16 a[28:31], v[44:47], v[72:75], a[28:31]
    ds_read_b64_tr_b16 v[48:49], v7 offset:15360
    ds_read_b64_tr_b16 v[50:51], v7 offset:17920
    s_waitcnt lgkmcnt(11)
    v_mfma_f32_16x16x32_bf16 a[12:15], v[52:55], v[72:75], a[12:15]
    v_mfma_f32_16x16x32_bf16 a[32:35], v[72:75], v[72:75], a[32:35]
    ds_read_b64_tr_b16 v[52:53], v8 offset:15360
    ds_read_b64_tr_b16 v[54:55], v8 offset:17920
    s_waitcnt lgkmcnt(11)
    v_mfma_f32_16x16x32_bf16 a[16:19], v[56:59], v[72:75], a[16:19]
    s_waitcnt lgkmcnt(8)
    v_mfma_f32_16x16x32_bf16 a[0:3], v[60:63], v[76:79], a[0:3]
    v_mfma_f32_16x16x32_bf16 a[20:23], v[60:63], v[44:47], a[20:23]
    s_waitcnt lgkmcnt(6)
    v_mfma_f32_16x16x32_bf16 a[4:7], v[64:67], v[76:79], a[4:7]
    v_mfma_f32_16x16x32_bf16 a[24:27], v[64:67], v[44:47], a[24:27]
    s_waitcnt lgkmcnt(4)
    v_mfma_f32_16x16x32_bf16 a[8:11], v[68:71], v[76:79], a[8:11]
    v_mfma_f32_16x16x32_bf16 a[28:31], v[44:47], v[76:79], a[28:31]
    s_waitcnt lgkmcnt(2)
    v_mfma_f32_16x16x32_bf16 a[12:15], v[48:51], v[76:79], a[12:15]
    v_mfma_f32_16x16x32_bf16 a[32:35], v[76:79], v[76:79], a[32:35]
    s_waitcnt lgkmcnt(0)
    v_mfma_f32_16x16x32_bf16 a[16:19], v[52:55], v[76:79], a[16:19]
    s_barrier
    ds_read_b128 v[72:75], v19 offset:36864
    ds_read_b64_tr_b16 v[56:57], v4 offset:36864
    ds_read_b64_tr_b16 v[58:59], v4 offset:39424
    ds_read_b64_tr_b16 v[60:61], v5 offset:36864
    ds_read_b64_tr_b16 v[62:63], v5 offset:39424
    ds_read_b64_tr_b16 v[64:65], v6 offset:36864
    ds_read_b64_tr_b16 v[66:67], v6 offset:39424
    ds_read_b64_tr_b16 v[68:69], v7 offset:36864
    ds_read_b64_tr_b16 v[70:71], v7 offset:39424
    ds_read_b64_tr_b16 v[48:49], v8 offset:36864
    ds_read_b64_tr_b16 v[50:51], v8 offset:39424
    ds_read_b128 v[76:79], v20 offset:36864
    ds_read_b64_tr_b16 v[52:53], v4 offset:41984
    ds_read_b64_tr_b16 v[54:55], v4 offset:44544
    s_waitcnt lgkmcnt(11)
    v_mfma_f32_16x16x32_bf16 a[0:3], v[56:59], v[72:75], a[0:3]
    v_mfma_f32_16x16x32_bf16 a[20:23], v[56:59], v[44:47], a[20:23]
    ds_read_b64_tr_b16 v[56:57], v5 offset:41984
    ds_read_b64_tr_b16 v[58:59], v5 offset:44544
    s_waitcnt lgkmcnt(11)
    v_mfma_f32_16x16x32_bf16 a[4:7], v[60:63], v[72:75], a[4:7]
    v_mfma_f32_16x16x32_bf16 a[24:27], v[60:63], v[44:47], a[24:27]
    ds_read_b64_tr_b16 v[60:61], v6 offset:41984
    ds_read_b64_tr_b16 v[62:63], v6 offset:44544
    s_waitcnt lgkmcnt(11)
    v_mfma_f32_16x16x32_bf16 a[8:11], v[64:67], v[72:75], a[8:11]
    v_mfma_f32_16x16x32_bf16 a[28:31], v[44:47], v[72:75], a[28:31]
    ds_read_b64_tr_b16 v[64:65], v7 offset:41984
    ds_read_b64_tr_b16 v[66:67], v7 offset:44544
    s_waitcnt lgkmcnt(11)
    v_mfma_f32_16x16x32_bf16 a[12:15], v[68:71], v[72:75], a[12:15]
    v_mfma_f32_16x16x32_bf16 a[32:35], v[72:75], v[72:75], a[32:35]
    ds_read_b64_tr_b16 v[68:69], v8 offset:41984
    ds_read_b64_tr_b16 v[70:71], v8 offset:44544
    s_waitcnt lgkmcnt(11)
    v_mfma_f32_16x16x32_bf16 a[16:19], v[48:51], v[72:75], a[16:19]
    ds_read_b128 v[72:75], v21 offset:36864
    ds_read_b64_tr_b16 v[48:49], v4 offset:47104
    ds_read_b64_tr_b16 v[50:51], v4 offset:49664
    s_waitcnt lgkmcnt(11)
    v_mfma_f32_16x16x32_bf16 a[0:3], v[52:55], v[76:79], a[0:3]
    v_mfma_f32_16x16x32_bf16 a[20:23], v[52:55], v[44:47], a[20:23]
    ds_read_b64_tr_b16 v[52:53], v5 offset:47104
    ds_read_b64_tr_b16 v[54:55], v5 offset:49664
    s_waitcnt lgkmcnt(11)
    v_mfma_f32_16x16x32_bf16 a[4:7], v[56:59], v[76:79], a[4:7]
    v_mfma_f32_16x16x32_bf16 a[24:27], v[56:59], v[44:47], a[24:27]
    ds_read_b64_tr_b16 v[56:57], v6 offset:47104
    ds_read_b64_tr_b16 v[58:59], v6 offset:49664
    s_waitcnt lgkmcnt(11)
    v_mfma_f32_16x16x32_bf16 a[8:11], v[60:63], v[76:79], a[8:11]
    v_mfma_f32_16x16x32_bf16 a[28:31], v[44:47], v[76:79], a[28:31]
    ds_read_b64_tr_b16 v[60:61], v7 offset:47104
    ds_read_b64_tr_b16 v[62:63], v7 offset:49664
    s_waitcnt lgkmcnt(11)
    v_mfma_f32_16x16x32_bf16 a[12:15], v[64:67], v[76:79], a[12:15]
    v_mfma_f32_16x16x32_bf16 a[32:35], v[76:79], v[76:79], a[32:35]
    ds_read_b64_tr_b16 v[64:65], v8 offset:47104
    ds_read_b64_tr_b16 v[66:67], v8 offset:49664
    s_waitcnt lgkmcnt(11)
    v_mfma_f32_16x16x32_bf16 a[16:19], v[68:71], v[76:79], a[16:19]
    ds_read_b128 v[76:79], v22 offset:36864
    ds_read_b64_tr_b16 v[68:69], v4 offset:52224
    ds_read_b64_tr_b16 v[70:71], v4 offset:54784
    s_waitcnt lgkmcnt(11)
    v_mfma_f32_16x16x32_bf16 a[0:3], v[48:51], v[72:75], a[0:3]
    v_mfma_f32_16x16x32_bf16 a[20:23], v[48:51], v[44:47], a[20:23]
    ds_read_b64_tr_b16 v[48:49], v5 offset:52224
    ds_read_b64_tr_b16 v[50:51], v5 offset:54784
    s_waitcnt lgkmcnt(11)
    v_mfma_f32_16x16x32_bf16 a[4:7], v[52:55], v[72:75], a[4:7]
    v_mfma_f32_16x16x32_bf16 a[24:27], v[52:55], v[44:47], a[24:27]
    ds_read_b64_tr_b16 v[52:53], v6 offset:52224
    ds_read_b64_tr_b16 v[54:55], v6 offset:54784
    s_waitcnt lgkmcnt(11)
    v_mfma_f32_16x16x32_bf16 a[8:11], v[56:59], v[72:75], a[8:11]
    v_mfma_f32_16x16x32_bf16 a[28:31], v[44:47], v[72:75], a[28:31]
    ds_read_b64_tr_b16 v[56:57], v7 offset:52224
    ds_read_b64_tr_b16 v[58:59], v7 offset:54784
    s_waitcnt lgkmcnt(11)
    v_mfma_f32_16x16x32_bf16 a[12:15], v[60:63], v[72:75], a[12:15]
    v_mfma_f32_16x16x32_bf16 a[32:35], v[72:75], v[72:75], a[32:35]
    ds_read_b64_tr_b16 v[60:61], v8 offset:52224
    ds_read_b64_tr_b16 v[62:63], v8 offset:54784
    s_waitcnt lgkmcnt(11)
    v_mfma_f32_16x16x32_bf16 a[16:19], v[64:67], v[72:75], a[16:19]
    s_waitcnt lgkmcnt(8)
    v_mfma_f32_16x16x32_bf16 a[0:3], v[68:71], v[76:79], a[0:3]
    v_mfma_f32_16x16x32_bf16 a[20:23], v[68:71], v[44:47], a[20:23]
    s_waitcnt lgkmcnt(6)
    v_mfma_f32_16x16x32_bf16 a[4:7], v[48:51], v[76:79], a[4:7]
    v_mfma_f32_16x16x32_bf16 a[24:27], v[48:51], v[44:47], a[24:27]
    s_waitcnt lgkmcnt(4)
    v_mfma_f32_16x16x32_bf16 a[8:11], v[52:55], v[76:79], a[8:11]
    v_mfma_f32_16x16x32_bf16 a[28:31], v[44:47], v[76:79], a[28:31]
    s_waitcnt lgkmcnt(2)
    v_mfma_f32_16x16x32_bf16 a[12:15], v[56:59], v[76:79], a[12:15]
    v_mfma_f32_16x16x32_bf16 a[32:35], v[76:79], v[76:79], a[32:35]
    s_waitcnt lgkmcnt(0)
    v_mfma_f32_16x16x32_bf16 a[16:19], v[60:63], v[76:79], a[16:19]
    s_barrier
    ds_read_b128 v[72:75], v23 offset:8192
    ds_read_b64_tr_b16 v[64:65], v9 offset:8192
    ds_read_b64_tr_b16 v[66:67], v9 offset:10752
    ds_read_b64_tr_b16 v[68:69], v10 offset:8192
    ds_read_b64_tr_b16 v[70:71], v10 offset:10752
    ds_read_b64_tr_b16 v[48:49], v11 offset:8192
    ds_read_b64_tr_b16 v[50:51], v11 offset:10752
    ds_read_b64_tr_b16 v[52:53], v12 offset:8192
    ds_read_b64_tr_b16 v[54:55], v12 offset:10752
    ds_read_b64_tr_b16 v[56:57], v13 offset:8192
    ds_read_b64_tr_b16 v[58:59], v13 offset:10752
    ds_read_b128 v[76:79], v24 offset:8192
    ds_read_b64_tr_b16 v[60:61], v9 offset:13312
    ds_read_b64_tr_b16 v[62:63], v9 offset:15872
    s_waitcnt lgkmcnt(11)
    v_mfma_f32_16x16x32_bf16 a[0:3], v[64:67], v[72:75], a[0:3]
    v_mfma_f32_16x16x32_bf16 a[20:23], v[64:67], v[44:47], a[20:23]
    ds_read_b64_tr_b16 v[64:65], v10 offset:13312
    ds_read_b64_tr_b16 v[66:67], v10 offset:15872
    s_waitcnt lgkmcnt(11)
    v_mfma_f32_16x16x32_bf16 a[4:7], v[68:71], v[72:75], a[4:7]
    v_mfma_f32_16x16x32_bf16 a[24:27], v[68:71], v[44:47], a[24:27]
    ds_read_b64_tr_b16 v[68:69], v11 offset:13312
    ds_read_b64_tr_b16 v[70:71], v11 offset:15872
    s_waitcnt lgkmcnt(11)
    v_mfma_f32_16x16x32_bf16 a[8:11], v[48:51], v[72:75], a[8:11]
    v_mfma_f32_16x16x32_bf16 a[28:31], v[44:47], v[72:75], a[28:31]
    ds_read_b64_tr_b16 v[48:49], v12 offset:13312
    ds_read_b64_tr_b16 v[50:51], v12 offset:15872
    s_waitcnt lgkmcnt(11)
    v_mfma_f32_16x16x32_bf16 a[12:15], v[52:55], v[72:75], a[12:15]
    v_mfma_f32_16x16x32_bf16 a[32:35], v[72:75], v[72:75], a[32:35]
    ds_read_b64_tr_b16 v[52:53], v13 offset:13312
    ds_read_b64_tr_b16 v[54:55], v13 offset:15872
    s_waitcnt lgkmcnt(11)
    v_mfma_f32_16x16x32_bf16 a[16:19], v[56:59], v[72:75], a[16:19]
    ds_read_b128 v[72:75], v25 offset:8192
    ds_read_b64_tr_b16 v[56:57], v9 offset:18432
    ds_read_b64_tr_b16 v[58:59], v9 offset:20992
    s_waitcnt lgkmcnt(11)
    v_mfma_f32_16x16x32_bf16 a[0:3], v[60:63], v[76:79], a[0:3]
    v_mfma_f32_16x16x32_bf16 a[20:23], v[60:63], v[44:47], a[20:23]
    ds_read_b64_tr_b16 v[60:61], v10 offset:18432
    ds_read_b64_tr_b16 v[62:63], v10 offset:20992
    s_waitcnt lgkmcnt(11)
    v_mfma_f32_16x16x32_bf16 a[4:7], v[64:67], v[76:79], a[4:7]
    v_mfma_f32_16x16x32_bf16 a[24:27], v[64:67], v[44:47], a[24:27]
    ds_read_b64_tr_b16 v[64:65], v11 offset:18432
    ds_read_b64_tr_b16 v[66:67], v11 offset:20992
    s_waitcnt lgkmcnt(11)
    v_mfma_f32_16x16x32_bf16 a[8:11], v[68:71], v[76:79], a[8:11]
    v_mfma_f32_16x16x32_bf16 a[28:31], v[44:47], v[76:79], a[28:31]
    ds_read_b64_tr_b16 v[68:69], v12 offset:18432
    ds_read_b64_tr_b16 v[70:71], v12 offset:20992
    s_waitcnt lgkmcnt(11)
    v_mfma_f32_16x16x32_bf16 a[12:15], v[48:51], v[76:79], a[12:15]
    v_mfma_f32_16x16x32_bf16 a[32:35], v[76:79], v[76:79], a[32:35]
    ds_read_b64_tr_b16 v[48:49], v13 offset:18432
    ds_read_b64_tr_b16 v[50:51], v13 offset:20992
    s_waitcnt lgkmcnt(11)
    v_mfma_f32_16x16x32_bf16 a[16:19], v[52:55], v[76:79], a[16:19]
    ds_read_b128 v[76:79], v26 offset:8192
    ds_read_b64_tr_b16 v[52:53], v9 offset:23552
    ds_read_b64_tr_b16 v[54:55], v9 offset:26112
    s_waitcnt lgkmcnt(11)
    v_mfma_f32_16x16x32_bf16 a[0:3], v[56:59], v[72:75], a[0:3]
    v_mfma_f32_16x16x32_bf16 a[20:23], v[56:59], v[44:47], a[20:23]
    ds_read_b64_tr_b16 v[56:57], v10 offset:23552
    ds_read_b64_tr_b16 v[58:59], v10 offset:26112
    s_waitcnt lgkmcnt(11)
    v_mfma_f32_16x16x32_bf16 a[4:7], v[60:63], v[72:75], a[4:7]
    v_mfma_f32_16x16x32_bf16 a[24:27], v[60:63], v[44:47], a[24:27]
    ds_read_b64_tr_b16 v[60:61], v11 offset:23552
    ds_read_b64_tr_b16 v[62:63], v11 offset:26112
    s_waitcnt lgkmcnt(11)
    v_mfma_f32_16x16x32_bf16 a[8:11], v[64:67], v[72:75], a[8:11]
    v_mfma_f32_16x16x32_bf16 a[28:31], v[44:47], v[72:75], a[28:31]
    ds_read_b64_tr_b16 v[64:65], v12 offset:23552
    ds_read_b64_tr_b16 v[66:67], v12 offset:26112
    s_waitcnt lgkmcnt(11)
    v_mfma_f32_16x16x32_bf16 a[12:15], v[68:71], v[72:75], a[12:15]
    v_mfma_f32_16x16x32_bf16 a[32:35], v[72:75], v[72:75], a[32:35]
    ds_read_b64_tr_b16 v[68:69], v13 offset:23552
    ds_read_b64_tr_b16 v[70:71], v13 offset:26112
    s_waitcnt lgkmcnt(11)
    v_mfma_f32_16x16x32_bf16 a[16:19], v[48:51], v[72:75], a[16:19]
    s_waitcnt lgkmcnt(8)
    v_mfma_f32_16x16x32_bf16 a[0:3], v[52:55], v[76:79], a[0:3]
    v_mfma_f32_16x16x32_bf16 a[20:23], v[52:55], v[44:47], a[20:23]
    s_waitcnt lgkmcnt(6)
    v_mfma_f32_16x16x32_bf16 a[4:7], v[56:59], v[76:79], a[4:7]
    v_mfma_f32_16x16x32_bf16 a[24:27], v[56:59], v[44:47], a[24:27]
    s_waitcnt lgkmcnt(4)
    v_mfma_f32_16x16x32_bf16 a[8:11], v[60:63], v[76:79], a[8:11]
    v_mfma_f32_16x16x32_bf16 a[28:31], v[44:47], v[76:79], a[28:31]
    s_waitcnt lgkmcnt(2)
    v_mfma_f32_16x16x32_bf16 a[12:15], v[64:67], v[76:79], a[12:15]
    v_mfma_f32_16x16x32_bf16 a[32:35], v[76:79], v[76:79], a[32:35]
    s_waitcnt lgkmcnt(0)
    v_mfma_f32_16x16x32_bf16 a[16:19], v[68:71], v[76:79], a[16:19]
    s_barrier
    ds_read_b128 v[72:75], v23 offset:45056
    ds_read_b64_tr_b16 v[48:49], v9 offset:45056
    ds_read_b64_tr_b16 v[50:51], v9 offset:47616
    ds_read_b64_tr_b16 v[52:53], v10 offset:45056
    ds_read_b64_tr_b16 v[54:55], v10 offset:47616
    ds_read_b64_tr_b16 v[56:57], v11 offset:45056
    ds_read_b64_tr_b16 v[58:59], v11 offset:47616
    ds_read_b64_tr_b16 v[60:61], v12 offset:45056
    ds_read_b64_tr_b16 v[62:63], v12 offset:47616
    ds_read_b64_tr_b16 v[64:65], v13 offset:45056
    ds_read_b64_tr_b16 v[66:67], v13 offset:47616
    ds_read_b128 v[76:79], v24 offset:45056
    ds_read_b64_tr_b16 v[68:69], v9 offset:50176
    ds_read_b64_tr_b16 v[70:71], v9 offset:52736
    s_waitcnt lgkmcnt(11)
    v_mfma_f32_16x16x32_bf16 a[0:3], v[48:51], v[72:75], a[0:3]
    v_mfma_f32_16x16x32_bf16 a[20:23], v[48:51], v[44:47], a[20:23]
    ds_read_b64_tr_b16 v[48:49], v10 offset:50176
    ds_read_b64_tr_b16 v[50:51], v10 offset:52736
    s_waitcnt lgkmcnt(11)
    v_mfma_f32_16x16x32_bf16 a[4:7], v[52:55], v[72:75], a[4:7]
    v_mfma_f32_16x16x32_bf16 a[24:27], v[52:55], v[44:47], a[24:27]
    ds_read_b64_tr_b16 v[52:53], v11 offset:50176
    ds_read_b64_tr_b16 v[54:55], v11 offset:52736
    s_waitcnt lgkmcnt(11)
    v_mfma_f32_16x16x32_bf16 a[8:11], v[56:59], v[72:75], a[8:11]
    v_mfma_f32_16x16x32_bf16 a[28:31], v[44:47], v[72:75], a[28:31]
    ds_read_b64_tr_b16 v[56:57], v12 offset:50176
    ds_read_b64_tr_b16 v[58:59], v12 offset:52736
    s_waitcnt lgkmcnt(11)
    v_mfma_f32_16x16x32_bf16 a[12:15], v[60:63], v[72:75], a[12:15]
    v_mfma_f32_16x16x32_bf16 a[32:35], v[72:75], v[72:75], a[32:35]
    ds_read_b64_tr_b16 v[60:61], v13 offset:50176
    ds_read_b64_tr_b16 v[62:63], v13 offset:52736
    s_waitcnt lgkmcnt(11)
    v_mfma_f32_16x16x32_bf16 a[16:19], v[64:67], v[72:75], a[16:19]
    ds_read_b128 v[72:75], v25 offset:45056
    ds_read_b64_tr_b16 v[64:65], v9 offset:55296
    ds_read_b64_tr_b16 v[66:67], v9 offset:57856
    s_waitcnt lgkmcnt(11)
    v_mfma_f32_16x16x32_bf16 a[0:3], v[68:71], v[76:79], a[0:3]
    v_mfma_f32_16x16x32_bf16 a[20:23], v[68:71], v[44:47], a[20:23]
    ds_read_b64_tr_b16 v[68:69], v10 offset:55296
    ds_read_b64_tr_b16 v[70:71], v10 offset:57856
    s_waitcnt lgkmcnt(11)
    v_mfma_f32_16x16x32_bf16 a[4:7], v[48:51], v[76:79], a[4:7]
    v_mfma_f32_16x16x32_bf16 a[24:27], v[48:51], v[44:47], a[24:27]
    ds_read_b64_tr_b16 v[48:49], v11 offset:55296
    ds_read_b64_tr_b16 v[50:51], v11 offset:57856
    s_waitcnt lgkmcnt(11)
    v_mfma_f32_16x16x32_bf16 a[8:11], v[52:55], v[76:79], a[8:11]
    v_mfma_f32_16x16x32_bf16 a[28:31], v[44:47], v[76:79], a[28:31]
    ds_read_b64_tr_b16 v[52:53], v12 offset:55296
    ds_read_b64_tr_b16 v[54:55], v12 offset:57856
    s_waitcnt lgkmcnt(11)
    v_mfma_f32_16x16x32_bf16 a[12:15], v[56:59], v[76:79], a[12:15]
    v_mfma_f32_16x16x32_bf16 a[32:35], v[76:79], v[76:79], a[32:35]
    ds_read_b64_tr_b16 v[56:57], v13 offset:55296
    ds_read_b64_tr_b16 v[58:59], v13 offset:57856
    s_waitcnt lgkmcnt(11)
    v_mfma_f32_16x16x32_bf16 a[16:19], v[60:63], v[76:79], a[16:19]
    ds_read_b128 v[76:79], v26 offset:45056
    ds_read_b64_tr_b16 v[60:61], v9 offset:60416
    ds_read_b64_tr_b16 v[62:63], v9 offset:62976
    s_waitcnt lgkmcnt(11)
    v_mfma_f32_16x16x32_bf16 a[0:3], v[64:67], v[72:75], a[0:3]
    v_mfma_f32_16x16x32_bf16 a[20:23], v[64:67], v[44:47], a[20:23]
    ds_read_b64_tr_b16 v[64:65], v10 offset:60416
    ds_read_b64_tr_b16 v[66:67], v10 offset:62976
    s_waitcnt lgkmcnt(11)
    v_mfma_f32_16x16x32_bf16 a[4:7], v[68:71], v[72:75], a[4:7]
    v_mfma_f32_16x16x32_bf16 a[24:27], v[68:71], v[44:47], a[24:27]
    ds_read_b64_tr_b16 v[68:69], v11 offset:60416
    ds_read_b64_tr_b16 v[70:71], v11 offset:62976
    s_waitcnt lgkmcnt(11)
    v_mfma_f32_16x16x32_bf16 a[8:11], v[48:51], v[72:75], a[8:11]
    v_mfma_f32_16x16x32_bf16 a[28:31], v[44:47], v[72:75], a[28:31]
    ds_read_b64_tr_b16 v[48:49], v12 offset:60416
    ds_read_b64_tr_b16 v[50:51], v12 offset:62976
    s_waitcnt lgkmcnt(11)
    v_mfma_f32_16x16x32_bf16 a[12:15], v[52:55], v[72:75], a[12:15]
    v_mfma_f32_16x16x32_bf16 a[32:35], v[72:75], v[72:75], a[32:35]
    ds_read_b64_tr_b16 v[52:53], v13 offset:60416
    ds_read_b64_tr_b16 v[54:55], v13 offset:62976
    s_waitcnt lgkmcnt(11)
    v_mfma_f32_16x16x32_bf16 a[16:19], v[56:59], v[72:75], a[16:19]
    s_waitcnt lgkmcnt(8)
    v_mfma_f32_16x16x32_bf16 a[0:3], v[60:63], v[76:79], a[0:3]
    v_mfma_f32_16x16x32_bf16 a[20:23], v[60:63], v[44:47], a[20:23]
    s_waitcnt lgkmcnt(6)
    v_mfma_f32_16x16x32_bf16 a[4:7], v[64:67], v[76:79], a[4:7]
    v_mfma_f32_16x16x32_bf16 a[24:27], v[64:67], v[44:47], a[24:27]
    s_waitcnt lgkmcnt(4)
    v_mfma_f32_16x16x32_bf16 a[8:11], v[68:71], v[76:79], a[8:11]
    v_mfma_f32_16x16x32_bf16 a[28:31], v[44:47], v[76:79], a[28:31]
    s_waitcnt lgkmcnt(2)
    v_mfma_f32_16x16x32_bf16 a[12:15], v[48:51], v[76:79], a[12:15]
    v_mfma_f32_16x16x32_bf16 a[32:35], v[76:79], v[76:79], a[32:35]
    s_waitcnt lgkmcnt(0)
    v_mfma_f32_16x16x32_bf16 a[16:19], v[52:55], v[76:79], a[16:19]
    s_barrier
    ds_read_b128 v[72:75], v19 offset:0
    ds_read_b64_tr_b16 v[56:57], v4 offset:0
    ds_read_b64_tr_b16 v[58:59], v4 offset:2560
    ds_read_b64_tr_b16 v[60:61], v5 offset:0
    ds_read_b64_tr_b16 v[62:63], v5 offset:2560
    ds_read_b64_tr_b16 v[64:65], v6 offset:0
    ds_read_b64_tr_b16 v[66:67], v6 offset:2560
    ds_read_b64_tr_b16 v[68:69], v7 offset:0
    ds_read_b64_tr_b16 v[70:71], v7 offset:2560
    ds_read_b64_tr_b16 v[48:49], v8 offset:0
    ds_read_b64_tr_b16 v[50:51], v8 offset:2560
    ds_read_b128 v[76:79], v20 offset:0
    ds_read_b64_tr_b16 v[52:53], v4 offset:5120
    ds_read_b64_tr_b16 v[54:55], v4 offset:7680
    s_waitcnt lgkmcnt(11)
    v_mfma_f32_16x16x32_bf16 a[0:3], v[56:59], v[72:75], a[0:3]
    v_mfma_f32_16x16x32_bf16 a[20:23], v[56:59], v[44:47], a[20:23]
    ds_read_b64_tr_b16 v[56:57], v5 offset:5120
    ds_read_b64_tr_b16 v[58:59], v5 offset:7680
    s_waitcnt lgkmcnt(11)
    v_mfma_f32_16x16x32_bf16 a[4:7], v[60:63], v[72:75], a[4:7]
    v_mfma_f32_16x16x32_bf16 a[24:27], v[60:63], v[44:47], a[24:27]
    ds_read_b64_tr_b16 v[60:61], v6 offset:5120
    ds_read_b64_tr_b16 v[62:63], v6 offset:7680
    s_waitcnt lgkmcnt(11)
    v_mfma_f32_16x16x32_bf16 a[8:11], v[64:67], v[72:75], a[8:11]
    v_mfma_f32_16x16x32_bf16 a[28:31], v[44:47], v[72:75], a[28:31]
    ds_read_b64_tr_b16 v[64:65], v7 offset:5120
    ds_read_b64_tr_b16 v[66:67], v7 offset:7680
    s_waitcnt lgkmcnt(11)
    v_mfma_f32_16x16x32_bf16 a[12:15], v[68:71], v[72:75], a[12:15]
    v_mfma_f32_16x16x32_bf16 a[32:35], v[72:75], v[72:75], a[32:35]
    ds_read_b64_tr_b16 v[68:69], v8 offset:5120
    ds_read_b64_tr_b16 v[70:71], v8 offset:7680
    s_waitcnt lgkmcnt(11)
    v_mfma_f32_16x16x32_bf16 a[16:19], v[48:51], v[72:75], a[16:19]
    ds_read_b128 v[72:75], v21 offset:0
    ds_read_b64_tr_b16 v[48:49], v4 offset:10240
    ds_read_b64_tr_b16 v[50:51], v4 offset:12800
    s_waitcnt lgkmcnt(11)
    v_mfma_f32_16x16x32_bf16 a[0:3], v[52:55], v[76:79], a[0:3]
    v_mfma_f32_16x16x32_bf16 a[20:23], v[52:55], v[44:47], a[20:23]
    ds_read_b64_tr_b16 v[52:53], v5 offset:10240
    ds_read_b64_tr_b16 v[54:55], v5 offset:12800
    s_waitcnt lgkmcnt(11)
    v_mfma_f32_16x16x32_bf16 a[4:7], v[56:59], v[76:79], a[4:7]
    v_mfma_f32_16x16x32_bf16 a[24:27], v[56:59], v[44:47], a[24:27]
    ds_read_b64_tr_b16 v[56:57], v6 offset:10240
    ds_read_b64_tr_b16 v[58:59], v6 offset:12800
    s_waitcnt lgkmcnt(11)
    v_mfma_f32_16x16x32_bf16 a[8:11], v[60:63], v[76:79], a[8:11]
    v_mfma_f32_16x16x32_bf16 a[28:31], v[44:47], v[76:79], a[28:31]
    ds_read_b64_tr_b16 v[60:61], v7 offset:10240
    ds_read_b64_tr_b16 v[62:63], v7 offset:12800
    s_waitcnt lgkmcnt(11)
    v_mfma_f32_16x16x32_bf16 a[12:15], v[64:67], v[76:79], a[12:15]
    v_mfma_f32_16x16x32_bf16 a[32:35], v[76:79], v[76:79], a[32:35]
    ds_read_b64_tr_b16 v[64:65], v8 offset:10240
    ds_read_b64_tr_b16 v[66:67], v8 offset:12800
    s_waitcnt lgkmcnt(11)
    v_mfma_f32_16x16x32_bf16 a[16:19], v[68:71], v[76:79], a[16:19]
    ds_read_b128 v[76:79], v22 offset:0
    ds_read_b64_tr_b16 v[68:69], v4 offset:15360
    ds_read_b64_tr_b16 v[70:71], v4 offset:17920
    s_waitcnt lgkmcnt(11)
    v_mfma_f32_16x16x32_bf16 a[0:3], v[48:51], v[72:75], a[0:3]
    v_mfma_f32_16x16x32_bf16 a[20:23], v[48:51], v[44:47], a[20:23]
    ds_read_b64_tr_b16 v[48:49], v5 offset:15360
    ds_read_b64_tr_b16 v[50:51], v5 offset:17920
    s_waitcnt lgkmcnt(11)
    v_mfma_f32_16x16x32_bf16 a[4:7], v[52:55], v[72:75], a[4:7]
    v_mfma_f32_16x16x32_bf16 a[24:27], v[52:55], v[44:47], a[24:27]
    ds_read_b64_tr_b16 v[52:53], v6 offset:15360
    ds_read_b64_tr_b16 v[54:55], v6 offset:17920
    s_waitcnt lgkmcnt(11)
    v_mfma_f32_16x16x32_bf16 a[8:11], v[56:59], v[72:75], a[8:11]
    v_mfma_f32_16x16x32_bf16 a[28:31], v[44:47], v[72:75], a[28:31]
    ds_read_b64_tr_b16 v[56:57], v7 offset:15360
    ds_read_b64_tr_b16 v[58:59], v7 offset:17920
    s_waitcnt lgkmcnt(11)
    v_mfma_f32_16x16x32_bf16 a[12:15], v[60:63], v[72:75], a[12:15]
    v_mfma_f32_16x16x32_bf16 a[32:35], v[72:75], v[72:75], a[32:35]
    ds_read_b64_tr_b16 v[60:61], v8 offset:15360
    ds_read_b64_tr_b16 v[62:63], v8 offset:17920
    s_waitcnt lgkmcnt(11)
    v_mfma_f32_16x16x32_bf16 a[16:19], v[64:67], v[72:75], a[16:19]
    s_waitcnt lgkmcnt(8)
    v_mfma_f32_16x16x32_bf16 a[0:3], v[68:71], v[76:79], a[0:3]
    v_mfma_f32_16x16x32_bf16 a[20:23], v[68:71], v[44:47], a[20:23]
    s_waitcnt lgkmcnt(6)
    v_mfma_f32_16x16x32_bf16 a[4:7], v[48:51], v[76:79], a[4:7]
    v_mfma_f32_16x16x32_bf16 a[24:27], v[48:51], v[44:47], a[24:27]
    s_waitcnt lgkmcnt(4)
    v_mfma_f32_16x16x32_bf16 a[8:11], v[52:55], v[76:79], a[8:11]
    v_mfma_f32_16x16x32_bf16 a[28:31], v[44:47], v[76:79], a[28:31]
    s_waitcnt lgkmcnt(2)
    v_mfma_f32_16x16x32_bf16 a[12:15], v[56:59], v[76:79], a[12:15]
    v_mfma_f32_16x16x32_bf16 a[32:35], v[76:79], v[76:79], a[32:35]
    s_waitcnt lgkmcnt(0)
    v_mfma_f32_16x16x32_bf16 a[16:19], v[60:63], v[76:79], a[16:19]
    s_nop 7
    s_nop 1
    v_lshlrev_b32 v100, 4, v3
    v_cmp_eq_u32 vcc, 0, v2
    v_add_u32 v100, 0x24000, v100
    s_lshl_b32 s37, s48, 6
    v_add_u32 v83, s37, v100
    s_lshl_b32 s37, s49, 6
    v_add_u32 v87, s37, v100
    s_lshl_b32 s37, s50, 6
    v_add_u32 v91, s37, v100
    s_lshl_b32 s37, s51, 6
    v_add_u32 v95, s37, v100
    s_lshl_b32 s37, s52, 6
    v_add_u32 v99, s37, v100
    s_and_saveexec_b64 s[44:45], vcc
    v_accvgpr_read_b32 v104, a20
    v_accvgpr_read_b32 v105, a21
    v_accvgpr_read_b32 v106, a22
    v_accvgpr_read_b32 v107, a23
    ds_write_b128 v83, v[104:107]
    v_accvgpr_read_b32 v104, a24
    v_accvgpr_read_b32 v105, a25
    v_accvgpr_read_b32 v106, a26
    v_accvgpr_read_b32 v107, a27
    ds_write_b128 v87, v[104:107]
    s_mov_b64 exec, s[44:45]
    s_mov_b32 s37, 0x3acccccd
    s_mov_b32 s38, 0x3727c5ac
    v_and_b32 v40, 3, v2
    v_lshrrev_b32 v39, 2, v2
    v_cmp_eq_u32 s[44:45], v39, v3
    v_add_u32 v41, s56, v2
    v_lshlrev_b32 v42, 2, v41
    v_add_u32 v42, 0x24400, v42
    v_accvgpr_read_b32 v48, a28
    v_accvgpr_read_b32 v49, a32
    v_accvgpr_read_b32 v37, a33
    v_cmp_eq_u32 vcc, 1, v40
    s_nop 1
    v_cndmask_b32 v49, v49, v37, vcc
    v_accvgpr_read_b32 v37, a34
    v_cmp_eq_u32 vcc, 2, v40
    s_nop 1
    v_cndmask_b32 v49, v49, v37, vcc
    v_accvgpr_read_b32 v37, a35
    v_cmp_eq_u32 vcc, 3, v40
    s_nop 1
    v_cndmask_b32 v49, v49, v37, vcc
    v_mul_f32 v48, s37, v48
    v_mul_f32 v49, s37, v49
    v_fma_f32 v49, -v48, v48, v49
    v_max_f32 v49, 0, v49
    v_cvt_pk_bf16_f32 v31, v48, v48
    v_lshlrev_b32 v50, 16, v31
    v_cvt_pk_bf16_f32 v31, v49, v49
    v_lshlrev_b32 v32, 16, v31
    v_add_f32 v32, s38, v32
    v_cvt_pk_bf16_f32 v31, v32, v32
    v_lshlrev_b32 v32, 16, v31
    v_sqrt_f32 v32, v32
    s_nop 0
    v_cvt_pk_bf16_f32 v31, v32, v32
    v_lshlrev_b32 v32, 16, v31
    v_rcp_f32 v51, v32
    s_nop 0
    v_sub_f32 v33, v48, v50
    v_mul_f32 v33, v33, v51
    v_cvt_pk_bf16_f32 v31, v33, v33
    v_lshlrev_b32 v33, 16, v31
    v_mul_f32 v34, v49, v51
    v_mul_f32 v34, v34, v51
    v_cvt_pk_bf16_f32 v31, v34, v34
    v_lshlrev_b32 v34, 16, v31
    v_add_f32 v34, s38, v34
    v_cvt_pk_bf16_f32 v31, v34, v34
    v_lshlrev_b32 v34, 16, v31
    v_sqrt_f32 v34, v34
    s_nop 0
    v_cvt_pk_bf16_f32 v31, v34, v34
    v_lshlrev_b32 v34, 16, v31
    v_rcp_f32 v34, v34
    s_nop 0
    v_mul_f32 v35, v51, v34
    v_mul_f32 v33, v33, v34
    v_fma_f32 v36, v50, v35, v33
    s_mov_b64 s[90:91], exec
    s_mov_b64 exec, s[44:45]
    ds_write_b32 v42, v35 offset:0
    ds_write_b32 v42, v36 offset:256
    s_cmp_eq_u32 s34, 0
    s_cbranch_scc0 L_st_10
    v_add_u32 v37, s35, v41
    v_lshlrev_b32 v37, 3, v37
    buffer_store_dwordx2 v[50:51], v37, s[28:31], 0 offen offset:0
L_st_10:
    s_mov_b64 exec, s[90:91]
    s_waitcnt lgkmcnt(0)
    s_barrier
    ds_read_b128 v[80:83], v83
    ds_read_b128 v[84:87], v87
    ds_read_b128 v[88:91], v91
    ds_read_b128 v[92:95], v95
    ds_read_b128 v[96:99], v99
    v_add_u32 v100, s56, v2
    v_lshlrev_b32 v100, 2, v100
    v_add_u32 v100, 0x24400, v100
    ds_read_b32 v124, v100 offset:0
    ds_read_b32 v128, v100 offset:256
    s_waitcnt lgkmcnt(0)
    v_mov_b32 v125, v124
    v_sub_f32 v128, 0, v128
    v_mov_b32 v129, v128
    v_add_u32 v100, s56, v2
    v_mul_u32_u24 v100, 176, v100
    v_lshl_add_u32 v100, v3, 3, v100
    s_mul_i32 s37, s48, 32
    v_add_u32 v101, s37, v100
    v_accvgpr_read_b32 v104, a0
    v_accvgpr_read_b32 v105, a1
    v_accvgpr_read_b32 v106, a2
    v_accvgpr_read_b32 v107, a3
    v_pk_mul_f32 v[104:105], v[104:105], v[124:125]
    v_pk_mul_f32 v[106:107], v[106:107], v[124:125]
    v_pk_fma_f32 v[104:105], v[128:129], v[80:81], v[104:105]
    v_pk_fma_f32 v[106:107], v[128:129], v[82:83], v[106:107]
    v_cvt_pk_bf16_f32 v108, v104, v105
    v_cvt_pk_bf16_f32 v109, v106, v107
    ds_write_b64 v101, v[108:109] offset:0
    s_mul_i32 s37, s49, 32
    v_add_u32 v101, s37, v100
    v_accvgpr_read_b32 v104, a4
    v_accvgpr_read_b32 v105, a5
    v_accvgpr_read_b32 v106, a6
    v_accvgpr_read_b32 v107, a7
    v_pk_mul_f32 v[104:105], v[104:105], v[124:125]
    v_pk_mul_f32 v[106:107], v[106:107], v[124:125]
    v_pk_fma_f32 v[104:105], v[128:129], v[84:85], v[104:105]
    v_pk_fma_f32 v[106:107], v[128:129], v[86:87], v[106:107]
    v_cvt_pk_bf16_f32 v108, v104, v105
    v_cvt_pk_bf16_f32 v109, v106, v107
    ds_write_b64 v101, v[108:109] offset:0
    s_mul_i32 s37, s50, 32
    v_add_u32 v101, s37, v100
    v_accvgpr_read_b32 v104, a8
    v_accvgpr_read_b32 v105, a9
    v_accvgpr_read_b32 v106, a10
    v_accvgpr_read_b32 v107, a11
    v_pk_mul_f32 v[104:105], v[104:105], v[124:125]
    v_pk_mul_f32 v[106:107], v[106:107], v[124:125]
    v_pk_fma_f32 v[104:105], v[128:129], v[88:89], v[104:105]
    v_pk_fma_f32 v[106:107], v[128:129], v[90:91], v[106:107]
    v_cvt_pk_bf16_f32 v108, v104, v105
    v_cvt_pk_bf16_f32 v109, v106, v107
    ds_write_b64 v101, v[108:109] offset:0
    s_mul_i32 s37, s51, 32
    v_add_u32 v101, s37, v100
    v_accvgpr_read_b32 v104, a12
    v_accvgpr_read_b32 v105, a13
    v_accvgpr_read_b32 v106, a14
    v_accvgpr_read_b32 v107, a15
    v_pk_mul_f32 v[104:105], v[104:105], v[124:125]
    v_pk_mul_f32 v[106:107], v[106:107], v[124:125]
    v_pk_fma_f32 v[104:105], v[128:129], v[92:93], v[104:105]
    v_pk_fma_f32 v[106:107], v[128:129], v[94:95], v[106:107]
    v_cvt_pk_bf16_f32 v108, v104, v105
    v_cvt_pk_bf16_f32 v109, v106, v107
    ds_write_b64 v101, v[108:109] offset:0
    s_mul_i32 s37, s52, 32
    v_add_u32 v101, s37, v100
    v_accvgpr_read_b32 v104, a16
    v_accvgpr_read_b32 v105, a17
    v_accvgpr_read_b32 v106, a18
    v_accvgpr_read_b32 v107, a19
    v_pk_mul_f32 v[104:105], v[104:105], v[124:125]
    v_pk_mul_f32 v[106:107], v[106:107], v[124:125]
    v_pk_fma_f32 v[104:105], v[128:129], v[96:97], v[104:105]
    v_pk_fma_f32 v[106:107], v[128:129], v[98:99], v[106:107]
    v_cvt_pk_bf16_f32 v108, v104, v105
    v_cvt_pk_bf16_f32 v109, v106, v107
    ds_write_b64 v101, v[108:109] offset:0
    s_waitcnt lgkmcnt(0)
k4_kernel_phase2:
    s_barrier
    ds_read_b128 v[80:83], v134
    ds_read_b128 v[84:87], v135
    v_mov_b32 v100, 0xc0135761
    v_mov_b32 v101, 0xc0135761
    v_mov_b32 v102, 0xbdd2d3e8
    v_mov_b32 v103, 0xbdd2d3e8
    v_mov_b32 v120, 1.0
    v_mov_b32 v121, 1.0
    s_waitcnt lgkmcnt(1)
    v_lshlrev_b32 v104, 16, v80
    v_and_b32 v105, 0xffff0000, v80
    v_lshlrev_b32 v106, 16, v81
    v_and_b32 v107, 0xffff0000, v81
    v_lshlrev_b32 v108, 16, v82
    v_and_b32 v109, 0xffff0000, v82
    v_lshlrev_b32 v110, 16, v83
    v_and_b32 v111, 0xffff0000, v83
    v_pk_mul_f32 v[112:113], v[104:105], v[104:105]
    v_pk_mul_f32 v[114:115], v[106:107], v[106:107]
    v_pk_mul_f32 v[116:117], v[108:109], v[108:109]
    v_pk_mul_f32 v[118:119], v[110:111], v[110:111]
    v_pk_fma_f32 v[112:113], v[112:113], v[102:103], v[100:101]
    v_pk_fma_f32 v[114:115], v[114:115], v[102:103], v[100:101]
    v_pk_fma_f32 v[116:117], v[116:117], v[102:103], v[100:101]
    v_pk_fma_f32 v[118:119], v[118:119], v[102:103], v[100:101]
    v_pk_mul_f32 v[112:113], v[112:113], v[104:105]
    v_pk_mul_f32 v[114:115], v[114:115], v[106:107]
    v_pk_mul_f32 v[116:117], v[116:117], v[108:109]
    v_pk_mul_f32 v[118:119], v[118:119], v[110:111]
    v_exp_f32 v112, v112
    v_exp_f32 v113, v113
    v_exp_f32 v114, v114
    v_exp_f32 v115, v115
    v_exp_f32 v116, v116
    v_exp_f32 v117, v117
    v_exp_f32 v118, v118
    v_exp_f32 v119, v119
    s_nop 0
    v_pk_add_f32 v[112:113], v[112:113], v[120:121]
    v_pk_add_f32 v[114:115], v[114:115], v[120:121]
    v_pk_add_f32 v[116:117], v[116:117], v[120:121]
    v_pk_add_f32 v[118:119], v[118:119], v[120:121]
    v_rcp_f32 v112, v112
    v_rcp_f32 v113, v113
    v_rcp_f32 v114, v114
    v_rcp_f32 v115, v115
    v_rcp_f32 v116, v116
    v_rcp_f32 v117, v117
    v_rcp_f32 v118, v118
    v_rcp_f32 v119, v119
    s_nop 0
    v_pk_mul_f32 v[104:105], v[104:105], v[112:113]
    v_pk_mul_f32 v[106:107], v[106:107], v[114:115]
    v_pk_mul_f32 v[108:109], v[108:109], v[116:117]
    v_pk_mul_f32 v[110:111], v[110:111], v[118:119]
    v_cvt_pk_bf16_f32 v80, v104, v105
    v_cvt_pk_bf16_f32 v81, v106, v107
    v_cvt_pk_bf16_f32 v82, v108, v109
    v_cvt_pk_bf16_f32 v83, v110, v111
    buffer_store_dwordx4 v[80:83], v132, s[16:19], 0 offen
    s_waitcnt lgkmcnt(0)
    v_lshlrev_b32 v104, 16, v84
    v_and_b32 v105, 0xffff0000, v84
    v_lshlrev_b32 v106, 16, v85
    v_and_b32 v107, 0xffff0000, v85
    v_lshlrev_b32 v108, 16, v86
    v_and_b32 v109, 0xffff0000, v86
    v_lshlrev_b32 v110, 16, v87
    v_and_b32 v111, 0xffff0000, v87
    v_pk_mul_f32 v[112:113], v[104:105], v[104:105]
    v_pk_mul_f32 v[114:115], v[106:107], v[106:107]
    v_pk_mul_f32 v[116:117], v[108:109], v[108:109]
    v_pk_mul_f32 v[118:119], v[110:111], v[110:111]
    v_pk_fma_f32 v[112:113], v[112:113], v[102:103], v[100:101]
    v_pk_fma_f32 v[114:115], v[114:115], v[102:103], v[100:101]
    v_pk_fma_f32 v[116:117], v[116:117], v[102:103], v[100:101]
    v_pk_fma_f32 v[118:119], v[118:119], v[102:103], v[100:101]
    v_pk_mul_f32 v[112:113], v[112:113], v[104:105]
    v_pk_mul_f32 v[114:115], v[114:115], v[106:107]
    v_pk_mul_f32 v[116:117], v[116:117], v[108:109]
    v_pk_mul_f32 v[118:119], v[118:119], v[110:111]
    v_exp_f32 v112, v112
    v_exp_f32 v113, v113
    v_exp_f32 v114, v114
    v_exp_f32 v115, v115
    v_exp_f32 v116, v116
    v_exp_f32 v117, v117
    v_exp_f32 v118, v118
    v_exp_f32 v119, v119
    s_nop 0
    v_pk_add_f32 v[112:113], v[112:113], v[120:121]
    v_pk_add_f32 v[114:115], v[114:115], v[120:121]
    v_pk_add_f32 v[116:117], v[116:117], v[120:121]
    v_pk_add_f32 v[118:119], v[118:119], v[120:121]
    v_rcp_f32 v112, v112
    v_rcp_f32 v113, v113
    v_rcp_f32 v114, v114
    v_rcp_f32 v115, v115
    v_rcp_f32 v116, v116
    v_rcp_f32 v117, v117
    v_rcp_f32 v118, v118
    v_rcp_f32 v119, v119
    s_nop 0
    v_pk_mul_f32 v[104:105], v[104:105], v[112:113]
    v_pk_mul_f32 v[106:107], v[106:107], v[114:115]
    v_pk_mul_f32 v[108:109], v[108:109], v[116:117]
    v_pk_mul_f32 v[110:111], v[110:111], v[118:119]
    v_cvt_pk_bf16_f32 v84, v104, v105
    v_cvt_pk_bf16_f32 v85, v106, v107
    v_cvt_pk_bf16_f32 v86, v108, v109
    v_cvt_pk_bf16_f32 v87, v110, v111
    buffer_store_dwordx4 v[84:87], v133, s[16:19], 0 offen
k4_kernel_end:
    s_endpgm
.p2align 8
.globl k5_kernel
.type k5_kernel,@function
k5_kernel:
    s_cmp_ge_u32 s2, 256
    s_cbranch_scc1 k5_kernel_end
    s_load_dwordx2 s[4:5], s[0:1], 80
    s_and_b32 s37, s2, 7
    s_lshr_b32 s38, s2, 3
    s_lshr_b32 s33, s38, 3
    s_and_b32 s34, s38, 7
    s_mul_i32 s37, s37, 4
    s_add_u32 s33, s33, s37
    s_mul_i32 s35, s33, 64
    s_mul_i32 s36, s34, 80
    v_and_b32 v1, 63, v0
    v_lshrrev_b32 v31, 6, v0
    v_and_b32 v2, 15, v0
    v_bfe_u32 v3, v0, 4, 2
    v_readfirstlane_b32 s43, v31
    s_and_b32 s32, s43, 3
    s_mul_i32 s56, s32, 16
    s_cmp_lt_u32 s43, 4
    s_cbranch_scc1 k5_kernel_cons
    v_lshrrev_b32 v31, 4, v1
    v_and_b32 v32, 15, v1
    v_add_u32 v31, s56, v31
    s_mov_b32 s38, 1280
    v_add_u32 v33, 0, v31
    v_and_b32 v34, 15, v33
    v_xor_b32 v34, v34, v32
    v_add_u32 v33, s35, v33
    v_mul_lo_u32 v33, v33, s38
    v_lshl_add_u32 v4, v34, 4, v33
    v_add_u32 v33, 4, v31
    v_and_b32 v34, 15, v33
    v_xor_b32 v34, v34, v32
    v_add_u32 v33, s35, v33
    v_mul_lo_u32 v33, v33, s38
    v_lshl_add_u32 v5, v34, 4, v33
    v_add_u32 v33, 8, v31
    v_and_b32 v34, 15, v33
    v_xor_b32 v34, v34, v32
    v_add_u32 v33, s35, v33
    v_mul_lo_u32 v33, v33, s38
    v_lshl_add_u32 v6, v34, 4, v33
    v_add_u32 v33, 12, v31
    v_and_b32 v34, 15, v33
    v_xor_b32 v34, v34, v32
    v_add_u32 v33, s35, v33
    v_mul_lo_u32 v33, v33, s38
    v_lshl_add_u32 v7, v34, 4, v33
    s_mul_i32 s37, s34, 102400
    s_mul_i32 s38, s32, 5120
    s_add_u32 s37, s37, s38
    v_lshl_add_u32 v8, v1, 4, s37
    s_waitcnt lgkmcnt(0)
    s_add_u32 s12, s4, 0x1c14000
    s_addc_u32 s13, s5, 0
    s_and_b32 s13, s13, 0xffff
    s_mov_b32 s14, 0xc8000
    s_mov_b32 s15, 0x00020000
    s_add_u32 s8, s4, 0xf80000
    s_addc_u32 s9, s5, 0
    s_and_b32 s9, s9, 0xffff
    s_mov_b32 s10, 0x280000
    s_mov_b32 s11, 0x00020000
    s_mul_i32 s39, s32, 4096
    s_mul_i32 s40, s32, 5120
    s_mov_b32 s46, 0x7ff00000
    s_mov_b32 s41, 0x0
    v_add_u32 v35, 0xfffffb00, v4
    s_add_u32 m0, s39, 0x0
    s_nop 0
    buffer_load_dwordx4 v35, s[8:11], s41 offen lds
    v_add_u32 v35, 0xfffffb00, v5
    s_add_u32 m0, s39, 0x400
    s_nop 0
    buffer_load_dwordx4 v35, s[8:11], s41 offen lds
    v_add_u32 v35, 0xfffffb00, v6
    s_add_u32 m0, s39, 0x800
    s_nop 0
    buffer_load_dwordx4 v35, s[8:11], s41 offen lds
    v_add_u32 v35, 0xfffffb00, v7
    s_add_u32 m0, s39, 0xc00
    s_nop 0
    buffer_load_dwordx4 v35, s[8:11], s41 offen lds
    s_add_u32 m0, s40, 0x4000
    s_mov_b32 s42, 0x0
    buffer_load_dwordx4 v8, s[12:15], s42 offen lds
    s_add_u32 m0, s40, 0x4400
    s_mov_b32 s42, 0x400
    buffer_load_dwordx4 v8, s[12:15], s42 offen lds
    s_add_u32 m0, s40, 0x4800
    s_mov_b32 s42, 0x800
    buffer_load_dwordx4 v8, s[12:15], s42 offen lds
    s_add_u32 m0, s40, 0x4c00
    s_mov_b32 s42, 0xc00
    buffer_load_dwordx4 v8, s[12:15], s42 offen lds
    s_add_u32 m0, s40, 0x5000
    s_mov_b32 s42, 0x1000
    buffer_load_dwordx4 v8, s[12:15], s42 offen lds
    s_mov_b32 s41, 0x100
    v_bfe_u32 v36, v4, 4, 4
    v_cmp_gt_u32 vcc, 4, v36
    v_add_u32 v35, 0xfffffb00, v4
    v_add_u32 v36, 0x500, v4
    v_cndmask_b32 v35, v36, v35, vcc
    s_add_u32 m0, s39, 0x9000
    s_nop 0
    buffer_load_dwordx4 v35, s[8:11], s41 offen lds
    v_bfe_u32 v36, v5, 4, 4
    v_cmp_gt_u32 vcc, 4, v36
    v_add_u32 v35, 0xfffffb00, v5
    v_add_u32 v36, 0x500, v5
    v_cndmask_b32 v35, v36, v35, vcc
    s_add_u32 m0, s39, 0x9400
    s_nop 0
    buffer_load_dwordx4 v35, s[8:11], s41 offen lds
    v_bfe_u32 v36, v6, 4, 4
    v_cmp_gt_u32 vcc, 4, v36
    v_add_u32 v35, 0xfffffb00, v6
    v_add_u32 v36, 0x500, v6
    v_cndmask_b32 v35, v36, v35, vcc
    s_add_u32 m0, s39, 0x9800
    s_nop 0
    buffer_load_dwordx4 v35, s[8:11], s41 offen lds
    v_bfe_u32 v36, v7, 4, 4
    v_cmp_gt_u32 vcc, 4, v36
    v_add_u32 v35, 0xfffffb00, v7
    v_add_u32 v36, 0x500, v7
    v_cndmask_b32 v35, v36, v35, vcc
    s_add_u32 m0, s39, 0x9c00
    s_nop 0
    buffer_load_dwordx4 v35, s[8:11], s41 offen lds
    s_add_u32 m0, s40, 0xd000
    s_mov_b32 s42, 0x5000
    buffer_load_dwordx4 v8, s[12:15], s42 offen lds
    s_add_u32 m0, s40, 0xd400
    s_mov_b32 s42, 0x5400
    buffer_load_dwordx4 v8, s[12:15], s42 offen lds
    s_add_u32 m0, s40, 0xd800
    s_mov_b32 s42, 0x5800
    buffer_load_dwordx4 v8, s[12:15], s42 offen lds
    s_add_u32 m0, s40, 0xdc00
    s_mov_b32 s42, 0x5c00
    buffer_load_dwordx4 v8, s[12:15], s42 offen lds
    s_add_u32 m0, s40, 0xe000
    s_mov_b32 s42, 0x6000
    buffer_load_dwordx4 v8, s[12:15], s42 offen lds
    s_mov_b32 s41, 0x200
    v_bfe_u32 v36, v4, 4, 4
    v_cmp_gt_u32 vcc, 8, v36
    v_add_u32 v35, 0x500, v4
    v_add_u32 v36, 0xfffff600, v4
    v_cndmask_b32 v35, v36, v35, vcc
    s_add_u32 m0, s39, 0x12000
    s_nop 0
    buffer_load_dwordx4 v35, s[8:11], s41 offen lds
    v_bfe_u32 v36, v5, 4, 4
    v_cmp_gt_u32 vcc, 8, v36
    v_add_u32 v35, 0x500, v5
    v_add_u32 v36, 0xfffff600, v5
    v_cndmask_b32 v35, v36, v35, vcc
    s_add_u32 m0, s39, 0x12400
    s_nop 0
    buffer_load_dwordx4 v35, s[8:11], s41 offen lds
    v_bfe_u32 v36, v6, 4, 4
    v_cmp_gt_u32 vcc, 8, v36
    v_add_u32 v35, 0x500, v6
    v_add_u32 v36, 0xfffff600, v6
    v_cndmask_b32 v35, v36, v35, vcc
    s_add_u32 m0, s39, 0x12800
    s_nop 0
    buffer_load_dwordx4 v35, s[8:11], s41 offen lds
    v_bfe_u32 v36, v7, 4, 4
    v_cmp_gt_u32 vcc, 8, v36
    v_add_u32 v35, 0x500, v7
    v_add_u32 v36, 0xfffff600, v7
    v_cndmask_b32 v35, v36, v35, vcc
    s_add_u32 m0, s39, 0x12c00
    s_nop 0
    buffer_load_dwordx4 v35, s[8:11], s41 offen lds
    s_add_u32 m0, s40, 0x16000
    s_mov_b32 s42, 0xa000
    buffer_load_dwordx4 v8, s[12:15], s42 offen lds
    s_add_u32 m0, s40, 0x16400
    s_mov_b32 s42, 0xa400
    buffer_load_dwordx4 v8, s[12:15], s42 offen lds
    s_add_u32 m0, s40, 0x16800
    s_mov_b32 s42, 0xa800
    buffer_load_dwordx4 v8, s[12:15], s42 offen lds
    s_add_u32 m0, s40, 0x16c00
    s_mov_b32 s42, 0xac00
    buffer_load_dwordx4 v8, s[12:15], s42 offen lds
    s_add_u32 m0, s40, 0x17000
    s_mov_b32 s42, 0xb000
    buffer_load_dwordx4 v8, s[12:15], s42 offen lds
    s_add_u32 s16, s4, 0x1200000
    s_addc_u32 s17, s5, 0
    s_and_b32 s17, s17, 0xffff
    s_mov_b32 s18, 0x280000
    s_mov_b32 s19, 0x00020000
    s_add_u32 s20, s4, 0xd00000
    s_addc_u32 s21, s5, 0
    s_and_b32 s21, s21, 0xffff
    s_mov_b32 s22, 0x280000
    s_mov_b32 s23, 0x00020000
    s_add_u32 s28, s4, 0x1a80000
    s_addc_u32 s29, s5, 0
    s_and_b32 s29, s29, 0xffff
    s_mov_b32 s30, 0x4000
    s_mov_b32 s31, 0x00020000
    s_mov_b32 s38, 6554
    s_mul_i32 s37, s43, 128
    v_add_u32 v31, s37, v1
    v_mul_lo_u32 v32, v31, s38
    v_lshrrev_b32 v32, 16, v32
    v_mul_u32_u24 v33, 10, v32
    v_sub_u32 v33, v31, v33
    v_mul_u32_u24 v34, 176, v32
    v_lshl_add_u32 v134, v33, 4, v34
    v_add_u32 v34, s35, v32
    v_lshlrev_b32 v144, 3, v34
    v_mul_u32_u24 v34, 1280, v34
    v_lshl_add_u32 v34, v33, 4, v34
    v_lshl_add_u32 v132, s36, 1, v34
    v_cmp_le_u32 vcc, 640, v31
    v_mov_b32 v35, 0x7fffff00
    v_mov_b32 v36, 0
    v_cndmask_b32 v132, v132, v35, vcc
    v_cndmask_b32 v144, v144, v35, vcc
    v_cndmask_b32 v134, v134, v36, vcc
    v_add_u32 v31, s37, v1
    v_add_u32 v31, 64, v31
    v_mul_lo_u32 v32, v31, s38
    v_lshrrev_b32 v32, 16, v32
    v_mul_u32_u24 v33, 10, v32
    v_sub_u32 v33, v31, v33
    v_mul_u32_u24 v34, 176, v32
    v_lshl_add_u32 v135, v33, 4, v34
    v_add_u32 v34, s35, v32
    v_lshlrev_b32 v146, 3, v34
    v_mul_u32_u24 v34, 1280, v34
    v_lshl_add_u32 v34, v33, 4, v34
    v_lshl_add_u32 v133, s36, 1, v34
    v_cmp_le_u32 vcc, 640, v31
    v_mov_b32 v35, 0x7fffff00
    v_mov_b32 v36, 0
    v_cndmask_b32 v133, v133, v35, vcc
    v_cndmask_b32 v146, v146, v35, vcc
    v_cndmask_b32 v135, v135, v36, vcc
    s_waitcnt vmcnt(18)
    s_barrier
    s_mov_b32 s41, 0x300
    v_bfe_u32 v36, v4, 4, 4
    v_cmp_gt_u32 vcc, 12, v36
    v_add_u32 v35, 0xfffff600, v4
    v_add_u32 v36, 0xa00, v4
    v_cndmask_b32 v35, v36, v35, vcc
    s_add_u32 m0, s39, 0x1b000
    s_nop 0
    buffer_load_dwordx4 v35, s[8:11], s41 offen lds
    v_bfe_u32 v36, v5, 4, 4
    v_cmp_gt_u32 vcc, 12, v36
    v_add_u32 v35, 0xfffff600, v5
    v_add_u32 v36, 0xa00, v5
    v_cndmask_b32 v35, v36, v35, vcc
    s_add_u32 m0, s39, 0x1b400
    s_nop 0
    buffer_load_dwordx4 v35, s[8:11], s41 offen lds
    v_bfe_u32 v36, v6, 4, 4
    v_cmp_gt_u32 vcc, 12, v36
    v_add_u32 v35, 0xfffff600, v6
    v_add_u32 v36, 0xa00, v6
    v_cndmask_b32 v35, v36, v35, vcc
    s_add_u32 m0, s39, 0x1b800
    s_nop 0
    buffer_load_dwordx4 v35, s[8:11], s41 offen lds
    v_bfe_u32 v36, v7, 4, 4
    v_cmp_gt_u32 vcc, 12, v36
    v_add_u32 v35, 0xfffff600, v7
    v_add_u32 v36, 0xa00, v7
    v_cndmask_b32 v35, v36, v35, vcc
    s_add_u32 m0, s39, 0x1bc00
    s_nop 0
    buffer_load_dwordx4 v35, s[8:11], s41 offen lds
    s_add_u32 m0, s40, 0x1f000
    s_mov_b32 s42, 0xf000
    buffer_load_dwordx4 v8, s[12:15], s42 offen lds
    s_add_u32 m0, s40, 0x1f400
    s_mov_b32 s42, 0xf400
    buffer_load_dwordx4 v8, s[12:15], s42 offen lds
    s_add_u32 m0, s40, 0x1f800
    s_mov_b32 s42, 0xf800
    buffer_load_dwordx4 v8, s[12:15], s42 offen lds
    s_add_u32 m0, s40, 0x1fc00
    s_mov_b32 s42, 0xfc00
    buffer_load_dwordx4 v8, s[12:15], s42 offen lds
    s_add_u32 m0, s40, 0x20000
    s_mov_b32 s42, 0x10000
    buffer_load_dwordx4 v8, s[12:15], s42 offen lds
    s_waitcnt vmcnt(18)
    s_barrier
    s_mov_b32 s41, 0x400
    v_add_u32 v35, 0xa00, v4
    s_add_u32 m0, s39, 0x0
    s_nop 0
    buffer_load_dwordx4 v35, s[8:11], s41 offen lds
    v_add_u32 v35, 0xa00, v5
    s_add_u32 m0, s39, 0x400
    s_nop 0
    buffer_load_dwordx4 v35, s[8:11], s41 offen lds
    v_add_u32 v35, 0xa00, v6
    s_add_u32 m0, s39, 0x800
    s_nop 0
    buffer_load_dwordx4 v35, s[8:11], s41 offen lds
    v_add_u32 v35, 0xa00, v7
    s_add_u32 m0, s39, 0xc00
    s_nop 0
    buffer_load_dwordx4 v35, s[8:11], s41 offen lds
    s_add_u32 m0, s40, 0x4000
    s_mov_b32 s42, 0x14000
    buffer_load_dwordx4 v8, s[12:15], s42 offen lds
    s_add_u32 m0, s40, 0x4400
    s_mov_b32 s42, 0x14400
    buffer_load_dwordx4 v8, s[12:15], s42 offen lds
    s_add_u32 m0, s40, 0x4800
    s_mov_b32 s42, 0x14800
    buffer_load_dwordx4 v8, s[12:15], s42 offen lds
    s_add_u32 m0, s40, 0x4c00
    s_mov_b32 s42, 0x14c00
    buffer_load_dwordx4 v8, s[12:15], s42 offen lds
    s_add_u32 m0, s40, 0x5000
    s_mov_b32 s42, 0x15000
    buffer_load_dwordx4 v8, s[12:15], s42 offen lds
    s_waitcnt vmcnt(18)
    s_barrier
    s_waitcnt vmcnt(9)
    s_barrier
    buffer_load_dwordx4 v[136:139], v132, s[20:23], 0 offen
    buffer_load_dwordx4 v[140:143], v133, s[20:23], 0 offen
    buffer_load_dwordx2 v[144:145], v144, s[28:31], 0 offen
    buffer_load_dwordx2 v[146:147], v146, s[28:31], 0 offen
    s_waitcnt vmcnt(4)
    s_barrier
    s_barrier
    s_branch k5_kernel_phase2
k5_kernel_cons:
    s_waitcnt lgkmcnt(0)
    s_add_u32 s16, s4, 0x1200000
    s_addc_u32 s17, s5, 0
    s_and_b32 s17, s17, 0xffff
    s_mov_b32 s18, 0x280000
    s_mov_b32 s19, 0x00020000
    s_add_u32 s20, s4, 0xd00000
    s_addc_u32 s21, s5, 0
    s_and_b32 s21, s21, 0xffff
    s_mov_b32 s22, 0x280000
    s_mov_b32 s23, 0x00020000
    s_add_u32 s28, s4, 0x1a80000
    s_addc_u32 s29, s5, 0
    s_and_b32 s29, s29, 0xffff
    s_mov_b32 s30, 0x4000
    s_mov_b32 s31, 0x00020000
    s_mov_b32 s48, 0
    s_mov_b32 s49, 1
    s_mov_b32 s50, 2
    s_mov_b32 s51, 3
    s_mov_b32 s52, 4
    v_lshrrev_b32 v31, 2, v2
    v_lshl_add_u32 v32, v3, 2, v31
    v_mul_u32_u24 v33, 160, v32
    v_and_b32 v34, 3, v2
    v_lshl_add_u32 v33, v34, 3, v33
    v_add_u32 v33, 16384, v33
    v_and_b32 v32, 7, v32
    s_lshl_b32 s37, s48, 5
    v_add_u32 v4, s37, v33
    s_lshl_b32 s37, s49, 5
    v_add_u32 v5, s37, v33
    s_lshl_b32 s37, s50, 5
    v_add_u32 v6, s37, v33
    s_lshl_b32 s37, s51, 5
    v_add_u32 v7, s37, v33
    s_lshl_b32 s37, s52, 5
    v_add_u32 v8, s37, v33
    v_add_u32 v31, s56, v2
    v_mul_u32_u24 v31, 256, v31
    v_xor_b32 v32, v2, v3
    v_xor_b32 v33, 0, v32
    v_lshl_add_u32 v19, v33, 4, v31
    v_xor_b32 v33, 4, v32
    v_lshl_add_u32 v20, v33, 4, v31
    v_xor_b32 v33, 8, v32
    v_lshl_add_u32 v21, v33, 4, v31
    v_xor_b32 v33, 12, v32
    v_lshl_add_u32 v22, v33, 4, v31
    v_add_u32 v9, 0x10000, v4
    v_add_u32 v10, 0x10000, v5
    v_add_u32 v11, 0x10000, v6
    v_add_u32 v12, 0x10000, v7
    v_add_u32 v13, 0x10000, v8
    v_add_u32 v23, 0x10000, v19
    v_add_u32 v24, 0x10000, v20
    v_add_u32 v25, 0x10000, v21
    v_add_u32 v26, 0x10000, v22
    v_add_u32 v14, 0x20000, v4
    v_add_u32 v15, 0x20000, v5
    v_add_u32 v16, 0x20000, v6
    v_add_u32 v17, 0x20000, v7
    v_add_u32 v18, 0x20000, v8
    v_add_u32 v27, 0x20000, v19
    v_add_u32 v28, 0x20000, v20
    v_add_u32 v29, 0x20000, v21
    v_add_u32 v30, 0x20000, v22
    v_mov_b32 v44, 0x3f803f80
    v_mov_b32 v45, 0x3f803f80
    v_mov_b32 v46, 0x3f803f80
    v_mov_b32 v47, 0x3f803f80
    v_accvgpr_write_b32 a0, 0
    v_accvgpr_write_b32 a1, 0
    v_accvgpr_write_b32 a2, 0
    v_accvgpr_write_b32 a3, 0
    v_accvgpr_write_b32 a4, 0
    v_accvgpr_write_b32 a5, 0
    v_accvgpr_write_b32 a6, 0
    v_accvgpr_write_b32 a7, 0
    v_accvgpr_write_b32 a8, 0
    v_accvgpr_write_b32 a9, 0
    v_accvgpr_write_b32 a10, 0
    v_accvgpr_write_b32 a11, 0
    v_accvgpr_write_b32 a12, 0
    v_accvgpr_write_b32 a13, 0
    v_accvgpr_write_b32 a14, 0
    v_accvgpr_write_b32 a15, 0
    v_accvgpr_write_b32 a16, 0
    v_accvgpr_write_b32 a17, 0
    v_accvgpr_write_b32 a18, 0
    v_accvgpr_write_b32 a19, 0
    s_mov_b32 s38, 6554
    s_mul_i32 s37, s43, 128
    v_add_u32 v31, s37, v1
    v_mul_lo_u32 v32, v31, s38
    v_lshrrev_b32 v32, 16, v32
    v_mul_u32_u24 v33, 10, v32
    v_sub_u32 v33, v31, v33
    v_mul_u32_u24 v34, 176, v32
    v_lshl_add_u32 v134, v33, 4, v34
    v_add_u32 v34, s35, v32
    v_lshlrev_b32 v144, 3, v34
    v_mul_u32_u24 v34, 1280, v34
    v_lshl_add_u32 v34, v33, 4, v34
    v_lshl_add_u32 v132, s36, 1, v34
    v_cmp_le_u32 vcc, 640, v31
    v_mov_b32 v35, 0x7fffff00
    v_mov_b32 v36, 0
    v_cndmask_b32 v132, v132, v35, vcc
    v_cndmask_b32 v144, v144, v35, vcc
    v_cndmask_b32 v134, v134, v36, vcc
    v_add_u32 v31, s37, v1
    v_add_u32 v31, 64, v31
    v_mul_lo_u32 v32, v31, s38
    v_lshrrev_b32 v32, 16, v32
    v_mul_u32_u24 v33, 10, v32
    v_sub_u32 v33, v31, v33
    v_mul_u32_u24 v34, 176, v32
    v_lshl_add_u32 v135, v33, 4, v34
    v_add_u32 v34, s35, v32
    v_lshlrev_b32 v146, 3, v34
    v_mul_u32_u24 v34, 1280, v34
    v_lshl_add_u32 v34, v33, 4, v34
    v_lshl_add_u32 v133, s36, 1, v34
    v_cmp_le_u32 vcc, 640, v31
    v_mov_b32 v35, 0x7fffff00
    v_mov_b32 v36, 0
    v_cndmask_b32 v133, v133, v35, vcc
    v_cndmask_b32 v146, v146, v35, vcc
    v_cndmask_b32 v135, v135, v36, vcc
    s_barrier
    ds_read_b128 v[72:75], v19 offset:0
    ds_read_b64_tr_b16 v[48:49], v4 offset:0
    ds_read_b64_tr_b16 v[50:51], v4 offset:2560
    ds_read_b64_tr_b16 v[52:53], v5 offset:0
    ds_read_b64_tr_b16 v[54:55], v5 offset:2560
    ds_read_b64_tr_b16 v[56:57], v6 offset:0
    ds_read_b64_tr_b16 v[58:59], v6 offset:2560
    ds_read_b64_tr_b16 v[60:61], v7 offset:0
    ds_read_b64_tr_b16 v[62:63], v7 offset:2560
    ds_read_b64_tr_b16 v[64:65], v8 offset:0
    ds_read_b64_tr_b16 v[66:67], v8 offset:2560
    ds_read_b128 v[76:79], v20 offset:0
    ds_read_b64_tr_b16 v[68:69], v4 offset:5120
    ds_read_b64_tr_b16 v[70:71], v4 offset:7680
    s_waitcnt lgkmcnt(11)
    v_mfma_f32_16x16x32_bf16 a[0:3], v[48:51], v[72:75], a[0:3]
    ds_read_b64_tr_b16 v[48:49], v5 offset:5120
    ds_read_b64_tr_b16 v[50:51], v5 offset:7680
    s_waitcnt lgkmcnt(11)
    v_mfma_f32_16x16x32_bf16 a[4:7], v[52:55], v[72:75], a[4:7]
    ds_read_b64_tr_b16 v[52:53], v6 offset:5120
    ds_read_b64_tr_b16 v[54:55], v6 offset:7680
    s_waitcnt lgkmcnt(11)
    v_mfma_f32_16x16x32_bf16 a[8:11], v[56:59], v[72:75], a[8:11]
    ds_read_b64_tr_b16 v[56:57], v7 offset:5120
    ds_read_b64_tr_b16 v[58:59], v7 offset:7680
    s_waitcnt lgkmcnt(11)
    v_mfma_f32_16x16x32_bf16 a[12:15], v[60:63], v[72:75], a[12:15]
    ds_read_b64_tr_b16 v[60:61], v8 offset:5120
    ds_read_b64_tr_b16 v[62:63], v8 offset:7680
    s_waitcnt lgkmcnt(11)
    v_mfma_f32_16x16x32_bf16 a[16:19], v[64:67], v[72:75], a[16:19]
    ds_read_b128 v[72:75], v21 offset:0
    ds_read_b64_tr_b16 v[64:65], v4 offset:10240
    ds_read_b64_tr_b16 v[66:67], v4 offset:12800
    s_waitcnt lgkmcnt(11)
    v_mfma_f32_16x16x32_bf16 a[0:3], v[68:71], v[76:79], a[0:3]
    ds_read_b64_tr_b16 v[68:69], v5 offset:10240
    ds_read_b64_tr_b16 v[70:71], v5 offset:12800
    s_waitcnt lgkmcnt(11)
    v_mfma_f32_16x16x32_bf16 a[4:7], v[48:51], v[76:79], a[4:7]
    ds_read_b64_tr_b16 v[48:49], v6 offset:10240
    ds_read_b64_tr_b16 v[50:51], v6 offset:12800
    s_waitcnt lgkmcnt(11)
    v_mfma_f32_16x16x32_bf16 a[8:11], v[52:55], v[76:79], a[8:11]
    ds_read_b64_tr_b16 v[52:53], v7 offset:10240
    ds_read_b64_tr_b16 v[54:55], v7 offset:12800
    s_waitcnt lgkmcnt(11)
    v_mfma_f32_16x16x32_bf16 a[12:15], v[56:59], v[76:79], a[12:15]
    ds_read_b64_tr_b16 v[56:57], v8 offset:10240
    ds_read_b64_tr_b16 v[58:59], v8 offset:12800
    s_waitcnt lgkmcnt(11)
    v_mfma_f32_16x16x32_bf16 a[16:19], v[60:63], v[76:79], a[16:19]
    ds_read_b128 v[76:79], v22 offset:0
    ds_read_b64_tr_b16 v[60:61], v4 offset:15360
    ds_read_b64_tr_b16 v[62:63], v4 offset:17920
    s_waitcnt lgkmcnt(11)
    v_mfma_f32_16x16x32_bf16 a[0:3], v[64:67], v[72:75], a[0:3]
    ds_read_b64_tr_b16 v[64:65], v5 offset:15360
    ds_read_b64_tr_b16 v[66:67], v5 offset:17920
    s_waitcnt lgkmcnt(11)
    v_mfma_f32_16x16x32_bf16 a[4:7], v[68:71], v[72:75], a[4:7]
    ds_read_b64_tr_b16 v[68:69], v6 offset:15360
    ds_read_b64_tr_b16 v[70:71], v6 offset:17920
    s_waitcnt lgkmcnt(11)
    v_mfma_f32_16x16x32_bf16 a[8:11], v[48:51], v[72:75], a[8:11]
    ds_read_b64_tr_b16 v[48:49], v7 offset:15360
    ds_read_b64_tr_b16 v[50:51], v7 offset:17920
    s_waitcnt lgkmcnt(11)
    v_mfma_f32_16x16x32_bf16 a[12:15], v[52:55], v[72:75], a[12:15]
    ds_read_b64_tr_b16 v[52:53], v8 offset:15360
    ds_read_b64_tr_b16 v[54:55], v8 offset:17920
    s_waitcnt lgkmcnt(11)
    v_mfma_f32_16x16x32_bf16 a[16:19], v[56:59], v[72:75], a[16:19]
    s_waitcnt lgkmcnt(8)
    v_mfma_f32_16x16x32_bf16 a[0:3], v[60:63], v[76:79], a[0:3]
    s_waitcnt lgkmcnt(6)
    v_mfma_f32_16x16x32_bf16 a[4:7], v[64:67], v[76:79], a[4:7]
    s_waitcnt lgkmcnt(4)
    v_mfma_f32_16x16x32_bf16 a[8:11], v[68:71], v[76:79], a[8:11]
    s_waitcnt lgkmcnt(2)
    v_mfma_f32_16x16x32_bf16 a[12:15], v[48:51], v[76:79], a[12:15]
    s_waitcnt lgkmcnt(0)
    v_mfma_f32_16x16x32_bf16 a[16:19], v[52:55], v[76:79], a[16:19]
    s_barrier
    ds_read_b128 v[72:75], v19 offset:36864
    ds_read_b64_tr_b16 v[56:57], v4 offset:36864
    ds_read_b64_tr_b16 v[58:59], v4 offset:39424
    ds_read_b64_tr_b16 v[60:61], v5 offset:36864
    ds_read_b64_tr_b16 v[62:63], v5 offset:39424
    ds_read_b64_tr_b16 v[64:65], v6 offset:36864
    ds_read_b64_tr_b16 v[66:67], v6 offset:39424
    ds_read_b64_tr_b16 v[68:69], v7 offset:36864
    ds_read_b64_tr_b16 v[70:71], v7 offset:39424
    ds_read_b64_tr_b16 v[48:49], v8 offset:36864
    ds_read_b64_tr_b16 v[50:51], v8 offset:39424
    ds_read_b128 v[76:79], v20 offset:36864
    ds_read_b64_tr_b16 v[52:53], v4 offset:41984
    ds_read_b64_tr_b16 v[54:55], v4 offset:44544
    s_waitcnt lgkmcnt(11)
    v_mfma_f32_16x16x32_bf16 a[0:3], v[56:59], v[72:75], a[0:3]
    ds_read_b64_tr_b16 v[56:57], v5 offset:41984
    ds_read_b64_tr_b16 v[58:59], v5 offset:44544
    s_waitcnt lgkmcnt(11)
    v_mfma_f32_16x16x32_bf16 a[4:7], v[60:63], v[72:75], a[4:7]
    ds_read_b64_tr_b16 v[60:61], v6 offset:41984
    ds_read_b64_tr_b16 v[62:63], v6 offset:44544
    s_waitcnt lgkmcnt(11)
    v_mfma_f32_16x16x32_bf16 a[8:11], v[64:67], v[72:75], a[8:11]
    ds_read_b64_tr_b16 v[64:65], v7 offset:41984
    ds_read_b64_tr_b16 v[66:67], v7 offset:44544
    s_waitcnt lgkmcnt(11)
    v_mfma_f32_16x16x32_bf16 a[12:15], v[68:71], v[72:75], a[12:15]
    ds_read_b64_tr_b16 v[68:69], v8 offset:41984
    ds_read_b64_tr_b16 v[70:71], v8 offset:44544
    s_waitcnt lgkmcnt(11)
    v_mfma_f32_16x16x32_bf16 a[16:19], v[48:51], v[72:75], a[16:19]
    ds_read_b128 v[72:75], v21 offset:36864
    ds_read_b64_tr_b16 v[48:49], v4 offset:47104
    ds_read_b64_tr_b16 v[50:51], v4 offset:49664
    s_waitcnt lgkmcnt(11)
    v_mfma_f32_16x16x32_bf16 a[0:3], v[52:55], v[76:79], a[0:3]
    ds_read_b64_tr_b16 v[52:53], v5 offset:47104
    ds_read_b64_tr_b16 v[54:55], v5 offset:49664
    s_waitcnt lgkmcnt(11)
    v_mfma_f32_16x16x32_bf16 a[4:7], v[56:59], v[76:79], a[4:7]
    ds_read_b64_tr_b16 v[56:57], v6 offset:47104
    ds_read_b64_tr_b16 v[58:59], v6 offset:49664
    s_waitcnt lgkmcnt(11)
    v_mfma_f32_16x16x32_bf16 a[8:11], v[60:63], v[76:79], a[8:11]
    ds_read_b64_tr_b16 v[60:61], v7 offset:47104
    ds_read_b64_tr_b16 v[62:63], v7 offset:49664
    s_waitcnt lgkmcnt(11)
    v_mfma_f32_16x16x32_bf16 a[12:15], v[64:67], v[76:79], a[12:15]
    ds_read_b64_tr_b16 v[64:65], v8 offset:47104
    ds_read_b64_tr_b16 v[66:67], v8 offset:49664
    s_waitcnt lgkmcnt(11)
    v_mfma_f32_16x16x32_bf16 a[16:19], v[68:71], v[76:79], a[16:19]
    ds_read_b128 v[76:79], v22 offset:36864
    ds_read_b64_tr_b16 v[68:69], v4 offset:52224
    ds_read_b64_tr_b16 v[70:71], v4 offset:54784
    s_waitcnt lgkmcnt(11)
    v_mfma_f32_16x16x32_bf16 a[0:3], v[48:51], v[72:75], a[0:3]
    ds_read_b64_tr_b16 v[48:49], v5 offset:52224
    ds_read_b64_tr_b16 v[50:51], v5 offset:54784
    s_waitcnt lgkmcnt(11)
    v_mfma_f32_16x16x32_bf16 a[4:7], v[52:55], v[72:75], a[4:7]
    ds_read_b64_tr_b16 v[52:53], v6 offset:52224
    ds_read_b64_tr_b16 v[54:55], v6 offset:54784
    s_waitcnt lgkmcnt(11)
    v_mfma_f32_16x16x32_bf16 a[8:11], v[56:59], v[72:75], a[8:11]
    ds_read_b64_tr_b16 v[56:57], v7 offset:52224
    ds_read_b64_tr_b16 v[58:59], v7 offset:54784
    s_waitcnt lgkmcnt(11)
    v_mfma_f32_16x16x32_bf16 a[12:15], v[60:63], v[72:75], a[12:15]
    ds_read_b64_tr_b16 v[60:61], v8 offset:52224
    ds_read_b64_tr_b16 v[62:63], v8 offset:54784
    s_waitcnt lgkmcnt(11)
    v_mfma_f32_16x16x32_bf16 a[16:19], v[64:67], v[72:75], a[16:19]
    s_waitcnt lgkmcnt(8)
    v_mfma_f32_16x16x32_bf16 a[0:3], v[68:71], v[76:79], a[0:3]
    s_waitcnt lgkmcnt(6)
    v_mfma_f32_16x16x32_bf16 a[4:7], v[48:51], v[76:79], a[4:7]
    s_waitcnt lgkmcnt(4)
    v_mfma_f32_16x16x32_bf16 a[8:11], v[52:55], v[76:79], a[8:11]
    s_waitcnt lgkmcnt(2)
    v_mfma_f32_16x16x32_bf16 a[12:15], v[56:59], v[76:79], a[12:15]
    s_waitcnt lgkmcnt(0)
    v_mfma_f32_16x16x32_bf16 a[16:19], v[60:63], v[76:79], a[16:19]
    s_barrier
    ds_read_b128 v[72:75], v23 offset:8192
    ds_read_b64_tr_b16 v[64:65], v9 offset:8192
    ds_read_b64_tr_b16 v[66:67], v9 offset:10752
    ds_read_b64_tr_b16 v[68:69], v10 offset:8192
    ds_read_b64_tr_b16 v[70:71], v10 offset:10752
    ds_read_b64_tr_b16 v[48:49], v11 offset:8192
    ds_read_b64_tr_b16 v[50:51], v11 offset:10752
    ds_read_b64_tr_b16 v[52:53], v12 offset:8192
    ds_read_b64_tr_b16 v[54:55], v12 offset:10752
    ds_read_b64_tr_b16 v[56:57], v13 offset:8192
    ds_read_b64_tr_b16 v[58:59], v13 offset:10752
    ds_read_b128 v[76:79], v24 offset:8192
    ds_read_b64_tr_b16 v[60:61], v9 offset:13312
    ds_read_b64_tr_b16 v[62:63], v9 offset:15872
    s_waitcnt lgkmcnt(11)
    v_mfma_f32_16x16x32_bf16 a[0:3], v[64:67], v[72:75], a[0:3]
    ds_read_b64_tr_b16 v[64:65], v10 offset:13312
    ds_read_b64_tr_b16 v[66:67], v10 offset:15872
    s_waitcnt lgkmcnt(11)
    v_mfma_f32_16x16x32_bf16 a[4:7], v[68:71], v[72:75], a[4:7]
    ds_read_b64_tr_b16 v[68:69], v11 offset:13312
    ds_read_b64_tr_b16 v[70:71], v11 offset:15872
    s_waitcnt lgkmcnt(11)
    v_mfma_f32_16x16x32_bf16 a[8:11], v[48:51], v[72:75], a[8:11]
    ds_read_b64_tr_b16 v[48:49], v12 offset:13312
    ds_read_b64_tr_b16 v[50:51], v12 offset:15872
    s_waitcnt lgkmcnt(11)
    v_mfma_f32_16x16x32_bf16 a[12:15], v[52:55], v[72:75], a[12:15]
    ds_read_b64_tr_b16 v[52:53], v13 offset:13312
    ds_read_b64_tr_b16 v[54:55], v13 offset:15872
    s_waitcnt lgkmcnt(11)
    v_mfma_f32_16x16x32_bf16 a[16:19], v[56:59], v[72:75], a[16:19]
    ds_read_b128 v[72:75], v25 offset:8192
    ds_read_b64_tr_b16 v[56:57], v9 offset:18432
    ds_read_b64_tr_b16 v[58:59], v9 offset:20992
    s_waitcnt lgkmcnt(11)
    v_mfma_f32_16x16x32_bf16 a[0:3], v[60:63], v[76:79], a[0:3]
    ds_read_b64_tr_b16 v[60:61], v10 offset:18432
    ds_read_b64_tr_b16 v[62:63], v10 offset:20992
    s_waitcnt lgkmcnt(11)
    v_mfma_f32_16x16x32_bf16 a[4:7], v[64:67], v[76:79], a[4:7]
    ds_read_b64_tr_b16 v[64:65], v11 offset:18432
    ds_read_b64_tr_b16 v[66:67], v11 offset:20992
    s_waitcnt lgkmcnt(11)
    v_mfma_f32_16x16x32_bf16 a[8:11], v[68:71], v[76:79], a[8:11]
    ds_read_b64_tr_b16 v[68:69], v12 offset:18432
    ds_read_b64_tr_b16 v[70:71], v12 offset:20992
    s_waitcnt lgkmcnt(11)
    v_mfma_f32_16x16x32_bf16 a[12:15], v[48:51], v[76:79], a[12:15]
    ds_read_b64_tr_b16 v[48:49], v13 offset:18432
    ds_read_b64_tr_b16 v[50:51], v13 offset:20992
    s_waitcnt lgkmcnt(11)
    v_mfma_f32_16x16x32_bf16 a[16:19], v[52:55], v[76:79], a[16:19]
    ds_read_b128 v[76:79], v26 offset:8192
    ds_read_b64_tr_b16 v[52:53], v9 offset:23552
    ds_read_b64_tr_b16 v[54:55], v9 offset:26112
    s_waitcnt lgkmcnt(11)
    v_mfma_f32_16x16x32_bf16 a[0:3], v[56:59], v[72:75], a[0:3]
    ds_read_b64_tr_b16 v[56:57], v10 offset:23552
    ds_read_b64_tr_b16 v[58:59], v10 offset:26112
    s_waitcnt lgkmcnt(11)
    v_mfma_f32_16x16x32_bf16 a[4:7], v[60:63], v[72:75], a[4:7]
    ds_read_b64_tr_b16 v[60:61], v11 offset:23552
    ds_read_b64_tr_b16 v[62:63], v11 offset:26112
    s_waitcnt lgkmcnt(11)
    v_mfma_f32_16x16x32_bf16 a[8:11], v[64:67], v[72:75], a[8:11]
    ds_read_b64_tr_b16 v[64:65], v12 offset:23552
    ds_read_b64_tr_b16 v[66:67], v12 offset:26112
    s_waitcnt lgkmcnt(11)
    v_mfma_f32_16x16x32_bf16 a[12:15], v[68:71], v[72:75], a[12:15]
    ds_read_b64_tr_b16 v[68:69], v13 offset:23552
    ds_read_b64_tr_b16 v[70:71], v13 offset:26112
    s_waitcnt lgkmcnt(11)
    v_mfma_f32_16x16x32_bf16 a[16:19], v[48:51], v[72:75], a[16:19]
    s_waitcnt lgkmcnt(8)
    v_mfma_f32_16x16x32_bf16 a[0:3], v[52:55], v[76:79], a[0:3]
    s_waitcnt lgkmcnt(6)
    v_mfma_f32_16x16x32_bf16 a[4:7], v[56:59], v[76:79], a[4:7]
    s_waitcnt lgkmcnt(4)
    v_mfma_f32_16x16x32_bf16 a[8:11], v[60:63], v[76:79], a[8:11]
    s_waitcnt lgkmcnt(2)
    v_mfma_f32_16x16x32_bf16 a[12:15], v[64:67], v[76:79], a[12:15]
    s_waitcnt lgkmcnt(0)
    v_mfma_f32_16x16x32_bf16 a[16:19], v[68:71], v[76:79], a[16:19]
    s_barrier
    buffer_load_dwordx4 v[136:139], v132, s[20:23], 0 offen
    buffer_load_dwordx4 v[140:143], v133, s[20:23], 0 offen
    buffer_load_dwordx2 v[144:145], v144, s[28:31], 0 offen
    buffer_load_dwordx2 v[146:147], v146, s[28:31], 0 offen
    ds_read_b128 v[72:75], v23 offset:45056
    ds_read_b64_tr_b16 v[48:49], v9 offset:45056
    ds_read_b64_tr_b16 v[50:51], v9 offset:47616
    ds_read_b64_tr_b16 v[52:53], v10 offset:45056
    ds_read_b64_tr_b16 v[54:55], v10 offset:47616
    ds_read_b64_tr_b16 v[56:57], v11 offset:45056
    ds_read_b64_tr_b16 v[58:59], v11 offset:47616
    ds_read_b64_tr_b16 v[60:61], v12 offset:45056
    ds_read_b64_tr_b16 v[62:63], v12 offset:47616
    ds_read_b64_tr_b16 v[64:65], v13 offset:45056
    ds_read_b64_tr_b16 v[66:67], v13 offset:47616
    ds_read_b128 v[76:79], v24 offset:45056
    ds_read_b64_tr_b16 v[68:69], v9 offset:50176
    ds_read_b64_tr_b16 v[70:71], v9 offset:52736
    s_waitcnt lgkmcnt(11)
    v_mfma_f32_16x16x32_bf16 a[0:3], v[48:51], v[72:75], a[0:3]
    ds_read_b64_tr_b16 v[48:49], v10 offset:50176
    ds_read_b64_tr_b16 v[50:51], v10 offset:52736
    s_waitcnt lgkmcnt(11)
    v_mfma_f32_16x16x32_bf16 a[4:7], v[52:55], v[72:75], a[4:7]
    ds_read_b64_tr_b16 v[52:53], v11 offset:50176
    ds_read_b64_tr_b16 v[54:55], v11 offset:52736
    s_waitcnt lgkmcnt(11)
    v_mfma_f32_16x16x32_bf16 a[8:11], v[56:59], v[72:75], a[8:11]
    ds_read_b64_tr_b16 v[56:57], v12 offset:50176
    ds_read_b64_tr_b16 v[58:59], v12 offset:52736
    s_waitcnt lgkmcnt(11)
    v_mfma_f32_16x16x32_bf16 a[12:15], v[60:63], v[72:75], a[12:15]
    ds_read_b64_tr_b16 v[60:61], v13 offset:50176
    ds_read_b64_tr_b16 v[62:63], v13 offset:52736
    s_waitcnt lgkmcnt(11)
    v_mfma_f32_16x16x32_bf16 a[16:19], v[64:67], v[72:75], a[16:19]
    ds_read_b128 v[72:75], v25 offset:45056
    ds_read_b64_tr_b16 v[64:65], v9 offset:55296
    ds_read_b64_tr_b16 v[66:67], v9 offset:57856
    s_waitcnt lgkmcnt(11)
    v_mfma_f32_16x16x32_bf16 a[0:3], v[68:71], v[76:79], a[0:3]
    ds_read_b64_tr_b16 v[68:69], v10 offset:55296
    ds_read_b64_tr_b16 v[70:71], v10 offset:57856
    s_waitcnt lgkmcnt(11)
    v_mfma_f32_16x16x32_bf16 a[4:7], v[48:51], v[76:79], a[4:7]
    ds_read_b64_tr_b16 v[48:49], v11 offset:55296
    ds_read_b64_tr_b16 v[50:51], v11 offset:57856
    s_waitcnt lgkmcnt(11)
    v_mfma_f32_16x16x32_bf16 a[8:11], v[52:55], v[76:79], a[8:11]
    ds_read_b64_tr_b16 v[52:53], v12 offset:55296
    ds_read_b64_tr_b16 v[54:55], v12 offset:57856
    s_waitcnt lgkmcnt(11)
    v_mfma_f32_16x16x32_bf16 a[12:15], v[56:59], v[76:79], a[12:15]
    ds_read_b64_tr_b16 v[56:57], v13 offset:55296
    ds_read_b64_tr_b16 v[58:59], v13 offset:57856
    s_waitcnt lgkmcnt(11)
    v_mfma_f32_16x16x32_bf16 a[16:19], v[60:63], v[76:79], a[16:19]
    ds_read_b128 v[76:79], v26 offset:45056
    ds_read_b64_tr_b16 v[60:61], v9 offset:60416
    ds_read_b64_tr_b16 v[62:63], v9 offset:62976
    s_waitcnt lgkmcnt(11)
    v_mfma_f32_16x16x32_bf16 a[0:3], v[64:67], v[72:75], a[0:3]
    ds_read_b64_tr_b16 v[64:65], v10 offset:60416
    ds_read_b64_tr_b16 v[66:67], v10 offset:62976
    s_waitcnt lgkmcnt(11)
    v_mfma_f32_16x16x32_bf16 a[4:7], v[68:71], v[72:75], a[4:7]
    ds_read_b64_tr_b16 v[68:69], v11 offset:60416
    ds_read_b64_tr_b16 v[70:71], v11 offset:62976
    s_waitcnt lgkmcnt(11)
    v_mfma_f32_16x16x32_bf16 a[8:11], v[48:51], v[72:75], a[8:11]
    ds_read_b64_tr_b16 v[48:49], v12 offset:60416
    ds_read_b64_tr_b16 v[50:51], v12 offset:62976
    s_waitcnt lgkmcnt(11)
    v_mfma_f32_16x16x32_bf16 a[12:15], v[52:55], v[72:75], a[12:15]
    ds_read_b64_tr_b16 v[52:53], v13 offset:60416
    ds_read_b64_tr_b16 v[54:55], v13 offset:62976
    s_waitcnt lgkmcnt(11)
    v_mfma_f32_16x16x32_bf16 a[16:19], v[56:59], v[72:75], a[16:19]
    s_waitcnt lgkmcnt(8)
    v_mfma_f32_16x16x32_bf16 a[0:3], v[60:63], v[76:79], a[0:3]
    s_waitcnt lgkmcnt(6)
    v_mfma_f32_16x16x32_bf16 a[4:7], v[64:67], v[76:79], a[4:7]
    s_waitcnt lgkmcnt(4)
    v_mfma_f32_16x16x32_bf16 a[8:11], v[68:71], v[76:79], a[8:11]
    s_waitcnt lgkmcnt(2)
    v_mfma_f32_16x16x32_bf16 a[12:15], v[48:51], v[76:79], a[12:15]
    s_waitcnt lgkmcnt(0)
    v_mfma_f32_16x16x32_bf16 a[16:19], v[52:55], v[76:79], a[16:19]
    s_barrier
    ds_read_b128 v[72:75], v19 offset:0
    ds_read_b64_tr_b16 v[56:57], v4 offset:0
    ds_read_b64_tr_b16 v[58:59], v4 offset:2560
    ds_read_b64_tr_b16 v[60:61], v5 offset:0
    ds_read_b64_tr_b16 v[62:63], v5 offset:2560
    ds_read_b64_tr_b16 v[64:65], v6 offset:0
    ds_read_b64_tr_b16 v[66:67], v6 offset:2560
    ds_read_b64_tr_b16 v[68:69], v7 offset:0
    ds_read_b64_tr_b16 v[70:71], v7 offset:2560
    ds_read_b64_tr_b16 v[48:49], v8 offset:0
    ds_read_b64_tr_b16 v[50:51], v8 offset:2560
    ds_read_b128 v[76:79], v20 offset:0
    ds_read_b64_tr_b16 v[52:53], v4 offset:5120
    ds_read_b64_tr_b16 v[54:55], v4 offset:7680
    s_waitcnt lgkmcnt(11)
    v_mfma_f32_16x16x32_bf16 a[0:3], v[56:59], v[72:75], a[0:3]
    ds_read_b64_tr_b16 v[56:57], v5 offset:5120
    ds_read_b64_tr_b16 v[58:59], v5 offset:7680
    s_waitcnt lgkmcnt(11)
    v_mfma_f32_16x16x32_bf16 a[4:7], v[60:63], v[72:75], a[4:7]
    ds_read_b64_tr_b16 v[60:61], v6 offset:5120
    ds_read_b64_tr_b16 v[62:63], v6 offset:7680
    s_waitcnt lgkmcnt(11)
    v_mfma_f32_16x16x32_bf16 a[8:11], v[64:67], v[72:75], a[8:11]
    ds_read_b64_tr_b16 v[64:65], v7 offset:5120
    ds_read_b64_tr_b16 v[66:67], v7 offset:7680
    s_waitcnt lgkmcnt(11)
    v_mfma_f32_16x16x32_bf16 a[12:15], v[68:71], v[72:75], a[12:15]
    ds_read_b64_tr_b16 v[68:69], v8 offset:5120
    ds_read_b64_tr_b16 v[70:71], v8 offset:7680
    s_waitcnt lgkmcnt(11)
    v_mfma_f32_16x16x32_bf16 a[16:19], v[48:51], v[72:75], a[16:19]
    ds_read_b128 v[72:75], v21 offset:0
    ds_read_b64_tr_b16 v[48:49], v4 offset:10240
    ds_read_b64_tr_b16 v[50:51], v4 offset:12800
    s_waitcnt lgkmcnt(11)
    v_mfma_f32_16x16x32_bf16 a[0:3], v[52:55], v[76:79], a[0:3]
    ds_read_b64_tr_b16 v[52:53], v5 offset:10240
    ds_read_b64_tr_b16 v[54:55], v5 offset:12800
    s_waitcnt lgkmcnt(11)
    v_mfma_f32_16x16x32_bf16 a[4:7], v[56:59], v[76:79], a[4:7]
    ds_read_b64_tr_b16 v[56:57], v6 offset:10240
    ds_read_b64_tr_b16 v[58:59], v6 offset:12800
    s_waitcnt lgkmcnt(11)
    v_mfma_f32_16x16x32_bf16 a[8:11], v[60:63], v[76:79], a[8:11]
    ds_read_b64_tr_b16 v[60:61], v7 offset:10240
    ds_read_b64_tr_b16 v[62:63], v7 offset:12800
    s_waitcnt lgkmcnt(11)
    v_mfma_f32_16x16x32_bf16 a[12:15], v[64:67], v[76:79], a[12:15]
    ds_read_b64_tr_b16 v[64:65], v8 offset:10240
    ds_read_b64_tr_b16 v[66:67], v8 offset:12800
    s_waitcnt lgkmcnt(11)
    v_mfma_f32_16x16x32_bf16 a[16:19], v[68:71], v[76:79], a[16:19]
    ds_read_b128 v[76:79], v22 offset:0
    ds_read_b64_tr_b16 v[68:69], v4 offset:15360
    ds_read_b64_tr_b16 v[70:71], v4 offset:17920
    s_waitcnt lgkmcnt(11)
    v_mfma_f32_16x16x32_bf16 a[0:3], v[48:51], v[72:75], a[0:3]
    ds_read_b64_tr_b16 v[48:49], v5 offset:15360
    ds_read_b64_tr_b16 v[50:51], v5 offset:17920
    s_waitcnt lgkmcnt(11)
    v_mfma_f32_16x16x32_bf16 a[4:7], v[52:55], v[72:75], a[4:7]
    ds_read_b64_tr_b16 v[52:53], v6 offset:15360
    ds_read_b64_tr_b16 v[54:55], v6 offset:17920
    s_waitcnt lgkmcnt(11)
    v_mfma_f32_16x16x32_bf16 a[8:11], v[56:59], v[72:75], a[8:11]
    ds_read_b64_tr_b16 v[56:57], v7 offset:15360
    ds_read_b64_tr_b16 v[58:59], v7 offset:17920
    s_waitcnt lgkmcnt(11)
    v_mfma_f32_16x16x32_bf16 a[12:15], v[60:63], v[72:75], a[12:15]
    ds_read_b64_tr_b16 v[60:61], v8 offset:15360
    ds_read_b64_tr_b16 v[62:63], v8 offset:17920
    s_waitcnt lgkmcnt(11)
    v_mfma_f32_16x16x32_bf16 a[16:19], v[64:67], v[72:75], a[16:19]
    s_waitcnt lgkmcnt(8)
    v_mfma_f32_16x16x32_bf16 a[0:3], v[68:71], v[76:79], a[0:3]
    s_waitcnt lgkmcnt(6)
    v_mfma_f32_16x16x32_bf16 a[4:7], v[48:51], v[76:79], a[4:7]
    s_waitcnt lgkmcnt(4)
    v_mfma_f32_16x16x32_bf16 a[8:11], v[52:55], v[76:79], a[8:11]
    s_waitcnt lgkmcnt(2)
    v_mfma_f32_16x16x32_bf16 a[12:15], v[56:59], v[76:79], a[12:15]
    s_waitcnt lgkmcnt(0)
    v_mfma_f32_16x16x32_bf16 a[16:19], v[60:63], v[76:79], a[16:19]
    s_nop 7
    s_nop 1
    s_waitcnt lgkmcnt(0)
    s_barrier
    v_add_u32 v100, s56, v2
    v_mul_u32_u24 v100, 176, v100
    v_lshl_add_u32 v100, v3, 3, v100
    s_mul_i32 s37, s48, 32
    v_add_u32 v101, s37, v100
    v_accvgpr_read_b32 v104, a0
    v_accvgpr_read_b32 v105, a1
    v_accvgpr_read_b32 v106, a2
    v_accvgpr_read_b32 v107, a3
    v_cvt_pk_bf16_f32 v108, v104, v105
    v_cvt_pk_bf16_f32 v109, v106, v107
    ds_write_b64 v101, v[108:109] offset:0
    s_mul_i32 s37, s49, 32
    v_add_u32 v101, s37, v100
    v_accvgpr_read_b32 v104, a4
    v_accvgpr_read_b32 v105, a5
    v_accvgpr_read_b32 v106, a6
    v_accvgpr_read_b32 v107, a7
    v_cvt_pk_bf16_f32 v108, v104, v105
    v_cvt_pk_bf16_f32 v109, v106, v107
    ds_write_b64 v101, v[108:109] offset:0
    s_mul_i32 s37, s50, 32
    v_add_u32 v101, s37, v100
    v_accvgpr_read_b32 v104, a8
    v_accvgpr_read_b32 v105, a9
    v_accvgpr_read_b32 v106, a10
    v_accvgpr_read_b32 v107, a11
    v_cvt_pk_bf16_f32 v108, v104, v105
    v_cvt_pk_bf16_f32 v109, v106, v107
    ds_write_b64 v101, v[108:109] offset:0
    s_mul_i32 s37, s51, 32
    v_add_u32 v101, s37, v100
    v_accvgpr_read_b32 v104, a12
    v_accvgpr_read_b32 v105, a13
    v_accvgpr_read_b32 v106, a14
    v_accvgpr_read_b32 v107, a15
    v_cvt_pk_bf16_f32 v108, v104, v105
    v_cvt_pk_bf16_f32 v109, v106, v107
    ds_write_b64 v101, v[108:109] offset:0
    s_mul_i32 s37, s52, 32
    v_add_u32 v101, s37, v100
    v_accvgpr_read_b32 v104, a16
    v_accvgpr_read_b32 v105, a17
    v_accvgpr_read_b32 v106, a18
    v_accvgpr_read_b32 v107, a19
    v_cvt_pk_bf16_f32 v108, v104, v105
    v_cvt_pk_bf16_f32 v109, v106, v107
    ds_write_b64 v101, v[108:109] offset:0
    s_waitcnt lgkmcnt(0)
k5_kernel_phase2:
    s_barrier
    ds_read_b128 v[80:83], v134
    ds_read_b128 v[84:87], v135
    s_waitcnt vmcnt(0)
    s_waitcnt lgkmcnt(1)
    v_lshlrev_b32 v104, 16, v80
    v_and_b32 v105, 0xffff0000, v80
    v_lshlrev_b32 v106, 16, v81
    v_and_b32 v107, 0xffff0000, v81
    v_lshlrev_b32 v108, 16, v82
    v_and_b32 v109, 0xffff0000, v82
    v_lshlrev_b32 v110, 16, v83
    v_and_b32 v111, 0xffff0000, v83
    v_lshlrev_b32 v112, 16, v136
    v_and_b32 v113, 0xffff0000, v136
    v_lshlrev_b32 v114, 16, v137
    v_and_b32 v115, 0xffff0000, v137
    v_lshlrev_b32 v116, 16, v138
    v_and_b32 v117, 0xffff0000, v138
    v_lshlrev_b32 v118, 16, v139
    v_and_b32 v119, 0xffff0000, v139
    v_sub_f32 v112, v112, v144
    v_sub_f32 v113, v113, v144
    v_sub_f32 v114, v114, v144
    v_sub_f32 v115, v115, v144
    v_sub_f32 v116, v116, v144
    v_sub_f32 v117, v117, v144
    v_sub_f32 v118, v118, v144
    v_sub_f32 v119, v119, v144
    v_cvt_pk_bf16_f32 v120, v112, v113
    v_cvt_pk_bf16_f32 v121, v114, v115
    v_cvt_pk_bf16_f32 v122, v116, v117
    v_cvt_pk_bf16_f32 v123, v118, v119
    v_lshlrev_b32 v112, 16, v120
    v_and_b32 v113, 0xffff0000, v120
    v_lshlrev_b32 v114, 16, v121
    v_and_b32 v115, 0xffff0000, v121
    v_lshlrev_b32 v116, 16, v122
    v_and_b32 v117, 0xffff0000, v122
    v_lshlrev_b32 v118, 16, v123
    v_and_b32 v119, 0xffff0000, v123
    v_mul_f32 v112, v112, v145
    v_mul_f32 v113, v113, v145
    v_mul_f32 v114, v114, v145
    v_mul_f32 v115, v115, v145
    v_mul_f32 v116, v116, v145
    v_mul_f32 v117, v117, v145
    v_mul_f32 v118, v118, v145
    v_mul_f32 v119, v119, v145
    v_cvt_pk_bf16_f32 v120, v112, v113
    v_cvt_pk_bf16_f32 v121, v114, v115
    v_cvt_pk_bf16_f32 v122, v116, v117
    v_cvt_pk_bf16_f32 v123, v118, v119
    v_lshlrev_b32 v112, 16, v120
    v_and_b32 v113, 0xffff0000, v120
    v_lshlrev_b32 v114, 16, v121
    v_and_b32 v115, 0xffff0000, v121
    v_lshlrev_b32 v116, 16, v122
    v_and_b32 v117, 0xffff0000, v122
    v_lshlrev_b32 v118, 16, v123
    v_and_b32 v119, 0xffff0000, v123
    v_pk_add_f32 v[104:105], v[104:105], v[112:113]
    v_pk_add_f32 v[106:107], v[106:107], v[114:115]
    v_pk_add_f32 v[108:109], v[108:109], v[116:117]
    v_pk_add_f32 v[110:111], v[110:111], v[118:119]
    v_cvt_pk_bf16_f32 v80, v104, v105
    v_cvt_pk_bf16_f32 v81, v106, v107
    v_cvt_pk_bf16_f32 v82, v108, v109
    v_cvt_pk_bf16_f32 v83, v110, v111
    buffer_store_dwordx4 v[80:83], v132, s[16:19], 0 offen
    s_waitcnt lgkmcnt(0)
    v_lshlrev_b32 v104, 16, v84
    v_and_b32 v105, 0xffff0000, v84
    v_lshlrev_b32 v106, 16, v85
    v_and_b32 v107, 0xffff0000, v85
    v_lshlrev_b32 v108, 16, v86
    v_and_b32 v109, 0xffff0000, v86
    v_lshlrev_b32 v110, 16, v87
    v_and_b32 v111, 0xffff0000, v87
    v_lshlrev_b32 v112, 16, v140
    v_and_b32 v113, 0xffff0000, v140
    v_lshlrev_b32 v114, 16, v141
    v_and_b32 v115, 0xffff0000, v141
    v_lshlrev_b32 v116, 16, v142
    v_and_b32 v117, 0xffff0000, v142
    v_lshlrev_b32 v118, 16, v143
    v_and_b32 v119, 0xffff0000, v143
    v_sub_f32 v112, v112, v146
    v_sub_f32 v113, v113, v146
    v_sub_f32 v114, v114, v146
    v_sub_f32 v115, v115, v146
    v_sub_f32 v116, v116, v146
    v_sub_f32 v117, v117, v146
    v_sub_f32 v118, v118, v146
    v_sub_f32 v119, v119, v146
    v_cvt_pk_bf16_f32 v120, v112, v113
    v_cvt_pk_bf16_f32 v121, v114, v115
    v_cvt_pk_bf16_f32 v122, v116, v117
    v_cvt_pk_bf16_f32 v123, v118, v119
    v_lshlrev_b32 v112, 16, v120
    v_and_b32 v113, 0xffff0000, v120
    v_lshlrev_b32 v114, 16, v121
    v_and_b32 v115, 0xffff0000, v121
    v_lshlrev_b32 v116, 16, v122
    v_and_b32 v117, 0xffff0000, v122
    v_lshlrev_b32 v118, 16, v123
    v_and_b32 v119, 0xffff0000, v123
    v_mul_f32 v112, v112, v147
    v_mul_f32 v113, v113, v147
    v_mul_f32 v114, v114, v147
    v_mul_f32 v115, v115, v147
    v_mul_f32 v116, v116, v147
    v_mul_f32 v117, v117, v147
    v_mul_f32 v118, v118, v147
    v_mul_f32 v119, v119, v147
    v_cvt_pk_bf16_f32 v120, v112, v113
    v_cvt_pk_bf16_f32 v121, v114, v115
    v_cvt_pk_bf16_f32 v122, v116, v117
    v_cvt_pk_bf16_f32 v123, v118, v119
    v_lshlrev_b32 v112, 16, v120
    v_and_b32 v113, 0xffff0000, v120
    v_lshlrev_b32 v114, 16, v121
    v_and_b32 v115, 0xffff0000, v121
    v_lshlrev_b32 v116, 16, v122
    v_and_b32 v117, 0xffff0000, v122
    v_lshlrev_b32 v118, 16, v123
    v_and_b32 v119, 0xffff0000, v123
    v_pk_add_f32 v[104:105], v[104:105], v[112:113]
    v_pk_add_f32 v[106:107], v[106:107], v[114:115]
    v_pk_add_f32 v[108:109], v[108:109], v[116:117]
    v_pk_add_f32 v[110:111], v[110:111], v[118:119]
    v_cvt_pk_bf16_f32 v84, v104, v105
    v_cvt_pk_bf16_f32 v85, v106, v107
    v_cvt_pk_bf16_f32 v86, v108, v109
    v_cvt_pk_bf16_f32 v87, v110, v111
    buffer_store_dwordx4 v[84:87], v133, s[16:19], 0 offen
k5_kernel_end:
    s_endpgm
.p2align 8
.globl k6_kernel
.type k6_kernel,@function
k6_kernel:
    s_cmp_ge_u32 s2, 256
    s_cbranch_scc1 k6_kernel_end
    s_load_dwordx2 s[4:5], s[0:1], 80
    s_and_b32 s37, s2, 7
    s_lshr_b32 s38, s2, 3
    s_lshr_b32 s33, s38, 4
    s_and_b32 s34, s38, 15
    s_mul_i32 s37, s37, 2
    s_add_u32 s33, s33, s37
    s_mul_i32 s35, s33, 128
    s_mul_i32 s36, s34, 96
    v_and_b32 v1, 63, v0
    v_lshrrev_b32 v28, 6, v0
    v_and_b32 v2, 15, v0
    v_bfe_u32 v3, v0, 4, 2
    v_readfirstlane_b32 s43, v28
    s_and_b32 s32, s43, 3
    s_mul_i32 s56, s32, 32
    s_cmp_lt_u32 s43, 4
    s_cbranch_scc1 k6_kernel_cons
    v_lshrrev_b32 v28, 3, v1
    v_and_b32 v29, 7, v1
    v_add_u32 v28, s56, v28
    s_mov_b32 s38, 1280
    v_add_u32 v30, 0, v28
    v_bfe_u32 v31, v30, 1, 3
    v_xor_b32 v31, v31, v29
    v_add_u32 v30, s35, v30
    v_mul_lo_u32 v30, v30, s38
    v_lshl_add_u32 v4, v31, 4, v30
    v_add_u32 v30, 8, v28
    v_bfe_u32 v31, v30, 1, 3
    v_xor_b32 v31, v31, v29
    v_add_u32 v30, s35, v30
    v_mul_lo_u32 v30, v30, s38
    v_lshl_add_u32 v5, v31, 4, v30
    v_add_u32 v30, 16, v28
    v_bfe_u32 v31, v30, 1, 3
    v_xor_b32 v31, v31, v29
    v_add_u32 v30, s35, v30
    v_mul_lo_u32 v30, v30, s38
    v_lshl_add_u32 v6, v31, 4, v30
    v_add_u32 v30, 24, v28
    v_bfe_u32 v31, v30, 1, 3
    v_xor_b32 v31, v31, v29
    v_add_u32 v30, s35, v30
    v_mul_lo_u32 v30, v30, s38
    v_lshl_add_u32 v7, v31, 4, v30
    s_mul_i32 s37, s34, 122880
    s_mul_i32 s38, s32, 3072
    s_add_u32 s37, s37, s38
    v_lshl_add_u32 v8, v1, 4, s37
    s_waitcnt lgkmcnt(0)
    s_add_u32 s12, s4, 0x1cdc000
    s_addc_u32 s13, s5, 0
    s_and_b32 s13, s13, 0xffff
    s_mov_b32 s14, 0x1e0000
    s_mov_b32 s15, 0x00020000
    s_add_u32 s8, s4, 0x1200000
    s_addc_u32 s9, s5, 0
    s_and_b32 s9, s9, 0xffff
    s_mov_b32 s10, 0x280000
    s_mov_b32 s11, 0x00020000
    s_mul_i32 s39, s32, 4096
    s_mul_i32 s40, s32, 3072
    s_mov_b32 s46, 0x7ff00000
    s_mov_b32 s41, 0x0
    s_add_u32 m0, s39, 0x0
    s_nop 0
    buffer_load_dwordx4 v4, s[8:11], s41 offen lds
    s_add_u32 m0, s39, 0x400
    s_nop 0
    buffer_load_dwordx4 v5, s[8:11], s41 offen lds
    s_add_u32 m0, s39, 0x800
    s_nop 0
    buffer_load_dwordx4 v6, s[8:11], s41 offen lds
    s_add_u32 m0, s39, 0xc00
    s_nop 0
    buffer_load_dwordx4 v7, s[8:11], s41 offen lds
    s_add_u32 m0, s40, 0x4000
    s_mov_b32 s42, 0x0
    buffer_load_dwordx4 v8, s[12:15], s42 offen lds
    s_add_u32 m0, s40, 0x4400
    s_mov_b32 s42, 0x400
    buffer_load_dwordx4 v8, s[12:15], s42 offen lds
    s_add_u32 m0, s40, 0x4800
    s_mov_b32 s42, 0x800
    buffer_load_dwordx4 v8, s[12:15], s42 offen lds
    s_mov_b32 s41, 0x80
    s_add_u32 m0, s39, 0x7000
    s_nop 0
    buffer_load_dwordx4 v4, s[8:11], s41 offen lds
    s_add_u32 m0, s39, 0x7400
    s_nop 0
    buffer_load_dwordx4 v5, s[8:11], s41 offen lds
    s_add_u32 m0, s39, 0x7800
    s_nop 0
    buffer_load_dwordx4 v6, s[8:11], s41 offen lds
    s_add_u32 m0, s39, 0x7c00
    s_nop 0
    buffer_load_dwordx4 v7, s[8:11], s41 offen lds
    s_add_u32 m0, s40, 0xb000
    s_mov_b32 s42, 0x3000
    buffer_load_dwordx4 v8, s[12:15], s42 offen lds
    s_add_u32 m0, s40, 0xb400
    s_mov_b32 s42, 0x3400
    buffer_load_dwordx4 v8, s[12:15], s42 offen lds
    s_add_u32 m0, s40, 0xb800
    s_mov_b32 s42, 0x3800
    buffer_load_dwordx4 v8, s[12:15], s42 offen lds
    s_mov_b32 s41, 0x100
    s_add_u32 m0, s39, 0xe000
    s_nop 0
    buffer_load_dwordx4 v4, s[8:11], s41 offen lds
    s_add_u32 m0, s39, 0xe400
    s_nop 0
    buffer_load_dwordx4 v5, s[8:11], s41 offen lds
    s_add_u32 m0, s39, 0xe800
    s_nop 0
    buffer_load_dwordx4 v6, s[8:11], s41 offen lds
    s_add_u32 m0, s39, 0xec00
    s_nop 0
    buffer_load_dwordx4 v7, s[8:11], s41 offen lds
    s_add_u32 m0, s40, 0x12000
    s_mov_b32 s42, 0x6000
    buffer_load_dwordx4 v8, s[12:15], s42 offen lds
    s_add_u32 m0, s40, 0x12400
    s_mov_b32 s42, 0x6400
    buffer_load_dwordx4 v8, s[12:15], s42 offen lds
    s_add_u32 m0, s40, 0x12800
    s_mov_b32 s42, 0x6800
    buffer_load_dwordx4 v8, s[12:15], s42 offen lds
    s_mov_b32 s41, 0x180
    s_add_u32 m0, s39, 0x15000
    s_nop 0
    buffer_load_dwordx4 v4, s[8:11], s41 offen lds
    s_add_u32 m0, s39, 0x15400
    s_nop 0
    buffer_load_dwordx4 v5, s[8:11], s41 offen lds
    s_add_u32 m0, s39, 0x15800
    s_nop 0
    buffer_load_dwordx4 v6, s[8:11], s41 offen lds
    s_add_u32 m0, s39, 0x15c00
    s_nop 0
    buffer_load_dwordx4 v7, s[8:11], s41 offen lds
    s_add_u32 m0, s40, 0x19000
    s_mov_b32 s42, 0x9000
    buffer_load_dwordx4 v8, s[12:15], s42 offen lds
    s_add_u32 m0, s40, 0x19400
    s_mov_b32 s42, 0x9400
    buffer_load_dwordx4 v8, s[12:15], s42 offen lds
    s_add_u32 m0, s40, 0x19800
    s_mov_b32 s42, 0x9800
    buffer_load_dwordx4 v8, s[12:15], s42 offen lds
    s_add_u32 s16, s4, 0x1480000
    s_addc_u32 s17, s5, 0
    s_and_b32 s17, s17, 0xffff
    s_mov_b32 s18, 0x600000
    s_mov_b32 s19, 0x00020000
    s_mov_b32 s38, 5462
    s_mul_i32 s37, s43, 192
    v_add_u32 v28, s37, v1
    v_mul_lo_u32 v29, v28, s38
    v_lshrrev_b32 v29, 16, v29
    v_mul_u32_u24 v30, 12, v29
    v_sub_u32 v30, v28, v30
    v_mul_u32_u24 v31, 208, v29
    v_lshl_add_u32 v151, v30, 4, v31
    v_add_u32 v31, s35, v29
    v_mul_u32_u24 v31, 3072, v31
    v_lshl_add_u32 v31, v30, 4, v31
    v_lshl_add_u32 v148, s36, 1, v31
    v_add_u32 v28, s37, v1
    v_add_u32 v28, 64, v28
    v_mul_lo_u32 v29, v28, s38
    v_lshrrev_b32 v29, 16, v29
    v_mul_u32_u24 v30, 12, v29
    v_sub_u32 v30, v28, v30
    v_mul_u32_u24 v31, 208, v29
    v_lshl_add_u32 v152, v30, 4, v31
    v_add_u32 v31, s35, v29
    v_mul_u32_u24 v31, 3072, v31
    v_lshl_add_u32 v31, v30, 4, v31
    v_lshl_add_u32 v149, s36, 1, v31
    v_add_u32 v28, s37, v1
    v_add_u32 v28, 128, v28
    v_mul_lo_u32 v29, v28, s38
    v_lshrrev_b32 v29, 16, v29
    v_mul_u32_u24 v30, 12, v29
    v_sub_u32 v30, v28, v30
    v_mul_u32_u24 v31, 208, v29
    v_lshl_add_u32 v153, v30, 4, v31
    v_add_u32 v31, s35, v29
    v_mul_u32_u24 v31, 3072, v31
    v_lshl_add_u32 v31, v30, 4, v31
    v_lshl_add_u32 v150, s36, 1, v31
    s_waitcnt vmcnt(21)
    s_barrier
    s_mov_b32 s41, 0x200
    s_add_u32 m0, s39, 0x1c000
    s_nop 0
    buffer_load_dwordx4 v4, s[8:11], s41 offen lds
    s_add_u32 m0, s39, 0x1c400
    s_nop 0
    buffer_load_dwordx4 v5, s[8:11], s41 offen lds
    s_add_u32 m0, s39, 0x1c800
    s_nop 0
    buffer_load_dwordx4 v6, s[8:11], s41 offen lds
    s_add_u32 m0, s39, 0x1cc00
    s_nop 0
    buffer_load_dwordx4 v7, s[8:11], s41 offen lds
    s_add_u32 m0, s40, 0x20000
    s_mov_b32 s42, 0xc000
    buffer_load_dwordx4 v8, s[12:15], s42 offen lds
    s_add_u32 m0, s40, 0x20400
    s_mov_b32 s42, 0xc400
    buffer_load_dwordx4 v8, s[12:15], s42 offen lds
    s_add_u32 m0, s40, 0x20800
    s_mov_b32 s42, 0xc800
    buffer_load_dwordx4 v8, s[12:15], s42 offen lds
    s_waitcnt vmcnt(21)
    s_barrier
    s_mov_b32 s41, 0x280
    s_add_u32 m0, s39, 0x0
    s_nop 0
    buffer_load_dwordx4 v4, s[8:11], s41 offen lds
    s_add_u32 m0, s39, 0x400
    s_nop 0
    buffer_load_dwordx4 v5, s[8:11], s41 offen lds
    s_add_u32 m0, s39, 0x800
    s_nop 0
    buffer_load_dwordx4 v6, s[8:11], s41 offen lds
    s_add_u32 m0, s39, 0xc00
    s_nop 0
    buffer_load_dwordx4 v7, s[8:11], s41 offen lds
    s_add_u32 m0, s40, 0x4000
    s_mov_b32 s42, 0xf000
    buffer_load_dwordx4 v8, s[12:15], s42 offen lds
    s_add_u32 m0, s40, 0x4400
    s_mov_b32 s42, 0xf400
    buffer_load_dwordx4 v8, s[12:15], s42 offen lds
    s_add_u32 m0, s40, 0x4800
    s_mov_b32 s42, 0xf800
    buffer_load_dwordx4 v8, s[12:15], s42 offen lds
    s_waitcnt vmcnt(21)
    s_barrier
    s_mov_b32 s41, 0x300
    s_add_u32 m0, s39, 0x7000
    s_nop 0
    buffer_load_dwordx4 v4, s[8:11], s41 offen lds
    s_add_u32 m0, s39, 0x7400
    s_nop 0
    buffer_load_dwordx4 v5, s[8:11], s41 offen lds
    s_add_u32 m0, s39, 0x7800
    s_nop 0
    buffer_load_dwordx4 v6, s[8:11], s41 offen lds
    s_add_u32 m0, s39, 0x7c00
    s_nop 0
    buffer_load_dwordx4 v7, s[8:11], s41 offen lds
    s_add_u32 m0, s40, 0xb000
    s_mov_b32 s42, 0x12000
    buffer_load_dwordx4 v8, s[12:15], s42 offen lds
    s_add_u32 m0, s40, 0xb400
    s_mov_b32 s42, 0x12400
    buffer_load_dwordx4 v8, s[12:15], s42 offen lds
    s_add_u32 m0, s40, 0xb800
    s_mov_b32 s42, 0x12800
    buffer_load_dwordx4 v8, s[12:15], s42 offen lds
    s_waitcnt vmcnt(21)
    s_barrier
    s_mov_b32 s41, 0x380
    s_add_u32 m0, s39, 0xe000
    s_nop 0
    buffer_load_dwordx4 v4, s[8:11], s41 offen lds
    s_add_u32 m0, s39, 0xe400
    s_nop 0
    buffer_load_dwordx4 v5, s[8:11], s41 offen lds
    s_add_u32 m0, s39, 0xe800
    s_nop 0
    buffer_load_dwordx4 v6, s[8:11], s41 offen lds
    s_add_u32 m0, s39, 0xec00
    s_nop 0
    buffer_load_dwordx4 v7, s[8:11], s41 offen lds
    s_add_u32 m0, s40, 0x12000
    s_mov_b32 s42, 0x15000
    buffer_load_dwordx4 v8, s[12:15], s42 offen lds
    s_add_u32 m0, s40, 0x12400
    s_mov_b32 s42, 0x15400
    buffer_load_dwordx4 v8, s[12:15], s42 offen lds
    s_add_u32 m0, s40, 0x12800
    s_mov_b32 s42, 0x15800
    buffer_load_dwordx4 v8, s[12:15], s42 offen lds
    s_waitcnt vmcnt(21)
    s_barrier
    s_mov_b32 s41, 0x400
    s_add_u32 m0, s39, 0x15000
    s_nop 0
    buffer_load_dwordx4 v4, s[8:11], s41 offen lds
    s_add_u32 m0, s39, 0x15400
    s_nop 0
    buffer_load_dwordx4 v5, s[8:11], s41 offen lds
    s_add_u32 m0, s39, 0x15800
    s_nop 0
    buffer_load_dwordx4 v6, s[8:11], s41 offen lds
    s_add_u32 m0, s39, 0x15c00
    s_nop 0
    buffer_load_dwordx4 v7, s[8:11], s41 offen lds
    s_add_u32 m0, s40, 0x19000
    s_mov_b32 s42, 0x18000
    buffer_load_dwordx4 v8, s[12:15], s42 offen lds
    s_add_u32 m0, s40, 0x19400
    s_mov_b32 s42, 0x18400
    buffer_load_dwordx4 v8, s[12:15], s42 offen lds
    s_add_u32 m0, s40, 0x19800
    s_mov_b32 s42, 0x18800
    buffer_load_dwordx4 v8, s[12:15], s42 offen lds
    s_waitcnt vmcnt(21)
    s_barrier
    s_mov_b32 s41, 0x480
    s_add_u32 m0, s39, 0x1c000
    s_nop 0
    buffer_load_dwordx4 v4, s[8:11], s41 offen lds
    s_add_u32 m0, s39, 0x1c400
    s_nop 0
    buffer_load_dwordx4 v5, s[8:11], s41 offen lds
    s_add_u32 m0, s39, 0x1c800
    s_nop 0
    buffer_load_dwordx4 v6, s[8:11], s41 offen lds
    s_add_u32 m0, s39, 0x1cc00
    s_nop 0
    buffer_load_dwordx4 v7, s[8:11], s41 offen lds
    s_add_u32 m0, s40, 0x20000
    s_mov_b32 s42, 0x1b000
    buffer_load_dwordx4 v8, s[12:15], s42 offen lds
    s_add_u32 m0, s40, 0x20400
    s_mov_b32 s42, 0x1b400
    buffer_load_dwordx4 v8, s[12:15], s42 offen lds
    s_add_u32 m0, s40, 0x20800
    s_mov_b32 s42, 0x1b800
    buffer_load_dwordx4 v8, s[12:15], s42 offen lds
    s_waitcnt vmcnt(21)
    s_barrier
    s_waitcnt vmcnt(14)
    s_barrier
    s_waitcnt vmcnt(7)
    s_barrier
    s_waitcnt vmcnt(0)
    s_barrier
    s_barrier
    s_branch k6_kernel_phase2
k6_kernel_cons:
    s_waitcnt lgkmcnt(0)
    s_add_u32 s16, s4, 0x1480000
    s_addc_u32 s17, s5, 0
    s_and_b32 s17, s17, 0xffff
    s_mov_b32 s18, 0x600000
    s_mov_b32 s19, 0x00020000
    s_mul_i32 s48, s32, 2
    s_add_u32 s48, s48, 0
    s_cmp_ge_u32 s48, 6
    s_cselect_b32 s37, 6, 0
    s_sub_u32 s48, s48, s37
    s_mul_i32 s49, s32, 2
    s_add_u32 s49, s49, 1
    s_cmp_ge_u32 s49, 6
    s_cselect_b32 s37, 6, 0
    s_sub_u32 s49, s49, s37
    s_mul_i32 s50, s32, 2
    s_add_u32 s50, s50, 2
    s_cmp_ge_u32 s50, 6
    s_cselect_b32 s37, 6, 0
    s_sub_u32 s50, s50, s37
    s_mul_i32 s51, s32, 2
    s_add_u32 s51, s51, 3
    s_cmp_ge_u32 s51, 6
    s_cselect_b32 s37, 6, 0
    s_sub_u32 s51, s51, s37
    s_mul_i32 s52, s32, 2
    s_add_u32 s52, s52, 4
    s_cmp_ge_u32 s52, 6
    s_cselect_b32 s37, 6, 0
    s_sub_u32 s52, s52, s37
    s_mul_i32 s53, s32, 2
    s_add_u32 s53, s53, 5
    s_cmp_ge_u32 s53, 6
    s_cselect_b32 s37, 6, 0
    s_sub_u32 s53, s53, s37
    v_lshrrev_b32 v28, 2, v2
    v_lshl_add_u32 v29, v3, 2, v28
    v_mul_u32_u24 v30, 192, v29
    v_and_b32 v31, 3, v2
    v_lshl_add_u32 v30, v31, 3, v30
    v_add_u32 v30, 16384, v30
    v_and_b32 v29, 7, v29
    v_lshrrev_b32 v31, 2, v29
    v_add_u32 v31, s48, v31
    v_subrev_u32 v32, 6, v31
    v_min_u32 v31, v31, v32
    v_lshl_add_u32 v4, v31, 5, v30
    v_lshrrev_b32 v31, 2, v29
    v_add_u32 v31, s49, v31
    v_subrev_u32 v32, 6, v31
    v_min_u32 v31, v31, v32
    v_lshl_add_u32 v5, v31, 5, v30
    v_lshrrev_b32 v31, 2, v29
    v_add_u32 v31, s50, v31
    v_subrev_u32 v32, 6, v31
    v_min_u32 v31, v31, v32
    v_lshl_add_u32 v6, v31, 5, v30
    v_lshrrev_b32 v31, 2, v29
    v_add_u32 v31, s51, v31
    v_subrev_u32 v32, 6, v31
    v_min_u32 v31, v31, v32
    v_lshl_add_u32 v7, v31, 5, v30
    v_lshrrev_b32 v31, 2, v29
    v_add_u32 v31, s52, v31
    v_subrev_u32 v32, 6, v31
    v_min_u32 v31, v31, v32
    v_lshl_add_u32 v8, v31, 5, v30
    v_lshrrev_b32 v31, 2, v29
    v_add_u32 v31, s53, v31
    v_subrev_u32 v32, 6, v31
    v_min_u32 v31, v31, v32
    v_lshl_add_u32 v9, v31, 5, v30
    v_add_u32 v28, s56, v2
    v_mul_u32_u24 v28, 128, v28
    v_lshrrev_b32 v29, 1, v2
    v_xor_b32 v29, v29, v3
    v_xor_b32 v30, 0, v29
    v_lshl_add_u32 v22, v30, 4, v28
    v_xor_b32 v30, 4, v29
    v_lshl_add_u32 v23, v30, 4, v28
    v_add_u32 v10, 0x10000, v4
    v_add_u32 v11, 0x10000, v5
    v_add_u32 v12, 0x10000, v6
    v_add_u32 v13, 0x10000, v7
    v_add_u32 v14, 0x10000, v8
    v_add_u32 v15, 0x10000, v9
    v_add_u32 v24, 0x10000, v22
    v_add_u32 v25, 0x10000, v23
    v_add_u32 v16, 0x20000, v4
    v_add_u32 v17, 0x20000, v5
    v_add_u32 v18, 0x20000, v6
    v_add_u32 v19, 0x20000, v7
    v_add_u32 v20, 0x20000, v8
    v_add_u32 v21, 0x20000, v9
    v_add_u32 v26, 0x20000, v22
    v_add_u32 v27, 0x20000, v23
    v_mov_b32 v40, 0x3f803f80
    v_mov_b32 v41, 0x3f803f80
    v_mov_b32 v42, 0x3f803f80
    v_mov_b32 v43, 0x3f803f80
    v_accvgpr_write_b32 a0, 0
    v_accvgpr_write_b32 a1, 0
    v_accvgpr_write_b32 a2, 0
    v_accvgpr_write_b32 a3, 0
    v_accvgpr_write_b32 a4, 0
    v_accvgpr_write_b32 a5, 0
    v_accvgpr_write_b32 a6, 0
    v_accvgpr_write_b32 a7, 0
    v_accvgpr_write_b32 a8, 0
    v_accvgpr_write_b32 a9, 0
    v_accvgpr_write_b32 a10, 0
    v_accvgpr_write_b32 a11, 0
    v_accvgpr_write_b32 a12, 0
    v_accvgpr_write_b32 a13, 0
    v_accvgpr_write_b32 a14, 0
    v_accvgpr_write_b32 a15, 0
    v_accvgpr_write_b32 a16, 0
    v_accvgpr_write_b32 a17, 0
    v_accvgpr_write_b32 a18, 0
    v_accvgpr_write_b32 a19, 0
    v_accvgpr_write_b32 a20, 0
    v_accvgpr_write_b32 a21, 0
    v_accvgpr_write_b32 a22, 0
    v_accvgpr_write_b32 a23, 0
    v_accvgpr_write_b32 a24, 0
    v_accvgpr_write_b32 a25, 0
    v_accvgpr_write_b32 a26, 0
    v_accvgpr_write_b32 a27, 0
    v_accvgpr_write_b32 a28, 0
    v_accvgpr_write_b32 a29, 0
    v_accvgpr_write_b32 a30, 0
    v_accvgpr_write_b32 a31, 0
    v_accvgpr_write_b32 a32, 0
    v_accvgpr_write_b32 a33, 0
    v_accvgpr_write_b32 a34, 0
    v_accvgpr_write_b32 a35, 0
    v_accvgpr_write_b32 a36, 0
    v_accvgpr_write_b32 a37, 0
    v_accvgpr_write_b32 a38, 0
    v_accvgpr_write_b32 a39, 0
    v_accvgpr_write_b32 a40, 0
    v_accvgpr_write_b32 a41, 0
    v_accvgpr_write_b32 a42, 0
    v_accvgpr_write_b32 a43, 0
    v_accvgpr_write_b32 a44, 0
    v_accvgpr_write_b32 a45, 0
    v_accvgpr_write_b32 a46, 0
    v_accvgpr_write_b32 a47, 0
    v_accvgpr_write_b32 a48, 0
    v_accvgpr_write_b32 a49, 0
    v_accvgpr_write_b32 a50, 0
    v_accvgpr_write_b32 a51, 0
    v_accvgpr_write_b32 a52, 0
    v_accvgpr_write_b32 a53, 0
    v_accvgpr_write_b32 a54, 0
    v_accvgpr_write_b32 a55, 0
    v_accvgpr_write_b32 a56, 0
    v_accvgpr_write_b32 a57, 0
    v_accvgpr_write_b32 a58, 0
    v_accvgpr_write_b32 a59, 0
    v_accvgpr_write_b32 a60, 0
    v_accvgpr_write_b32 a61, 0
    v_accvgpr_write_b32 a62, 0
    v_accvgpr_write_b32 a63, 0
    v_accvgpr_write_b32 a64, 0
    v_accvgpr_write_b32 a65, 0
    v_accvgpr_write_b32 a66, 0
    v_accvgpr_write_b32 a67, 0
    v_accvgpr_write_b32 a68, 0
    v_accvgpr_write_b32 a69, 0
    v_accvgpr_write_b32 a70, 0
    v_accvgpr_write_b32 a71, 0
    s_mov_b32 s38, 5462
    s_mul_i32 s37, s43, 192
    v_add_u32 v28, s37, v1
    v_mul_lo_u32 v29, v28, s38
    v_lshrrev_b32 v29, 16, v29
    v_mul_u32_u24 v30, 12, v29
    v_sub_u32 v30, v28, v30
    v_mul_u32_u24 v31, 208, v29
    v_lshl_add_u32 v151, v30, 4, v31
    v_add_u32 v31, s35, v29
    v_mul_u32_u24 v31, 3072, v31
    v_lshl_add_u32 v31, v30, 4, v31
    v_lshl_add_u32 v148, s36, 1, v31
    v_add_u32 v28, s37, v1
    v_add_u32 v28, 64, v28
    v_mul_lo_u32 v29, v28, s38
    v_lshrrev_b32 v29, 16, v29
    v_mul_u32_u24 v30, 12, v29
    v_sub_u32 v30, v28, v30
    v_mul_u32_u24 v31, 208, v29
    v_lshl_add_u32 v152, v30, 4, v31
    v_add_u32 v31, s35, v29
    v_mul_u32_u24 v31, 3072, v31
    v_lshl_add_u32 v31, v30, 4, v31
    v_lshl_add_u32 v149, s36, 1, v31
    v_add_u32 v28, s37, v1
    v_add_u32 v28, 128, v28
    v_mul_lo_u32 v29, v28, s38
    v_lshrrev_b32 v29, 16, v29
    v_mul_u32_u24 v30, 12, v29
    v_sub_u32 v30, v28, v30
    v_mul_u32_u24 v31, 208, v29
    v_lshl_add_u32 v153, v30, 4, v31
    v_add_u32 v31, s35, v29
    v_mul_u32_u24 v31, 3072, v31
    v_lshl_add_u32 v31, v30, 4, v31
    v_lshl_add_u32 v150, s36, 1, v31
    s_barrier
    ds_read_b128 v[68:71], v22 offset:0
    ds_read_b128 v[72:75], v22 offset:2048
    ds_read_b64_tr_b16 v[44:45], v4 offset:0
    ds_read_b64_tr_b16 v[46:47], v4 offset:3072
    ds_read_b64_tr_b16 v[48:49], v5 offset:0
    ds_read_b64_tr_b16 v[50:51], v5 offset:3072
    ds_read_b64_tr_b16 v[52:53], v6 offset:0
    ds_read_b64_tr_b16 v[54:55], v6 offset:3072
    ds_read_b64_tr_b16 v[56:57], v7 offset:0
    ds_read_b64_tr_b16 v[58:59], v7 offset:3072
    ds_read_b64_tr_b16 v[60:61], v8 offset:0
    ds_read_b64_tr_b16 v[62:63], v8 offset:3072
    ds_read_b64_tr_b16 v[64:65], v9 offset:0
    ds_read_b64_tr_b16 v[66:67], v9 offset:3072
    s_waitcnt lgkmcnt(10)
    v_mfma_f32_16x16x32_bf16 a[0:3], v[44:47], v[68:71], a[0:3]
    v_mfma_f32_16x16x32_bf16 a[24:27], v[44:47], v[72:75], a[24:27]
    v_mfma_f32_16x16x32_bf16 a[48:51], v[44:47], v[40:43], a[48:51]
    ds_read_b128 v[76:79], v23 offset:0
    ds_read_b128 v[80:83], v23 offset:2048
    ds_read_b64_tr_b16 v[44:45], v4 offset:6144
    ds_read_b64_tr_b16 v[46:47], v4 offset:9216
    s_waitcnt lgkmcnt(12)
    v_mfma_f32_16x16x32_bf16 a[4:7], v[48:51], v[68:71], a[4:7]
    v_mfma_f32_16x16x32_bf16 a[28:31], v[48:51], v[72:75], a[28:31]
    v_mfma_f32_16x16x32_bf16 a[52:55], v[48:51], v[40:43], a[52:55]
    ds_read_b64_tr_b16 v[48:49], v5 offset:6144
    ds_read_b64_tr_b16 v[50:51], v5 offset:9216
    s_waitcnt lgkmcnt(12)
    v_mfma_f32_16x16x32_bf16 a[8:11], v[52:55], v[68:71], a[8:11]
    v_mfma_f32_16x16x32_bf16 a[32:35], v[52:55], v[72:75], a[32:35]
    v_mfma_f32_16x16x32_bf16 a[56:59], v[40:43], v[68:71], a[56:59]
    v_mfma_f32_16x16x32_bf16 a[60:63], v[40:43], v[72:75], a[60:63]
    ds_read_b64_tr_b16 v[52:53], v6 offset:6144
    ds_read_b64_tr_b16 v[54:55], v6 offset:9216
    s_waitcnt lgkmcnt(12)
    v_mfma_f32_16x16x32_bf16 a[12:15], v[56:59], v[68:71], a[12:15]
    v_mfma_f32_16x16x32_bf16 a[36:39], v[56:59], v[72:75], a[36:39]
    v_mfma_f32_16x16x32_bf16 a[64:67], v[68:71], v[68:71], a[64:67]
    v_mfma_f32_16x16x32_bf16 a[68:71], v[72:75], v[72:75], a[68:71]
    ds_read_b64_tr_b16 v[56:57], v7 offset:6144
    ds_read_b64_tr_b16 v[58:59], v7 offset:9216
    s_waitcnt lgkmcnt(12)
    v_mfma_f32_16x16x32_bf16 a[16:19], v[60:63], v[68:71], a[16:19]
    v_mfma_f32_16x16x32_bf16 a[40:43], v[60:63], v[72:75], a[40:43]
    ds_read_b64_tr_b16 v[60:61], v8 offset:6144
    ds_read_b64_tr_b16 v[62:63], v8 offset:9216
    s_waitcnt lgkmcnt(12)
    v_mfma_f32_16x16x32_bf16 a[20:23], v[64:67], v[68:71], a[20:23]
    v_mfma_f32_16x16x32_bf16 a[44:47], v[64:67], v[72:75], a[44:47]
    ds_read_b64_tr_b16 v[64:65], v9 offset:6144
    ds_read_b64_tr_b16 v[66:67], v9 offset:9216
    s_waitcnt lgkmcnt(10)
    v_mfma_f32_16x16x32_bf16 a[0:3], v[44:47], v[76:79], a[0:3]
    v_mfma_f32_16x16x32_bf16 a[24:27], v[44:47], v[80:83], a[24:27]
    v_mfma_f32_16x16x32_bf16 a[48:51], v[44:47], v[40:43], a[48:51]
    s_barrier
    ds_read_b128 v[68:71], v22 offset:28672
    ds_read_b128 v[72:75], v22 offset:30720
    ds_read_b64_tr_b16 v[44:45], v4 offset:28672
    ds_read_b64_tr_b16 v[46:47], v4 offset:31744
    s_waitcnt lgkmcnt(12)
    v_mfma_f32_16x16x32_bf16 a[4:7], v[48:51], v[76:79], a[4:7]
    v_mfma_f32_16x16x32_bf16 a[28:31], v[48:51], v[80:83], a[28:31]
    v_mfma_f32_16x16x32_bf16 a[52:55], v[48:51], v[40:43], a[52:55]
    ds_read_b64_tr_b16 v[48:49], v5 offset:28672
    ds_read_b64_tr_b16 v[50:51], v5 offset:31744
    s_waitcnt lgkmcnt(12)
    v_mfma_f32_16x16x32_bf16 a[8:11], v[52:55], v[76:79], a[8:11]
    v_mfma_f32_16x16x32_bf16 a[32:35], v[52:55], v[80:83], a[32:35]
    v_mfma_f32_16x16x32_bf16 a[56:59], v[40:43], v[76:79], a[56:59]
    v_mfma_f32_16x16x32_bf16 a[60:63], v[40:43], v[80:83], a[60:63]
    ds_read_b64_tr_b16 v[52:53], v6 offset:28672
    ds_read_b64_tr_b16 v[54:55], v6 offset:31744
    s_waitcnt lgkmcnt(12)
    v_mfma_f32_16x16x32_bf16 a[12:15], v[56:59], v[76:79], a[12:15]
    v_mfma_f32_16x16x32_bf16 a[36:39], v[56:59], v[80:83], a[36:39]
    v_mfma_f32_16x16x32_bf16 a[64:67], v[76:79], v[76:79], a[64:67]
    v_mfma_f32_16x16x32_bf16 a[68:71], v[80:83], v[80:83], a[68:71]
    ds_read_b64_tr_b16 v[56:57], v7 offset:28672
    ds_read_b64_tr_b16 v[58:59], v7 offset:31744
    s_waitcnt lgkmcnt(12)
    v_mfma_f32_16x16x32_bf16 a[16:19], v[60:63], v[76:79], a[16:19]
    v_mfma_f32_16x16x32_bf16 a[40:43], v[60:63], v[80:83], a[40:43]
    ds_read_b64_tr_b16 v[60:61], v8 offset:28672
    ds_read_b64_tr_b16 v[62:63], v8 offset:31744
    s_waitcnt lgkmcnt(12)
    v_mfma_f32_16x16x32_bf16 a[20:23], v[64:67], v[76:79], a[20:23]
    v_mfma_f32_16x16x32_bf16 a[44:47], v[64:67], v[80:83], a[44:47]
    ds_read_b64_tr_b16 v[64:65], v9 offset:28672
    ds_read_b64_tr_b16 v[66:67], v9 offset:31744
    s_waitcnt lgkmcnt(10)
    v_mfma_f32_16x16x32_bf16 a[0:3], v[44:47], v[68:71], a[0:3]
    v_mfma_f32_16x16x32_bf16 a[24:27], v[44:47], v[72:75], a[24:27]
    v_mfma_f32_16x16x32_bf16 a[48:51], v[44:47], v[40:43], a[48:51]
    ds_read_b128 v[76:79], v23 offset:28672
    ds_read_b128 v[80:83], v23 offset:30720
    ds_read_b64_tr_b16 v[44:45], v4 offset:34816
    ds_read_b64_tr_b16 v[46:47], v4 offset:37888
    s_waitcnt lgkmcnt(12)
    v_mfma_f32_16x16x32_bf16 a[4:7], v[48:51], v[68:71], a[4:7]
    v_mfma_f32_16x16x32_bf16 a[28:31], v[48:51], v[72:75], a[28:31]
    v_mfma_f32_16x16x32_bf16 a[52:55], v[48:51], v[40:43], a[52:55]
    ds_read_b64_tr_b16 v[48:49], v5 offset:34816
    ds_read_b64_tr_b16 v[50:51], v5 offset:37888
    s_waitcnt lgkmcnt(12)
    v_mfma_f32_16x16x32_bf16 a[8:11], v[52:55], v[68:71], a[8:11]
    v_mfma_f32_16x16x32_bf16 a[32:35], v[52:55], v[72:75], a[32:35]
    v_mfma_f32_16x16x32_bf16 a[56:59], v[40:43], v[68:71], a[56:59]
    v_mfma_f32_16x16x32_bf16 a[60:63], v[40:43], v[72:75], a[60:63]
    ds_read_b64_tr_b16 v[52:53], v6 offset:34816
    ds_read_b64_tr_b16 v[54:55], v6 offset:37888
    s_waitcnt lgkmcnt(12)
    v_mfma_f32_16x16x32_bf16 a[12:15], v[56:59], v[68:71], a[12:15]
    v_mfma_f32_16x16x32_bf16 a[36:39], v[56:59], v[72:75], a[36:39]
    v_mfma_f32_16x16x32_bf16 a[64:67], v[68:71], v[68:71], a[64:67]
    v_mfma_f32_16x16x32_bf16 a[68:71], v[72:75], v[72:75], a[68:71]
    ds_read_b64_tr_b16 v[56:57], v7 offset:34816
    ds_read_b64_tr_b16 v[58:59], v7 offset:37888
    s_waitcnt lgkmcnt(12)
    v_mfma_f32_16x16x32_bf16 a[16:19], v[60:63], v[68:71], a[16:19]
    v_mfma_f32_16x16x32_bf16 a[40:43], v[60:63], v[72:75], a[40:43]
    ds_read_b64_tr_b16 v[60:61], v8 offset:34816
    ds_read_b64_tr_b16 v[62:63], v8 offset:37888
    s_waitcnt lgkmcnt(12)
    v_mfma_f32_16x16x32_bf16 a[20:23], v[64:67], v[68:71], a[20:23]
    v_mfma_f32_16x16x32_bf16 a[44:47], v[64:67], v[72:75], a[44:47]
    ds_read_b64_tr_b16 v[64:65], v9 offset:34816
    ds_read_b64_tr_b16 v[66:67], v9 offset:37888
    s_waitcnt lgkmcnt(10)
    v_mfma_f32_16x16x32_bf16 a[0:3], v[44:47], v[76:79], a[0:3]
    v_mfma_f32_16x16x32_bf16 a[24:27], v[44:47], v[80:83], a[24:27]
    v_mfma_f32_16x16x32_bf16 a[48:51], v[44:47], v[40:43], a[48:51]
    s_barrier
    ds_read_b128 v[68:71], v22 offset:57344
    ds_read_b128 v[72:75], v22 offset:59392
    ds_read_b64_tr_b16 v[44:45], v4 offset:57344
    ds_read_b64_tr_b16 v[46:47], v4 offset:60416
    s_waitcnt lgkmcnt(12)
    v_mfma_f32_16x16x32_bf16 a[4:7], v[48:51], v[76:79], a[4:7]
    v_mfma_f32_16x16x32_bf16 a[28:31], v[48:51], v[80:83], a[28:31]
    v_mfma_f32_16x16x32_bf16 a[52:55], v[48:51], v[40:43], a[52:55]
    ds_read_b64_tr_b16 v[48:49], v5 offset:57344
    ds_read_b64_tr_b16 v[50:51], v5 offset:60416
    s_waitcnt lgkmcnt(12)
    v_mfma_f32_16x16x32_bf16 a[8:11], v[52:55], v[76:79], a[8:11]
    v_mfma_f32_16x16x32_bf16 a[32:35], v[52:55], v[80:83], a[32:35]
    v_mfma_f32_16x16x32_bf16 a[56:59], v[40:43], v[76:79], a[56:59]
    v_mfma_f32_16x16x32_bf16 a[60:63], v[40:43], v[80:83], a[60:63]
    ds_read_b64_tr_b16 v[52:53], v6 offset:57344
    ds_read_b64_tr_b16 v[54:55], v6 offset:60416
    s_waitcnt lgkmcnt(12)
    v_mfma_f32_16x16x32_bf16 a[12:15], v[56:59], v[76:79], a[12:15]
    v_mfma_f32_16x16x32_bf16 a[36:39], v[56:59], v[80:83], a[36:39]
    v_mfma_f32_16x16x32_bf16 a[64:67], v[76:79], v[76:79], a[64:67]
    v_mfma_f32_16x16x32_bf16 a[68:71], v[80:83], v[80:83], a[68:71]
    ds_read_b64_tr_b16 v[56:57], v7 offset:57344
    ds_read_b64_tr_b16 v[58:59], v7 offset:60416
    s_waitcnt lgkmcnt(12)
    v_mfma_f32_16x16x32_bf16 a[16:19], v[60:63], v[76:79], a[16:19]
    v_mfma_f32_16x16x32_bf16 a[40:43], v[60:63], v[80:83], a[40:43]
    ds_read_b64_tr_b16 v[60:61], v8 offset:57344
    ds_read_b64_tr_b16 v[62:63], v8 offset:60416
    s_waitcnt lgkmcnt(12)
    v_mfma_f32_16x16x32_bf16 a[20:23], v[64:67], v[76:79], a[20:23]
    v_mfma_f32_16x16x32_bf16 a[44:47], v[64:67], v[80:83], a[44:47]
    ds_read_b64_tr_b16 v[64:65], v9 offset:57344
    ds_read_b64_tr_b16 v[66:67], v9 offset:60416
    s_waitcnt lgkmcnt(10)
    v_mfma_f32_16x16x32_bf16 a[0:3], v[44:47], v[68:71], a[0:3]
    v_mfma_f32_16x16x32_bf16 a[24:27], v[44:47], v[72:75], a[24:27]
    v_mfma_f32_16x16x32_bf16 a[48:51], v[44:47], v[40:43], a[48:51]
    ds_read_b128 v[76:79], v23 offset:57344
    ds_read_b128 v[80:83], v23 offset:59392
    ds_read_b64_tr_b16 v[44:45], v4 offset:63488
    ds_read_b64_tr_b16 v[46:47], v10 offset:1024
    s_waitcnt lgkmcnt(12)
    v_mfma_f32_16x16x32_bf16 a[4:7], v[48:51], v[68:71], a[4:7]
    v_mfma_f32_16x16x32_bf16 a[28:31], v[48:51], v[72:75], a[28:31]
    v_mfma_f32_16x16x32_bf16 a[52:55], v[48:51], v[40:43], a[52:55]
    ds_read_b64_tr_b16 v[48:49], v5 offset:63488
    ds_read_b64_tr_b16 v[50:51], v11 offset:1024
    s_waitcnt lgkmcnt(12)
    v_mfma_f32_16x16x32_bf16 a[8:11], v[52:55], v[68:71], a[8:11]
    v_mfma_f32_16x16x32_bf16 a[32:35], v[52:55], v[72:75], a[32:35]
    v_mfma_f32_16x16x32_bf16 a[56:59], v[40:43], v[68:71], a[56:59]
    v_mfma_f32_16x16x32_bf16 a[60:63], v[40:43], v[72:75], a[60:63]
    ds_read_b64_tr_b16 v[52:53], v6 offset:63488
    ds_read_b64_tr_b16 v[54:55], v12 offset:1024
    s_waitcnt lgkmcnt(12)
    v_mfma_f32_16x16x32_bf16 a[12:15], v[56:59], v[68:71], a[12:15]
    v_mfma_f32_16x16x32_bf16 a[36:39], v[56:59], v[72:75], a[36:39]
    v_mfma_f32_16x16x32_bf16 a[64:67], v[68:71], v[68:71], a[64:67]
    v_mfma_f32_16x16x32_bf16 a[68:71], v[72:75], v[72:75], a[68:71]
    ds_read_b64_tr_b16 v[56:57], v7 offset:63488
    ds_read_b64_tr_b16 v[58:59], v13 offset:1024
    s_waitcnt lgkmcnt(12)
    v_mfma_f32_16x16x32_bf16 a[16:19], v[60:63], v[68:71], a[16:19]
    v_mfma_f32_16x16x32_bf16 a[40:43], v[60:63], v[72:75], a[40:43]
    ds_read_b64_tr_b16 v[60:61], v8 offset:63488
    ds_read_b64_tr_b16 v[62:63], v14 offset:1024
    s_waitcnt lgkmcnt(12)
    v_mfma_f32_16x16x32_bf16 a[20:23], v[64:67], v[68:71], a[20:23]
    v_mfma_f32_16x16x32_bf16 a[44:47], v[64:67], v[72:75], a[44:47]
    ds_read_b64_tr_b16 v[64:65], v9 offset:63488
    ds_read_b64_tr_b16 v[66:67], v15 offset:1024
    s_waitcnt lgkmcnt(10)
    v_mfma_f32_16x16x32_bf16 a[0:3], v[44:47], v[76:79], a[0:3]
    v_mfma_f32_16x16x32_bf16 a[24:27], v[44:47], v[80:83], a[24:27]
    v_mfma_f32_16x16x32_bf16 a[48:51], v[44:47], v[40:43], a[48:51]
    s_barrier
    ds_read_b128 v[68:71], v24 offset:20480
    ds_read_b128 v[72:75], v24 offset:22528
    ds_read_b64_tr_b16 v[44:45], v10 offset:20480
    ds_read_b64_tr_b16 v[46:47], v10 offset:23552
    s_waitcnt lgkmcnt(12)
    v_mfma_f32_16x16x32_bf16 a[4:7], v[48:51], v[76:79], a[4:7]
    v_mfma_f32_16x16x32_bf16 a[28:31], v[48:51], v[80:83], a[28:31]
    v_mfma_f32_16x16x32_bf16 a[52:55], v[48:51], v[40:43], a[52:55]
    ds_read_b64_tr_b16 v[48:49], v11 offset:20480
    ds_read_b64_tr_b16 v[50:51], v11 offset:23552
    s_waitcnt lgkmcnt(12)
    v_mfma_f32_16x16x32_bf16 a[8:11], v[52:55], v[76:79], a[8:11]
    v_mfma_f32_16x16x32_bf16 a[32:35], v[52:55], v[80:83], a[32:35]
    v_mfma_f32_16x16x32_bf16 a[56:59], v[40:43], v[76:79], a[56:59]
    v_mfma_f32_16x16x32_bf16 a[60:63], v[40:43], v[80:83], a[60:63]
    ds_read_b64_tr_b16 v[52:53], v12 offset:20480
    ds_read_b64_tr_b16 v[54:55], v12 offset:23552
    s_waitcnt lgkmcnt(12)
    v_mfma_f32_16x16x32_bf16 a[12:15], v[56:59], v[76:79], a[12:15]
    v_mfma_f32_16x16x32_bf16 a[36:39], v[56:59], v[80:83], a[36:39]
    v_mfma_f32_16x16x32_bf16 a[64:67], v[76:79], v[76:79], a[64:67]
    v_mfma_f32_16x16x32_bf16 a[68:71], v[80:83], v[80:83], a[68:71]
    ds_read_b64_tr_b16 v[56:57], v13 offset:20480
    ds_read_b64_tr_b16 v[58:59], v13 offset:23552
    s_waitcnt lgkmcnt(12)
    v_mfma_f32_16x16x32_bf16 a[16:19], v[60:63], v[76:79], a[16:19]
    v_mfma_f32_16x16x32_bf16 a[40:43], v[60:63], v[80:83], a[40:43]
    ds_read_b64_tr_b16 v[60:61], v14 offset:20480
    ds_read_b64_tr_b16 v[62:63], v14 offset:23552
    s_waitcnt lgkmcnt(12)
    v_mfma_f32_16x16x32_bf16 a[20:23], v[64:67], v[76:79], a[20:23]
    v_mfma_f32_16x16x32_bf16 a[44:47], v[64:67], v[80:83], a[44:47]
    ds_read_b64_tr_b16 v[64:65], v15 offset:20480
    ds_read_b64_tr_b16 v[66:67], v15 offset:23552
    s_waitcnt lgkmcnt(10)
    v_mfma_f32_16x16x32_bf16 a[0:3], v[44:47], v[68:71], a[0:3]
    v_mfma_f32_16x16x32_bf16 a[24:27], v[44:47], v[72:75], a[24:27]
    v_mfma_f32_16x16x32_bf16 a[48:51], v[44:47], v[40:43], a[48:51]
    ds_read_b128 v[76:79], v25 offset:20480
    ds_read_b128 v[80:83], v25 offset:22528
    ds_read_b64_tr_b16 v[44:45], v10 offset:26624
    ds_read_b64_tr_b16 v[46:47], v10 offset:29696
    s_waitcnt lgkmcnt(12)
    v_mfma_f32_16x16x32_bf16 a[4:7], v[48:51], v[68:71], a[4:7]
    v_mfma_f32_16x16x32_bf16 a[28:31], v[48:51], v[72:75], a[28:31]
    v_mfma_f32_16x16x32_bf16 a[52:55], v[48:51], v[40:43], a[52:55]
    ds_read_b64_tr_b16 v[48:49], v11 offset:26624
    ds_read_b64_tr_b16 v[50:51], v11 offset:29696
    s_waitcnt lgkmcnt(12)
    v_mfma_f32_16x16x32_bf16 a[8:11], v[52:55], v[68:71], a[8:11]
    v_mfma_f32_16x16x32_bf16 a[32:35], v[52:55], v[72:75], a[32:35]
    v_mfma_f32_16x16x32_bf16 a[56:59], v[40:43], v[68:71], a[56:59]
    v_mfma_f32_16x16x32_bf16 a[60:63], v[40:43], v[72:75], a[60:63]
    ds_read_b64_tr_b16 v[52:53], v12 offset:26624
    ds_read_b64_tr_b16 v[54:55], v12 offset:29696
    s_waitcnt lgkmcnt(12)
    v_mfma_f32_16x16x32_bf16 a[12:15], v[56:59], v[68:71], a[12:15]
    v_mfma_f32_16x16x32_bf16 a[36:39], v[56:59], v[72:75], a[36:39]
    v_mfma_f32_16x16x32_bf16 a[64:67], v[68:71], v[68:71], a[64:67]
    v_mfma_f32_16x16x32_bf16 a[68:71], v[72:75], v[72:75], a[68:71]
    ds_read_b64_tr_b16 v[56:57], v13 offset:26624
    ds_read_b64_tr_b16 v[58:59], v13 offset:29696
    s_waitcnt lgkmcnt(12)
    v_mfma_f32_16x16x32_bf16 a[16:19], v[60:63], v[68:71], a[16:19]
    v_mfma_f32_16x16x32_bf16 a[40:43], v[60:63], v[72:75], a[40:43]
    ds_read_b64_tr_b16 v[60:61], v14 offset:26624
    ds_read_b64_tr_b16 v[62:63], v14 offset:29696
    s_waitcnt lgkmcnt(12)
    v_mfma_f32_16x16x32_bf16 a[20:23], v[64:67], v[68:71], a[20:23]
    v_mfma_f32_16x16x32_bf16 a[44:47], v[64:67], v[72:75], a[44:47]
    ds_read_b64_tr_b16 v[64:65], v15 offset:26624
    ds_read_b64_tr_b16 v[66:67], v15 offset:29696
    s_waitcnt lgkmcnt(10)
    v_mfma_f32_16x16x32_bf16 a[0:3], v[44:47], v[76:79], a[0:3]
    v_mfma_f32_16x16x32_bf16 a[24:27], v[44:47], v[80:83], a[24:27]
    v_mfma_f32_16x16x32_bf16 a[48:51], v[44:47], v[40:43], a[48:51]
    s_barrier
    ds_read_b128 v[68:71], v24 offset:49152
    ds_read_b128 v[72:75], v24 offset:51200
    ds_read_b64_tr_b16 v[44:45], v10 offset:49152
    ds_read_b64_tr_b16 v[46:47], v10 offset:52224
    s_waitcnt lgkmcnt(12)
    v_mfma_f32_16x16x32_bf16 a[4:7], v[48:51], v[76:79], a[4:7]
    v_mfma_f32_16x16x32_bf16 a[28:31], v[48:51], v[80:83], a[28:31]
    v_mfma_f32_16x16x32_bf16 a[52:55], v[48:51], v[40:43], a[52:55]
    ds_read_b64_tr_b16 v[48:49], v11 offset:49152
    ds_read_b64_tr_b16 v[50:51], v11 offset:52224
    s_waitcnt lgkmcnt(12)
    v_mfma_f32_16x16x32_bf16 a[8:11], v[52:55], v[76:79], a[8:11]
    v_mfma_f32_16x16x32_bf16 a[32:35], v[52:55], v[80:83], a[32:35]
    v_mfma_f32_16x16x32_bf16 a[56:59], v[40:43], v[76:79], a[56:59]
    v_mfma_f32_16x16x32_bf16 a[60:63], v[40:43], v[80:83], a[60:63]
    ds_read_b64_tr_b16 v[52:53], v12 offset:49152
    ds_read_b64_tr_b16 v[54:55], v12 offset:52224
    s_waitcnt lgkmcnt(12)
    v_mfma_f32_16x16x32_bf16 a[12:15], v[56:59], v[76:79], a[12:15]
    v_mfma_f32_16x16x32_bf16 a[36:39], v[56:59], v[80:83], a[36:39]
    v_mfma_f32_16x16x32_bf16 a[64:67], v[76:79], v[76:79], a[64:67]
    v_mfma_f32_16x16x32_bf16 a[68:71], v[80:83], v[80:83], a[68:71]
    ds_read_b64_tr_b16 v[56:57], v13 offset:49152
    ds_read_b64_tr_b16 v[58:59], v13 offset:52224
    s_waitcnt lgkmcnt(12)
    v_mfma_f32_16x16x32_bf16 a[16:19], v[60:63], v[76:79], a[16:19]
    v_mfma_f32_16x16x32_bf16 a[40:43], v[60:63], v[80:83], a[40:43]
    ds_read_b64_tr_b16 v[60:61], v14 offset:49152
    ds_read_b64_tr_b16 v[62:63], v14 offset:52224
    s_waitcnt lgkmcnt(12)
    v_mfma_f32_16x16x32_bf16 a[20:23], v[64:67], v[76:79], a[20:23]
    v_mfma_f32_16x16x32_bf16 a[44:47], v[64:67], v[80:83], a[44:47]
    ds_read_b64_tr_b16 v[64:65], v15 offset:49152
    ds_read_b64_tr_b16 v[66:67], v15 offset:52224
    s_waitcnt lgkmcnt(10)
    v_mfma_f32_16x16x32_bf16 a[0:3], v[44:47], v[68:71], a[0:3]
    v_mfma_f32_16x16x32_bf16 a[24:27], v[44:47], v[72:75], a[24:27]
    v_mfma_f32_16x16x32_bf16 a[48:51], v[44:47], v[40:43], a[48:51]
    ds_read_b128 v[76:79], v25 offset:49152
    ds_read_b128 v[80:83], v25 offset:51200
    ds_read_b64_tr_b16 v[44:45], v10 offset:55296
    ds_read_b64_tr_b16 v[46:47], v10 offset:58368
    s_waitcnt lgkmcnt(12)
    v_mfma_f32_16x16x32_bf16 a[4:7], v[48:51], v[68:71], a[4:7]
    v_mfma_f32_16x16x32_bf16 a[28:31], v[48:51], v[72:75], a[28:31]
    v_mfma_f32_16x16x32_bf16 a[52:55], v[48:51], v[40:43], a[52:55]
    ds_read_b64_tr_b16 v[48:49], v11 offset:55296
    ds_read_b64_tr_b16 v[50:51], v11 offset:58368
    s_waitcnt lgkmcnt(12)
    v_mfma_f32_16x16x32_bf16 a[8:11], v[52:55], v[68:71], a[8:11]
    v_mfma_f32_16x16x32_bf16 a[32:35], v[52:55], v[72:75], a[32:35]
    v_mfma_f32_16x16x32_bf16 a[56:59], v[40:43], v[68:71], a[56:59]
    v_mfma_f32_16x16x32_bf16 a[60:63], v[40:43], v[72:75], a[60:63]
    ds_read_b64_tr_b16 v[52:53], v12 offset:55296
    ds_read_b64_tr_b16 v[54:55], v12 offset:58368
    s_waitcnt lgkmcnt(12)
    v_mfma_f32_16x16x32_bf16 a[12:15], v[56:59], v[68:71], a[12:15]
    v_mfma_f32_16x16x32_bf16 a[36:39], v[56:59], v[72:75], a[36:39]
    v_mfma_f32_16x16x32_bf16 a[64:67], v[68:71], v[68:71], a[64:67]
    v_mfma_f32_16x16x32_bf16 a[68:71], v[72:75], v[72:75], a[68:71]
    ds_read_b64_tr_b16 v[56:57], v13 offset:55296
    ds_read_b64_tr_b16 v[58:59], v13 offset:58368
    s_waitcnt lgkmcnt(12)
    v_mfma_f32_16x16x32_bf16 a[16:19], v[60:63], v[68:71], a[16:19]
    v_mfma_f32_16x16x32_bf16 a[40:43], v[60:63], v[72:75], a[40:43]
    ds_read_b64_tr_b16 v[60:61], v14 offset:55296
    ds_read_b64_tr_b16 v[62:63], v14 offset:58368
    s_waitcnt lgkmcnt(12)
    v_mfma_f32_16x16x32_bf16 a[20:23], v[64:67], v[68:71], a[20:23]
    v_mfma_f32_16x16x32_bf16 a[44:47], v[64:67], v[72:75], a[44:47]
    ds_read_b64_tr_b16 v[64:65], v15 offset:55296
    ds_read_b64_tr_b16 v[66:67], v15 offset:58368
    s_waitcnt lgkmcnt(10)
    v_mfma_f32_16x16x32_bf16 a[0:3], v[44:47], v[76:79], a[0:3]
    v_mfma_f32_16x16x32_bf16 a[24:27], v[44:47], v[80:83], a[24:27]
    v_mfma_f32_16x16x32_bf16 a[48:51], v[44:47], v[40:43], a[48:51]
    s_barrier
    ds_read_b128 v[68:71], v22 offset:0
    ds_read_b128 v[72:75], v22 offset:2048
    ds_read_b64_tr_b16 v[44:45], v4 offset:0
    ds_read_b64_tr_b16 v[46:47], v4 offset:3072
    s_waitcnt lgkmcnt(12)
    v_mfma_f32_16x16x32_bf16 a[4:7], v[48:51], v[76:79], a[4:7]
    v_mfma_f32_16x16x32_bf16 a[28:31], v[48:51], v[80:83], a[28:31]
    v_mfma_f32_16x16x32_bf16 a[52:55], v[48:51], v[40:43], a[52:55]
    ds_read_b64_tr_b16 v[48:49], v5 offset:0
    ds_read_b64_tr_b16 v[50:51], v5 offset:3072
    s_waitcnt lgkmcnt(12)
    v_mfma_f32_16x16x32_bf16 a[8:11], v[52:55], v[76:79], a[8:11]
    v_mfma_f32_16x16x32_bf16 a[32:35], v[52:55], v[80:83], a[32:35]
    v_mfma_f32_16x16x32_bf16 a[56:59], v[40:43], v[76:79], a[56:59]
    v_mfma_f32_16x16x32_bf16 a[60:63], v[40:43], v[80:83], a[60:63]
    ds_read_b64_tr_b16 v[52:53], v6 offset:0
    ds_read_b64_tr_b16 v[54:55], v6 offset:3072
    s_waitcnt lgkmcnt(12)
    v_mfma_f32_16x16x32_bf16 a[12:15], v[56:59], v[76:79], a[12:15]
    v_mfma_f32_16x16x32_bf16 a[36:39], v[56:59], v[80:83], a[36:39]
    v_mfma_f32_16x16x32_bf16 a[64:67], v[76:79], v[76:79], a[64:67]
    v_mfma_f32_16x16x32_bf16 a[68:71], v[80:83], v[80:83], a[68:71]
    ds_read_b64_tr_b16 v[56:57], v7 offset:0
    ds_read_b64_tr_b16 v[58:59], v7 offset:3072
    s_waitcnt lgkmcnt(12)
    v_mfma_f32_16x16x32_bf16 a[16:19], v[60:63], v[76:79], a[16:19]
    v_mfma_f32_16x16x32_bf16 a[40:43], v[60:63], v[80:83], a[40:43]
    ds_read_b64_tr_b16 v[60:61], v8 offset:0
    ds_read_b64_tr_b16 v[62:63], v8 offset:3072
    s_waitcnt lgkmcnt(12)
    v_mfma_f32_16x16x32_bf16 a[20:23], v[64:67], v[76:79], a[20:23]
    v_mfma_f32_16x16x32_bf16 a[44:47], v[64:67], v[80:83], a[44:47]
    ds_read_b64_tr_b16 v[64:65], v9 offset:0
    ds_read_b64_tr_b16 v[66:67], v9 offset:3072
    s_waitcnt lgkmcnt(10)
    v_mfma_f32_16x16x32_bf16 a[0:3], v[44:47], v[68:71], a[0:3]
    v_mfma_f32_16x16x32_bf16 a[24:27], v[44:47], v[72:75], a[24:27]
    v_mfma_f32_16x16x32_bf16 a[48:51], v[44:47], v[40:43], a[48:51]
    ds_read_b128 v[76:79], v23 offset:0
    ds_read_b128 v[80:83], v23 offset:2048
    ds_read_b64_tr_b16 v[44:45], v4 offset:6144
    ds_read_b64_tr_b16 v[46:47], v4 offset:9216
    s_waitcnt lgkmcnt(12)
    v_mfma_f32_16x16x32_bf16 a[4:7], v[48:51], v[68:71], a[4:7]
    v_mfma_f32_16x16x32_bf16 a[28:31], v[48:51], v[72:75], a[28:31]
    v_mfma_f32_16x16x32_bf16 a[52:55], v[48:51], v[40:43], a[52:55]
    ds_read_b64_tr_b16 v[48:49], v5 offset:6144
    ds_read_b64_tr_b16 v[50:51], v5 offset:9216
    s_waitcnt lgkmcnt(12)
    v_mfma_f32_16x16x32_bf16 a[8:11], v[52:55], v[68:71], a[8:11]
    v_mfma_f32_16x16x32_bf16 a[32:35], v[52:55], v[72:75], a[32:35]
    v_mfma_f32_16x16x32_bf16 a[56:59], v[40:43], v[68:71], a[56:59]
    v_mfma_f32_16x16x32_bf16 a[60:63], v[40:43], v[72:75], a[60:63]
    ds_read_b64_tr_b16 v[52:53], v6 offset:6144
    ds_read_b64_tr_b16 v[54:55], v6 offset:9216
    s_waitcnt lgkmcnt(12)
    v_mfma_f32_16x16x32_bf16 a[12:15], v[56:59], v[68:71], a[12:15]
    v_mfma_f32_16x16x32_bf16 a[36:39], v[56:59], v[72:75], a[36:39]
    v_mfma_f32_16x16x32_bf16 a[64:67], v[68:71], v[68:71], a[64:67]
    v_mfma_f32_16x16x32_bf16 a[68:71], v[72:75], v[72:75], a[68:71]
    ds_read_b64_tr_b16 v[56:57], v7 offset:6144
    ds_read_b64_tr_b16 v[58:59], v7 offset:9216
    s_waitcnt lgkmcnt(12)
    v_mfma_f32_16x16x32_bf16 a[16:19], v[60:63], v[68:71], a[16:19]
    v_mfma_f32_16x16x32_bf16 a[40:43], v[60:63], v[72:75], a[40:43]
    ds_read_b64_tr_b16 v[60:61], v8 offset:6144
    ds_read_b64_tr_b16 v[62:63], v8 offset:9216
    s_waitcnt lgkmcnt(12)
    v_mfma_f32_16x16x32_bf16 a[20:23], v[64:67], v[68:71], a[20:23]
    v_mfma_f32_16x16x32_bf16 a[44:47], v[64:67], v[72:75], a[44:47]
    ds_read_b64_tr_b16 v[64:65], v9 offset:6144
    ds_read_b64_tr_b16 v[66:67], v9 offset:9216
    s_waitcnt lgkmcnt(10)
    v_mfma_f32_16x16x32_bf16 a[0:3], v[44:47], v[76:79], a[0:3]
    v_mfma_f32_16x16x32_bf16 a[24:27], v[44:47], v[80:83], a[24:27]
    v_mfma_f32_16x16x32_bf16 a[48:51], v[44:47], v[40:43], a[48:51]
    s_barrier
    ds_read_b128 v[68:71], v22 offset:28672
    ds_read_b128 v[72:75], v22 offset:30720
    ds_read_b64_tr_b16 v[44:45], v4 offset:28672
    ds_read_b64_tr_b16 v[46:47], v4 offset:31744
    s_waitcnt lgkmcnt(12)
    v_mfma_f32_16x16x32_bf16 a[4:7], v[48:51], v[76:79], a[4:7]
    v_mfma_f32_16x16x32_bf16 a[28:31], v[48:51], v[80:83], a[28:31]
    v_mfma_f32_16x16x32_bf16 a[52:55], v[48:51], v[40:43], a[52:55]
    ds_read_b64_tr_b16 v[48:49], v5 offset:28672
    ds_read_b64_tr_b16 v[50:51], v5 offset:31744
    s_waitcnt lgkmcnt(12)
    v_mfma_f32_16x16x32_bf16 a[8:11], v[52:55], v[76:79], a[8:11]
    v_mfma_f32_16x16x32_bf16 a[32:35], v[52:55], v[80:83], a[32:35]
    v_mfma_f32_16x16x32_bf16 a[56:59], v[40:43], v[76:79], a[56:59]
    v_mfma_f32_16x16x32_bf16 a[60:63], v[40:43], v[80:83], a[60:63]
    ds_read_b64_tr_b16 v[52:53], v6 offset:28672
    ds_read_b64_tr_b16 v[54:55], v6 offset:31744
    s_waitcnt lgkmcnt(12)
    v_mfma_f32_16x16x32_bf16 a[12:15], v[56:59], v[76:79], a[12:15]
    v_mfma_f32_16x16x32_bf16 a[36:39], v[56:59], v[80:83], a[36:39]
    v_mfma_f32_16x16x32_bf16 a[64:67], v[76:79], v[76:79], a[64:67]
    v_mfma_f32_16x16x32_bf16 a[68:71], v[80:83], v[80:83], a[68:71]
    ds_read_b64_tr_b16 v[56:57], v7 offset:28672
    ds_read_b64_tr_b16 v[58:59], v7 offset:31744
    s_waitcnt lgkmcnt(12)
    v_mfma_f32_16x16x32_bf16 a[16:19], v[60:63], v[76:79], a[16:19]
    v_mfma_f32_16x16x32_bf16 a[40:43], v[60:63], v[80:83], a[40:43]
    ds_read_b64_tr_b16 v[60:61], v8 offset:28672
    ds_read_b64_tr_b16 v[62:63], v8 offset:31744
    s_waitcnt lgkmcnt(12)
    v_mfma_f32_16x16x32_bf16 a[20:23], v[64:67], v[76:79], a[20:23]
    v_mfma_f32_16x16x32_bf16 a[44:47], v[64:67], v[80:83], a[44:47]
    ds_read_b64_tr_b16 v[64:65], v9 offset:28672
    ds_read_b64_tr_b16 v[66:67], v9 offset:31744
    s_waitcnt lgkmcnt(10)
    v_mfma_f32_16x16x32_bf16 a[0:3], v[44:47], v[68:71], a[0:3]
    v_mfma_f32_16x16x32_bf16 a[24:27], v[44:47], v[72:75], a[24:27]
    v_mfma_f32_16x16x32_bf16 a[48:51], v[44:47], v[40:43], a[48:51]
    ds_read_b128 v[76:79], v23 offset:28672
    ds_read_b128 v[80:83], v23 offset:30720
    ds_read_b64_tr_b16 v[44:45], v4 offset:34816
    ds_read_b64_tr_b16 v[46:47], v4 offset:37888
    s_waitcnt lgkmcnt(12)
    v_mfma_f32_16x16x32_bf16 a[4:7], v[48:51], v[68:71], a[4:7]
    v_mfma_f32_16x16x32_bf16 a[28:31], v[48:51], v[72:75], a[28:31]
    v_mfma_f32_16x16x32_bf16 a[52:55], v[48:51], v[40:43], a[52:55]
    ds_read_b64_tr_b16 v[48:49], v5 offset:34816
    ds_read_b64_tr_b16 v[50:51], v5 offset:37888
    s_waitcnt lgkmcnt(12)
    v_mfma_f32_16x16x32_bf16 a[8:11], v[52:55], v[68:71], a[8:11]
    v_mfma_f32_16x16x32_bf16 a[32:35], v[52:55], v[72:75], a[32:35]
    v_mfma_f32_16x16x32_bf16 a[56:59], v[40:43], v[68:71], a[56:59]
    v_mfma_f32_16x16x32_bf16 a[60:63], v[40:43], v[72:75], a[60:63]
    ds_read_b64_tr_b16 v[52:53], v6 offset:34816
    ds_read_b64_tr_b16 v[54:55], v6 offset:37888
    s_waitcnt lgkmcnt(12)
    v_mfma_f32_16x16x32_bf16 a[12:15], v[56:59], v[68:71], a[12:15]
    v_mfma_f32_16x16x32_bf16 a[36:39], v[56:59], v[72:75], a[36:39]
    v_mfma_f32_16x16x32_bf16 a[64:67], v[68:71], v[68:71], a[64:67]
    v_mfma_f32_16x16x32_bf16 a[68:71], v[72:75], v[72:75], a[68:71]
    ds_read_b64_tr_b16 v[56:57], v7 offset:34816
    ds_read_b64_tr_b16 v[58:59], v7 offset:37888
    s_waitcnt lgkmcnt(12)
    v_mfma_f32_16x16x32_bf16 a[16:19], v[60:63], v[68:71], a[16:19]
    v_mfma_f32_16x16x32_bf16 a[40:43], v[60:63], v[72:75], a[40:43]
    ds_read_b64_tr_b16 v[60:61], v8 offset:34816
    ds_read_b64_tr_b16 v[62:63], v8 offset:37888
    s_waitcnt lgkmcnt(12)
    v_mfma_f32_16x16x32_bf16 a[20:23], v[64:67], v[68:71], a[20:23]
    v_mfma_f32_16x16x32_bf16 a[44:47], v[64:67], v[72:75], a[44:47]
    ds_read_b64_tr_b16 v[64:65], v9 offset:34816
    ds_read_b64_tr_b16 v[66:67], v9 offset:37888
    s_waitcnt lgkmcnt(10)
    v_mfma_f32_16x16x32_bf16 a[0:3], v[44:47], v[76:79], a[0:3]
    v_mfma_f32_16x16x32_bf16 a[24:27], v[44:47], v[80:83], a[24:27]
    v_mfma_f32_16x16x32_bf16 a[48:51], v[44:47], v[40:43], a[48:51]
    s_barrier
    ds_read_b128 v[68:71], v22 offset:57344
    ds_read_b128 v[72:75], v22 offset:59392
    ds_read_b64_tr_b16 v[44:45], v4 offset:57344
    ds_read_b64_tr_b16 v[46:47], v4 offset:60416
    s_waitcnt lgkmcnt(12)
    v_mfma_f32_16x16x32_bf16 a[4:7], v[48:51], v[76:79], a[4:7]
    v_mfma_f32_16x16x32_bf16 a[28:31], v[48:51], v[80:83], a[28:31]
    v_mfma_f32_16x16x32_bf16 a[52:55], v[48:51], v[40:43], a[52:55]
    ds_read_b64_tr_b16 v[48:49], v5 offset:57344
    ds_read_b64_tr_b16 v[50:51], v5 offset:60416
    s_waitcnt lgkmcnt(12)
    v_mfma_f32_16x16x32_bf16 a[8:11], v[52:55], v[76:79], a[8:11]
    v_mfma_f32_16x16x32_bf16 a[32:35], v[52:55], v[80:83], a[32:35]
    v_mfma_f32_16x16x32_bf16 a[56:59], v[40:43], v[76:79], a[56:59]
    v_mfma_f32_16x16x32_bf16 a[60:63], v[40:43], v[80:83], a[60:63]
    ds_read_b64_tr_b16 v[52:53], v6 offset:57344
    ds_read_b64_tr_b16 v[54:55], v6 offset:60416
    s_waitcnt lgkmcnt(12)
    v_mfma_f32_16x16x32_bf16 a[12:15], v[56:59], v[76:79], a[12:15]
    v_mfma_f32_16x16x32_bf16 a[36:39], v[56:59], v[80:83], a[36:39]
    v_mfma_f32_16x16x32_bf16 a[64:67], v[76:79], v[76:79], a[64:67]
    v_mfma_f32_16x16x32_bf16 a[68:71], v[80:83], v[80:83], a[68:71]
    ds_read_b64_tr_b16 v[56:57], v7 offset:57344
    ds_read_b64_tr_b16 v[58:59], v7 offset:60416
    s_waitcnt lgkmcnt(12)
    v_mfma_f32_16x16x32_bf16 a[16:19], v[60:63], v[76:79], a[16:19]
    v_mfma_f32_16x16x32_bf16 a[40:43], v[60:63], v[80:83], a[40:43]
    ds_read_b64_tr_b16 v[60:61], v8 offset:57344
    ds_read_b64_tr_b16 v[62:63], v8 offset:60416
    s_waitcnt lgkmcnt(12)
    v_mfma_f32_16x16x32_bf16 a[20:23], v[64:67], v[76:79], a[20:23]
    v_mfma_f32_16x16x32_bf16 a[44:47], v[64:67], v[80:83], a[44:47]
    ds_read_b64_tr_b16 v[64:65], v9 offset:57344
    ds_read_b64_tr_b16 v[66:67], v9 offset:60416
    s_waitcnt lgkmcnt(10)
    v_mfma_f32_16x16x32_bf16 a[0:3], v[44:47], v[68:71], a[0:3]
    v_mfma_f32_16x16x32_bf16 a[24:27], v[44:47], v[72:75], a[24:27]
    v_mfma_f32_16x16x32_bf16 a[48:51], v[44:47], v[40:43], a[48:51]
    ds_read_b128 v[76:79], v23 offset:57344
    ds_read_b128 v[80:83], v23 offset:59392
    ds_read_b64_tr_b16 v[44:45], v4 offset:63488
    ds_read_b64_tr_b16 v[46:47], v10 offset:1024
    s_waitcnt lgkmcnt(12)
    v_mfma_f32_16x16x32_bf16 a[4:7], v[48:51], v[68:71], a[4:7]
    v_mfma_f32_16x16x32_bf16 a[28:31], v[48:51], v[72:75], a[28:31]
    v_mfma_f32_16x16x32_bf16 a[52:55], v[48:51], v[40:43], a[52:55]
    ds_read_b64_tr_b16 v[48:49], v5 offset:63488
    ds_read_b64_tr_b16 v[50:51], v11 offset:1024
    s_waitcnt lgkmcnt(12)
    v_mfma_f32_16x16x32_bf16 a[8:11], v[52:55], v[68:71], a[8:11]
    v_mfma_f32_16x16x32_bf16 a[32:35], v[52:55], v[72:75], a[32:35]
    v_mfma_f32_16x16x32_bf16 a[56:59], v[40:43], v[68:71], a[56:59]
    v_mfma_f32_16x16x32_bf16 a[60:63], v[40:43], v[72:75], a[60:63]
    ds_read_b64_tr_b16 v[52:53], v6 offset:63488
    ds_read_b64_tr_b16 v[54:55], v12 offset:1024
    s_waitcnt lgkmcnt(12)
    v_mfma_f32_16x16x32_bf16 a[12:15], v[56:59], v[68:71], a[12:15]
    v_mfma_f32_16x16x32_bf16 a[36:39], v[56:59], v[72:75], a[36:39]
    v_mfma_f32_16x16x32_bf16 a[64:67], v[68:71], v[68:71], a[64:67]
    v_mfma_f32_16x16x32_bf16 a[68:71], v[72:75], v[72:75], a[68:71]
    ds_read_b64_tr_b16 v[56:57], v7 offset:63488
    ds_read_b64_tr_b16 v[58:59], v13 offset:1024
    s_waitcnt lgkmcnt(12)
    v_mfma_f32_16x16x32_bf16 a[16:19], v[60:63], v[68:71], a[16:19]
    v_mfma_f32_16x16x32_bf16 a[40:43], v[60:63], v[72:75], a[40:43]
    ds_read_b64_tr_b16 v[60:61], v8 offset:63488
    ds_read_b64_tr_b16 v[62:63], v14 offset:1024
    s_waitcnt lgkmcnt(12)
    v_mfma_f32_16x16x32_bf16 a[20:23], v[64:67], v[68:71], a[20:23]
    v_mfma_f32_16x16x32_bf16 a[44:47], v[64:67], v[72:75], a[44:47]
    ds_read_b64_tr_b16 v[64:65], v9 offset:63488
    ds_read_b64_tr_b16 v[66:67], v15 offset:1024
    s_waitcnt lgkmcnt(10)
    v_mfma_f32_16x16x32_bf16 a[0:3], v[44:47], v[76:79], a[0:3]
    v_mfma_f32_16x16x32_bf16 a[24:27], v[44:47], v[80:83], a[24:27]
    v_mfma_f32_16x16x32_bf16 a[48:51], v[44:47], v[40:43], a[48:51]
    s_barrier
    ds_read_b128 v[68:71], v24 offset:20480
    ds_read_b128 v[72:75], v24 offset:22528
    ds_read_b64_tr_b16 v[44:45], v10 offset:20480
    ds_read_b64_tr_b16 v[46:47], v10 offset:23552
    s_waitcnt lgkmcnt(12)
    v_mfma_f32_16x16x32_bf16 a[4:7], v[48:51], v[76:79], a[4:7]
    v_mfma_f32_16x16x32_bf16 a[28:31], v[48:51], v[80:83], a[28:31]
    v_mfma_f32_16x16x32_bf16 a[52:55], v[48:51], v[40:43], a[52:55]
    ds_read_b64_tr_b16 v[48:49], v11 offset:20480
    ds_read_b64_tr_b16 v[50:51], v11 offset:23552
    s_waitcnt lgkmcnt(12)
    v_mfma_f32_16x16x32_bf16 a[8:11], v[52:55], v[76:79], a[8:11]
    v_mfma_f32_16x16x32_bf16 a[32:35], v[52:55], v[80:83], a[32:35]
    v_mfma_f32_16x16x32_bf16 a[56:59], v[40:43], v[76:79], a[56:59]
    v_mfma_f32_16x16x32_bf16 a[60:63], v[40:43], v[80:83], a[60:63]
    ds_read_b64_tr_b16 v[52:53], v12 offset:20480
    ds_read_b64_tr_b16 v[54:55], v12 offset:23552
    s_waitcnt lgkmcnt(12)
    v_mfma_f32_16x16x32_bf16 a[12:15], v[56:59], v[76:79], a[12:15]
    v_mfma_f32_16x16x32_bf16 a[36:39], v[56:59], v[80:83], a[36:39]
    v_mfma_f32_16x16x32_bf16 a[64:67], v[76:79], v[76:79], a[64:67]
    v_mfma_f32_16x16x32_bf16 a[68:71], v[80:83], v[80:83], a[68:71]
    ds_read_b64_tr_b16 v[56:57], v13 offset:20480
    ds_read_b64_tr_b16 v[58:59], v13 offset:23552
    s_waitcnt lgkmcnt(12)
    v_mfma_f32_16x16x32_bf16 a[16:19], v[60:63], v[76:79], a[16:19]
    v_mfma_f32_16x16x32_bf16 a[40:43], v[60:63], v[80:83], a[40:43]
    ds_read_b64_tr_b16 v[60:61], v14 offset:20480
    ds_read_b64_tr_b16 v[62:63], v14 offset:23552
    s_waitcnt lgkmcnt(12)
    v_mfma_f32_16x16x32_bf16 a[20:23], v[64:67], v[76:79], a[20:23]
    v_mfma_f32_16x16x32_bf16 a[44:47], v[64:67], v[80:83], a[44:47]
    ds_read_b64_tr_b16 v[64:65], v15 offset:20480
    ds_read_b64_tr_b16 v[66:67], v15 offset:23552
    s_waitcnt lgkmcnt(10)
    v_mfma_f32_16x16x32_bf16 a[0:3], v[44:47], v[68:71], a[0:3]
    v_mfma_f32_16x16x32_bf16 a[24:27], v[44:47], v[72:75], a[24:27]
    v_mfma_f32_16x16x32_bf16 a[48:51], v[44:47], v[40:43], a[48:51]
    ds_read_b128 v[76:79], v25 offset:20480
    ds_read_b128 v[80:83], v25 offset:22528
    ds_read_b64_tr_b16 v[44:45], v10 offset:26624
    ds_read_b64_tr_b16 v[46:47], v10 offset:29696
    s_waitcnt lgkmcnt(12)
    v_mfma_f32_16x16x32_bf16 a[4:7], v[48:51], v[68:71], a[4:7]
    v_mfma_f32_16x16x32_bf16 a[28:31], v[48:51], v[72:75], a[28:31]
    v_mfma_f32_16x16x32_bf16 a[52:55], v[48:51], v[40:43], a[52:55]
    ds_read_b64_tr_b16 v[48:49], v11 offset:26624
    ds_read_b64_tr_b16 v[50:51], v11 offset:29696
    s_waitcnt lgkmcnt(12)
    v_mfma_f32_16x16x32_bf16 a[8:11], v[52:55], v[68:71], a[8:11]
    v_mfma_f32_16x16x32_bf16 a[32:35], v[52:55], v[72:75], a[32:35]
    v_mfma_f32_16x16x32_bf16 a[56:59], v[40:43], v[68:71], a[56:59]
    v_mfma_f32_16x16x32_bf16 a[60:63], v[40:43], v[72:75], a[60:63]
    ds_read_b64_tr_b16 v[52:53], v12 offset:26624
    ds_read_b64_tr_b16 v[54:55], v12 offset:29696
    s_waitcnt lgkmcnt(12)
    v_mfma_f32_16x16x32_bf16 a[12:15], v[56:59], v[68:71], a[12:15]
    v_mfma_f32_16x16x32_bf16 a[36:39], v[56:59], v[72:75], a[36:39]
    v_mfma_f32_16x16x32_bf16 a[64:67], v[68:71], v[68:71], a[64:67]
    v_mfma_f32_16x16x32_bf16 a[68:71], v[72:75], v[72:75], a[68:71]
    ds_read_b64_tr_b16 v[56:57], v13 offset:26624
    ds_read_b64_tr_b16 v[58:59], v13 offset:29696
    s_waitcnt lgkmcnt(12)
    v_mfma_f32_16x16x32_bf16 a[16:19], v[60:63], v[68:71], a[16:19]
    v_mfma_f32_16x16x32_bf16 a[40:43], v[60:63], v[72:75], a[40:43]
    ds_read_b64_tr_b16 v[60:61], v14 offset:26624
    ds_read_b64_tr_b16 v[62:63], v14 offset:29696
    s_waitcnt lgkmcnt(12)
    v_mfma_f32_16x16x32_bf16 a[20:23], v[64:67], v[68:71], a[20:23]
    v_mfma_f32_16x16x32_bf16 a[44:47], v[64:67], v[72:75], a[44:47]
    ds_read_b64_tr_b16 v[64:65], v15 offset:26624
    ds_read_b64_tr_b16 v[66:67], v15 offset:29696
    s_waitcnt lgkmcnt(10)
    v_mfma_f32_16x16x32_bf16 a[0:3], v[44:47], v[76:79], a[0:3]
    v_mfma_f32_16x16x32_bf16 a[24:27], v[44:47], v[80:83], a[24:27]
    v_mfma_f32_16x16x32_bf16 a[48:51], v[44:47], v[40:43], a[48:51]
    s_barrier
    ds_read_b128 v[68:71], v24 offset:49152
    ds_read_b128 v[72:75], v24 offset:51200
    ds_read_b64_tr_b16 v[44:45], v10 offset:49152
    ds_read_b64_tr_b16 v[46:47], v10 offset:52224
    s_waitcnt lgkmcnt(12)
    v_mfma_f32_16x16x32_bf16 a[4:7], v[48:51], v[76:79], a[4:7]
    v_mfma_f32_16x16x32_bf16 a[28:31], v[48:51], v[80:83], a[28:31]
    v_mfma_f32_16x16x32_bf16 a[52:55], v[48:51], v[40:43], a[52:55]
    ds_read_b64_tr_b16 v[48:49], v11 offset:49152
    ds_read_b64_tr_b16 v[50:51], v11 offset:52224
    s_waitcnt lgkmcnt(12)
    v_mfma_f32_16x16x32_bf16 a[8:11], v[52:55], v[76:79], a[8:11]
    v_mfma_f32_16x16x32_bf16 a[32:35], v[52:55], v[80:83], a[32:35]
    v_mfma_f32_16x16x32_bf16 a[56:59], v[40:43], v[76:79], a[56:59]
    v_mfma_f32_16x16x32_bf16 a[60:63], v[40:43], v[80:83], a[60:63]
    ds_read_b64_tr_b16 v[52:53], v12 offset:49152
    ds_read_b64_tr_b16 v[54:55], v12 offset:52224
    s_waitcnt lgkmcnt(12)
    v_mfma_f32_16x16x32_bf16 a[12:15], v[56:59], v[76:79], a[12:15]
    v_mfma_f32_16x16x32_bf16 a[36:39], v[56:59], v[80:83], a[36:39]
    v_mfma_f32_16x16x32_bf16 a[64:67], v[76:79], v[76:79], a[64:67]
    v_mfma_f32_16x16x32_bf16 a[68:71], v[80:83], v[80:83], a[68:71]
    ds_read_b64_tr_b16 v[56:57], v13 offset:49152
    ds_read_b64_tr_b16 v[58:59], v13 offset:52224
    s_waitcnt lgkmcnt(12)
    v_mfma_f32_16x16x32_bf16 a[16:19], v[60:63], v[76:79], a[16:19]
    v_mfma_f32_16x16x32_bf16 a[40:43], v[60:63], v[80:83], a[40:43]
    ds_read_b64_tr_b16 v[60:61], v14 offset:49152
    ds_read_b64_tr_b16 v[62:63], v14 offset:52224
    s_waitcnt lgkmcnt(12)
    v_mfma_f32_16x16x32_bf16 a[20:23], v[64:67], v[76:79], a[20:23]
    v_mfma_f32_16x16x32_bf16 a[44:47], v[64:67], v[80:83], a[44:47]
    ds_read_b64_tr_b16 v[64:65], v15 offset:49152
    ds_read_b64_tr_b16 v[66:67], v15 offset:52224
    s_waitcnt lgkmcnt(10)
    v_mfma_f32_16x16x32_bf16 a[0:3], v[44:47], v[68:71], a[0:3]
    v_mfma_f32_16x16x32_bf16 a[24:27], v[44:47], v[72:75], a[24:27]
    v_mfma_f32_16x16x32_bf16 a[48:51], v[44:47], v[40:43], a[48:51]
    ds_read_b128 v[76:79], v25 offset:49152
    ds_read_b128 v[80:83], v25 offset:51200
    ds_read_b64_tr_b16 v[44:45], v10 offset:55296
    ds_read_b64_tr_b16 v[46:47], v10 offset:58368
    s_waitcnt lgkmcnt(12)
    v_mfma_f32_16x16x32_bf16 a[4:7], v[48:51], v[68:71], a[4:7]
    v_mfma_f32_16x16x32_bf16 a[28:31], v[48:51], v[72:75], a[28:31]
    v_mfma_f32_16x16x32_bf16 a[52:55], v[48:51], v[40:43], a[52:55]
    ds_read_b64_tr_b16 v[48:49], v11 offset:55296
    ds_read_b64_tr_b16 v[50:51], v11 offset:58368
    s_waitcnt lgkmcnt(12)
    v_mfma_f32_16x16x32_bf16 a[8:11], v[52:55], v[68:71], a[8:11]
    v_mfma_f32_16x16x32_bf16 a[32:35], v[52:55], v[72:75], a[32:35]
    v_mfma_f32_16x16x32_bf16 a[56:59], v[40:43], v[68:71], a[56:59]
    v_mfma_f32_16x16x32_bf16 a[60:63], v[40:43], v[72:75], a[60:63]
    ds_read_b64_tr_b16 v[52:53], v12 offset:55296
    ds_read_b64_tr_b16 v[54:55], v12 offset:58368
    s_waitcnt lgkmcnt(12)
    v_mfma_f32_16x16x32_bf16 a[12:15], v[56:59], v[68:71], a[12:15]
    v_mfma_f32_16x16x32_bf16 a[36:39], v[56:59], v[72:75], a[36:39]
    v_mfma_f32_16x16x32_bf16 a[64:67], v[68:71], v[68:71], a[64:67]
    v_mfma_f32_16x16x32_bf16 a[68:71], v[72:75], v[72:75], a[68:71]
    ds_read_b64_tr_b16 v[56:57], v13 offset:55296
    ds_read_b64_tr_b16 v[58:59], v13 offset:58368
    s_waitcnt lgkmcnt(12)
    v_mfma_f32_16x16x32_bf16 a[16:19], v[60:63], v[68:71], a[16:19]
    v_mfma_f32_16x16x32_bf16 a[40:43], v[60:63], v[72:75], a[40:43]
    ds_read_b64_tr_b16 v[60:61], v14 offset:55296
    ds_read_b64_tr_b16 v[62:63], v14 offset:58368
    s_waitcnt lgkmcnt(12)
    v_mfma_f32_16x16x32_bf16 a[20:23], v[64:67], v[68:71], a[20:23]
    v_mfma_f32_16x16x32_bf16 a[44:47], v[64:67], v[72:75], a[44:47]
    ds_read_b64_tr_b16 v[64:65], v15 offset:55296
    ds_read_b64_tr_b16 v[66:67], v15 offset:58368
    s_waitcnt lgkmcnt(10)
    v_mfma_f32_16x16x32_bf16 a[0:3], v[44:47], v[76:79], a[0:3]
    v_mfma_f32_16x16x32_bf16 a[24:27], v[44:47], v[80:83], a[24:27]
    v_mfma_f32_16x16x32_bf16 a[48:51], v[44:47], v[40:43], a[48:51]
    s_waitcnt lgkmcnt(8)
    v_mfma_f32_16x16x32_bf16 a[4:7], v[48:51], v[76:79], a[4:7]
    v_mfma_f32_16x16x32_bf16 a[28:31], v[48:51], v[80:83], a[28:31]
    v_mfma_f32_16x16x32_bf16 a[52:55], v[48:51], v[40:43], a[52:55]
    s_waitcnt lgkmcnt(6)
    v_mfma_f32_16x16x32_bf16 a[8:11], v[52:55], v[76:79], a[8:11]
    v_mfma_f32_16x16x32_bf16 a[32:35], v[52:55], v[80:83], a[32:35]
    v_mfma_f32_16x16x32_bf16 a[56:59], v[40:43], v[76:79], a[56:59]
    v_mfma_f32_16x16x32_bf16 a[60:63], v[40:43], v[80:83], a[60:63]
    s_waitcnt lgkmcnt(4)
    v_mfma_f32_16x16x32_bf16 a[12:15], v[56:59], v[76:79], a[12:15]
    v_mfma_f32_16x16x32_bf16 a[36:39], v[56:59], v[80:83], a[36:39]
    v_mfma_f32_16x16x32_bf16 a[64:67], v[76:79], v[76:79], a[64:67]
    v_mfma_f32_16x16x32_bf16 a[68:71], v[80:83], v[80:83], a[68:71]
    s_waitcnt lgkmcnt(2)
    v_mfma_f32_16x16x32_bf16 a[16:19], v[60:63], v[76:79], a[16:19]
    v_mfma_f32_16x16x32_bf16 a[40:43], v[60:63], v[80:83], a[40:43]
    s_waitcnt lgkmcnt(0)
    v_mfma_f32_16x16x32_bf16 a[20:23], v[64:67], v[76:79], a[20:23]
    v_mfma_f32_16x16x32_bf16 a[44:47], v[64:67], v[80:83], a[44:47]
    s_nop 7
    s_nop 1
    v_lshlrev_b32 v108, 4, v3
    v_cmp_eq_u32 vcc, 0, v2
    v_add_u32 v108, 0x23000, v108
    s_lshl_b32 s37, s48, 6
    v_add_u32 v87, s37, v108
    s_lshl_b32 s37, s49, 6
    v_add_u32 v91, s37, v108
    s_lshl_b32 s37, s50, 6
    v_add_u32 v95, s37, v108
    s_lshl_b32 s37, s51, 6
    v_add_u32 v99, s37, v108
    s_lshl_b32 s37, s52, 6
    v_add_u32 v103, s37, v108
    s_lshl_b32 s37, s53, 6
    v_add_u32 v107, s37, v108
    s_and_saveexec_b64 s[44:45], vcc
    v_accvgpr_read_b32 v112, a48
    v_accvgpr_read_b32 v113, a49
    v_accvgpr_read_b32 v114, a50
    v_accvgpr_read_b32 v115, a51
    ds_write_b128 v87, v[112:115]
    v_accvgpr_read_b32 v112, a52
    v_accvgpr_read_b32 v113, a53
    v_accvgpr_read_b32 v114, a54
    v_accvgpr_read_b32 v115, a55
    ds_write_b128 v91, v[112:115]
    s_mov_b64 exec, s[44:45]
    s_mov_b32 s37, 0x3acccccd
    s_mov_b32 s38, 0x3727c5ac
    v_and_b32 v37, 3, v2
    v_lshrrev_b32 v36, 2, v2
    v_cmp_eq_u32 s[44:45], v36, v3
    v_add_u32 v38, s56, v2
    v_lshlrev_b32 v39, 2, v38
    v_add_u32 v39, 0x23400, v39
    v_accvgpr_read_b32 v44, a56
    v_accvgpr_read_b32 v45, a64
    v_accvgpr_read_b32 v34, a65
    v_cmp_eq_u32 vcc, 1, v37
    s_nop 1
    v_cndmask_b32 v45, v45, v34, vcc
    v_accvgpr_read_b32 v34, a66
    v_cmp_eq_u32 vcc, 2, v37
    s_nop 1
    v_cndmask_b32 v45, v45, v34, vcc
    v_accvgpr_read_b32 v34, a67
    v_cmp_eq_u32 vcc, 3, v37
    s_nop 1
    v_cndmask_b32 v45, v45, v34, vcc
    v_mul_f32 v44, s37, v44
    v_mul_f32 v45, s37, v45
    v_fma_f32 v45, -v44, v44, v45
    v_max_f32 v45, 0, v45
    v_cvt_pk_bf16_f32 v28, v44, v44
    v_lshlrev_b32 v46, 16, v28
    v_cvt_pk_bf16_f32 v28, v45, v45
    v_lshlrev_b32 v29, 16, v28
    v_add_f32 v29, s38, v29
    v_cvt_pk_bf16_f32 v28, v29, v29
    v_lshlrev_b32 v29, 16, v28
    v_sqrt_f32 v29, v29
    s_nop 0
    v_cvt_pk_bf16_f32 v28, v29, v29
    v_lshlrev_b32 v29, 16, v28
    v_rcp_f32 v47, v29
    s_nop 0
    v_mov_b32 v32, v47
    v_mul_f32 v33, v46, v47
    s_mov_b64 s[90:91], exec
    s_mov_b64 exec, s[44:45]
    ds_write_b32 v39, v32 offset:0
    ds_write_b32 v39, v33 offset:512
    s_mov_b64 exec, s[90:91]
    v_accvgpr_read_b32 v44, a60
    v_accvgpr_read_b32 v45, a68
    v_accvgpr_read_b32 v34, a69
    v_cmp_eq_u32 vcc, 1, v37
    s_nop 1
    v_cndmask_b32 v45, v45, v34, vcc
    v_accvgpr_read_b32 v34, a70
    v_cmp_eq_u32 vcc, 2, v37
    s_nop 1
    v_cndmask_b32 v45, v45, v34, vcc
    v_accvgpr_read_b32 v34, a71
    v_cmp_eq_u32 vcc, 3, v37
    s_nop 1
    v_cndmask_b32 v45, v45, v34, vcc
    v_mul_f32 v44, s37, v44
    v_mul_f32 v45, s37, v45
    v_fma_f32 v45, -v44, v44, v45
    v_max_f32 v45, 0, v45
    v_cvt_pk_bf16_f32 v28, v44, v44
    v_lshlrev_b32 v46, 16, v28
    v_cvt_pk_bf16_f32 v28, v45, v45
    v_lshlrev_b32 v29, 16, v28
    v_add_f32 v29, s38, v29
    v_cvt_pk_bf16_f32 v28, v29, v29
    v_lshlrev_b32 v29, 16, v28
    v_sqrt_f32 v29, v29
    s_nop 0
    v_cvt_pk_bf16_f32 v28, v29, v29
    v_lshlrev_b32 v29, 16, v28
    v_rcp_f32 v47, v29
    s_nop 0
    v_mov_b32 v32, v47
    v_mul_f32 v33, v46, v47
    s_mov_b64 s[90:91], exec
    s_mov_b64 exec, s[44:45]
    ds_write_b32 v39, v32 offset:64
    ds_write_b32 v39, v33 offset:576
    s_mov_b64 exec, s[90:91]
    s_waitcnt lgkmcnt(0)
    s_barrier
    ds_read_b128 v[84:87], v87
    ds_read_b128 v[88:91], v91
    ds_read_b128 v[92:95], v95
    ds_read_b128 v[96:99], v99
    ds_read_b128 v[100:103], v103
    ds_read_b128 v[104:107], v107
    v_add_u32 v108, s56, v2
    v_lshlrev_b32 v108, 2, v108
    v_add_u32 v108, 0x23400, v108
    ds_read_b32 v132, v108 offset:0
    ds_read_b32 v140, v108 offset:512
    ds_read_b32 v136, v108 offset:64
    ds_read_b32 v144, v108 offset:576
    s_waitcnt lgkmcnt(0)
    v_mov_b32 v133, v132
    v_sub_f32 v140, 0, v140
    v_mov_b32 v141, v140
    v_mov_b32 v137, v136
    v_sub_f32 v144, 0, v144
    v_mov_b32 v145, v144
    v_add_u32 v108, s56, v2
    v_mul_u32_u24 v108, 208, v108
    v_lshl_add_u32 v108, v3, 3, v108
    s_mul_i32 s37, s48, 32
    v_add_u32 v109, s37, v108
    v_accvgpr_read_b32 v112, a0
    v_accvgpr_read_b32 v113, a1
    v_accvgpr_read_b32 v114, a2
    v_accvgpr_read_b32 v115, a3
    v_pk_mul_f32 v[112:113], v[112:113], v[132:133]
    v_pk_mul_f32 v[114:115], v[114:115], v[132:133]
    v_pk_fma_f32 v[112:113], v[140:141], v[84:85], v[112:113]
    v_pk_fma_f32 v[114:115], v[140:141], v[86:87], v[114:115]
    v_cvt_pk_bf16_f32 v116, v112, v113
    v_cvt_pk_bf16_f32 v117, v114, v115
    ds_write_b64 v109, v[116:117] offset:0
    v_accvgpr_read_b32 v120, a24
    v_accvgpr_read_b32 v121, a25
    v_accvgpr_read_b32 v122, a26
    v_accvgpr_read_b32 v123, a27
    v_pk_mul_f32 v[120:121], v[120:121], v[136:137]
    v_pk_mul_f32 v[122:123], v[122:123], v[136:137]
    v_pk_fma_f32 v[120:121], v[144:145], v[84:85], v[120:121]
    v_pk_fma_f32 v[122:123], v[144:145], v[86:87], v[122:123]
    v_cvt_pk_bf16_f32 v124, v120, v121
    v_cvt_pk_bf16_f32 v125, v122, v123
    ds_write_b64 v109, v[124:125] offset:3328
    s_mul_i32 s37, s49, 32
    v_add_u32 v109, s37, v108
    v_accvgpr_read_b32 v112, a4
    v_accvgpr_read_b32 v113, a5
    v_accvgpr_read_b32 v114, a6
    v_accvgpr_read_b32 v115, a7
    v_pk_mul_f32 v[112:113], v[112:113], v[132:133]
    v_pk_mul_f32 v[114:115], v[114:115], v[132:133]
    v_pk_fma_f32 v[112:113], v[140:141], v[88:89], v[112:113]
    v_pk_fma_f32 v[114:115], v[140:141], v[90:91], v[114:115]
    v_cvt_pk_bf16_f32 v116, v112, v113
    v_cvt_pk_bf16_f32 v117, v114, v115
    ds_write_b64 v109, v[116:117] offset:0
    v_accvgpr_read_b32 v120, a28
    v_accvgpr_read_b32 v121, a29
    v_accvgpr_read_b32 v122, a30
    v_accvgpr_read_b32 v123, a31
    v_pk_mul_f32 v[120:121], v[120:121], v[136:137]
    v_pk_mul_f32 v[122:123], v[122:123], v[136:137]
    v_pk_fma_f32 v[120:121], v[144:145], v[88:89], v[120:121]
    v_pk_fma_f32 v[122:123], v[144:145], v[90:91], v[122:123]
    v_cvt_pk_bf16_f32 v124, v120, v121
    v_cvt_pk_bf16_f32 v125, v122, v123
    ds_write_b64 v109, v[124:125] offset:3328
    s_mul_i32 s37, s50, 32
    v_add_u32 v109, s37, v108
    v_accvgpr_read_b32 v112, a8
    v_accvgpr_read_b32 v113, a9
    v_accvgpr_read_b32 v114, a10
    v_accvgpr_read_b32 v115, a11
    v_pk_mul_f32 v[112:113], v[112:113], v[132:133]
    v_pk_mul_f32 v[114:115], v[114:115], v[132:133]
    v_pk_fma_f32 v[112:113], v[140:141], v[92:93], v[112:113]
    v_pk_fma_f32 v[114:115], v[140:141], v[94:95], v[114:115]
    v_cvt_pk_bf16_f32 v116, v112, v113
    v_cvt_pk_bf16_f32 v117, v114, v115
    ds_write_b64 v109, v[116:117] offset:0
    v_accvgpr_read_b32 v120, a32
    v_accvgpr_read_b32 v121, a33
    v_accvgpr_read_b32 v122, a34
    v_accvgpr_read_b32 v123, a35
    v_pk_mul_f32 v[120:121], v[120:121], v[136:137]
    v_pk_mul_f32 v[122:123], v[122:123], v[136:137]
    v_pk_fma_f32 v[120:121], v[144:145], v[92:93], v[120:121]
    v_pk_fma_f32 v[122:123], v[144:145], v[94:95], v[122:123]
    v_cvt_pk_bf16_f32 v124, v120, v121
    v_cvt_pk_bf16_f32 v125, v122, v123
    ds_write_b64 v109, v[124:125] offset:3328
    s_mul_i32 s37, s51, 32
    v_add_u32 v109, s37, v108
    v_accvgpr_read_b32 v112, a12
    v_accvgpr_read_b32 v113, a13
    v_accvgpr_read_b32 v114, a14
    v_accvgpr_read_b32 v115, a15
    v_pk_mul_f32 v[112:113], v[112:113], v[132:133]
    v_pk_mul_f32 v[114:115], v[114:115], v[132:133]
    v_pk_fma_f32 v[112:113], v[140:141], v[96:97], v[112:113]
    v_pk_fma_f32 v[114:115], v[140:141], v[98:99], v[114:115]
    v_cvt_pk_bf16_f32 v116, v112, v113
    v_cvt_pk_bf16_f32 v117, v114, v115
    ds_write_b64 v109, v[116:117] offset:0
    v_accvgpr_read_b32 v120, a36
    v_accvgpr_read_b32 v121, a37
    v_accvgpr_read_b32 v122, a38
    v_accvgpr_read_b32 v123, a39
    v_pk_mul_f32 v[120:121], v[120:121], v[136:137]
    v_pk_mul_f32 v[122:123], v[122:123], v[136:137]
    v_pk_fma_f32 v[120:121], v[144:145], v[96:97], v[120:121]
    v_pk_fma_f32 v[122:123], v[144:145], v[98:99], v[122:123]
    v_cvt_pk_bf16_f32 v124, v120, v121
    v_cvt_pk_bf16_f32 v125, v122, v123
    ds_write_b64 v109, v[124:125] offset:3328
    s_mul_i32 s37, s52, 32
    v_add_u32 v109, s37, v108
    v_accvgpr_read_b32 v112, a16
    v_accvgpr_read_b32 v113, a17
    v_accvgpr_read_b32 v114, a18
    v_accvgpr_read_b32 v115, a19
    v_pk_mul_f32 v[112:113], v[112:113], v[132:133]
    v_pk_mul_f32 v[114:115], v[114:115], v[132:133]
    v_pk_fma_f32 v[112:113], v[140:141], v[100:101], v[112:113]
    v_pk_fma_f32 v[114:115], v[140:141], v[102:103], v[114:115]
    v_cvt_pk_bf16_f32 v116, v112, v113
    v_cvt_pk_bf16_f32 v117, v114, v115
    ds_write_b64 v109, v[116:117] offset:0
    v_accvgpr_read_b32 v120, a40
    v_accvgpr_read_b32 v121, a41
    v_accvgpr_read_b32 v122, a42
    v_accvgpr_read_b32 v123, a43
    v_pk_mul_f32 v[120:121], v[120:121], v[136:137]
    v_pk_mul_f32 v[122:123], v[122:123], v[136:137]
    v_pk_fma_f32 v[120:121], v[144:145], v[100:101], v[120:121]
    v_pk_fma_f32 v[122:123], v[144:145], v[102:103], v[122:123]
    v_cvt_pk_bf16_f32 v124, v120, v121
    v_cvt_pk_bf16_f32 v125, v122, v123
    ds_write_b64 v109, v[124:125] offset:3328
    s_mul_i32 s37, s53, 32
    v_add_u32 v109, s37, v108
    v_accvgpr_read_b32 v112, a20
    v_accvgpr_read_b32 v113, a21
    v_accvgpr_read_b32 v114, a22
    v_accvgpr_read_b32 v115, a23
    v_pk_mul_f32 v[112:113], v[112:113], v[132:133]
    v_pk_mul_f32 v[114:115], v[114:115], v[132:133]
    v_pk_fma_f32 v[112:113], v[140:141], v[104:105], v[112:113]
    v_pk_fma_f32 v[114:115], v[140:141], v[106:107], v[114:115]
    v_cvt_pk_bf16_f32 v116, v112, v113
    v_cvt_pk_bf16_f32 v117, v114, v115
    ds_write_b64 v109, v[116:117] offset:0
    v_accvgpr_read_b32 v120, a44
    v_accvgpr_read_b32 v121, a45
    v_accvgpr_read_b32 v122, a46
    v_accvgpr_read_b32 v123, a47
    v_pk_mul_f32 v[120:121], v[120:121], v[136:137]
    v_pk_mul_f32 v[122:123], v[122:123], v[136:137]
    v_pk_fma_f32 v[120:121], v[144:145], v[104:105], v[120:121]
    v_pk_fma_f32 v[122:123], v[144:145], v[106:107], v[122:123]
    v_cvt_pk_bf16_f32 v124, v120, v121
    v_cvt_pk_bf16_f32 v125, v122, v123
    ds_write_b64 v109, v[124:125] offset:3328
    s_waitcnt lgkmcnt(0)
k6_kernel_phase2:
    s_barrier
    ds_read_b128 v[84:87], v151
    ds_read_b128 v[88:91], v152
    ds_read_b128 v[92:95], v153
    v_mov_b32 v108, 0xc0135761
    v_mov_b32 v109, 0xc0135761
    v_mov_b32 v110, 0xbdd2d3e8
    v_mov_b32 v111, 0xbdd2d3e8
    v_mov_b32 v128, 1.0
    v_mov_b32 v129, 1.0
    s_waitcnt lgkmcnt(2)
    v_lshlrev_b32 v112, 16, v84
    v_and_b32 v113, 0xffff0000, v84
    v_lshlrev_b32 v114, 16, v85
    v_and_b32 v115, 0xffff0000, v85
    v_lshlrev_b32 v116, 16, v86
    v_and_b32 v117, 0xffff0000, v86
    v_lshlrev_b32 v118, 16, v87
    v_and_b32 v119, 0xffff0000, v87
    v_pk_mul_f32 v[120:121], v[112:113], v[112:113]
    v_pk_mul_f32 v[122:123], v[114:115], v[114:115]
    v_pk_mul_f32 v[124:125], v[116:117], v[116:117]
    v_pk_mul_f32 v[126:127], v[118:119], v[118:119]
    v_pk_fma_f32 v[120:121], v[120:121], v[110:111], v[108:109]
    v_pk_fma_f32 v[122:123], v[122:123], v[110:111], v[108:109]
    v_pk_fma_f32 v[124:125], v[124:125], v[110:111], v[108:109]
    v_pk_fma_f32 v[126:127], v[126:127], v[110:111], v[108:109]
    v_pk_mul_f32 v[120:121], v[120:121], v[112:113]
    v_pk_mul_f32 v[122:123], v[122:123], v[114:115]
    v_pk_mul_f32 v[124:125], v[124:125], v[116:117]
    v_pk_mul_f32 v[126:127], v[126:127], v[118:119]
    v_exp_f32 v120, v120
    v_exp_f32 v121, v121
    v_exp_f32 v122, v122
    v_exp_f32 v123, v123
    v_exp_f32 v124, v124
    v_exp_f32 v125, v125
    v_exp_f32 v126, v126
    v_exp_f32 v127, v127
    s_nop 0
    v_pk_add_f32 v[120:121], v[120:121], v[128:129]
    v_pk_add_f32 v[122:123], v[122:123], v[128:129]
    v_pk_add_f32 v[124:125], v[124:125], v[128:129]
    v_pk_add_f32 v[126:127], v[126:127], v[128:129]
    v_rcp_f32 v120, v120
    v_rcp_f32 v121, v121
    v_rcp_f32 v122, v122
    v_rcp_f32 v123, v123
    v_rcp_f32 v124, v124
    v_rcp_f32 v125, v125
    v_rcp_f32 v126, v126
    v_rcp_f32 v127, v127
    s_nop 0
    v_pk_mul_f32 v[112:113], v[112:113], v[120:121]
    v_pk_mul_f32 v[114:115], v[114:115], v[122:123]
    v_pk_mul_f32 v[116:117], v[116:117], v[124:125]
    v_pk_mul_f32 v[118:119], v[118:119], v[126:127]
    v_cvt_pk_bf16_f32 v84, v112, v113
    v_cvt_pk_bf16_f32 v85, v114, v115
    v_cvt_pk_bf16_f32 v86, v116, v117
    v_cvt_pk_bf16_f32 v87, v118, v119
    buffer_store_dwordx4 v[84:87], v148, s[16:19], 0 offen
    s_waitcnt lgkmcnt(1)
    v_lshlrev_b32 v112, 16, v88
    v_and_b32 v113, 0xffff0000, v88
    v_lshlrev_b32 v114, 16, v89
    v_and_b32 v115, 0xffff0000, v89
    v_lshlrev_b32 v116, 16, v90
    v_and_b32 v117, 0xffff0000, v90
    v_lshlrev_b32 v118, 16, v91
    v_and_b32 v119, 0xffff0000, v91
    v_pk_mul_f32 v[120:121], v[112:113], v[112:113]
    v_pk_mul_f32 v[122:123], v[114:115], v[114:115]
    v_pk_mul_f32 v[124:125], v[116:117], v[116:117]
    v_pk_mul_f32 v[126:127], v[118:119], v[118:119]
    v_pk_fma_f32 v[120:121], v[120:121], v[110:111], v[108:109]
    v_pk_fma_f32 v[122:123], v[122:123], v[110:111], v[108:109]
    v_pk_fma_f32 v[124:125], v[124:125], v[110:111], v[108:109]
    v_pk_fma_f32 v[126:127], v[126:127], v[110:111], v[108:109]
    v_pk_mul_f32 v[120:121], v[120:121], v[112:113]
    v_pk_mul_f32 v[122:123], v[122:123], v[114:115]
    v_pk_mul_f32 v[124:125], v[124:125], v[116:117]
    v_pk_mul_f32 v[126:127], v[126:127], v[118:119]
    v_exp_f32 v120, v120
    v_exp_f32 v121, v121
    v_exp_f32 v122, v122
    v_exp_f32 v123, v123
    v_exp_f32 v124, v124
    v_exp_f32 v125, v125
    v_exp_f32 v126, v126
    v_exp_f32 v127, v127
    s_nop 0
    v_pk_add_f32 v[120:121], v[120:121], v[128:129]
    v_pk_add_f32 v[122:123], v[122:123], v[128:129]
    v_pk_add_f32 v[124:125], v[124:125], v[128:129]
    v_pk_add_f32 v[126:127], v[126:127], v[128:129]
    v_rcp_f32 v120, v120
    v_rcp_f32 v121, v121
    v_rcp_f32 v122, v122
    v_rcp_f32 v123, v123
    v_rcp_f32 v124, v124
    v_rcp_f32 v125, v125
    v_rcp_f32 v126, v126
    v_rcp_f32 v127, v127
    s_nop 0
    v_pk_mul_f32 v[112:113], v[112:113], v[120:121]
    v_pk_mul_f32 v[114:115], v[114:115], v[122:123]
    v_pk_mul_f32 v[116:117], v[116:117], v[124:125]
    v_pk_mul_f32 v[118:119], v[118:119], v[126:127]
    v_cvt_pk_bf16_f32 v88, v112, v113
    v_cvt_pk_bf16_f32 v89, v114, v115
    v_cvt_pk_bf16_f32 v90, v116, v117
    v_cvt_pk_bf16_f32 v91, v118, v119
    buffer_store_dwordx4 v[88:91], v149, s[16:19], 0 offen
    s_waitcnt lgkmcnt(0)
    v_lshlrev_b32 v112, 16, v92
    v_and_b32 v113, 0xffff0000, v92
    v_lshlrev_b32 v114, 16, v93
    v_and_b32 v115, 0xffff0000, v93
    v_lshlrev_b32 v116, 16, v94
    v_and_b32 v117, 0xffff0000, v94
    v_lshlrev_b32 v118, 16, v95
    v_and_b32 v119, 0xffff0000, v95
    v_pk_mul_f32 v[120:121], v[112:113], v[112:113]
    v_pk_mul_f32 v[122:123], v[114:115], v[114:115]
    v_pk_mul_f32 v[124:125], v[116:117], v[116:117]
    v_pk_mul_f32 v[126:127], v[118:119], v[118:119]
    v_pk_fma_f32 v[120:121], v[120:121], v[110:111], v[108:109]
    v_pk_fma_f32 v[122:123], v[122:123], v[110:111], v[108:109]
    v_pk_fma_f32 v[124:125], v[124:125], v[110:111], v[108:109]
    v_pk_fma_f32 v[126:127], v[126:127], v[110:111], v[108:109]
    v_pk_mul_f32 v[120:121], v[120:121], v[112:113]
    v_pk_mul_f32 v[122:123], v[122:123], v[114:115]
    v_pk_mul_f32 v[124:125], v[124:125], v[116:117]
    v_pk_mul_f32 v[126:127], v[126:127], v[118:119]
    v_exp_f32 v120, v120
    v_exp_f32 v121, v121
    v_exp_f32 v122, v122
    v_exp_f32 v123, v123
    v_exp_f32 v124, v124
    v_exp_f32 v125, v125
    v_exp_f32 v126, v126
    v_exp_f32 v127, v127
    s_nop 0
    v_pk_add_f32 v[120:121], v[120:121], v[128:129]
    v_pk_add_f32 v[122:123], v[122:123], v[128:129]
    v_pk_add_f32 v[124:125], v[124:125], v[128:129]
    v_pk_add_f32 v[126:127], v[126:127], v[128:129]
    v_rcp_f32 v120, v120
    v_rcp_f32 v121, v121
    v_rcp_f32 v122, v122
    v_rcp_f32 v123, v123
    v_rcp_f32 v124, v124
    v_rcp_f32 v125, v125
    v_rcp_f32 v126, v126
    v_rcp_f32 v127, v127
    s_nop 0
    v_pk_mul_f32 v[112:113], v[112:113], v[120:121]
    v_pk_mul_f32 v[114:115], v[114:115], v[122:123]
    v_pk_mul_f32 v[116:117], v[116:117], v[124:125]
    v_pk_mul_f32 v[118:119], v[118:119], v[126:127]
    v_cvt_pk_bf16_f32 v92, v112, v113
    v_cvt_pk_bf16_f32 v93, v114, v115
    v_cvt_pk_bf16_f32 v94, v116, v117
    v_cvt_pk_bf16_f32 v95, v118, v119
    buffer_store_dwordx4 v[92:95], v150, s[16:19], 0 offen
k6_kernel_end:
    s_endpgm
.p2align 8
.globl k7_kernel
.type k7_kernel,@function
k7_kernel:
    s_cmp_ge_u32 s2, 256
    s_cbranch_scc1 k7_kernel_end
    s_load_dwordx2 s[4:5], s[0:1], 80
    s_load_dwordx2 s[16:17], s[0:1], 64
    s_and_b32 s37, s2, 7
    s_lshr_b32 s38, s2, 3
    s_lshr_b32 s33, s38, 3
    s_and_b32 s34, s38, 7
    s_mul_i32 s37, s37, 4
    s_add_u32 s33, s33, s37
    s_mul_i32 s35, s33, 64
    s_mul_i32 s36, s34, 80
    v_and_b32 v1, 63, v0
    v_lshrrev_b32 v31, 6, v0
    v_and_b32 v2, 15, v0
    v_bfe_u32 v3, v0, 4, 2
    v_readfirstlane_b32 s43, v31
    s_and_b32 s32, s43, 3
    s_mul_i32 s56, s32, 16
    s_cmp_lt_u32 s43, 4
    s_cbranch_scc1 k7_kernel_cons
    v_lshrrev_b32 v31, 4, v1
    v_and_b32 v32, 15, v1
    v_add_u32 v31, s56, v31
    s_mov_b32 s38, 3072
    v_add_u32 v33, 0, v31
    v_and_b32 v34, 15, v33
    v_xor_b32 v34, v34, v32
    v_add_u32 v33, s35, v33
    v_mul_lo_u32 v33, v33, s38
    v_lshl_add_u32 v4, v34, 4, v33
    v_add_u32 v33, 4, v31
    v_and_b32 v34, 15, v33
    v_xor_b32 v34, v34, v32
    v_add_u32 v33, s35, v33
    v_mul_lo_u32 v33, v33, s38
    v_lshl_add_u32 v5, v34, 4, v33
    v_add_u32 v33, 8, v31
    v_and_b32 v34, 15, v33
    v_xor_b32 v34, v34, v32
    v_add_u32 v33, s35, v33
    v_mul_lo_u32 v33, v33, s38
    v_lshl_add_u32 v6, v34, 4, v33
    v_add_u32 v33, 12, v31
    v_and_b32 v34, 15, v33
    v_xor_b32 v34, v34, v32
    v_add_u32 v33, s35, v33
    v_mul_lo_u32 v33, v33, s38
    v_lshl_add_u32 v7, v34, 4, v33
    s_mul_i32 s37, s34, 245760
    s_mul_i32 s38, s32, 5120
    s_add_u32 s37, s37, s38
    v_lshl_add_u32 v8, v1, 4, s37
    s_waitcnt lgkmcnt(0)
    s_add_u32 s12, s4, 0x1ebc000
    s_addc_u32 s13, s5, 0
    s_and_b32 s13, s13, 0xffff
    s_mov_b32 s14, 0x1e0000
    s_mov_b32 s15, 0x00020000
    s_add_u32 s8, s4, 0x1480000
    s_addc_u32 s9, s5, 0
    s_and_b32 s9, s9, 0xffff
    s_mov_b32 s10, 0x600000
    s_mov_b32 s11, 0x00020000
    s_mul_i32 s39, s32, 4096
    s_mul_i32 s40, s32, 5120
    s_mov_b32 s46, 0x7ff00000
    s_mov_b32 s41, 0x0
    s_add_u32 m0, s39, 0x0
    s_nop 0
    buffer_load_dwordx4 v4, s[8:11], s41 offen lds
    s_add_u32 m0, s39, 0x400
    s_nop 0
    buffer_load_dwordx4 v5, s[8:11], s41 offen lds
    s_add_u32 m0, s39, 0x800
    s_nop 0
    buffer_load_dwordx4 v6, s[8:11], s41 offen lds
    s_add_u32 m0, s39, 0xc00
    s_nop 0
    buffer_load_dwordx4 v7, s[8:11], s41 offen lds
    s_add_u32 m0, s40, 0x4000
    s_mov_b32 s42, 0x0
    buffer_load_dwordx4 v8, s[12:15], s42 offen lds
    s_add_u32 m0, s40, 0x4400
    s_mov_b32 s42, 0x400
    buffer_load_dwordx4 v8, s[12:15], s42 offen lds
    s_add_u32 m0, s40, 0x4800
    s_mov_b32 s42, 0x800
    buffer_load_dwordx4 v8, s[12:15], s42 offen lds
    s_add_u32 m0, s40, 0x4c00
    s_mov_b32 s42, 0xc00
    buffer_load_dwordx4 v8, s[12:15], s42 offen lds
    s_add_u32 m0, s40, 0x5000
    s_mov_b32 s42, 0x1000
    buffer_load_dwordx4 v8, s[12:15], s42 offen lds
    s_mov_b32 s41, 0x100
    s_add_u32 m0, s39, 0x9000
    s_nop 0
    buffer_load_dwordx4 v4, s[8:11], s41 offen lds
    s_add_u32 m0, s39, 0x9400
    s_nop 0
    buffer_load_dwordx4 v5, s[8:11], s41 offen lds
    s_add_u32 m0, s39, 0x9800
    s_nop 0
    buffer_load_dwordx4 v6, s[8:11], s41 offen lds
    s_add_u32 m0, s39, 0x9c00
    s_nop 0
    buffer_load_dwordx4 v7, s[8:11], s41 offen lds
    s_add_u32 m0, s40, 0xd000
    s_mov_b32 s42, 0x5000
    buffer_load_dwordx4 v8, s[12:15], s42 offen lds
    s_add_u32 m0, s40, 0xd400
    s_mov_b32 s42, 0x5400
    buffer_load_dwordx4 v8, s[12:15], s42 offen lds
    s_add_u32 m0, s40, 0xd800
    s_mov_b32 s42, 0x5800
    buffer_load_dwordx4 v8, s[12:15], s42 offen lds
    s_add_u32 m0, s40, 0xdc00
    s_mov_b32 s42, 0x5c00
    buffer_load_dwordx4 v8, s[12:15], s42 offen lds
    s_add_u32 m0, s40, 0xe000
    s_mov_b32 s42, 0x6000
    buffer_load_dwordx4 v8, s[12:15], s42 offen lds
    s_mov_b32 s41, 0x200
    s_add_u32 m0, s39, 0x12000
    s_nop 0
    buffer_load_dwordx4 v4, s[8:11], s41 offen lds
    s_add_u32 m0, s39, 0x12400
    s_nop 0
    buffer_load_dwordx4 v5, s[8:11], s41 offen lds
    s_add_u32 m0, s39, 0x12800
    s_nop 0
    buffer_load_dwordx4 v6, s[8:11], s41 offen lds
    s_add_u32 m0, s39, 0x12c00
    s_nop 0
    buffer_load_dwordx4 v7, s[8:11], s41 offen lds
    s_add_u32 m0, s40, 0x16000
    s_mov_b32 s42, 0xa000
    buffer_load_dwordx4 v8, s[12:15], s42 offen lds
    s_add_u32 m0, s40, 0x16400
    s_mov_b32 s42, 0xa400
    buffer_load_dwordx4 v8, s[12:15], s42 offen lds
    s_add_u32 m0, s40, 0x16800
    s_mov_b32 s42, 0xa800
    buffer_load_dwordx4 v8, s[12:15], s42 offen lds
    s_add_u32 m0, s40, 0x16c00
    s_mov_b32 s42, 0xac00
    buffer_load_dwordx4 v8, s[12:15], s42 offen lds
    s_add_u32 m0, s40, 0x17000
    s_mov_b32 s42, 0xb000
    buffer_load_dwordx4 v8, s[12:15], s42 offen lds
    s_and_b32 s17, s17, 0xffff
    s_mov_b32 s18, 0x280000
    s_mov_b32 s19, 0x00020000
    s_add_u32 s20, s4, 0x1200000
    s_addc_u32 s21, s5, 0
    s_and_b32 s21, s21, 0xffff
    s_mov_b32 s22, 0x280000
    s_mov_b32 s23, 0x00020000
    s_add_u32 s24, s4, 0xd00000
    s_addc_u32 s25, s5, 0
    s_and_b32 s25, s25, 0xffff
    s_mov_b32 s26, 0x280000
    s_mov_b32 s27, 0x00020000
    s_mov_b32 s38, 6554
    s_mul_i32 s37, s43, 128
    v_add_u32 v31, s37, v1
    v_mul_lo_u32 v32, v31, s38
    v_lshrrev_b32 v32, 16, v32
    v_mul_u32_u24 v33, 10, v32
    v_sub_u32 v33, v31, v33
    v_mul_u32_u24 v34, 176, v32
    v_lshl_add_u32 v134, v33, 4, v34
    v_add_u32 v34, s35, v32
    v_mul_u32_u24 v34, 1280, v34
    v_lshl_add_u32 v34, v33, 4, v34
    v_lshl_add_u32 v132, s36, 1, v34
    v_cmp_le_u32 vcc, 640, v31
    v_mov_b32 v35, 0x7fffff00
    v_mov_b32 v36, 0
    v_cndmask_b32 v132, v132, v35, vcc
    v_cndmask_b32 v134, v134, v36, vcc
    v_add_u32 v31, s37, v1
    v_add_u32 v31, 64, v31
    v_mul_lo_u32 v32, v31, s38
    v_lshrrev_b32 v32, 16, v32
    v_mul_u32_u24 v33, 10, v32
    v_sub_u32 v33, v31, v33
    v_mul_u32_u24 v34, 176, v32
    v_lshl_add_u32 v135, v33, 4, v34
    v_add_u32 v34, s35, v32
    v_mul_u32_u24 v34, 1280, v34
    v_lshl_add_u32 v34, v33, 4, v34
    v_lshl_add_u32 v133, s36, 1, v34
    v_cmp_le_u32 vcc, 640, v31
    v_mov_b32 v35, 0x7fffff00
    v_mov_b32 v36, 0
    v_cndmask_b32 v133, v133, v35, vcc
    v_cndmask_b32 v135, v135, v36, vcc
    s_waitcnt vmcnt(18)
    s_barrier
    s_mov_b32 s41, 0x300
    s_add_u32 m0, s39, 0x1b000
    s_nop 0
    buffer_load_dwordx4 v4, s[8:11], s41 offen lds
    s_add_u32 m0, s39, 0x1b400
    s_nop 0
    buffer_load_dwordx4 v5, s[8:11], s41 offen lds
    s_add_u32 m0, s39, 0x1b800
    s_nop 0
    buffer_load_dwordx4 v6, s[8:11], s41 offen lds
    s_add_u32 m0, s39, 0x1bc00
    s_nop 0
    buffer_load_dwordx4 v7, s[8:11], s41 offen lds
    s_add_u32 m0, s40, 0x1f000
    s_mov_b32 s42, 0xf000
    buffer_load_dwordx4 v8, s[12:15], s42 offen lds
    s_add_u32 m0, s40, 0x1f400
    s_mov_b32 s42, 0xf400
    buffer_load_dwordx4 v8, s[12:15], s42 offen lds
    s_add_u32 m0, s40, 0x1f800
    s_mov_b32 s42, 0xf800
    buffer_load_dwordx4 v8, s[12:15], s42 offen lds
    s_add_u32 m0, s40, 0x1fc00
    s_mov_b32 s42, 0xfc00
    buffer_load_dwordx4 v8, s[12:15], s42 offen lds
    s_add_u32 m0, s40, 0x20000
    s_mov_b32 s42, 0x10000
    buffer_load_dwordx4 v8, s[12:15], s42 offen lds
    s_waitcnt vmcnt(18)
    s_barrier
    s_mov_b32 s41, 0x400
    s_add_u32 m0, s39, 0x0
    s_nop 0
    buffer_load_dwordx4 v4, s[8:11], s41 offen lds
    s_add_u32 m0, s39, 0x400
    s_nop 0
    buffer_load_dwordx4 v5, s[8:11], s41 offen lds
    s_add_u32 m0, s39, 0x800
    s_nop 0
    buffer_load_dwordx4 v6, s[8:11], s41 offen lds
    s_add_u32 m0, s39, 0xc00
    s_nop 0
    buffer_load_dwordx4 v7, s[8:11], s41 offen lds
    s_add_u32 m0, s40, 0x4000
    s_mov_b32 s42, 0x14000
    buffer_load_dwordx4 v8, s[12:15], s42 offen lds
    s_add_u32 m0, s40, 0x4400
    s_mov_b32 s42, 0x14400
    buffer_load_dwordx4 v8, s[12:15], s42 offen lds
    s_add_u32 m0, s40, 0x4800
    s_mov_b32 s42, 0x14800
    buffer_load_dwordx4 v8, s[12:15], s42 offen lds
    s_add_u32 m0, s40, 0x4c00
    s_mov_b32 s42, 0x14c00
    buffer_load_dwordx4 v8, s[12:15], s42 offen lds
    s_add_u32 m0, s40, 0x5000
    s_mov_b32 s42, 0x15000
    buffer_load_dwordx4 v8, s[12:15], s42 offen lds
    s_waitcnt vmcnt(18)
    s_barrier
    s_mov_b32 s41, 0x500
    s_add_u32 m0, s39, 0x9000
    s_nop 0
    buffer_load_dwordx4 v4, s[8:11], s41 offen lds
    s_add_u32 m0, s39, 0x9400
    s_nop 0
    buffer_load_dwordx4 v5, s[8:11], s41 offen lds
    s_add_u32 m0, s39, 0x9800
    s_nop 0
    buffer_load_dwordx4 v6, s[8:11], s41 offen lds
    s_add_u32 m0, s39, 0x9c00
    s_nop 0
    buffer_load_dwordx4 v7, s[8:11], s41 offen lds
    s_add_u32 m0, s40, 0xd000
    s_mov_b32 s42, 0x19000
    buffer_load_dwordx4 v8, s[12:15], s42 offen lds
    s_add_u32 m0, s40, 0xd400
    s_mov_b32 s42, 0x19400
    buffer_load_dwordx4 v8, s[12:15], s42 offen lds
    s_add_u32 m0, s40, 0xd800
    s_mov_b32 s42, 0x19800
    buffer_load_dwordx4 v8, s[12:15], s42 offen lds
    s_add_u32 m0, s40, 0xdc00
    s_mov_b32 s42, 0x19c00
    buffer_load_dwordx4 v8, s[12:15], s42 offen lds
    s_add_u32 m0, s40, 0xe000
    s_mov_b32 s42, 0x1a000
    buffer_load_dwordx4 v8, s[12:15], s42 offen lds
    s_waitcnt vmcnt(18)
    s_barrier
    s_mov_b32 s41, 0x600
    s_add_u32 m0, s39, 0x12000
    s_nop 0
    buffer_load_dwordx4 v4, s[8:11], s41 offen lds
    s_add_u32 m0, s39, 0x12400
    s_nop 0
    buffer_load_dwordx4 v5, s[8:11], s41 offen lds
    s_add_u32 m0, s39, 0x12800
    s_nop 0
    buffer_load_dwordx4 v6, s[8:11], s41 offen lds
    s_add_u32 m0, s39, 0x12c00
    s_nop 0
    buffer_load_dwordx4 v7, s[8:11], s41 offen lds
    s_add_u32 m0, s40, 0x16000
    s_mov_b32 s42, 0x1e000
    buffer_load_dwordx4 v8, s[12:15], s42 offen lds
    s_add_u32 m0, s40, 0x16400
    s_mov_b32 s42, 0x1e400
    buffer_load_dwordx4 v8, s[12:15], s42 offen lds
    s_add_u32 m0, s40, 0x16800
    s_mov_b32 s42, 0x1e800
    buffer_load_dwordx4 v8, s[12:15], s42 offen lds
    s_add_u32 m0, s40, 0x16c00
    s_mov_b32 s42, 0x1ec00
    buffer_load_dwordx4 v8, s[12:15], s42 offen lds
    s_add_u32 m0, s40, 0x17000
    s_mov_b32 s42, 0x1f000
    buffer_load_dwordx4 v8, s[12:15], s42 offen lds
    s_waitcnt vmcnt(18)
    s_barrier
    s_mov_b32 s41, 0x700
    s_add_u32 m0, s39, 0x1b000
    s_nop 0
    buffer_load_dwordx4 v4, s[8:11], s41 offen lds
    s_add_u32 m0, s39, 0x1b400
    s_nop 0
    buffer_load_dwordx4 v5, s[8:11], s41 offen lds
    s_add_u32 m0, s39, 0x1b800
    s_nop 0
    buffer_load_dwordx4 v6, s[8:11], s41 offen lds
    s_add_u32 m0, s39, 0x1bc00
    s_nop 0
    buffer_load_dwordx4 v7, s[8:11], s41 offen lds
    s_add_u32 m0, s40, 0x1f000
    s_mov_b32 s42, 0x23000
    buffer_load_dwordx4 v8, s[12:15], s42 offen lds
    s_add_u32 m0, s40, 0x1f400
    s_mov_b32 s42, 0x23400
    buffer_load_dwordx4 v8, s[12:15], s42 offen lds
    s_add_u32 m0, s40, 0x1f800
    s_mov_b32 s42, 0x23800
    buffer_load_dwordx4 v8, s[12:15], s42 offen lds
    s_add_u32 m0, s40, 0x1fc00
    s_mov_b32 s42, 0x23c00
    buffer_load_dwordx4 v8, s[12:15], s42 offen lds
    s_add_u32 m0, s40, 0x20000
    s_mov_b32 s42, 0x24000
    buffer_load_dwordx4 v8, s[12:15], s42 offen lds
    s_waitcnt vmcnt(18)
    s_barrier
    s_mov_b32 s41, 0x800
    s_add_u32 m0, s39, 0x0
    s_nop 0
    buffer_load_dwordx4 v4, s[8:11], s41 offen lds
    s_add_u32 m0, s39, 0x400
    s_nop 0
    buffer_load_dwordx4 v5, s[8:11], s41 offen lds
    s_add_u32 m0, s39, 0x800
    s_nop 0
    buffer_load_dwordx4 v6, s[8:11], s41 offen lds
    s_add_u32 m0, s39, 0xc00
    s_nop 0
    buffer_load_dwordx4 v7, s[8:11], s41 offen lds
    s_add_u32 m0, s40, 0x4000
    s_mov_b32 s42, 0x28000
    buffer_load_dwordx4 v8, s[12:15], s42 offen lds
    s_add_u32 m0, s40, 0x4400
    s_mov_b32 s42, 0x28400
    buffer_load_dwordx4 v8, s[12:15], s42 offen lds
    s_add_u32 m0, s40, 0x4800
    s_mov_b32 s42, 0x28800
    buffer_load_dwordx4 v8, s[12:15], s42 offen lds
    s_add_u32 m0, s40, 0x4c00
    s_mov_b32 s42, 0x28c00
    buffer_load_dwordx4 v8, s[12:15], s42 offen lds
    s_add_u32 m0, s40, 0x5000
    s_mov_b32 s42, 0x29000
    buffer_load_dwordx4 v8, s[12:15], s42 offen lds
    s_waitcnt vmcnt(18)
    s_barrier
    s_mov_b32 s41, 0x900
    s_add_u32 m0, s39, 0x9000
    s_nop 0
    buffer_load_dwordx4 v4, s[8:11], s41 offen lds
    s_add_u32 m0, s39, 0x9400
    s_nop 0
    buffer_load_dwordx4 v5, s[8:11], s41 offen lds
    s_add_u32 m0, s39, 0x9800
    s_nop 0
    buffer_load_dwordx4 v6, s[8:11], s41 offen lds
    s_add_u32 m0, s39, 0x9c00
    s_nop 0
    buffer_load_dwordx4 v7, s[8:11], s41 offen lds
    s_add_u32 m0, s40, 0xd000
    s_mov_b32 s42, 0x2d000
    buffer_load_dwordx4 v8, s[12:15], s42 offen lds
    s_add_u32 m0, s40, 0xd400
    s_mov_b32 s42, 0x2d400
    buffer_load_dwordx4 v8, s[12:15], s42 offen lds
    s_add_u32 m0, s40, 0xd800
    s_mov_b32 s42, 0x2d800
    buffer_load_dwordx4 v8, s[12:15], s42 offen lds
    s_add_u32 m0, s40, 0xdc00
    s_mov_b32 s42, 0x2dc00
    buffer_load_dwordx4 v8, s[12:15], s42 offen lds
    s_add_u32 m0, s40, 0xe000
    s_mov_b32 s42, 0x2e000
    buffer_load_dwordx4 v8, s[12:15], s42 offen lds
    s_waitcnt vmcnt(18)
    s_barrier
    s_mov_b32 s41, 0xa00
    s_add_u32 m0, s39, 0x12000
    s_nop 0
    buffer_load_dwordx4 v4, s[8:11], s41 offen lds
    s_add_u32 m0, s39, 0x12400
    s_nop 0
    buffer_load_dwordx4 v5, s[8:11], s41 offen lds
    s_add_u32 m0, s39, 0x12800
    s_nop 0
    buffer_load_dwordx4 v6, s[8:11], s41 offen lds
    s_add_u32 m0, s39, 0x12c00
    s_nop 0
    buffer_load_dwordx4 v7, s[8:11], s41 offen lds
    s_add_u32 m0, s40, 0x16000
    s_mov_b32 s42, 0x32000
    buffer_load_dwordx4 v8, s[12:15], s42 offen lds
    s_add_u32 m0, s40, 0x16400
    s_mov_b32 s42, 0x32400
    buffer_load_dwordx4 v8, s[12:15], s42 offen lds
    s_add_u32 m0, s40, 0x16800
    s_mov_b32 s42, 0x32800
    buffer_load_dwordx4 v8, s[12:15], s42 offen lds
    s_add_u32 m0, s40, 0x16c00
    s_mov_b32 s42, 0x32c00
    buffer_load_dwordx4 v8, s[12:15], s42 offen lds
    s_add_u32 m0, s40, 0x17000
    s_mov_b32 s42, 0x33000
    buffer_load_dwordx4 v8, s[12:15], s42 offen lds
    s_waitcnt vmcnt(18)
    s_barrier
    s_mov_b32 s41, 0xb00
    s_add_u32 m0, s39, 0x1b000
    s_nop 0
    buffer_load_dwordx4 v4, s[8:11], s41 offen lds
    s_add_u32 m0, s39, 0x1b400
    s_nop 0
    buffer_load_dwordx4 v5, s[8:11], s41 offen lds
    s_add_u32 m0, s39, 0x1b800
    s_nop 0
    buffer_load_dwordx4 v6, s[8:11], s41 offen lds
    s_add_u32 m0, s39, 0x1bc00
    s_nop 0
    buffer_load_dwordx4 v7, s[8:11], s41 offen lds
    s_add_u32 m0, s40, 0x1f000
    s_mov_b32 s42, 0x37000
    buffer_load_dwordx4 v8, s[12:15], s42 offen lds
    s_add_u32 m0, s40, 0x1f400
    s_mov_b32 s42, 0x37400
    buffer_load_dwordx4 v8, s[12:15], s42 offen lds
    s_add_u32 m0, s40, 0x1f800
    s_mov_b32 s42, 0x37800
    buffer_load_dwordx4 v8, s[12:15], s42 offen lds
    s_add_u32 m0, s40, 0x1fc00
    s_mov_b32 s42, 0x37c00
    buffer_load_dwordx4 v8, s[12:15], s42 offen lds
    s_add_u32 m0, s40, 0x20000
    s_mov_b32 s42, 0x38000
    buffer_load_dwordx4 v8, s[12:15], s42 offen lds
    s_waitcnt vmcnt(18)
    s_barrier
    s_waitcnt vmcnt(9)
    s_barrier
    buffer_load_dwordx4 v[136:139], v132, s[20:23], 0 offen
    buffer_load_dwordx4 v[140:143], v133, s[20:23], 0 offen
    buffer_load_dwordx4 v[144:147], v132, s[24:27], 0 offen
    buffer_load_dwordx4 v[148:151], v133, s[24:27], 0 offen
    s_waitcnt vmcnt(4)
    s_barrier
    s_barrier
    s_branch k7_kernel_phase2
k7_kernel_cons:
    s_waitcnt lgkmcnt(0)
    s_and_b32 s17, s17, 0xffff
    s_mov_b32 s18, 0x280000
    s_mov_b32 s19, 0x00020000
    s_add_u32 s20, s4, 0x1200000
    s_addc_u32 s21, s5, 0
    s_and_b32 s21, s21, 0xffff
    s_mov_b32 s22, 0x280000
    s_mov_b32 s23, 0x00020000
    s_add_u32 s24, s4, 0xd00000
    s_addc_u32 s25, s5, 0
    s_and_b32 s25, s25, 0xffff
    s_mov_b32 s26, 0x280000
    s_mov_b32 s27, 0x00020000
    s_mov_b32 s48, 0
    s_mov_b32 s49, 1
    s_mov_b32 s50, 2
    s_mov_b32 s51, 3
    s_mov_b32 s52, 4
    v_lshrrev_b32 v31, 2, v2
    v_lshl_add_u32 v32, v3, 2, v31
    v_mul_u32_u24 v33, 160, v32
    v_and_b32 v34, 3, v2
    v_lshl_add_u32 v33, v34, 3, v33
    v_add_u32 v33, 16384, v33
    v_and_b32 v32, 7, v32
    s_lshl_b32 s37, s48, 5
    v_add_u32 v4, s37, v33
    s_lshl_b32 s37, s49, 5
    v_add_u32 v5, s37, v33
    s_lshl_b32 s37, s50, 5
    v_add_u32 v6, s37, v33
    s_lshl_b32 s37, s51, 5
    v_add_u32 v7, s37, v33
    s_lshl_b32 s37, s52, 5
    v_add_u32 v8, s37, v33
    v_add_u32 v31, s56, v2
    v_mul_u32_u24 v31, 256, v31
    v_xor_b32 v32, v2, v3
    v_xor_b32 v33, 0, v32
    v_lshl_add_u32 v19, v33, 4, v31
    v_xor_b32 v33, 4, v32
    v_lshl_add_u32 v20, v33, 4, v31
    v_xor_b32 v33, 8, v32
    v_lshl_add_u32 v21, v33, 4, v31
    v_xor_b32 v33, 12, v32
    v_lshl_add_u32 v22, v33, 4, v31
    v_add_u32 v9, 0x10000, v4
    v_add_u32 v10, 0x10000, v5
    v_add_u32 v11, 0x10000, v6
    v_add_u32 v12, 0x10000, v7
    v_add_u32 v13, 0x10000, v8
    v_add_u32 v23, 0x10000, v19
    v_add_u32 v24, 0x10000, v20
    v_add_u32 v25, 0x10000, v21
    v_add_u32 v26, 0x10000, v22
    v_add_u32 v14, 0x20000, v4
    v_add_u32 v15, 0x20000, v5
    v_add_u32 v16, 0x20000, v6
    v_add_u32 v17, 0x20000, v7
    v_add_u32 v18, 0x20000, v8
    v_add_u32 v27, 0x20000, v19
    v_add_u32 v28, 0x20000, v20
    v_add_u32 v29, 0x20000, v21
    v_add_u32 v30, 0x20000, v22
    v_mov_b32 v44, 0x3f803f80
    v_mov_b32 v45, 0x3f803f80
    v_mov_b32 v46, 0x3f803f80
    v_mov_b32 v47, 0x3f803f80
    v_accvgpr_write_b32 a0, 0
    v_accvgpr_write_b32 a1, 0
    v_accvgpr_write_b32 a2, 0
    v_accvgpr_write_b32 a3, 0
    v_accvgpr_write_b32 a4, 0
    v_accvgpr_write_b32 a5, 0
    v_accvgpr_write_b32 a6, 0
    v_accvgpr_write_b32 a7, 0
    v_accvgpr_write_b32 a8, 0
    v_accvgpr_write_b32 a9, 0
    v_accvgpr_write_b32 a10, 0
    v_accvgpr_write_b32 a11, 0
    v_accvgpr_write_b32 a12, 0
    v_accvgpr_write_b32 a13, 0
    v_accvgpr_write_b32 a14, 0
    v_accvgpr_write_b32 a15, 0
    v_accvgpr_write_b32 a16, 0
    v_accvgpr_write_b32 a17, 0
    v_accvgpr_write_b32 a18, 0
    v_accvgpr_write_b32 a19, 0
    s_mov_b32 s38, 6554
    s_mul_i32 s37, s43, 128
    v_add_u32 v31, s37, v1
    v_mul_lo_u32 v32, v31, s38
    v_lshrrev_b32 v32, 16, v32
    v_mul_u32_u24 v33, 10, v32
    v_sub_u32 v33, v31, v33
    v_mul_u32_u24 v34, 176, v32
    v_lshl_add_u32 v134, v33, 4, v34
    v_add_u32 v34, s35, v32
    v_mul_u32_u24 v34, 1280, v34
    v_lshl_add_u32 v34, v33, 4, v34
    v_lshl_add_u32 v132, s36, 1, v34
    v_cmp_le_u32 vcc, 640, v31
    v_mov_b32 v35, 0x7fffff00
    v_mov_b32 v36, 0
    v_cndmask_b32 v132, v132, v35, vcc
    v_cndmask_b32 v134, v134, v36, vcc
    v_add_u32 v31, s37, v1
    v_add_u32 v31, 64, v31
    v_mul_lo_u32 v32, v31, s38
    v_lshrrev_b32 v32, 16, v32
    v_mul_u32_u24 v33, 10, v32
    v_sub_u32 v33, v31, v33
    v_mul_u32_u24 v34, 176, v32
    v_lshl_add_u32 v135, v33, 4, v34
    v_add_u32 v34, s35, v32
    v_mul_u32_u24 v34, 1280, v34
    v_lshl_add_u32 v34, v33, 4, v34
    v_lshl_add_u32 v133, s36, 1, v34
    v_cmp_le_u32 vcc, 640, v31
    v_mov_b32 v35, 0x7fffff00
    v_mov_b32 v36, 0
    v_cndmask_b32 v133, v133, v35, vcc
    v_cndmask_b32 v135, v135, v36, vcc
    s_barrier
    ds_read_b128 v[72:75], v19 offset:0
    ds_read_b64_tr_b16 v[48:49], v4 offset:0
    ds_read_b64_tr_b16 v[50:51], v4 offset:2560
    ds_read_b64_tr_b16 v[52:53], v5 offset:0
    ds_read_b64_tr_b16 v[54:55], v5 offset:2560
    ds_read_b64_tr_b16 v[56:57], v6 offset:0
    ds_read_b64_tr_b16 v[58:59], v6 offset:2560
    ds_read_b64_tr_b16 v[60:61], v7 offset:0
    ds_read_b64_tr_b16 v[62:63], v7 offset:2560
    ds_read_b64_tr_b16 v[64:65], v8 offset:0
    ds_read_b64_tr_b16 v[66:67], v8 offset:2560
    ds_read_b128 v[76:79], v20 offset:0
    ds_read_b64_tr_b16 v[68:69], v4 offset:5120
    ds_read_b64_tr_b16 v[70:71], v4 offset:7680
    s_waitcnt lgkmcnt(11)
    v_mfma_f32_16x16x32_bf16 a[0:3], v[48:51], v[72:75], a[0:3]
    ds_read_b64_tr_b16 v[48:49], v5 offset:5120
    ds_read_b64_tr_b16 v[50:51], v5 offset:7680
    s_waitcnt lgkmcnt(11)
    v_mfma_f32_16x16x32_bf16 a[4:7], v[52:55], v[72:75], a[4:7]
    ds_read_b64_tr_b16 v[52:53], v6 offset:5120
    ds_read_b64_tr_b16 v[54:55], v6 offset:7680
    s_waitcnt lgkmcnt(11)
    v_mfma_f32_16x16x32_bf16 a[8:11], v[56:59], v[72:75], a[8:11]
    ds_read_b64_tr_b16 v[56:57], v7 offset:5120
    ds_read_b64_tr_b16 v[58:59], v7 offset:7680
    s_waitcnt lgkmcnt(11)
    v_mfma_f32_16x16x32_bf16 a[12:15], v[60:63], v[72:75], a[12:15]
    ds_read_b64_tr_b16 v[60:61], v8 offset:5120
    ds_read_b64_tr_b16 v[62:63], v8 offset:7680
    s_waitcnt lgkmcnt(11)
    v_mfma_f32_16x16x32_bf16 a[16:19], v[64:67], v[72:75], a[16:19]
    ds_read_b128 v[72:75], v21 offset:0
    ds_read_b64_tr_b16 v[64:65], v4 offset:10240
    ds_read_b64_tr_b16 v[66:67], v4 offset:12800
    s_waitcnt lgkmcnt(11)
    v_mfma_f32_16x16x32_bf16 a[0:3], v[68:71], v[76:79], a[0:3]
    ds_read_b64_tr_b16 v[68:69], v5 offset:10240
    ds_read_b64_tr_b16 v[70:71], v5 offset:12800
    s_waitcnt lgkmcnt(11)
    v_mfma_f32_16x16x32_bf16 a[4:7], v[48:51], v[76:79], a[4:7]
    ds_read_b64_tr_b16 v[48:49], v6 offset:10240
    ds_read_b64_tr_b16 v[50:51], v6 offset:12800
    s_waitcnt lgkmcnt(11)
    v_mfma_f32_16x16x32_bf16 a[8:11], v[52:55], v[76:79], a[8:11]
    ds_read_b64_tr_b16 v[52:53], v7 offset:10240
    ds_read_b64_tr_b16 v[54:55], v7 offset:12800
    s_waitcnt lgkmcnt(11)
    v_mfma_f32_16x16x32_bf16 a[12:15], v[56:59], v[76:79], a[12:15]
    ds_read_b64_tr_b16 v[56:57], v8 offset:10240
    ds_read_b64_tr_b16 v[58:59], v8 offset:12800
    s_waitcnt lgkmcnt(11)
    v_mfma_f32_16x16x32_bf16 a[16:19], v[60:63], v[76:79], a[16:19]
    ds_read_b128 v[76:79], v22 offset:0
    ds_read_b64_tr_b16 v[60:61], v4 offset:15360
    ds_read_b64_tr_b16 v[62:63], v4 offset:17920
    s_waitcnt lgkmcnt(11)
    v_mfma_f32_16x16x32_bf16 a[0:3], v[64:67], v[72:75], a[0:3]
    ds_read_b64_tr_b16 v[64:65], v5 offset:15360
    ds_read_b64_tr_b16 v[66:67], v5 offset:17920
    s_waitcnt lgkmcnt(11)
    v_mfma_f32_16x16x32_bf16 a[4:7], v[68:71], v[72:75], a[4:7]
    ds_read_b64_tr_b16 v[68:69], v6 offset:15360
    ds_read_b64_tr_b16 v[70:71], v6 offset:17920
    s_waitcnt lgkmcnt(11)
    v_mfma_f32_16x16x32_bf16 a[8:11], v[48:51], v[72:75], a[8:11]
    ds_read_b64_tr_b16 v[48:49], v7 offset:15360
    ds_read_b64_tr_b16 v[50:51], v7 offset:17920
    s_waitcnt lgkmcnt(11)
    v_mfma_f32_16x16x32_bf16 a[12:15], v[52:55], v[72:75], a[12:15]
    ds_read_b64_tr_b16 v[52:53], v8 offset:15360
    ds_read_b64_tr_b16 v[54:55], v8 offset:17920
    s_waitcnt lgkmcnt(11)
    v_mfma_f32_16x16x32_bf16 a[16:19], v[56:59], v[72:75], a[16:19]
    s_waitcnt lgkmcnt(8)
    v_mfma_f32_16x16x32_bf16 a[0:3], v[60:63], v[76:79], a[0:3]
    s_waitcnt lgkmcnt(6)
    v_mfma_f32_16x16x32_bf16 a[4:7], v[64:67], v[76:79], a[4:7]
    s_waitcnt lgkmcnt(4)
    v_mfma_f32_16x16x32_bf16 a[8:11], v[68:71], v[76:79], a[8:11]
    s_waitcnt lgkmcnt(2)
    v_mfma_f32_16x16x32_bf16 a[12:15], v[48:51], v[76:79], a[12:15]
    s_waitcnt lgkmcnt(0)
    v_mfma_f32_16x16x32_bf16 a[16:19], v[52:55], v[76:79], a[16:19]
    s_barrier
    ds_read_b128 v[72:75], v19 offset:36864
    ds_read_b64_tr_b16 v[56:57], v4 offset:36864
    ds_read_b64_tr_b16 v[58:59], v4 offset:39424
    ds_read_b64_tr_b16 v[60:61], v5 offset:36864
    ds_read_b64_tr_b16 v[62:63], v5 offset:39424
    ds_read_b64_tr_b16 v[64:65], v6 offset:36864
    ds_read_b64_tr_b16 v[66:67], v6 offset:39424
    ds_read_b64_tr_b16 v[68:69], v7 offset:36864
    ds_read_b64_tr_b16 v[70:71], v7 offset:39424
    ds_read_b64_tr_b16 v[48:49], v8 offset:36864
    ds_read_b64_tr_b16 v[50:51], v8 offset:39424
    ds_read_b128 v[76:79], v20 offset:36864
    ds_read_b64_tr_b16 v[52:53], v4 offset:41984
    ds_read_b64_tr_b16 v[54:55], v4 offset:44544
    s_waitcnt lgkmcnt(11)
    v_mfma_f32_16x16x32_bf16 a[0:3], v[56:59], v[72:75], a[0:3]
    ds_read_b64_tr_b16 v[56:57], v5 offset:41984
    ds_read_b64_tr_b16 v[58:59], v5 offset:44544
    s_waitcnt lgkmcnt(11)
    v_mfma_f32_16x16x32_bf16 a[4:7], v[60:63], v[72:75], a[4:7]
    ds_read_b64_tr_b16 v[60:61], v6 offset:41984
    ds_read_b64_tr_b16 v[62:63], v6 offset:44544
    s_waitcnt lgkmcnt(11)
    v_mfma_f32_16x16x32_bf16 a[8:11], v[64:67], v[72:75], a[8:11]
    ds_read_b64_tr_b16 v[64:65], v7 offset:41984
    ds_read_b64_tr_b16 v[66:67], v7 offset:44544
    s_waitcnt lgkmcnt(11)
    v_mfma_f32_16x16x32_bf16 a[12:15], v[68:71], v[72:75], a[12:15]
    ds_read_b64_tr_b16 v[68:69], v8 offset:41984
    ds_read_b64_tr_b16 v[70:71], v8 offset:44544
    s_waitcnt lgkmcnt(11)
    v_mfma_f32_16x16x32_bf16 a[16:19], v[48:51], v[72:75], a[16:19]
    ds_read_b128 v[72:75], v21 offset:36864
    ds_read_b64_tr_b16 v[48:49], v4 offset:47104
    ds_read_b64_tr_b16 v[50:51], v4 offset:49664
    s_waitcnt lgkmcnt(11)
    v_mfma_f32_16x16x32_bf16 a[0:3], v[52:55], v[76:79], a[0:3]
    ds_read_b64_tr_b16 v[52:53], v5 offset:47104
    ds_read_b64_tr_b16 v[54:55], v5 offset:49664
    s_waitcnt lgkmcnt(11)
    v_mfma_f32_16x16x32_bf16 a[4:7], v[56:59], v[76:79], a[4:7]
    ds_read_b64_tr_b16 v[56:57], v6 offset:47104
    ds_read_b64_tr_b16 v[58:59], v6 offset:49664
    s_waitcnt lgkmcnt(11)
    v_mfma_f32_16x16x32_bf16 a[8:11], v[60:63], v[76:79], a[8:11]
    ds_read_b64_tr_b16 v[60:61], v7 offset:47104
    ds_read_b64_tr_b16 v[62:63], v7 offset:49664
    s_waitcnt lgkmcnt(11)
    v_mfma_f32_16x16x32_bf16 a[12:15], v[64:67], v[76:79], a[12:15]
    ds_read_b64_tr_b16 v[64:65], v8 offset:47104
    ds_read_b64_tr_b16 v[66:67], v8 offset:49664
    s_waitcnt lgkmcnt(11)
    v_mfma_f32_16x16x32_bf16 a[16:19], v[68:71], v[76:79], a[16:19]
    ds_read_b128 v[76:79], v22 offset:36864
    ds_read_b64_tr_b16 v[68:69], v4 offset:52224
    ds_read_b64_tr_b16 v[70:71], v4 offset:54784
    s_waitcnt lgkmcnt(11)
    v_mfma_f32_16x16x32_bf16 a[0:3], v[48:51], v[72:75], a[0:3]
    ds_read_b64_tr_b16 v[48:49], v5 offset:52224
    ds_read_b64_tr_b16 v[50:51], v5 offset:54784
    s_waitcnt lgkmcnt(11)
    v_mfma_f32_16x16x32_bf16 a[4:7], v[52:55], v[72:75], a[4:7]
    ds_read_b64_tr_b16 v[52:53], v6 offset:52224
    ds_read_b64_tr_b16 v[54:55], v6 offset:54784
    s_waitcnt lgkmcnt(11)
    v_mfma_f32_16x16x32_bf16 a[8:11], v[56:59], v[72:75], a[8:11]
    ds_read_b64_tr_b16 v[56:57], v7 offset:52224
    ds_read_b64_tr_b16 v[58:59], v7 offset:54784
    s_waitcnt lgkmcnt(11)
    v_mfma_f32_16x16x32_bf16 a[12:15], v[60:63], v[72:75], a[12:15]
    ds_read_b64_tr_b16 v[60:61], v8 offset:52224
    ds_read_b64_tr_b16 v[62:63], v8 offset:54784
    s_waitcnt lgkmcnt(11)
    v_mfma_f32_16x16x32_bf16 a[16:19], v[64:67], v[72:75], a[16:19]
    s_waitcnt lgkmcnt(8)
    v_mfma_f32_16x16x32_bf16 a[0:3], v[68:71], v[76:79], a[0:3]
    s_waitcnt lgkmcnt(6)
    v_mfma_f32_16x16x32_bf16 a[4:7], v[48:51], v[76:79], a[4:7]
    s_waitcnt lgkmcnt(4)
    v_mfma_f32_16x16x32_bf16 a[8:11], v[52:55], v[76:79], a[8:11]
    s_waitcnt lgkmcnt(2)
    v_mfma_f32_16x16x32_bf16 a[12:15], v[56:59], v[76:79], a[12:15]
    s_waitcnt lgkmcnt(0)
    v_mfma_f32_16x16x32_bf16 a[16:19], v[60:63], v[76:79], a[16:19]
    s_barrier
    ds_read_b128 v[72:75], v23 offset:8192
    ds_read_b64_tr_b16 v[64:65], v9 offset:8192
    ds_read_b64_tr_b16 v[66:67], v9 offset:10752
    ds_read_b64_tr_b16 v[68:69], v10 offset:8192
    ds_read_b64_tr_b16 v[70:71], v10 offset:10752
    ds_read_b64_tr_b16 v[48:49], v11 offset:8192
    ds_read_b64_tr_b16 v[50:51], v11 offset:10752
    ds_read_b64_tr_b16 v[52:53], v12 offset:8192
    ds_read_b64_tr_b16 v[54:55], v12 offset:10752
    ds_read_b64_tr_b16 v[56:57], v13 offset:8192
    ds_read_b64_tr_b16 v[58:59], v13 offset:10752
    ds_read_b128 v[76:79], v24 offset:8192
    ds_read_b64_tr_b16 v[60:61], v9 offset:13312
    ds_read_b64_tr_b16 v[62:63], v9 offset:15872
    s_waitcnt lgkmcnt(11)
    v_mfma_f32_16x16x32_bf16 a[0:3], v[64:67], v[72:75], a[0:3]
    ds_read_b64_tr_b16 v[64:65], v10 offset:13312
    ds_read_b64_tr_b16 v[66:67], v10 offset:15872
    s_waitcnt lgkmcnt(11)
    v_mfma_f32_16x16x32_bf16 a[4:7], v[68:71], v[72:75], a[4:7]
    ds_read_b64_tr_b16 v[68:69], v11 offset:13312
    ds_read_b64_tr_b16 v[70:71], v11 offset:15872
    s_waitcnt lgkmcnt(11)
    v_mfma_f32_16x16x32_bf16 a[8:11], v[48:51], v[72:75], a[8:11]
    ds_read_b64_tr_b16 v[48:49], v12 offset:13312
    ds_read_b64_tr_b16 v[50:51], v12 offset:15872
    s_waitcnt lgkmcnt(11)
    v_mfma_f32_16x16x32_bf16 a[12:15], v[52:55], v[72:75], a[12:15]
    ds_read_b64_tr_b16 v[52:53], v13 offset:13312
    ds_read_b64_tr_b16 v[54:55], v13 offset:15872
    s_waitcnt lgkmcnt(11)
    v_mfma_f32_16x16x32_bf16 a[16:19], v[56:59], v[72:75], a[16:19]
    ds_read_b128 v[72:75], v25 offset:8192
    ds_read_b64_tr_b16 v[56:57], v9 offset:18432
    ds_read_b64_tr_b16 v[58:59], v9 offset:20992
    s_waitcnt lgkmcnt(11)
    v_mfma_f32_16x16x32_bf16 a[0:3], v[60:63], v[76:79], a[0:3]
    ds_read_b64_tr_b16 v[60:61], v10 offset:18432
    ds_read_b64_tr_b16 v[62:63], v10 offset:20992
    s_waitcnt lgkmcnt(11)
    v_mfma_f32_16x16x32_bf16 a[4:7], v[64:67], v[76:79], a[4:7]
    ds_read_b64_tr_b16 v[64:65], v11 offset:18432
    ds_read_b64_tr_b16 v[66:67], v11 offset:20992
    s_waitcnt lgkmcnt(11)
    v_mfma_f32_16x16x32_bf16 a[8:11], v[68:71], v[76:79], a[8:11]
    ds_read_b64_tr_b16 v[68:69], v12 offset:18432
    ds_read_b64_tr_b16 v[70:71], v12 offset:20992
    s_waitcnt lgkmcnt(11)
    v_mfma_f32_16x16x32_bf16 a[12:15], v[48:51], v[76:79], a[12:15]
    ds_read_b64_tr_b16 v[48:49], v13 offset:18432
    ds_read_b64_tr_b16 v[50:51], v13 offset:20992
    s_waitcnt lgkmcnt(11)
    v_mfma_f32_16x16x32_bf16 a[16:19], v[52:55], v[76:79], a[16:19]
    ds_read_b128 v[76:79], v26 offset:8192
    ds_read_b64_tr_b16 v[52:53], v9 offset:23552
    ds_read_b64_tr_b16 v[54:55], v9 offset:26112
    s_waitcnt lgkmcnt(11)
    v_mfma_f32_16x16x32_bf16 a[0:3], v[56:59], v[72:75], a[0:3]
    ds_read_b64_tr_b16 v[56:57], v10 offset:23552
    ds_read_b64_tr_b16 v[58:59], v10 offset:26112
    s_waitcnt lgkmcnt(11)
    v_mfma_f32_16x16x32_bf16 a[4:7], v[60:63], v[72:75], a[4:7]
    ds_read_b64_tr_b16 v[60:61], v11 offset:23552
    ds_read_b64_tr_b16 v[62:63], v11 offset:26112
    s_waitcnt lgkmcnt(11)
    v_mfma_f32_16x16x32_bf16 a[8:11], v[64:67], v[72:75], a[8:11]
    ds_read_b64_tr_b16 v[64:65], v12 offset:23552
    ds_read_b64_tr_b16 v[66:67], v12 offset:26112
    s_waitcnt lgkmcnt(11)
    v_mfma_f32_16x16x32_bf16 a[12:15], v[68:71], v[72:75], a[12:15]
    ds_read_b64_tr_b16 v[68:69], v13 offset:23552
    ds_read_b64_tr_b16 v[70:71], v13 offset:26112
    s_waitcnt lgkmcnt(11)
    v_mfma_f32_16x16x32_bf16 a[16:19], v[48:51], v[72:75], a[16:19]
    s_waitcnt lgkmcnt(8)
    v_mfma_f32_16x16x32_bf16 a[0:3], v[52:55], v[76:79], a[0:3]
    s_waitcnt lgkmcnt(6)
    v_mfma_f32_16x16x32_bf16 a[4:7], v[56:59], v[76:79], a[4:7]
    s_waitcnt lgkmcnt(4)
    v_mfma_f32_16x16x32_bf16 a[8:11], v[60:63], v[76:79], a[8:11]
    s_waitcnt lgkmcnt(2)
    v_mfma_f32_16x16x32_bf16 a[12:15], v[64:67], v[76:79], a[12:15]
    s_waitcnt lgkmcnt(0)
    v_mfma_f32_16x16x32_bf16 a[16:19], v[68:71], v[76:79], a[16:19]
    s_barrier
    ds_read_b128 v[72:75], v23 offset:45056
    ds_read_b64_tr_b16 v[48:49], v9 offset:45056
    ds_read_b64_tr_b16 v[50:51], v9 offset:47616
    ds_read_b64_tr_b16 v[52:53], v10 offset:45056
    ds_read_b64_tr_b16 v[54:55], v10 offset:47616
    ds_read_b64_tr_b16 v[56:57], v11 offset:45056
    ds_read_b64_tr_b16 v[58:59], v11 offset:47616
    ds_read_b64_tr_b16 v[60:61], v12 offset:45056
    ds_read_b64_tr_b16 v[62:63], v12 offset:47616
    ds_read_b64_tr_b16 v[64:65], v13 offset:45056
    ds_read_b64_tr_b16 v[66:67], v13 offset:47616
    ds_read_b128 v[76:79], v24 offset:45056
    ds_read_b64_tr_b16 v[68:69], v9 offset:50176
    ds_read_b64_tr_b16 v[70:71], v9 offset:52736
    s_waitcnt lgkmcnt(11)
    v_mfma_f32_16x16x32_bf16 a[0:3], v[48:51], v[72:75], a[0:3]
    ds_read_b64_tr_b16 v[48:49], v10 offset:50176
    ds_read_b64_tr_b16 v[50:51], v10 offset:52736
    s_waitcnt lgkmcnt(11)
    v_mfma_f32_16x16x32_bf16 a[4:7], v[52:55], v[72:75], a[4:7]
    ds_read_b64_tr_b16 v[52:53], v11 offset:50176
    ds_read_b64_tr_b16 v[54:55], v11 offset:52736
    s_waitcnt lgkmcnt(11)
    v_mfma_f32_16x16x32_bf16 a[8:11], v[56:59], v[72:75], a[8:11]
    ds_read_b64_tr_b16 v[56:57], v12 offset:50176
    ds_read_b64_tr_b16 v[58:59], v12 offset:52736
    s_waitcnt lgkmcnt(11)
    v_mfma_f32_16x16x32_bf16 a[12:15], v[60:63], v[72:75], a[12:15]
    ds_read_b64_tr_b16 v[60:61], v13 offset:50176
    ds_read_b64_tr_b16 v[62:63], v13 offset:52736
    s_waitcnt lgkmcnt(11)
    v_mfma_f32_16x16x32_bf16 a[16:19], v[64:67], v[72:75], a[16:19]
    ds_read_b128 v[72:75], v25 offset:45056
    ds_read_b64_tr_b16 v[64:65], v9 offset:55296
    ds_read_b64_tr_b16 v[66:67], v9 offset:57856
    s_waitcnt lgkmcnt(11)
    v_mfma_f32_16x16x32_bf16 a[0:3], v[68:71], v[76:79], a[0:3]
    ds_read_b64_tr_b16 v[68:69], v10 offset:55296
    ds_read_b64_tr_b16 v[70:71], v10 offset:57856
    s_waitcnt lgkmcnt(11)
    v_mfma_f32_16x16x32_bf16 a[4:7], v[48:51], v[76:79], a[4:7]
    ds_read_b64_tr_b16 v[48:49], v11 offset:55296
    ds_read_b64_tr_b16 v[50:51], v11 offset:57856
    s_waitcnt lgkmcnt(11)
    v_mfma_f32_16x16x32_bf16 a[8:11], v[52:55], v[76:79], a[8:11]
    ds_read_b64_tr_b16 v[52:53], v12 offset:55296
    ds_read_b64_tr_b16 v[54:55], v12 offset:57856
    s_waitcnt lgkmcnt(11)
    v_mfma_f32_16x16x32_bf16 a[12:15], v[56:59], v[76:79], a[12:15]
    ds_read_b64_tr_b16 v[56:57], v13 offset:55296
    ds_read_b64_tr_b16 v[58:59], v13 offset:57856
    s_waitcnt lgkmcnt(11)
    v_mfma_f32_16x16x32_bf16 a[16:19], v[60:63], v[76:79], a[16:19]
    ds_read_b128 v[76:79], v26 offset:45056
    ds_read_b64_tr_b16 v[60:61], v9 offset:60416
    ds_read_b64_tr_b16 v[62:63], v9 offset:62976
    s_waitcnt lgkmcnt(11)
    v_mfma_f32_16x16x32_bf16 a[0:3], v[64:67], v[72:75], a[0:3]
    ds_read_b64_tr_b16 v[64:65], v10 offset:60416
    ds_read_b64_tr_b16 v[66:67], v10 offset:62976
    s_waitcnt lgkmcnt(11)
    v_mfma_f32_16x16x32_bf16 a[4:7], v[68:71], v[72:75], a[4:7]
    ds_read_b64_tr_b16 v[68:69], v11 offset:60416
    ds_read_b64_tr_b16 v[70:71], v11 offset:62976
    s_waitcnt lgkmcnt(11)
    v_mfma_f32_16x16x32_bf16 a[8:11], v[48:51], v[72:75], a[8:11]
    ds_read_b64_tr_b16 v[48:49], v12 offset:60416
    ds_read_b64_tr_b16 v[50:51], v12 offset:62976
    s_waitcnt lgkmcnt(11)
    v_mfma_f32_16x16x32_bf16 a[12:15], v[52:55], v[72:75], a[12:15]
    ds_read_b64_tr_b16 v[52:53], v13 offset:60416
    ds_read_b64_tr_b16 v[54:55], v13 offset:62976
    s_waitcnt lgkmcnt(11)
    v_mfma_f32_16x16x32_bf16 a[16:19], v[56:59], v[72:75], a[16:19]
    s_waitcnt lgkmcnt(8)
    v_mfma_f32_16x16x32_bf16 a[0:3], v[60:63], v[76:79], a[0:3]
    s_waitcnt lgkmcnt(6)
    v_mfma_f32_16x16x32_bf16 a[4:7], v[64:67], v[76:79], a[4:7]
    s_waitcnt lgkmcnt(4)
    v_mfma_f32_16x16x32_bf16 a[8:11], v[68:71], v[76:79], a[8:11]
    s_waitcnt lgkmcnt(2)
    v_mfma_f32_16x16x32_bf16 a[12:15], v[48:51], v[76:79], a[12:15]
    s_waitcnt lgkmcnt(0)
    v_mfma_f32_16x16x32_bf16 a[16:19], v[52:55], v[76:79], a[16:19]
    s_barrier
    ds_read_b128 v[72:75], v19 offset:0
    ds_read_b64_tr_b16 v[56:57], v4 offset:0
    ds_read_b64_tr_b16 v[58:59], v4 offset:2560
    ds_read_b64_tr_b16 v[60:61], v5 offset:0
    ds_read_b64_tr_b16 v[62:63], v5 offset:2560
    ds_read_b64_tr_b16 v[64:65], v6 offset:0
    ds_read_b64_tr_b16 v[66:67], v6 offset:2560
    ds_read_b64_tr_b16 v[68:69], v7 offset:0
    ds_read_b64_tr_b16 v[70:71], v7 offset:2560
    ds_read_b64_tr_b16 v[48:49], v8 offset:0
    ds_read_b64_tr_b16 v[50:51], v8 offset:2560
    ds_read_b128 v[76:79], v20 offset:0
    ds_read_b64_tr_b16 v[52:53], v4 offset:5120
    ds_read_b64_tr_b16 v[54:55], v4 offset:7680
    s_waitcnt lgkmcnt(11)
    v_mfma_f32_16x16x32_bf16 a[0:3], v[56:59], v[72:75], a[0:3]
    ds_read_b64_tr_b16 v[56:57], v5 offset:5120
    ds_read_b64_tr_b16 v[58:59], v5 offset:7680
    s_waitcnt lgkmcnt(11)
    v_mfma_f32_16x16x32_bf16 a[4:7], v[60:63], v[72:75], a[4:7]
    ds_read_b64_tr_b16 v[60:61], v6 offset:5120
    ds_read_b64_tr_b16 v[62:63], v6 offset:7680
    s_waitcnt lgkmcnt(11)
    v_mfma_f32_16x16x32_bf16 a[8:11], v[64:67], v[72:75], a[8:11]
    ds_read_b64_tr_b16 v[64:65], v7 offset:5120
    ds_read_b64_tr_b16 v[66:67], v7 offset:7680
    s_waitcnt lgkmcnt(11)
    v_mfma_f32_16x16x32_bf16 a[12:15], v[68:71], v[72:75], a[12:15]
    ds_read_b64_tr_b16 v[68:69], v8 offset:5120
    ds_read_b64_tr_b16 v[70:71], v8 offset:7680
    s_waitcnt lgkmcnt(11)
    v_mfma_f32_16x16x32_bf16 a[16:19], v[48:51], v[72:75], a[16:19]
    ds_read_b128 v[72:75], v21 offset:0
    ds_read_b64_tr_b16 v[48:49], v4 offset:10240
    ds_read_b64_tr_b16 v[50:51], v4 offset:12800
    s_waitcnt lgkmcnt(11)
    v_mfma_f32_16x16x32_bf16 a[0:3], v[52:55], v[76:79], a[0:3]
    ds_read_b64_tr_b16 v[52:53], v5 offset:10240
    ds_read_b64_tr_b16 v[54:55], v5 offset:12800
    s_waitcnt lgkmcnt(11)
    v_mfma_f32_16x16x32_bf16 a[4:7], v[56:59], v[76:79], a[4:7]
    ds_read_b64_tr_b16 v[56:57], v6 offset:10240
    ds_read_b64_tr_b16 v[58:59], v6 offset:12800
    s_waitcnt lgkmcnt(11)
    v_mfma_f32_16x16x32_bf16 a[8:11], v[60:63], v[76:79], a[8:11]
    ds_read_b64_tr_b16 v[60:61], v7 offset:10240
    ds_read_b64_tr_b16 v[62:63], v7 offset:12800
    s_waitcnt lgkmcnt(11)
    v_mfma_f32_16x16x32_bf16 a[12:15], v[64:67], v[76:79], a[12:15]
    ds_read_b64_tr_b16 v[64:65], v8 offset:10240
    ds_read_b64_tr_b16 v[66:67], v8 offset:12800
    s_waitcnt lgkmcnt(11)
    v_mfma_f32_16x16x32_bf16 a[16:19], v[68:71], v[76:79], a[16:19]
    ds_read_b128 v[76:79], v22 offset:0
    ds_read_b64_tr_b16 v[68:69], v4 offset:15360
    ds_read_b64_tr_b16 v[70:71], v4 offset:17920
    s_waitcnt lgkmcnt(11)
    v_mfma_f32_16x16x32_bf16 a[0:3], v[48:51], v[72:75], a[0:3]
    ds_read_b64_tr_b16 v[48:49], v5 offset:15360
    ds_read_b64_tr_b16 v[50:51], v5 offset:17920
    s_waitcnt lgkmcnt(11)
    v_mfma_f32_16x16x32_bf16 a[4:7], v[52:55], v[72:75], a[4:7]
    ds_read_b64_tr_b16 v[52:53], v6 offset:15360
    ds_read_b64_tr_b16 v[54:55], v6 offset:17920
    s_waitcnt lgkmcnt(11)
    v_mfma_f32_16x16x32_bf16 a[8:11], v[56:59], v[72:75], a[8:11]
    ds_read_b64_tr_b16 v[56:57], v7 offset:15360
    ds_read_b64_tr_b16 v[58:59], v7 offset:17920
    s_waitcnt lgkmcnt(11)
    v_mfma_f32_16x16x32_bf16 a[12:15], v[60:63], v[72:75], a[12:15]
    ds_read_b64_tr_b16 v[60:61], v8 offset:15360
    ds_read_b64_tr_b16 v[62:63], v8 offset:17920
    s_waitcnt lgkmcnt(11)
    v_mfma_f32_16x16x32_bf16 a[16:19], v[64:67], v[72:75], a[16:19]
    s_waitcnt lgkmcnt(8)
    v_mfma_f32_16x16x32_bf16 a[0:3], v[68:71], v[76:79], a[0:3]
    s_waitcnt lgkmcnt(6)
    v_mfma_f32_16x16x32_bf16 a[4:7], v[48:51], v[76:79], a[4:7]
    s_waitcnt lgkmcnt(4)
    v_mfma_f32_16x16x32_bf16 a[8:11], v[52:55], v[76:79], a[8:11]
    s_waitcnt lgkmcnt(2)
    v_mfma_f32_16x16x32_bf16 a[12:15], v[56:59], v[76:79], a[12:15]
    s_waitcnt lgkmcnt(0)
    v_mfma_f32_16x16x32_bf16 a[16:19], v[60:63], v[76:79], a[16:19]
    s_barrier
    ds_read_b128 v[72:75], v19 offset:36864
    ds_read_b64_tr_b16 v[64:65], v4 offset:36864
    ds_read_b64_tr_b16 v[66:67], v4 offset:39424
    ds_read_b64_tr_b16 v[68:69], v5 offset:36864
    ds_read_b64_tr_b16 v[70:71], v5 offset:39424
    ds_read_b64_tr_b16 v[48:49], v6 offset:36864
    ds_read_b64_tr_b16 v[50:51], v6 offset:39424
    ds_read_b64_tr_b16 v[52:53], v7 offset:36864
    ds_read_b64_tr_b16 v[54:55], v7 offset:39424
    ds_read_b64_tr_b16 v[56:57], v8 offset:36864
    ds_read_b64_tr_b16 v[58:59], v8 offset:39424
    ds_read_b128 v[76:79], v20 offset:36864
    ds_read_b64_tr_b16 v[60:61], v4 offset:41984
    ds_read_b64_tr_b16 v[62:63], v4 offset:44544
    s_waitcnt lgkmcnt(11)
    v_mfma_f32_16x16x32_bf16 a[0:3], v[64:67], v[72:75], a[0:3]
    ds_read_b64_tr_b16 v[64:65], v5 offset:41984
    ds_read_b64_tr_b16 v[66:67], v5 offset:44544
    s_waitcnt lgkmcnt(11)
    v_mfma_f32_16x16x32_bf16 a[4:7], v[68:71], v[72:75], a[4:7]
    ds_read_b64_tr_b16 v[68:69], v6 offset:41984
    ds_read_b64_tr_b16 v[70:71], v6 offset:44544
    s_waitcnt lgkmcnt(11)
    v_mfma_f32_16x16x32_bf16 a[8:11], v[48:51], v[72:75], a[8:11]
    ds_read_b64_tr_b16 v[48:49], v7 offset:41984
    ds_read_b64_tr_b16 v[50:51], v7 offset:44544
    s_waitcnt lgkmcnt(11)
    v_mfma_f32_16x16x32_bf16 a[12:15], v[52:55], v[72:75], a[12:15]
    ds_read_b64_tr_b16 v[52:53], v8 offset:41984
    ds_read_b64_tr_b16 v[54:55], v8 offset:44544
    s_waitcnt lgkmcnt(11)
    v_mfma_f32_16x16x32_bf16 a[16:19], v[56:59], v[72:75], a[16:19]
    ds_read_b128 v[72:75], v21 offset:36864
    ds_read_b64_tr_b16 v[56:57], v4 offset:47104
    ds_read_b64_tr_b16 v[58:59], v4 offset:49664
    s_waitcnt lgkmcnt(11)
    v_mfma_f32_16x16x32_bf16 a[0:3], v[60:63], v[76:79], a[0:3]
    ds_read_b64_tr_b16 v[60:61], v5 offset:47104
    ds_read_b64_tr_b16 v[62:63], v5 offset:49664
    s_waitcnt lgkmcnt(11)
    v_mfma_f32_16x16x32_bf16 a[4:7], v[64:67], v[76:79], a[4:7]
    ds_read_b64_tr_b16 v[64:65], v6 offset:47104
    ds_read_b64_tr_b16 v[66:67], v6 offset:49664
    s_waitcnt lgkmcnt(11)
    v_mfma_f32_16x16x32_bf16 a[8:11], v[68:71], v[76:79], a[8:11]
    ds_read_b64_tr_b16 v[68:69], v7 offset:47104
    ds_read_b64_tr_b16 v[70:71], v7 offset:49664
    s_waitcnt lgkmcnt(11)
    v_mfma_f32_16x16x32_bf16 a[12:15], v[48:51], v[76:79], a[12:15]
    ds_read_b64_tr_b16 v[48:49], v8 offset:47104
    ds_read_b64_tr_b16 v[50:51], v8 offset:49664
    s_waitcnt lgkmcnt(11)
    v_mfma_f32_16x16x32_bf16 a[16:19], v[52:55], v[76:79], a[16:19]
    ds_read_b128 v[76:79], v22 offset:36864
    ds_read_b64_tr_b16 v[52:53], v4 offset:52224
    ds_read_b64_tr_b16 v[54:55], v4 offset:54784
    s_waitcnt lgkmcnt(11)
    v_mfma_f32_16x16x32_bf16 a[0:3], v[56:59], v[72:75], a[0:3]
    ds_read_b64_tr_b16 v[56:57], v5 offset:52224
    ds_read_b64_tr_b16 v[58:59], v5 offset:54784
    s_waitcnt lgkmcnt(11)
    v_mfma_f32_16x16x32_bf16 a[4:7], v[60:63], v[72:75], a[4:7]
    ds_read_b64_tr_b16 v[60:61], v6 offset:52224
    ds_read_b64_tr_b16 v[62:63], v6 offset:54784
    s_waitcnt lgkmcnt(11)
    v_mfma_f32_16x16x32_bf16 a[8:11], v[64:67], v[72:75], a[8:11]
    ds_read_b64_tr_b16 v[64:65], v7 offset:52224
    ds_read_b64_tr_b16 v[66:67], v7 offset:54784
    s_waitcnt lgkmcnt(11)
    v_mfma_f32_16x16x32_bf16 a[12:15], v[68:71], v[72:75], a[12:15]
    ds_read_b64_tr_b16 v[68:69], v8 offset:52224
    ds_read_b64_tr_b16 v[70:71], v8 offset:54784
    s_waitcnt lgkmcnt(11)
    v_mfma_f32_16x16x32_bf16 a[16:19], v[48:51], v[72:75], a[16:19]
    s_waitcnt lgkmcnt(8)
    v_mfma_f32_16x16x32_bf16 a[0:3], v[52:55], v[76:79], a[0:3]
    s_waitcnt lgkmcnt(6)
    v_mfma_f32_16x16x32_bf16 a[4:7], v[56:59], v[76:79], a[4:7]
    s_waitcnt lgkmcnt(4)
    v_mfma_f32_16x16x32_bf16 a[8:11], v[60:63], v[76:79], a[8:11]
    s_waitcnt lgkmcnt(2)
    v_mfma_f32_16x16x32_bf16 a[12:15], v[64:67], v[76:79], a[12:15]
    s_waitcnt lgkmcnt(0)
    v_mfma_f32_16x16x32_bf16 a[16:19], v[68:71], v[76:79], a[16:19]
    s_barrier
    ds_read_b128 v[72:75], v23 offset:8192
    ds_read_b64_tr_b16 v[48:49], v9 offset:8192
    ds_read_b64_tr_b16 v[50:51], v9 offset:10752
    ds_read_b64_tr_b16 v[52:53], v10 offset:8192
    ds_read_b64_tr_b16 v[54:55], v10 offset:10752
    ds_read_b64_tr_b16 v[56:57], v11 offset:8192
    ds_read_b64_tr_b16 v[58:59], v11 offset:10752
    ds_read_b64_tr_b16 v[60:61], v12 offset:8192
    ds_read_b64_tr_b16 v[62:63], v12 offset:10752
    ds_read_b64_tr_b16 v[64:65], v13 offset:8192
    ds_read_b64_tr_b16 v[66:67], v13 offset:10752
    ds_read_b128 v[76:79], v24 offset:8192
    ds_read_b64_tr_b16 v[68:69], v9 offset:13312
    ds_read_b64_tr_b16 v[70:71], v9 offset:15872
    s_waitcnt lgkmcnt(11)
    v_mfma_f32_16x16x32_bf16 a[0:3], v[48:51], v[72:75], a[0:3]
    ds_read_b64_tr_b16 v[48:49], v10 offset:13312
    ds_read_b64_tr_b16 v[50:51], v10 offset:15872
    s_waitcnt lgkmcnt(11)
    v_mfma_f32_16x16x32_bf16 a[4:7], v[52:55], v[72:75], a[4:7]
    ds_read_b64_tr_b16 v[52:53], v11 offset:13312
    ds_read_b64_tr_b16 v[54:55], v11 offset:15872
    s_waitcnt lgkmcnt(11)
    v_mfma_f32_16x16x32_bf16 a[8:11], v[56:59], v[72:75], a[8:11]
    ds_read_b64_tr_b16 v[56:57], v12 offset:13312
    ds_read_b64_tr_b16 v[58:59], v12 offset:15872
    s_waitcnt lgkmcnt(11)
    v_mfma_f32_16x16x32_bf16 a[12:15], v[60:63], v[72:75], a[12:15]
    ds_read_b64_tr_b16 v[60:61], v13 offset:13312
    ds_read_b64_tr_b16 v[62:63], v13 offset:15872
    s_waitcnt lgkmcnt(11)
    v_mfma_f32_16x16x32_bf16 a[16:19], v[64:67], v[72:75], a[16:19]
    ds_read_b128 v[72:75], v25 offset:8192
    ds_read_b64_tr_b16 v[64:65], v9 offset:18432
    ds_read_b64_tr_b16 v[66:67], v9 offset:20992
    s_waitcnt lgkmcnt(11)
    v_mfma_f32_16x16x32_bf16 a[0:3], v[68:71], v[76:79], a[0:3]
    ds_read_b64_tr_b16 v[68:69], v10 offset:18432
    ds_read_b64_tr_b16 v[70:71], v10 offset:20992
    s_waitcnt lgkmcnt(11)
    v_mfma_f32_16x16x32_bf16 a[4:7], v[48:51], v[76:79], a[4:7]
    ds_read_b64_tr_b16 v[48:49], v11 offset:18432
    ds_read_b64_tr_b16 v[50:51], v11 offset:20992
    s_waitcnt lgkmcnt(11)
    v_mfma_f32_16x16x32_bf16 a[8:11], v[52:55], v[76:79], a[8:11]
    ds_read_b64_tr_b16 v[52:53], v12 offset:18432
    ds_read_b64_tr_b16 v[54:55], v12 offset:20992
    s_waitcnt lgkmcnt(11)
    v_mfma_f32_16x16x32_bf16 a[12:15], v[56:59], v[76:79], a[12:15]
    ds_read_b64_tr_b16 v[56:57], v13 offset:18432
    ds_read_b64_tr_b16 v[58:59], v13 offset:20992
    s_waitcnt lgkmcnt(11)
    v_mfma_f32_16x16x32_bf16 a[16:19], v[60:63], v[76:79], a[16:19]
    ds_read_b128 v[76:79], v26 offset:8192
    ds_read_b64_tr_b16 v[60:61], v9 offset:23552
    ds_read_b64_tr_b16 v[62:63], v9 offset:26112
    s_waitcnt lgkmcnt(11)
    v_mfma_f32_16x16x32_bf16 a[0:3], v[64:67], v[72:75], a[0:3]
    ds_read_b64_tr_b16 v[64:65], v10 offset:23552
    ds_read_b64_tr_b16 v[66:67], v10 offset:26112
    s_waitcnt lgkmcnt(11)
    v_mfma_f32_16x16x32_bf16 a[4:7], v[68:71], v[72:75], a[4:7]
    ds_read_b64_tr_b16 v[68:69], v11 offset:23552
    ds_read_b64_tr_b16 v[70:71], v11 offset:26112
    s_waitcnt lgkmcnt(11)
    v_mfma_f32_16x16x32_bf16 a[8:11], v[48:51], v[72:75], a[8:11]
    ds_read_b64_tr_b16 v[48:49], v12 offset:23552
    ds_read_b64_tr_b16 v[50:51], v12 offset:26112
    s_waitcnt lgkmcnt(11)
    v_mfma_f32_16x16x32_bf16 a[12:15], v[52:55], v[72:75], a[12:15]
    ds_read_b64_tr_b16 v[52:53], v13 offset:23552
    ds_read_b64_tr_b16 v[54:55], v13 offset:26112
    s_waitcnt lgkmcnt(11)
    v_mfma_f32_16x16x32_bf16 a[16:19], v[56:59], v[72:75], a[16:19]
    s_waitcnt lgkmcnt(8)
    v_mfma_f32_16x16x32_bf16 a[0:3], v[60:63], v[76:79], a[0:3]
    s_waitcnt lgkmcnt(6)
    v_mfma_f32_16x16x32_bf16 a[4:7], v[64:67], v[76:79], a[4:7]
    s_waitcnt lgkmcnt(4)
    v_mfma_f32_16x16x32_bf16 a[8:11], v[68:71], v[76:79], a[8:11]
    s_waitcnt lgkmcnt(2)
    v_mfma_f32_16x16x32_bf16 a[12:15], v[48:51], v[76:79], a[12:15]
    s_waitcnt lgkmcnt(0)
    v_mfma_f32_16x16x32_bf16 a[16:19], v[52:55], v[76:79], a[16:19]
    s_barrier
    ds_read_b128 v[72:75], v23 offset:45056
    ds_read_b64_tr_b16 v[56:57], v9 offset:45056
    ds_read_b64_tr_b16 v[58:59], v9 offset:47616
    ds_read_b64_tr_b16 v[60:61], v10 offset:45056
    ds_read_b64_tr_b16 v[62:63], v10 offset:47616
    ds_read_b64_tr_b16 v[64:65], v11 offset:45056
    ds_read_b64_tr_b16 v[66:67], v11 offset:47616
    ds_read_b64_tr_b16 v[68:69], v12 offset:45056
    ds_read_b64_tr_b16 v[70:71], v12 offset:47616
    ds_read_b64_tr_b16 v[48:49], v13 offset:45056
    ds_read_b64_tr_b16 v[50:51], v13 offset:47616
    ds_read_b128 v[76:79], v24 offset:45056
    ds_read_b64_tr_b16 v[52:53], v9 offset:50176
    ds_read_b64_tr_b16 v[54:55], v9 offset:52736
    s_waitcnt lgkmcnt(11)
    v_mfma_f32_16x16x32_bf16 a[0:3], v[56:59], v[72:75], a[0:3]
    ds_read_b64_tr_b16 v[56:57], v10 offset:50176
    ds_read_b64_tr_b16 v[58:59], v10 offset:52736
    s_waitcnt lgkmcnt(11)
    v_mfma_f32_16x16x32_bf16 a[4:7], v[60:63], v[72:75], a[4:7]
    ds_read_b64_tr_b16 v[60:61], v11 offset:50176
    ds_read_b64_tr_b16 v[62:63], v11 offset:52736
    s_waitcnt lgkmcnt(11)
    v_mfma_f32_16x16x32_bf16 a[8:11], v[64:67], v[72:75], a[8:11]
    ds_read_b64_tr_b16 v[64:65], v12 offset:50176
    ds_read_b64_tr_b16 v[66:67], v12 offset:52736
    s_waitcnt lgkmcnt(11)
    v_mfma_f32_16x16x32_bf16 a[12:15], v[68:71], v[72:75], a[12:15]
    ds_read_b64_tr_b16 v[68:69], v13 offset:50176
    ds_read_b64_tr_b16 v[70:71], v13 offset:52736
    s_waitcnt lgkmcnt(11)
    v_mfma_f32_16x16x32_bf16 a[16:19], v[48:51], v[72:75], a[16:19]
    ds_read_b128 v[72:75], v25 offset:45056
    ds_read_b64_tr_b16 v[48:49], v9 offset:55296
    ds_read_b64_tr_b16 v[50:51], v9 offset:57856
    s_waitcnt lgkmcnt(11)
    v_mfma_f32_16x16x32_bf16 a[0:3], v[52:55], v[76:79], a[0:3]
    ds_read_b64_tr_b16 v[52:53], v10 offset:55296
    ds_read_b64_tr_b16 v[54:55], v10 offset:57856
    s_waitcnt lgkmcnt(11)
    v_mfma_f32_16x16x32_bf16 a[4:7], v[56:59], v[76:79], a[4:7]
    ds_read_b64_tr_b16 v[56:57], v11 offset:55296
    ds_read_b64_tr_b16 v[58:59], v11 offset:57856
    s_waitcnt lgkmcnt(11)
    v_mfma_f32_16x16x32_bf16 a[8:11], v[60:63], v[76:79], a[8:11]
    ds_read_b64_tr_b16 v[60:61], v12 offset:55296
    ds_read_b64_tr_b16 v[62:63], v12 offset:57856
    s_waitcnt lgkmcnt(11)
    v_mfma_f32_16x16x32_bf16 a[12:15], v[64:67], v[76:79], a[12:15]
    ds_read_b64_tr_b16 v[64:65], v13 offset:55296
    ds_read_b64_tr_b16 v[66:67], v13 offset:57856
    s_waitcnt lgkmcnt(11)
    v_mfma_f32_16x16x32_bf16 a[16:19], v[68:71], v[76:79], a[16:19]
    ds_read_b128 v[76:79], v26 offset:45056
    ds_read_b64_tr_b16 v[68:69], v9 offset:60416
    ds_read_b64_tr_b16 v[70:71], v9 offset:62976
    s_waitcnt lgkmcnt(11)
    v_mfma_f32_16x16x32_bf16 a[0:3], v[48:51], v[72:75], a[0:3]
    ds_read_b64_tr_b16 v[48:49], v10 offset:60416
    ds_read_b64_tr_b16 v[50:51], v10 offset:62976
    s_waitcnt lgkmcnt(11)
    v_mfma_f32_16x16x32_bf16 a[4:7], v[52:55], v[72:75], a[4:7]
    ds_read_b64_tr_b16 v[52:53], v11 offset:60416
    ds_read_b64_tr_b16 v[54:55], v11 offset:62976
    s_waitcnt lgkmcnt(11)
    v_mfma_f32_16x16x32_bf16 a[8:11], v[56:59], v[72:75], a[8:11]
    ds_read_b64_tr_b16 v[56:57], v12 offset:60416
    ds_read_b64_tr_b16 v[58:59], v12 offset:62976
    s_waitcnt lgkmcnt(11)
    v_mfma_f32_16x16x32_bf16 a[12:15], v[60:63], v[72:75], a[12:15]
    ds_read_b64_tr_b16 v[60:61], v13 offset:60416
    ds_read_b64_tr_b16 v[62:63], v13 offset:62976
    s_waitcnt lgkmcnt(11)
    v_mfma_f32_16x16x32_bf16 a[16:19], v[64:67], v[72:75], a[16:19]
    s_waitcnt lgkmcnt(8)
    v_mfma_f32_16x16x32_bf16 a[0:3], v[68:71], v[76:79], a[0:3]
    s_waitcnt lgkmcnt(6)
    v_mfma_f32_16x16x32_bf16 a[4:7], v[48:51], v[76:79], a[4:7]
    s_waitcnt lgkmcnt(4)
    v_mfma_f32_16x16x32_bf16 a[8:11], v[52:55], v[76:79], a[8:11]
    s_waitcnt lgkmcnt(2)
    v_mfma_f32_16x16x32_bf16 a[12:15], v[56:59], v[76:79], a[12:15]
    s_waitcnt lgkmcnt(0)
    v_mfma_f32_16x16x32_bf16 a[16:19], v[60:63], v[76:79], a[16:19]
    s_barrier
    ds_read_b128 v[72:75], v19 offset:0
    ds_read_b64_tr_b16 v[64:65], v4 offset:0
    ds_read_b64_tr_b16 v[66:67], v4 offset:2560
    ds_read_b64_tr_b16 v[68:69], v5 offset:0
    ds_read_b64_tr_b16 v[70:71], v5 offset:2560
    ds_read_b64_tr_b16 v[48:49], v6 offset:0
    ds_read_b64_tr_b16 v[50:51], v6 offset:2560
    ds_read_b64_tr_b16 v[52:53], v7 offset:0
    ds_read_b64_tr_b16 v[54:55], v7 offset:2560
    ds_read_b64_tr_b16 v[56:57], v8 offset:0
    ds_read_b64_tr_b16 v[58:59], v8 offset:2560
    ds_read_b128 v[76:79], v20 offset:0
    ds_read_b64_tr_b16 v[60:61], v4 offset:5120
    ds_read_b64_tr_b16 v[62:63], v4 offset:7680
    s_waitcnt lgkmcnt(11)
    v_mfma_f32_16x16x32_bf16 a[0:3], v[64:67], v[72:75], a[0:3]
    ds_read_b64_tr_b16 v[64:65], v5 offset:5120
    ds_read_b64_tr_b16 v[66:67], v5 offset:7680
    s_waitcnt lgkmcnt(11)
    v_mfma_f32_16x16x32_bf16 a[4:7], v[68:71], v[72:75], a[4:7]
    ds_read_b64_tr_b16 v[68:69], v6 offset:5120
    ds_read_b64_tr_b16 v[70:71], v6 offset:7680
    s_waitcnt lgkmcnt(11)
    v_mfma_f32_16x16x32_bf16 a[8:11], v[48:51], v[72:75], a[8:11]
    ds_read_b64_tr_b16 v[48:49], v7 offset:5120
    ds_read_b64_tr_b16 v[50:51], v7 offset:7680
    s_waitcnt lgkmcnt(11)
    v_mfma_f32_16x16x32_bf16 a[12:15], v[52:55], v[72:75], a[12:15]
    ds_read_b64_tr_b16 v[52:53], v8 offset:5120
    ds_read_b64_tr_b16 v[54:55], v8 offset:7680
    s_waitcnt lgkmcnt(11)
    v_mfma_f32_16x16x32_bf16 a[16:19], v[56:59], v[72:75], a[16:19]
    ds_read_b128 v[72:75], v21 offset:0
    ds_read_b64_tr_b16 v[56:57], v4 offset:10240
    ds_read_b64_tr_b16 v[58:59], v4 offset:12800
    s_waitcnt lgkmcnt(11)
    v_mfma_f32_16x16x32_bf16 a[0:3], v[60:63], v[76:79], a[0:3]
    ds_read_b64_tr_b16 v[60:61], v5 offset:10240
    ds_read_b64_tr_b16 v[62:63], v5 offset:12800
    s_waitcnt lgkmcnt(11)
    v_mfma_f32_16x16x32_bf16 a[4:7], v[64:67], v[76:79], a[4:7]
    ds_read_b64_tr_b16 v[64:65], v6 offset:10240
    ds_read_b64_tr_b16 v[66:67], v6 offset:12800
    s_waitcnt lgkmcnt(11)
    v_mfma_f32_16x16x32_bf16 a[8:11], v[68:71], v[76:79], a[8:11]
    ds_read_b64_tr_b16 v[68:69], v7 offset:10240
    ds_read_b64_tr_b16 v[70:71], v7 offset:12800
    s_waitcnt lgkmcnt(11)
    v_mfma_f32_16x16x32_bf16 a[12:15], v[48:51], v[76:79], a[12:15]
    ds_read_b64_tr_b16 v[48:49], v8 offset:10240
    ds_read_b64_tr_b16 v[50:51], v8 offset:12800
    s_waitcnt lgkmcnt(11)
    v_mfma_f32_16x16x32_bf16 a[16:19], v[52:55], v[76:79], a[16:19]
    ds_read_b128 v[76:79], v22 offset:0
    ds_read_b64_tr_b16 v[52:53], v4 offset:15360
    ds_read_b64_tr_b16 v[54:55], v4 offset:17920
    s_waitcnt lgkmcnt(11)
    v_mfma_f32_16x16x32_bf16 a[0:3], v[56:59], v[72:75], a[0:3]
    ds_read_b64_tr_b16 v[56:57], v5 offset:15360
    ds_read_b64_tr_b16 v[58:59], v5 offset:17920
    s_waitcnt lgkmcnt(11)
    v_mfma_f32_16x16x32_bf16 a[4:7], v[60:63], v[72:75], a[4:7]
    ds_read_b64_tr_b16 v[60:61], v6 offset:15360
    ds_read_b64_tr_b16 v[62:63], v6 offset:17920
    s_waitcnt lgkmcnt(11)
    v_mfma_f32_16x16x32_bf16 a[8:11], v[64:67], v[72:75], a[8:11]
    ds_read_b64_tr_b16 v[64:65], v7 offset:15360
    ds_read_b64_tr_b16 v[66:67], v7 offset:17920
    s_waitcnt lgkmcnt(11)
    v_mfma_f32_16x16x32_bf16 a[12:15], v[68:71], v[72:75], a[12:15]
    ds_read_b64_tr_b16 v[68:69], v8 offset:15360
    ds_read_b64_tr_b16 v[70:71], v8 offset:17920
    s_waitcnt lgkmcnt(11)
    v_mfma_f32_16x16x32_bf16 a[16:19], v[48:51], v[72:75], a[16:19]
    s_waitcnt lgkmcnt(8)
    v_mfma_f32_16x16x32_bf16 a[0:3], v[52:55], v[76:79], a[0:3]
    s_waitcnt lgkmcnt(6)
    v_mfma_f32_16x16x32_bf16 a[4:7], v[56:59], v[76:79], a[4:7]
    s_waitcnt lgkmcnt(4)
    v_mfma_f32_16x16x32_bf16 a[8:11], v[60:63], v[76:79], a[8:11]
    s_waitcnt lgkmcnt(2)
    v_mfma_f32_16x16x32_bf16 a[12:15], v[64:67], v[76:79], a[12:15]
    s_waitcnt lgkmcnt(0)
    v_mfma_f32_16x16x32_bf16 a[16:19], v[68:71], v[76:79], a[16:19]
    s_barrier
    ds_read_b128 v[72:75], v19 offset:36864
    ds_read_b64_tr_b16 v[48:49], v4 offset:36864
    ds_read_b64_tr_b16 v[50:51], v4 offset:39424
    ds_read_b64_tr_b16 v[52:53], v5 offset:36864
    ds_read_b64_tr_b16 v[54:55], v5 offset:39424
    ds_read_b64_tr_b16 v[56:57], v6 offset:36864
    ds_read_b64_tr_b16 v[58:59], v6 offset:39424
    ds_read_b64_tr_b16 v[60:61], v7 offset:36864
    ds_read_b64_tr_b16 v[62:63], v7 offset:39424
    ds_read_b64_tr_b16 v[64:65], v8 offset:36864
    ds_read_b64_tr_b16 v[66:67], v8 offset:39424
    ds_read_b128 v[76:79], v20 offset:36864
    ds_read_b64_tr_b16 v[68:69], v4 offset:41984
    ds_read_b64_tr_b16 v[70:71], v4 offset:44544
    s_waitcnt lgkmcnt(11)
    v_mfma_f32_16x16x32_bf16 a[0:3], v[48:51], v[72:75], a[0:3]
    ds_read_b64_tr_b16 v[48:49], v5 offset:41984
    ds_read_b64_tr_b16 v[50:51], v5 offset:44544
    s_waitcnt lgkmcnt(11)
    v_mfma_f32_16x16x32_bf16 a[4:7], v[52:55], v[72:75], a[4:7]
    ds_read_b64_tr_b16 v[52:53], v6 offset:41984
    ds_read_b64_tr_b16 v[54:55], v6 offset:44544
    s_waitcnt lgkmcnt(11)
    v_mfma_f32_16x16x32_bf16 a[8:11], v[56:59], v[72:75], a[8:11]
    ds_read_b64_tr_b16 v[56:57], v7 offset:41984
    ds_read_b64_tr_b16 v[58:59], v7 offset:44544
    s_waitcnt lgkmcnt(11)
    v_mfma_f32_16x16x32_bf16 a[12:15], v[60:63], v[72:75], a[12:15]
    ds_read_b64_tr_b16 v[60:61], v8 offset:41984
    ds_read_b64_tr_b16 v[62:63], v8 offset:44544
    s_waitcnt lgkmcnt(11)
    v_mfma_f32_16x16x32_bf16 a[16:19], v[64:67], v[72:75], a[16:19]
    ds_read_b128 v[72:75], v21 offset:36864
    ds_read_b64_tr_b16 v[64:65], v4 offset:47104
    ds_read_b64_tr_b16 v[66:67], v4 offset:49664
    s_waitcnt lgkmcnt(11)
    v_mfma_f32_16x16x32_bf16 a[0:3], v[68:71], v[76:79], a[0:3]
    ds_read_b64_tr_b16 v[68:69], v5 offset:47104
    ds_read_b64_tr_b16 v[70:71], v5 offset:49664
    s_waitcnt lgkmcnt(11)
    v_mfma_f32_16x16x32_bf16 a[4:7], v[48:51], v[76:79], a[4:7]
    ds_read_b64_tr_b16 v[48:49], v6 offset:47104
    ds_read_b64_tr_b16 v[50:51], v6 offset:49664
    s_waitcnt lgkmcnt(11)
    v_mfma_f32_16x16x32_bf16 a[8:11], v[52:55], v[76:79], a[8:11]
    ds_read_b64_tr_b16 v[52:53], v7 offset:47104
    ds_read_b64_tr_b16 v[54:55], v7 offset:49664
    s_waitcnt lgkmcnt(11)
    v_mfma_f32_16x16x32_bf16 a[12:15], v[56:59], v[76:79], a[12:15]
    ds_read_b64_tr_b16 v[56:57], v8 offset:47104
    ds_read_b64_tr_b16 v[58:59], v8 offset:49664
    s_waitcnt lgkmcnt(11)
    v_mfma_f32_16x16x32_bf16 a[16:19], v[60:63], v[76:79], a[16:19]
    ds_read_b128 v[76:79], v22 offset:36864
    ds_read_b64_tr_b16 v[60:61], v4 offset:52224
    ds_read_b64_tr_b16 v[62:63], v4 offset:54784
    s_waitcnt lgkmcnt(11)
    v_mfma_f32_16x16x32_bf16 a[0:3], v[64:67], v[72:75], a[0:3]
    ds_read_b64_tr_b16 v[64:65], v5 offset:52224
    ds_read_b64_tr_b16 v[66:67], v5 offset:54784
    s_waitcnt lgkmcnt(11)
    v_mfma_f32_16x16x32_bf16 a[4:7], v[68:71], v[72:75], a[4:7]
    ds_read_b64_tr_b16 v[68:69], v6 offset:52224
    ds_read_b64_tr_b16 v[70:71], v6 offset:54784
    s_waitcnt lgkmcnt(11)
    v_mfma_f32_16x16x32_bf16 a[8:11], v[48:51], v[72:75], a[8:11]
    ds_read_b64_tr_b16 v[48:49], v7 offset:52224
    ds_read_b64_tr_b16 v[50:51], v7 offset:54784
    s_waitcnt lgkmcnt(11)
    v_mfma_f32_16x16x32_bf16 a[12:15], v[52:55], v[72:75], a[12:15]
    ds_read_b64_tr_b16 v[52:53], v8 offset:52224
    ds_read_b64_tr_b16 v[54:55], v8 offset:54784
    s_waitcnt lgkmcnt(11)
    v_mfma_f32_16x16x32_bf16 a[16:19], v[56:59], v[72:75], a[16:19]
    s_waitcnt lgkmcnt(8)
    v_mfma_f32_16x16x32_bf16 a[0:3], v[60:63], v[76:79], a[0:3]
    s_waitcnt lgkmcnt(6)
    v_mfma_f32_16x16x32_bf16 a[4:7], v[64:67], v[76:79], a[4:7]
    s_waitcnt lgkmcnt(4)
    v_mfma_f32_16x16x32_bf16 a[8:11], v[68:71], v[76:79], a[8:11]
    s_waitcnt lgkmcnt(2)
    v_mfma_f32_16x16x32_bf16 a[12:15], v[48:51], v[76:79], a[12:15]
    s_waitcnt lgkmcnt(0)
    v_mfma_f32_16x16x32_bf16 a[16:19], v[52:55], v[76:79], a[16:19]
    s_barrier
    buffer_load_dwordx4 v[136:139], v132, s[20:23], 0 offen
    buffer_load_dwordx4 v[140:143], v133, s[20:23], 0 offen
    buffer_load_dwordx4 v[144:147], v132, s[24:27], 0 offen
    buffer_load_dwordx4 v[148:151], v133, s[24:27], 0 offen
    ds_read_b128 v[72:75], v23 offset:8192
    ds_read_b64_tr_b16 v[56:57], v9 offset:8192
    ds_read_b64_tr_b16 v[58:59], v9 offset:10752
    ds_read_b64_tr_b16 v[60:61], v10 offset:8192
    ds_read_b64_tr_b16 v[62:63], v10 offset:10752
    ds_read_b64_tr_b16 v[64:65], v11 offset:8192
    ds_read_b64_tr_b16 v[66:67], v11 offset:10752
    ds_read_b64_tr_b16 v[68:69], v12 offset:8192
    ds_read_b64_tr_b16 v[70:71], v12 offset:10752
    ds_read_b64_tr_b16 v[48:49], v13 offset:8192
    ds_read_b64_tr_b16 v[50:51], v13 offset:10752
    ds_read_b128 v[76:79], v24 offset:8192
    ds_read_b64_tr_b16 v[52:53], v9 offset:13312
    ds_read_b64_tr_b16 v[54:55], v9 offset:15872
    s_waitcnt lgkmcnt(11)
    v_mfma_f32_16x16x32_bf16 a[0:3], v[56:59], v[72:75], a[0:3]
    ds_read_b64_tr_b16 v[56:57], v10 offset:13312
    ds_read_b64_tr_b16 v[58:59], v10 offset:15872
    s_waitcnt lgkmcnt(11)
    v_mfma_f32_16x16x32_bf16 a[4:7], v[60:63], v[72:75], a[4:7]
    ds_read_b64_tr_b16 v[60:61], v11 offset:13312
    ds_read_b64_tr_b16 v[62:63], v11 offset:15872
    s_waitcnt lgkmcnt(11)
    v_mfma_f32_16x16x32_bf16 a[8:11], v[64:67], v[72:75], a[8:11]
    ds_read_b64_tr_b16 v[64:65], v12 offset:13312
    ds_read_b64_tr_b16 v[66:67], v12 offset:15872
    s_waitcnt lgkmcnt(11)
    v_mfma_f32_16x16x32_bf16 a[12:15], v[68:71], v[72:75], a[12:15]
    ds_read_b64_tr_b16 v[68:69], v13 offset:13312
    ds_read_b64_tr_b16 v[70:71], v13 offset:15872
    s_waitcnt lgkmcnt(11)
    v_mfma_f32_16x16x32_bf16 a[16:19], v[48:51], v[72:75], a[16:19]
    ds_read_b128 v[72:75], v25 offset:8192
    ds_read_b64_tr_b16 v[48:49], v9 offset:18432
    ds_read_b64_tr_b16 v[50:51], v9 offset:20992
    s_waitcnt lgkmcnt(11)
    v_mfma_f32_16x16x32_bf16 a[0:3], v[52:55], v[76:79], a[0:3]
    ds_read_b64_tr_b16 v[52:53], v10 offset:18432
    ds_read_b64_tr_b16 v[54:55], v10 offset:20992
    s_waitcnt lgkmcnt(11)
    v_mfma_f32_16x16x32_bf16 a[4:7], v[56:59], v[76:79], a[4:7]
    ds_read_b64_tr_b16 v[56:57], v11 offset:18432
    ds_read_b64_tr_b16 v[58:59], v11 offset:20992
    s_waitcnt lgkmcnt(11)
    v_mfma_f32_16x16x32_bf16 a[8:11], v[60:63], v[76:79], a[8:11]
    ds_read_b64_tr_b16 v[60:61], v12 offset:18432
    ds_read_b64_tr_b16 v[62:63], v12 offset:20992
    s_waitcnt lgkmcnt(11)
    v_mfma_f32_16x16x32_bf16 a[12:15], v[64:67], v[76:79], a[12:15]
    ds_read_b64_tr_b16 v[64:65], v13 offset:18432
    ds_read_b64_tr_b16 v[66:67], v13 offset:20992
    s_waitcnt lgkmcnt(11)
    v_mfma_f32_16x16x32_bf16 a[16:19], v[68:71], v[76:79], a[16:19]
    ds_read_b128 v[76:79], v26 offset:8192
    ds_read_b64_tr_b16 v[68:69], v9 offset:23552
    ds_read_b64_tr_b16 v[70:71], v9 offset:26112
    s_waitcnt lgkmcnt(11)
    v_mfma_f32_16x16x32_bf16 a[0:3], v[48:51], v[72:75], a[0:3]
    ds_read_b64_tr_b16 v[48:49], v10 offset:23552
    ds_read_b64_tr_b16 v[50:51], v10 offset:26112
    s_waitcnt lgkmcnt(11)
    v_mfma_f32_16x16x32_bf16 a[4:7], v[52:55], v[72:75], a[4:7]
    ds_read_b64_tr_b16 v[52:53], v11 offset:23552
    ds_read_b64_tr_b16 v[54:55], v11 offset:26112
    s_waitcnt lgkmcnt(11)
    v_mfma_f32_16x16x32_bf16 a[8:11], v[56:59], v[72:75], a[8:11]
    ds_read_b64_tr_b16 v[56:57], v12 offset:23552
    ds_read_b64_tr_b16 v[58:59], v12 offset:26112
    s_waitcnt lgkmcnt(11)
    v_mfma_f32_16x16x32_bf16 a[12:15], v[60:63], v[72:75], a[12:15]
    ds_read_b64_tr_b16 v[60:61], v13 offset:23552
    ds_read_b64_tr_b16 v[62:63], v13 offset:26112
    s_waitcnt lgkmcnt(11)
    v_mfma_f32_16x16x32_bf16 a[16:19], v[64:67], v[72:75], a[16:19]
    s_waitcnt lgkmcnt(8)
    v_mfma_f32_16x16x32_bf16 a[0:3], v[68:71], v[76:79], a[0:3]
    s_waitcnt lgkmcnt(6)
    v_mfma_f32_16x16x32_bf16 a[4:7], v[48:51], v[76:79], a[4:7]
    s_waitcnt lgkmcnt(4)
    v_mfma_f32_16x16x32_bf16 a[8:11], v[52:55], v[76:79], a[8:11]
    s_waitcnt lgkmcnt(2)
    v_mfma_f32_16x16x32_bf16 a[12:15], v[56:59], v[76:79], a[12:15]
    s_waitcnt lgkmcnt(0)
    v_mfma_f32_16x16x32_bf16 a[16:19], v[60:63], v[76:79], a[16:19]
    s_barrier
    ds_read_b128 v[72:75], v23 offset:45056
    ds_read_b64_tr_b16 v[64:65], v9 offset:45056
    ds_read_b64_tr_b16 v[66:67], v9 offset:47616
    ds_read_b64_tr_b16 v[68:69], v10 offset:45056
    ds_read_b64_tr_b16 v[70:71], v10 offset:47616
    ds_read_b64_tr_b16 v[48:49], v11 offset:45056
    ds_read_b64_tr_b16 v[50:51], v11 offset:47616
    ds_read_b64_tr_b16 v[52:53], v12 offset:45056
    ds_read_b64_tr_b16 v[54:55], v12 offset:47616
    ds_read_b64_tr_b16 v[56:57], v13 offset:45056
    ds_read_b64_tr_b16 v[58:59], v13 offset:47616
    ds_read_b128 v[76:79], v24 offset:45056
    ds_read_b64_tr_b16 v[60:61], v9 offset:50176
    ds_read_b64_tr_b16 v[62:63], v9 offset:52736
    s_waitcnt lgkmcnt(11)
    v_mfma_f32_16x16x32_bf16 a[0:3], v[64:67], v[72:75], a[0:3]
    ds_read_b64_tr_b16 v[64:65], v10 offset:50176
    ds_read_b64_tr_b16 v[66:67], v10 offset:52736
    s_waitcnt lgkmcnt(11)
    v_mfma_f32_16x16x32_bf16 a[4:7], v[68:71], v[72:75], a[4:7]
    ds_read_b64_tr_b16 v[68:69], v11 offset:50176
    ds_read_b64_tr_b16 v[70:71], v11 offset:52736
    s_waitcnt lgkmcnt(11)
    v_mfma_f32_16x16x32_bf16 a[8:11], v[48:51], v[72:75], a[8:11]
    ds_read_b64_tr_b16 v[48:49], v12 offset:50176
    ds_read_b64_tr_b16 v[50:51], v12 offset:52736
    s_waitcnt lgkmcnt(11)
    v_mfma_f32_16x16x32_bf16 a[12:15], v[52:55], v[72:75], a[12:15]
    ds_read_b64_tr_b16 v[52:53], v13 offset:50176
    ds_read_b64_tr_b16 v[54:55], v13 offset:52736
    s_waitcnt lgkmcnt(11)
    v_mfma_f32_16x16x32_bf16 a[16:19], v[56:59], v[72:75], a[16:19]
    ds_read_b128 v[72:75], v25 offset:45056
    ds_read_b64_tr_b16 v[56:57], v9 offset:55296
    ds_read_b64_tr_b16 v[58:59], v9 offset:57856
    s_waitcnt lgkmcnt(11)
    v_mfma_f32_16x16x32_bf16 a[0:3], v[60:63], v[76:79], a[0:3]
    ds_read_b64_tr_b16 v[60:61], v10 offset:55296
    ds_read_b64_tr_b16 v[62:63], v10 offset:57856
    s_waitcnt lgkmcnt(11)
    v_mfma_f32_16x16x32_bf16 a[4:7], v[64:67], v[76:79], a[4:7]
    ds_read_b64_tr_b16 v[64:65], v11 offset:55296
    ds_read_b64_tr_b16 v[66:67], v11 offset:57856
    s_waitcnt lgkmcnt(11)
    v_mfma_f32_16x16x32_bf16 a[8:11], v[68:71], v[76:79], a[8:11]
    ds_read_b64_tr_b16 v[68:69], v12 offset:55296
    ds_read_b64_tr_b16 v[70:71], v12 offset:57856
    s_waitcnt lgkmcnt(11)
    v_mfma_f32_16x16x32_bf16 a[12:15], v[48:51], v[76:79], a[12:15]
    ds_read_b64_tr_b16 v[48:49], v13 offset:55296
    ds_read_b64_tr_b16 v[50:51], v13 offset:57856
    s_waitcnt lgkmcnt(11)
    v_mfma_f32_16x16x32_bf16 a[16:19], v[52:55], v[76:79], a[16:19]
    ds_read_b128 v[76:79], v26 offset:45056
    ds_read_b64_tr_b16 v[52:53], v9 offset:60416
    ds_read_b64_tr_b16 v[54:55], v9 offset:62976
    s_waitcnt lgkmcnt(11)
    v_mfma_f32_16x16x32_bf16 a[0:3], v[56:59], v[72:75], a[0:3]
    ds_read_b64_tr_b16 v[56:57], v10 offset:60416
    ds_read_b64_tr_b16 v[58:59], v10 offset:62976
    s_waitcnt lgkmcnt(11)
    v_mfma_f32_16x16x32_bf16 a[4:7], v[60:63], v[72:75], a[4:7]
    ds_read_b64_tr_b16 v[60:61], v11 offset:60416
    ds_read_b64_tr_b16 v[62:63], v11 offset:62976
    s_waitcnt lgkmcnt(11)
    v_mfma_f32_16x16x32_bf16 a[8:11], v[64:67], v[72:75], a[8:11]
    ds_read_b64_tr_b16 v[64:65], v12 offset:60416
    ds_read_b64_tr_b16 v[66:67], v12 offset:62976
    s_waitcnt lgkmcnt(11)
    v_mfma_f32_16x16x32_bf16 a[12:15], v[68:71], v[72:75], a[12:15]
    ds_read_b64_tr_b16 v[68:69], v13 offset:60416
    ds_read_b64_tr_b16 v[70:71], v13 offset:62976
    s_waitcnt lgkmcnt(11)
    v_mfma_f32_16x16x32_bf16 a[16:19], v[48:51], v[72:75], a[16:19]
    s_waitcnt lgkmcnt(8)
    v_mfma_f32_16x16x32_bf16 a[0:3], v[52:55], v[76:79], a[0:3]
    s_waitcnt lgkmcnt(6)
    v_mfma_f32_16x16x32_bf16 a[4:7], v[56:59], v[76:79], a[4:7]
    s_waitcnt lgkmcnt(4)
    v_mfma_f32_16x16x32_bf16 a[8:11], v[60:63], v[76:79], a[8:11]
    s_waitcnt lgkmcnt(2)
    v_mfma_f32_16x16x32_bf16 a[12:15], v[64:67], v[76:79], a[12:15]
    s_waitcnt lgkmcnt(0)
    v_mfma_f32_16x16x32_bf16 a[16:19], v[68:71], v[76:79], a[16:19]
    s_nop 7
    s_nop 1
    s_waitcnt lgkmcnt(0)
    s_barrier
    v_add_u32 v100, s56, v2
    v_mul_u32_u24 v100, 176, v100
    v_lshl_add_u32 v100, v3, 3, v100
    s_mul_i32 s37, s48, 32
    v_add_u32 v101, s37, v100
    v_accvgpr_read_b32 v104, a0
    v_accvgpr_read_b32 v105, a1
    v_accvgpr_read_b32 v106, a2
    v_accvgpr_read_b32 v107, a3
    v_cvt_pk_bf16_f32 v108, v104, v105
    v_cvt_pk_bf16_f32 v109, v106, v107
    ds_write_b64 v101, v[108:109] offset:0
    s_mul_i32 s37, s49, 32
    v_add_u32 v101, s37, v100
    v_accvgpr_read_b32 v104, a4
    v_accvgpr_read_b32 v105, a5
    v_accvgpr_read_b32 v106, a6
    v_accvgpr_read_b32 v107, a7
    v_cvt_pk_bf16_f32 v108, v104, v105
    v_cvt_pk_bf16_f32 v109, v106, v107
    ds_write_b64 v101, v[108:109] offset:0
    s_mul_i32 s37, s50, 32
    v_add_u32 v101, s37, v100
    v_accvgpr_read_b32 v104, a8
    v_accvgpr_read_b32 v105, a9
    v_accvgpr_read_b32 v106, a10
    v_accvgpr_read_b32 v107, a11
    v_cvt_pk_bf16_f32 v108, v104, v105
    v_cvt_pk_bf16_f32 v109, v106, v107
    ds_write_b64 v101, v[108:109] offset:0
    s_mul_i32 s37, s51, 32
    v_add_u32 v101, s37, v100
    v_accvgpr_read_b32 v104, a12
    v_accvgpr_read_b32 v105, a13
    v_accvgpr_read_b32 v106, a14
    v_accvgpr_read_b32 v107, a15
    v_cvt_pk_bf16_f32 v108, v104, v105
    v_cvt_pk_bf16_f32 v109, v106, v107
    ds_write_b64 v101, v[108:109] offset:0
    s_mul_i32 s37, s52, 32
    v_add_u32 v101, s37, v100
    v_accvgpr_read_b32 v104, a16
    v_accvgpr_read_b32 v105, a17
    v_accvgpr_read_b32 v106, a18
    v_accvgpr_read_b32 v107, a19
    v_cvt_pk_bf16_f32 v108, v104, v105
    v_cvt_pk_bf16_f32 v109, v106, v107
    ds_write_b64 v101, v[108:109] offset:0
    s_waitcnt lgkmcnt(0)
k7_kernel_phase2:
    s_barrier
    ds_read_b128 v[80:83], v134
    ds_read_b128 v[84:87], v135
    s_waitcnt vmcnt(0)
    s_waitcnt lgkmcnt(1)
    v_lshlrev_b32 v104, 16, v80
    v_and_b32 v105, 0xffff0000, v80
    v_lshlrev_b32 v106, 16, v81
    v_and_b32 v107, 0xffff0000, v81
    v_lshlrev_b32 v108, 16, v82
    v_and_b32 v109, 0xffff0000, v82
    v_lshlrev_b32 v110, 16, v83
    v_and_b32 v111, 0xffff0000, v83
    v_lshlrev_b32 v112, 16, v136
    v_and_b32 v113, 0xffff0000, v136
    v_lshlrev_b32 v114, 16, v137
    v_and_b32 v115, 0xffff0000, v137
    v_lshlrev_b32 v116, 16, v138
    v_and_b32 v117, 0xffff0000, v138
    v_lshlrev_b32 v118, 16, v139
    v_and_b32 v119, 0xffff0000, v139
    v_pk_add_f32 v[104:105], v[104:105], v[112:113]
    v_pk_add_f32 v[106:107], v[106:107], v[114:115]
    v_pk_add_f32 v[108:109], v[108:109], v[116:117]
    v_pk_add_f32 v[110:111], v[110:111], v[118:119]
    v_cvt_pk_bf16_f32 v120, v104, v105
    v_cvt_pk_bf16_f32 v121, v106, v107
    v_cvt_pk_bf16_f32 v122, v108, v109
    v_cvt_pk_bf16_f32 v123, v110, v111
    v_lshlrev_b32 v104, 16, v120
    v_and_b32 v105, 0xffff0000, v120
    v_lshlrev_b32 v106, 16, v121
    v_and_b32 v107, 0xffff0000, v121
    v_lshlrev_b32 v108, 16, v122
    v_and_b32 v109, 0xffff0000, v122
    v_lshlrev_b32 v110, 16, v123
    v_and_b32 v111, 0xffff0000, v123
    v_lshlrev_b32 v112, 16, v144
    v_and_b32 v113, 0xffff0000, v144
    v_lshlrev_b32 v114, 16, v145
    v_and_b32 v115, 0xffff0000, v145
    v_lshlrev_b32 v116, 16, v146
    v_and_b32 v117, 0xffff0000, v146
    v_lshlrev_b32 v118, 16, v147
    v_and_b32 v119, 0xffff0000, v147
    v_pk_add_f32 v[104:105], v[104:105], v[112:113]
    v_pk_add_f32 v[106:107], v[106:107], v[114:115]
    v_pk_add_f32 v[108:109], v[108:109], v[116:117]
    v_pk_add_f32 v[110:111], v[110:111], v[118:119]
    v_cvt_pk_bf16_f32 v80, v104, v105
    v_cvt_pk_bf16_f32 v81, v106, v107
    v_cvt_pk_bf16_f32 v82, v108, v109
    v_cvt_pk_bf16_f32 v83, v110, v111
    buffer_store_dwordx4 v[80:83], v132, s[16:19], 0 offen
    s_waitcnt lgkmcnt(0)
    v_lshlrev_b32 v104, 16, v84
    v_and_b32 v105, 0xffff0000, v84
    v_lshlrev_b32 v106, 16, v85
    v_and_b32 v107, 0xffff0000, v85
    v_lshlrev_b32 v108, 16, v86
    v_and_b32 v109, 0xffff0000, v86
    v_lshlrev_b32 v110, 16, v87
    v_and_b32 v111, 0xffff0000, v87
    v_lshlrev_b32 v112, 16, v140
    v_and_b32 v113, 0xffff0000, v140
    v_lshlrev_b32 v114, 16, v141
    v_and_b32 v115, 0xffff0000, v141
    v_lshlrev_b32 v116, 16, v142
    v_and_b32 v117, 0xffff0000, v142
    v_lshlrev_b32 v118, 16, v143
    v_and_b32 v119, 0xffff0000, v143
    v_pk_add_f32 v[104:105], v[104:105], v[112:113]
    v_pk_add_f32 v[106:107], v[106:107], v[114:115]
    v_pk_add_f32 v[108:109], v[108:109], v[116:117]
    v_pk_add_f32 v[110:111], v[110:111], v[118:119]
    v_cvt_pk_bf16_f32 v120, v104, v105
    v_cvt_pk_bf16_f32 v121, v106, v107
    v_cvt_pk_bf16_f32 v122, v108, v109
    v_cvt_pk_bf16_f32 v123, v110, v111
    v_lshlrev_b32 v104, 16, v120
    v_and_b32 v105, 0xffff0000, v120
    v_lshlrev_b32 v106, 16, v121
    v_and_b32 v107, 0xffff0000, v121
    v_lshlrev_b32 v108, 16, v122
    v_and_b32 v109, 0xffff0000, v122
    v_lshlrev_b32 v110, 16, v123
    v_and_b32 v111, 0xffff0000, v123
    v_lshlrev_b32 v112, 16, v148
    v_and_b32 v113, 0xffff0000, v148
    v_lshlrev_b32 v114, 16, v149
    v_and_b32 v115, 0xffff0000, v149
    v_lshlrev_b32 v116, 16, v150
    v_and_b32 v117, 0xffff0000, v150
    v_lshlrev_b32 v118, 16, v151
    v_and_b32 v119, 0xffff0000, v151
    v_pk_add_f32 v[104:105], v[104:105], v[112:113]
    v_pk_add_f32 v[106:107], v[106:107], v[114:115]
    v_pk_add_f32 v[108:109], v[108:109], v[116:117]
    v_pk_add_f32 v[110:111], v[110:111], v[118:119]
    v_cvt_pk_bf16_f32 v84, v104, v105
    v_cvt_pk_bf16_f32 v85, v106, v107
    v_cvt_pk_bf16_f32 v86, v108, v109
    v_cvt_pk_bf16_f32 v87, v110, v111
    buffer_store_dwordx4 v[84:87], v133, s[16:19], 0 offen
k7_kernel_end:
    s_endpgm
.section .rodata,"a"
.p2align 6
.amdhsa_kernel k1_kernel
  .amdhsa_next_free_vgpr 240
  .amdhsa_next_free_sgpr 96
  .amdhsa_accum_offset 152
  .amdhsa_group_segment_fixed_size 0
  .amdhsa_kernarg_size 88
  .amdhsa_user_sgpr_count 2
  .amdhsa_user_sgpr_kernarg_segment_ptr 1
  .amdhsa_system_sgpr_workgroup_id_x 1
.end_amdhsa_kernel

.p2align 6
.amdhsa_kernel k2_kernel
  .amdhsa_next_free_vgpr 249
  .amdhsa_next_free_sgpr 96
  .amdhsa_accum_offset 252
  .amdhsa_group_segment_fixed_size 0
  .amdhsa_kernarg_size 88
  .amdhsa_user_sgpr_count 2
  .amdhsa_user_sgpr_kernarg_segment_ptr 1
  .amdhsa_system_sgpr_workgroup_id_x 1
.end_amdhsa_kernel

.p2align 6
.amdhsa_kernel k3_kernel
  .amdhsa_next_free_vgpr 164
  .amdhsa_next_free_sgpr 96
  .amdhsa_accum_offset 144
  .amdhsa_group_segment_fixed_size 0
  .amdhsa_kernarg_size 88
  .amdhsa_user_sgpr_count 2
  .amdhsa_user_sgpr_kernarg_segment_ptr 1
  .amdhsa_system_sgpr_workgroup_id_x 1
.end_amdhsa_kernel

.p2align 6
.amdhsa_kernel k4_kernel
  .amdhsa_next_free_vgpr 172
  .amdhsa_next_free_sgpr 96
  .amdhsa_accum_offset 136
  .amdhsa_group_segment_fixed_size 0
  .amdhsa_kernarg_size 88
  .amdhsa_user_sgpr_count 2
  .amdhsa_user_sgpr_kernarg_segment_ptr 1
  .amdhsa_system_sgpr_workgroup_id_x 1
.end_amdhsa_kernel

.p2align 6
.amdhsa_kernel k5_kernel
  .amdhsa_next_free_vgpr 168
  .amdhsa_next_free_sgpr 96
  .amdhsa_accum_offset 148
  .amdhsa_group_segment_fixed_size 0
  .amdhsa_kernarg_size 88
  .amdhsa_user_sgpr_count 2
  .amdhsa_user_sgpr_kernarg_segment_ptr 1
  .amdhsa_system_sgpr_workgroup_id_x 1
.end_amdhsa_kernel

.p2align 6
.amdhsa_kernel k6_kernel
  .amdhsa_next_free_vgpr 228
  .amdhsa_next_free_sgpr 96
  .amdhsa_accum_offset 156
  .amdhsa_group_segment_fixed_size 0
  .amdhsa_kernarg_size 88
  .amdhsa_user_sgpr_count 2
  .amdhsa_user_sgpr_kernarg_segment_ptr 1
  .amdhsa_system_sgpr_workgroup_id_x 1
.end_amdhsa_kernel

.p2align 6
.amdhsa_kernel k7_kernel
  .amdhsa_next_free_vgpr 172
  .amdhsa_next_free_sgpr 96
  .amdhsa_accum_offset 152
  .amdhsa_group_segment_fixed_size 0
  .amdhsa_kernarg_size 88
  .amdhsa_user_sgpr_count 2
  .amdhsa_user_sgpr_kernarg_segment_ptr 1
  .amdhsa_system_sgpr_workgroup_id_x 1
.end_amdhsa_kernel
```
